```python
import torch

def _softmax(x, axis=-1):
    return torch.softmax(x, dim=axis)
def _gelu(x):
    return torch.nn.functional.gelu(x, approximate="tanh")
def _silu(x):
    return torch.nn.functional.silu(x)
def _sigmoid(x):
    return torch.sigmoid(x)
def _layernorm(x, axis=-1, eps=1e-5):
    m = x.mean(dim=axis, keepdim=True)
    v = x.var(dim=axis, keepdim=True, unbiased=False)
    return (x - m) / torch.sqrt(v + eps)
def _scatter_add(tgt, idx, src, axis=0):
    return tgt.clone().index_add_(axis, idx, src)
def _segment_sum(src, seg, n):
    out = torch.zeros((n,) + src.shape[1:], dtype=src.dtype)
    return out.index_add_(0, seg, src)
def _pad(x, pw):
    flat = tuple(v for pair in reversed(pw) for v in pair)
    return torch.nn.functional.pad(x, flat)

kernel_name = 'concat_heads__compressed_kv_cla__ssm_conv_h3__prompt'

def setup_inputs():

    _w = (lambda a: (lambda t: t.to(torch.bfloat16) if t.is_floating_point() else t)(torch.as_tensor(a)))
    def _A_setup():
        B, H, Sq, Sk, D, M = 1, 16, 2048, 2048, 256, 448
        Dc = 4 * D
        return {
            "x": _w((lambda *s: torch.randn(*s, dtype=torch.bfloat16) * 3.2)(B, Sq, M)),
            "c_kv": _w((lambda *s: torch.randn(*s, dtype=torch.bfloat16) * 0.05)(B, Sk, Dc)),
            "w_q": _w((lambda *s: torch.randn(*s, dtype=torch.bfloat16) * 3.2)(M, H, D) * (M ** -0.5)),
            "w_uk": _w((lambda *s: torch.randn(*s, dtype=torch.bfloat16) * 3.2)(Dc, H, D) * (Dc ** -0.5)),
            "w_uv": _w((lambda *s: torch.randn(*s, dtype=torch.bfloat16) * 0.05)(Dc, H, D) * (Dc ** -0.5)),
            "w_o": _w((lambda *s: torch.randn(*s, dtype=torch.bfloat16) * 0.05)(H, D, M) * ((H * D) ** -0.5)),
        }
    _A_in = _A_setup()

    def _B_setup():
        B, S, D = 1, 2048, 448
        ks = 4
        return {
            "q": _w((lambda *s: torch.randn(*s, dtype=torch.bfloat16) * 0.05)(B, S, D)),
            "k": _w((lambda *s: torch.randn(*s, dtype=torch.bfloat16) * 0.1)(B, S, D)),
            "v": _w((lambda *s: torch.randn(*s, dtype=torch.bfloat16) * 0.1)(B, S, D)),
            "shift_k": _w((lambda *s: torch.randn(*s, dtype=torch.bfloat16) * 0.1)(D, ks) * 0.5),
            "ssm_k": _w((lambda *s: torch.randn(*s, dtype=torch.bfloat16) * 0.1)(D, S) * (1.0 / S ** 0.5)),
            "ssm_D": _w((lambda *s: torch.randn(*s, dtype=torch.bfloat16) * 0.1)(D)),
        }
    _B_in = _B_setup()

    return {
        "A_x": _A_in["x"],
        "A_c_kv": _A_in["c_kv"],
        "A_w_q": _A_in["w_q"],
        "A_w_uk": _A_in["w_uk"],
        "A_w_uv": _A_in["w_uv"],
        "A_w_o": _A_in["w_o"],
        "B_q": _B_in["q"],
        "B_k": _B_in["k"],
        "B_v": _B_in["v"],
        "B_shift_k": _B_in["shift_k"],
        "B_ssm_k": _B_in["ssm_k"],
        "B_ssm_D": _B_in["ssm_D"],
    }

def reference(A_x, A_c_kv, A_w_q, A_w_uk, A_w_uv, A_w_o, B_q, B_k, B_v, B_shift_k, B_ssm_k, B_ssm_D):
    def _A_ref(x, c_kv, w_q, w_uk, w_uv, w_o):
        B, Sq, M = x.shape[0], x.shape[1], x.shape[2]
        Sk = c_kv.shape[1]
        H, D = w_q.shape[1], w_q.shape[2]
        q = torch.einsum("bqm,mhd->bhqd", x, w_q)
        k = torch.einsum("bkc,chd->bhkd", c_kv, w_uk)
        v = torch.einsum("bkc,chd->bhkd", c_kv, w_uv)
        scores = torch.einsum("bhqd,bhkd->bhqk", q, k) * (D ** -0.5)
        off = Sk - Sq
        qi = torch.arange(Sq)[:, None]
        kj = torch.arange(Sk)[None, :]
        cmask = kj <= (qi + off)
        scores = torch.where(cmask[None, None], scores, -1e9)
        p = _softmax(scores, axis=-1)
        ctx = torch.einsum("bhqk,bhkd->bhqd", p, v)
        return torch.einsum("bhqd,hdm->bqm", ctx, w_o)

    def _B_ref(q, k, v, shift_k, ssm_k, ssm_D):
        B, S, D = q.shape
        ks = shift_k.shape[-1]
        k_pad = _pad(k, ((0, 0), (ks - 1, 0), (0, 0)))
        k_shift = torch.zeros_like(k)
        for t in range(ks):
            k_shift = k_shift + k_pad[:, t:t + S, :] * shift_k[:, ks - 1 - t][None, None, :]
        kv = k_shift * v
        L = 2 * S
        kv_pad = _pad(kv, ((0, 0), (0, S), (0, 0)))
        kf_pad = _pad(ssm_k, ((0, 0), (0, S)))
        kv_f = (lambda x, axes=(-2,-1): torch.fft.rfft2(x.float(), dim=axes))(kv_pad[:, None, :, :], axes=(1, 2))
        kf_f = (lambda x, axes=(-2,-1): torch.fft.rfft2(x.float(), dim=axes))(kf_pad[:, None, :], axes=(1, 2))
        kf_f = (lambda x, *d: x.permute(*d))(kf_f, 1, 2, 0)
        y_f = kv_f * kf_f[None, :, :, :]
        y = (lambda x, s, axes=(-2,-1): torch.fft.irfft2(x, s=s, dim=axes).to(torch.bfloat16))(y_f, (1, L), axes=(1, 2))[:, 0, :S, :]
        y = y + kv * ssm_D[None, None, :]
        return q * y

    a = _A_ref(A_x, A_c_kv, A_w_q, A_w_uk, A_w_uv, A_w_o)
    b = _B_ref(B_q, B_k, B_v, B_shift_k, B_ssm_k, B_ssm_D)
    return torch.concatenate([a, b], axis=-1)
```

```asm
; @launch grid=(256,1,1) block=(256,1,1) lds=163840
.amdgcn_target "amdgcn-amd-amdhsa--gfx950"
.text
.globl concat_heads__compressed_kv_cla__ssm_conv_h3__prompt_kernel
.p2align 8
.type concat_heads__compressed_kv_cla__ssm_conv_h3__prompt_kernel,@function
concat_heads__compressed_kv_cla__ssm_conv_h3__prompt_kernel:
s_cmp_ge_u32 s2, 256
s_cbranch_scc1 F_END
s_load_dwordx4 s[64:67], s[0:1], 0
s_load_dwordx4 s[68:71], s[0:1], 16
s_load_dwordx2 s[72:73], s[0:1], 32
s_load_dwordx4 s[76:79], s[0:1], 104
s_load_dwordx4 s[44:47], s[0:1], 48
s_load_dwordx4 s[80:83], s[0:1], 64
s_load_dwordx4 s[96:99], s[0:1], 80
v_lshrrev_b32 v26, 6, v0
v_and_b32 v27, 63, v0
v_readfirstlane_b32 s12, v26
s_getreg_b32 s18, hwreg(HW_REG_XCC_ID, 0, 4)
s_and_b32 s13, s2, 7
s_lshr_b32 s14, s2, 3
s_and_b32 s22, s14, 1
s_lshl_b32 s15, s13, 1
s_add_u32 s15, s15, s22
s_lshr_b32 s16, s14, 2
s_bfe_u32 s17, s14, 0x10001
s_lshr_b32 s26, s12, 1
s_and_b32 s27, s12, 1
v_lshrrev_b32 v28, 3, v27
v_and_b32 v29, 7, v27
v_lshrrev_b32 v30, 4, v27
s_lshl_b32 s22, s12, 5
v_add_u32 v28, s22, v28
v_add_u32 v31, 0, v30
v_and_b32 v31, 7, v31
v_xor_b32 v31, v29, v31
v_lshlrev_b32 v31, 4, v31
v_add_u32 v32, 0, v28
v_add_u32 v34, 0, v28
v_lshlrev_b32 v33, 11, v34
v_add_u32 v33, v33, v31
v_subrev_u32 v1, 0, v33
v_mul_u32_u24 v33, 896, v32
v_add_u32 v33, v33, v31
v_subrev_u32 v9, 0, v33
v_add_u32 v31, 4, v30
v_and_b32 v31, 7, v31
v_xor_b32 v31, v29, v31
v_lshlrev_b32 v31, 4, v31
v_add_u32 v32, 8, v28
v_add_u32 v34, 8, v28
v_lshlrev_b32 v33, 11, v34
v_add_u32 v33, v33, v31
v_subrev_u32 v2, 1024, v33
v_mul_u32_u24 v33, 896, v32
v_add_u32 v33, v33, v31
v_subrev_u32 v10, 1024, v33
v_add_u32 v31, 8, v30
v_and_b32 v31, 7, v31
v_xor_b32 v31, v29, v31
v_lshlrev_b32 v31, 4, v31
v_add_u32 v32, 16, v28
v_add_u32 v34, 16, v28
v_lshlrev_b32 v33, 11, v34
v_add_u32 v33, v33, v31
v_subrev_u32 v3, 2048, v33
v_mul_u32_u24 v33, 896, v32
v_add_u32 v33, v33, v31
v_subrev_u32 v11, 2048, v33
v_add_u32 v31, 12, v30
v_and_b32 v31, 7, v31
v_xor_b32 v31, v29, v31
v_lshlrev_b32 v31, 4, v31
v_add_u32 v32, 24, v28
v_add_u32 v34, 24, v28
v_lshlrev_b32 v33, 11, v34
v_add_u32 v33, v33, v31
v_subrev_u32 v4, 3072, v33
v_mul_u32_u24 v33, 896, v32
v_add_u32 v33, v33, v31
v_subrev_u32 v12, 3072, v33
v_lshrrev_b32 v31, 2, v27
v_and_b32 v31, 7, v31
v_lshlrev_b32 v31, 13, v31
v_lshrrev_b32 v32, 5, v27
v_lshlrev_b32 v32, 6, v32
v_and_b32 v33, 3, v27
v_lshlrev_b32 v33, 4, v33
v_add3_u32 v31, v31, v32, v33
s_lshl_b32 s22, s12, 7
v_add_u32 v31, s22, v31
v_add_u32 v5, 0, v31
v_add_u32 v6, 64512, v31
v_add_u32 v7, 129024, v31
v_add_u32 v8, 193536, v31
v_and_b32 v31, 31, v27
v_lshlrev_b32 v31, 7, v31
v_lshrrev_b32 v32, 5, v27
v_lshrrev_b32 v33, 1, v27
v_and_b32 v33, 7, v33
v_add_u32 v34, 0, v32
v_xor_b32 v34, v34, v33
v_lshlrev_b32 v34, 4, v34
v_add_u32 v13, v31, v34
v_add_u32 v34, 2, v32
v_xor_b32 v34, v34, v33
v_lshlrev_b32 v34, 4, v34
v_add_u32 v14, v31, v34
v_add_u32 v34, 4, v32
v_xor_b32 v34, v34, v33
v_lshlrev_b32 v34, 4, v34
v_add_u32 v15, v31, v34
v_add_u32 v34, 6, v32
v_xor_b32 v34, v34, v33
v_lshlrev_b32 v34, 4, v34
v_add_u32 v16, v31, v34
v_lshlrev_b32 v31, 10, v32
v_lshrrev_b32 v33, 2, v27
v_and_b32 v33, 3, v33
v_lshlrev_b32 v33, 6, v33
v_add_u32 v31, v31, v33
v_lshrrev_b32 v33, 4, v27
v_and_b32 v33, 1, v33
v_lshlrev_b32 v33, 5, v33
v_add_u32 v31, v31, v33
v_and_b32 v33, 3, v27
v_lshlrev_b32 v33, 3, v33
s_lshl_b32 s22, s12, 12
v_add3_u32 v17, v31, v33, s22
v_lshrrev_b32 v31, 1, v27
v_and_b32 v32, 3, v31
v_lshrrev_b32 v33, 2, v31
v_and_b32 v33, 1, v33
v_lshl_add_u32 v32, v33, 3, v32
v_lshlrev_b32 v32, 13, v32
v_lshrrev_b32 v33, 4, v27
v_lshlrev_b32 v33, 5, v33
v_and_b32 v34, 1, v27
v_lshlrev_b32 v34, 4, v34
v_add_u32 v32, v32, v34
s_lshl_b32 s22, s12, 7
v_add3_u32 v32, v32, v33, s22
v_add_u32 v232, 0, v32
v_add_u32 v233, 31744, v32
v_add_u32 v234, 129024, v32
v_add_u32 v235, 160768, v32
v_and_b32 v31, 15, v27
v_lshrrev_b32 v32, 1, v31
v_lshlrev_b32 v31, 7, v31
v_lshrrev_b32 v33, 4, v27
v_add_u32 v34, 0, v33
v_xor_b32 v34, v34, v32
v_lshlrev_b32 v34, 4, v34
v_add_u32 v236, v31, v34
v_add_u32 v34, 4, v33
v_xor_b32 v34, v34, v32
v_lshlrev_b32 v34, 4, v34
v_add_u32 v237, v31, v34
v_lshrrev_b32 v31, 5, v27
v_lshlrev_b32 v31, 11, v31
v_lshrrev_b32 v32, 4, v27
v_and_b32 v32, 1, v32
v_lshlrev_b32 v32, 7, v32
v_lshrrev_b32 v33, 2, v27
v_and_b32 v33, 3, v33
v_lshlrev_b32 v33, 5, v33
v_add3_u32 v31, v31, v32, v33
v_and_b32 v32, 3, v27
v_lshlrev_b32 v32, 3, v32
s_lshl_b32 s22, s27, 13
v_add3_u32 v238, v31, v32, s22
v_lshlrev_b32 v239, 4, v27
v_mov_b32 v23, 0
s_waitcnt lgkmcnt(0)
s_mov_b32 s36, s64
s_and_b32 s37, s65, 0xffff
s_mov_b32 s38, 1835008
s_mov_b32 s39, 0x20000
s_mov_b32 s28, s66
s_and_b32 s29, s67, 0xffff
s_mov_b32 s30, 4194304
s_mov_b32 s31, 0x20000
s_mov_b32 s40, s68
s_and_b32 s41, s69, 0xffff
s_mov_b32 s42, 3670016
s_mov_b32 s43, 0x20000
s_cmp_eq_u32 s17, 0
s_cselect_b32 s22, s70, s72
s_cselect_b32 s23, s71, s73
s_mov_b32 s32, s22
s_and_b32 s33, s23, 0xffff
s_mov_b32 s34, 8388608
s_mov_b32 s35, 0x20000
s_mov_b32 s8, s76
s_and_b32 s9, s77, 0xffff
s_mov_b32 s10, 256
s_mov_b32 s11, 0x20000
s_mov_b32 s4, s78
s_and_b32 s5, s79, 0xffff
s_mov_b32 s6, 268435456
s_mov_b32 s7, 0x20000
s_cmp_lt_u32 s2, 224
s_cselect_b32 s24, 1835008, 0
s_cselect_b32 s25, 3584, 0
s_cselect_b32 s3, 268435456, 0
s_mov_b32 s56, s82
s_and_b32 s57, s83, 0xffff
s_mov_b32 s58, s25
s_mov_b32 s59, 0x20000
s_mov_b32 s52, s80
s_and_b32 s53, s81, 0xffff
s_mov_b32 s54, s24
s_mov_b32 s55, 0x20000
s_mov_b32 s48, s46
s_and_b32 s49, s47, 0xffff
s_mov_b32 s50, s24
s_mov_b32 s51, 0x20000
s_mov_b32 s44, s44
s_and_b32 s45, s45, 0xffff
s_mov_b32 s46, s24
s_mov_b32 s47, 0x20000
s_mov_b32 s60, s78
s_and_b32 s61, s79, 0xffff
s_mov_b32 s62, s3
s_mov_b32 s63, 0x20000
s_lshl_b32 s70, s12, 12
s_lshl_b32 s68, s16, 19
s_lshl_b32 s69, s15, 9
s_lshl_b32 s74, s15, 20
s_lshl_b32 s22, s16, 17
s_add_u32 s74, s74, s22
s_lshl_b32 s22, s26, 16
s_add_u32 s74, s74, s22
s_lshl_b32 s23, s17, 1
s_add_u32 s23, s23, 12
s_lshl_b32 s22, s27, s23
s_add_u32 s74, s74, s22
s_lshl_b32 s22, 16777216, s17
s_add_u32 s74, s74, s22
s_mov_b32 s64, 0
s_lshl_b32 s65, s26, 14
s_add_u32 s65, s65, 16384
s_mov_b32 s66, 49152
s_mov_b32 s67, 0
s_and_b32 s18, s18, 7
s_lshl_b32 s20, s15, 7
s_add_u32 s20, s20, 100663296
s_lshr_b32 s23, s14, 1
s_lshl_b32 s21, s15, 4
s_add_u32 s21, s21, s23
v_lshlrev_b32 v25, 2, v27
s_sub_u32 s22, 15, s16
s_cmp_eq_u32 s17, 0
s_cselect_b32 s22, s22, s16
s_lshl_b32 s22, s22, 7
s_lshl_b32 s23, s15, 2
s_add_u32 s3, s22, s23
s_add_u32 s3, s3, 100667392
s_cmp_lg_u32 s12, 0
s_cbranch_scc1 F_NOZERO
s_mov_b64 exec, 1
buffer_store_dword v23, v23, s[4:7], s3 offen sc1
s_lshr_b32 s23, s14, 1
s_lshl_b32 s23, s23, 2
s_add_u32 s23, s23, s20
buffer_store_dword v23, v23, s[4:7], s23 offen sc1
s_lshl_b32 s23, s16, 2
s_add_u32 s23, s23, 64
s_add_u32 s23, s23, s20
buffer_store_dword v23, v23, s[4:7], s23 offen sc1
s_lshl_b32 s23, s16, 2
s_add_u32 s23, s23, 96
s_add_u32 s23, s23, s20
buffer_store_dword v23, v23, s[4:7], s23 offen sc1
s_mov_b64 exec, -1
F_NOZERO:
s_add_u32 m0, s67, s70
s_add_u32 s22, s67, 16384
s_sub_u32 s67, s22, 163840
s_cselect_b32 s67, s22, s67
buffer_load_dwordx4 v232, s[32:35], s69 offen lds
buffer_load_dwordx4 v233, s[32:35], s69 offen offset:1024 lds
buffer_load_dwordx4 v234, s[32:35], s69 offen offset:2048 lds
buffer_load_dwordx4 v235, s[32:35], s69 offen offset:3072 lds
s_add_u32 s69, s69, 262144
s_and_b32 s69, s69, 0x7fffff
s_add_u32 m0, s67, s70
s_add_u32 s22, s67, 16384
s_sub_u32 s67, s22, 163840
s_cselect_b32 s67, s22, s67
buffer_load_dwordx4 v1, s[28:31], s68 offen lds
buffer_load_dwordx4 v2, s[28:31], s68 offen offset:1024 lds
buffer_load_dwordx4 v3, s[28:31], s68 offen offset:2048 lds
buffer_load_dwordx4 v4, s[28:31], s68 offen offset:3072 lds
s_add_u32 s68, s68, 262144
s_add_u32 m0, s67, s70
s_add_u32 s22, s67, 16384
s_sub_u32 s67, s22, 163840
s_cselect_b32 s67, s22, s67
buffer_load_dwordx4 v1, s[28:31], s68 offen lds
buffer_load_dwordx4 v2, s[28:31], s68 offen offset:1024 lds
buffer_load_dwordx4 v3, s[28:31], s68 offen offset:2048 lds
buffer_load_dwordx4 v4, s[28:31], s68 offen offset:3072 lds
s_sub_u32 s68, s68, 262016
s_bitset0_b32 s68, 11
s_add_u32 m0, s67, s70
s_add_u32 s22, s67, 16384
s_sub_u32 s67, s22, 163840
s_cselect_b32 s67, s22, s67
buffer_load_dwordx4 v232, s[32:35], s69 offen lds
buffer_load_dwordx4 v233, s[32:35], s69 offen offset:1024 lds
buffer_load_dwordx4 v234, s[32:35], s69 offen offset:2048 lds
buffer_load_dwordx4 v235, s[32:35], s69 offen offset:3072 lds
s_add_u32 s69, s69, 262144
s_and_b32 s69, s69, 0x7fffff
s_add_u32 m0, s67, s70
s_add_u32 s22, s67, 16384
s_sub_u32 s67, s22, 163840
s_cselect_b32 s67, s22, s67
buffer_load_dwordx4 v232, s[32:35], s69 offen lds
buffer_load_dwordx4 v233, s[32:35], s69 offen offset:1024 lds
buffer_load_dwordx4 v234, s[32:35], s69 offen offset:2048 lds
buffer_load_dwordx4 v235, s[32:35], s69 offen offset:3072 lds
s_add_u32 s69, s69, 262144
s_and_b32 s69, s69, 0x7fffff
s_add_u32 m0, s67, s70
s_add_u32 s22, s67, 16384
s_sub_u32 s67, s22, 163840
s_cselect_b32 s67, s22, s67
buffer_load_dwordx4 v1, s[28:31], s68 offen lds
buffer_load_dwordx4 v2, s[28:31], s68 offen offset:1024 lds
buffer_load_dwordx4 v3, s[28:31], s68 offen offset:2048 lds
buffer_load_dwordx4 v4, s[28:31], s68 offen offset:3072 lds
s_add_u32 s68, s68, 262144
s_sub_u32 s22, 15, s16
s_cmp_eq_u32 s17, 0
s_cselect_b32 s22, s22, s16
s_mul_i32 s76, s22, 114688
s_lshl_b32 s77, s15, 9
s_cmp_eq_u32 s13, 7
s_cselect_b32 s75, 3, s13
s_lshl_b32 s25, s75, 7
s_add_u32 s72, s76, s25
s_lshl_b32 s25, s75, 19
s_add_u32 s73, s77, s25
s_mul_hi_u32 s26, s2, 0x24924925
s_mul_i32 s27, s26, 7
s_sub_u32 s27, s2, s27
s_lshl_b32 s26, s26, 6
s_lshl_b32 s27, s27, 6
s_mov_b32 s80, 3584
v_and_b32 v196, 31, v0
v_lshrrev_b32 v197, 5, v0
v_lshlrev_b32 v197, 3, v197
v_add_u32 v197, s26, v197
v_lshlrev_b32 v198, 1, v196
v_add_u32 v198, s27, v198
v_mul_u32_u24 v160, 896, v197
v_lshl_add_u32 v160, v198, 1, v160
v_lshlrev_b32 v161, 3, v198
v_sub_u32 v199, 2040, v197
v_lshlrev_b32 v199, 1, v199
v_lshl_add_u32 v162, v198, 12, v199
v_subrev_u32 v199, 2688, v160
v_add_u32 v200, 0, v199
v_add_u32 v201, 896, v199
v_add_u32 v202, 1792, v199
s_mov_b64 s[26:27], s[96:97]
s_mov_b64 s[78:79], s[98:99]
.p2align 3
s_getpc_b64 s[24:25]
F_PC_A:
s_add_u32 s24, s24, F_K-F_PC_A
s_addc_u32 s25, s25, 0
s_mov_b32 s22, s14
s_lshl_b32 s22, s22, 2
s_add_u32 s22, s22, s12
v_and_b32 v26, 7, v0
v_lshlrev_b32 v26, 7, v26
v_add_u32 v26, s22, v26
v_lshlrev_b32 v26, 7, v26
v_min_u32 v26, F_ATT-F_K-4, v26
s_mov_b64 exec, 0xff
global_load_dword v27, v26, s[24:25]
s_mov_b64 exec, -1
v_add_u32 v19, s65, v236
v_add_u32 v20, s65, v237
v_add_u32 v21, s64, v238
v_add_u32 v22, s66, v238
s_waitcnt vmcnt(13)
s_barrier
ds_read_b128 v[32:35], v19 offset:0
ds_read_b64_tr_b16 v[64:65], v21 offset:0
ds_read_b64_tr_b16 v[66:67], v21 offset:1024
ds_read_b128 v[36:39], v19 offset:2048
ds_read_b64_tr_b16 v[68:69], v21 offset:256
ds_read_b64_tr_b16 v[70:71], v21 offset:1280
ds_read_b128 v[40:43], v19 offset:4096
ds_read_b64_tr_b16 v[72:73], v21 offset:512
ds_read_b64_tr_b16 v[74:75], v21 offset:1536
ds_read_b128 v[44:47], v19 offset:6144
ds_read_b64_tr_b16 v[76:77], v21 offset:768
ds_read_b64_tr_b16 v[78:79], v21 offset:1792
ds_read_b128 v[48:51], v19 offset:8192
ds_read_b64_tr_b16 v[80:81], v21 offset:4096
ds_read_b64_tr_b16 v[82:83], v21 offset:5120
ds_read_b128 v[52:55], v19 offset:10240
ds_read_b64_tr_b16 v[84:85], v21 offset:4352
ds_read_b64_tr_b16 v[86:87], v21 offset:5376
ds_read_b128 v[56:59], v19 offset:12288
ds_read_b64_tr_b16 v[88:89], v21 offset:4608
ds_read_b64_tr_b16 v[90:91], v21 offset:5632
ds_read_b128 v[60:63], v19 offset:14336
ds_read_b64_tr_b16 v[92:93], v21 offset:4864
ds_read_b64_tr_b16 v[94:95], v21 offset:5888
s_mov_b32 s71, 0
s_and_b32 s19, s14, 3
s_add_u32 s19, s19, 1
s_lshl_b32 s22, s12, 6
s_add_u32 s19, s19, s22
s_cmp_lg_u32 s17, 0
s_cbranch_scc1 F_V
F_K:
s_waitcnt lgkmcnt(0)
s_waitcnt vmcnt(8)
s_barrier
v_mfma_f32_16x16x32_bf16 a[0:3], v[64:67], v[32:35], 0
ds_read_b128 v[96:99], v20 offset:0
v_mfma_f32_16x16x32_bf16 a[4:7], v[64:67], v[36:39], 0
s_add_u32 m0, s67, s70
s_add_u32 s22, s67, 16384
v_mfma_f32_16x16x32_bf16 a[8:11], v[64:67], v[40:43], 0
ds_read_b64_tr_b16 v[128:129], v22 offset:0
v_mfma_f32_16x16x32_bf16 a[12:15], v[64:67], v[44:47], 0
s_sub_u32 s67, s22, 163840
s_cselect_b32 s67, s22, s67
buffer_load_dwordx4 v1, s[28:31], s68 offen lds
v_mfma_f32_16x16x32_bf16 a[16:19], v[64:67], v[48:51], 0
ds_read_b64_tr_b16 v[130:131], v22 offset:1024
v_mfma_f32_16x16x32_bf16 a[20:23], v[64:67], v[52:55], 0
buffer_load_dwordx4 v2, s[28:31], s68 offen offset:1024 lds
v_mfma_f32_16x16x32_bf16 a[24:27], v[64:67], v[56:59], 0
ds_read_b128 v[100:103], v20 offset:2048
v_mfma_f32_16x16x32_bf16 a[28:31], v[64:67], v[60:63], 0
buffer_load_dwordx4 v3, s[28:31], s68 offen offset:2048 lds
buffer_load_dwordx4 v4, s[28:31], s68 offen offset:3072 lds
v_mfma_f32_16x16x32_bf16 a[32:35], v[68:71], v[32:35], 0
ds_read_b64_tr_b16 v[132:133], v22 offset:256
v_mfma_f32_16x16x32_bf16 a[36:39], v[68:71], v[36:39], 0
s_sub_u32 s68, s68, 262016
s_bitset0_b32 s68, 11
v_mfma_f32_16x16x32_bf16 a[40:43], v[68:71], v[40:43], 0
ds_read_b64_tr_b16 v[134:135], v22 offset:1280
v_mfma_f32_16x16x32_bf16 a[44:47], v[68:71], v[44:47], 0
s_add_u32 m0, s67, s70
v_mfma_f32_16x16x32_bf16 a[48:51], v[68:71], v[48:51], 0
ds_read_b128 v[104:107], v20 offset:4096
v_mfma_f32_16x16x32_bf16 a[52:55], v[68:71], v[52:55], 0
s_add_u32 s22, s67, 16384
s_sub_u32 s67, s22, 163840
s_cselect_b32 s67, s22, s67
v_mfma_f32_16x16x32_bf16 a[56:59], v[68:71], v[56:59], 0
ds_read_b64_tr_b16 v[136:137], v22 offset:512
v_mfma_f32_16x16x32_bf16 a[60:63], v[68:71], v[60:63], 0
buffer_load_dwordx4 v232, s[32:35], s69 offen lds
v_mfma_f32_16x16x32_bf16 a[64:67], v[72:75], v[32:35], 0
ds_read_b64_tr_b16 v[138:139], v22 offset:1536
v_mfma_f32_16x16x32_bf16 a[68:71], v[72:75], v[36:39], 0
buffer_load_dwordx4 v233, s[32:35], s69 offen offset:1024 lds
buffer_load_dwordx4 v234, s[32:35], s69 offen offset:2048 lds
v_mfma_f32_16x16x32_bf16 a[72:75], v[72:75], v[40:43], 0
ds_read_b128 v[108:111], v20 offset:6144
v_mfma_f32_16x16x32_bf16 a[76:79], v[72:75], v[44:47], 0
buffer_load_dwordx4 v235, s[32:35], s69 offen offset:3072 lds
s_add_u32 s69, s69, 262144
v_mfma_f32_16x16x32_bf16 a[80:83], v[72:75], v[48:51], 0
ds_read_b64_tr_b16 v[140:141], v22 offset:768
v_mfma_f32_16x16x32_bf16 a[84:87], v[72:75], v[52:55], 0
s_and_b32 s69, s69, 0x7fffff
v_mfma_f32_16x16x32_bf16 a[88:91], v[72:75], v[56:59], 0
ds_read_b64_tr_b16 v[142:143], v22 offset:1792
v_mfma_f32_16x16x32_bf16 a[92:95], v[72:75], v[60:63], 0
s_add_u32 m0, s67, s70
s_add_u32 s22, s67, 16384
v_mfma_f32_16x16x32_bf16 a[96:99], v[76:79], v[32:35], 0
ds_read_b128 v[112:115], v20 offset:8192
v_mfma_f32_16x16x32_bf16 a[100:103], v[76:79], v[36:39], 0
s_sub_u32 s67, s22, 163840
s_cselect_b32 s67, s22, s67
buffer_load_dwordx4 v232, s[32:35], s69 offen lds
v_mfma_f32_16x16x32_bf16 a[104:107], v[76:79], v[40:43], 0
ds_read_b64_tr_b16 v[144:145], v22 offset:4096
v_mfma_f32_16x16x32_bf16 a[108:111], v[76:79], v[44:47], 0
buffer_load_dwordx4 v233, s[32:35], s69 offen offset:1024 lds
v_mfma_f32_16x16x32_bf16 a[112:115], v[76:79], v[48:51], 0
ds_read_b64_tr_b16 v[146:147], v22 offset:5120
v_mfma_f32_16x16x32_bf16 a[116:119], v[76:79], v[52:55], 0
buffer_load_dwordx4 v234, s[32:35], s69 offen offset:2048 lds
buffer_load_dwordx4 v235, s[32:35], s69 offen offset:3072 lds
v_mfma_f32_16x16x32_bf16 a[120:123], v[76:79], v[56:59], 0
ds_read_b128 v[116:119], v20 offset:10240
v_mfma_f32_16x16x32_bf16 a[124:127], v[76:79], v[60:63], 0
s_add_u32 s69, s69, 262144
v_mfma_f32_16x16x32_bf16 a[128:131], v[80:83], v[32:35], 0
ds_read_b64_tr_b16 v[148:149], v22 offset:4352
v_mfma_f32_16x16x32_bf16 a[132:135], v[80:83], v[36:39], 0
s_and_b32 s69, s69, 0x7fffff
s_add_u32 m0, s67, s70
v_mfma_f32_16x16x32_bf16 a[136:139], v[80:83], v[40:43], 0
ds_read_b64_tr_b16 v[150:151], v22 offset:5376
v_mfma_f32_16x16x32_bf16 a[140:143], v[80:83], v[44:47], 0
s_add_u32 s22, s67, 16384
s_sub_u32 s67, s22, 163840
s_cselect_b32 s67, s22, s67
v_mfma_f32_16x16x32_bf16 a[144:147], v[80:83], v[48:51], 0
ds_read_b128 v[120:123], v20 offset:12288
v_mfma_f32_16x16x32_bf16 a[148:151], v[80:83], v[52:55], 0
buffer_load_dwordx4 v1, s[28:31], s68 offen lds
v_mfma_f32_16x16x32_bf16 a[152:155], v[80:83], v[56:59], 0
ds_read_b64_tr_b16 v[152:153], v22 offset:4608
v_mfma_f32_16x16x32_bf16 a[156:159], v[80:83], v[60:63], 0
buffer_load_dwordx4 v2, s[28:31], s68 offen offset:1024 lds
buffer_load_dwordx4 v3, s[28:31], s68 offen offset:2048 lds
v_mfma_f32_16x16x32_bf16 a[160:163], v[84:87], v[32:35], 0
ds_read_b64_tr_b16 v[154:155], v22 offset:5632
v_mfma_f32_16x16x32_bf16 a[164:167], v[84:87], v[36:39], 0
buffer_load_dwordx4 v4, s[28:31], s68 offen offset:3072 lds
s_add_u32 s68, s68, 262144
v_mfma_f32_16x16x32_bf16 a[168:171], v[84:87], v[40:43], 0
ds_read_b128 v[124:127], v20 offset:14336
v_mfma_f32_16x16x32_bf16 a[172:175], v[84:87], v[44:47], 0
s_add_u32 m0, s67, s70
v_mfma_f32_16x16x32_bf16 a[176:179], v[84:87], v[48:51], 0
ds_read_b64_tr_b16 v[156:157], v22 offset:4864
v_mfma_f32_16x16x32_bf16 a[180:183], v[84:87], v[52:55], 0
s_add_u32 s22, s67, 16384
s_sub_u32 s67, s22, 163840
s_cselect_b32 s67, s22, s67
v_mfma_f32_16x16x32_bf16 a[184:187], v[84:87], v[56:59], 0
ds_read_b64_tr_b16 v[158:159], v22 offset:5888
v_mfma_f32_16x16x32_bf16 a[188:191], v[84:87], v[60:63], 0
buffer_load_dwordx4 v1, s[28:31], s68 offen lds
v_mfma_f32_16x16x32_bf16 a[192:195], v[88:91], v[32:35], 0
v_mfma_f32_16x16x32_bf16 a[196:199], v[88:91], v[36:39], 0
buffer_load_dwordx4 v2, s[28:31], s68 offen offset:1024 lds
buffer_load_dwordx4 v3, s[28:31], s68 offen offset:2048 lds
v_mfma_f32_16x16x32_bf16 a[200:203], v[88:91], v[40:43], 0
v_mfma_f32_16x16x32_bf16 a[204:207], v[88:91], v[44:47], 0
buffer_load_dwordx4 v4, s[28:31], s68 offen offset:3072 lds
s_sub_u32 s68, s68, 262016
v_mfma_f32_16x16x32_bf16 a[208:211], v[88:91], v[48:51], 0
v_mfma_f32_16x16x32_bf16 a[212:215], v[88:91], v[52:55], 0
s_bitset0_b32 s68, 11
v_mfma_f32_16x16x32_bf16 a[216:219], v[88:91], v[56:59], 0
v_mfma_f32_16x16x32_bf16 a[220:223], v[88:91], v[60:63], 0
s_add_u32 s23, s64, 65536
s_sub_u32 s64, s23, 163840
s_cselect_b32 s64, s23, s64
v_mfma_f32_16x16x32_bf16 a[224:227], v[92:95], v[32:35], 0
v_mfma_f32_16x16x32_bf16 a[228:231], v[92:95], v[36:39], 0
s_add_u32 s23, s65, 65536
s_sub_u32 s65, s23, 163840
s_cselect_b32 s65, s23, s65
v_mfma_f32_16x16x32_bf16 a[232:235], v[92:95], v[40:43], 0
v_mfma_f32_16x16x32_bf16 a[236:239], v[92:95], v[44:47], 0
s_add_u32 s23, s66, 65536
v_mfma_f32_16x16x32_bf16 a[240:243], v[92:95], v[48:51], 0
v_mfma_f32_16x16x32_bf16 a[244:247], v[92:95], v[52:55], 0
s_sub_u32 s66, s23, 163840
s_cselect_b32 s66, s23, s66
v_add_u32 v19, s65, v236
v_mfma_f32_16x16x32_bf16 a[248:251], v[92:95], v[56:59], 0
v_mfma_f32_16x16x32_bf16 a[252:255], v[92:95], v[60:63], 0
v_add_u32 v21, s64, v238
s_waitcnt lgkmcnt(0)
s_waitcnt vmcnt(16)
s_barrier
v_mfma_f32_16x16x32_bf16 a[0:3], v[128:131], v[96:99], a[0:3]
ds_read_b128 v[32:35], v19 offset:0
v_mfma_f32_16x16x32_bf16 a[4:7], v[128:131], v[100:103], a[4:7]
s_add_u32 m0, s67, s70
v_mfma_f32_16x16x32_bf16 a[8:11], v[128:131], v[104:107], a[8:11]
ds_read_b64_tr_b16 v[64:65], v21 offset:0
v_mfma_f32_16x16x32_bf16 a[12:15], v[128:131], v[108:111], a[12:15]
s_add_u32 s22, s67, 16384
v_mfma_f32_16x16x32_bf16 a[16:19], v[128:131], v[112:115], a[16:19]
ds_read_b64_tr_b16 v[66:67], v21 offset:1024
v_mfma_f32_16x16x32_bf16 a[20:23], v[128:131], v[116:119], a[20:23]
buffer_load_dword v164, v200, s[48:51], 0 offen
v_mfma_f32_16x16x32_bf16 a[24:27], v[128:131], v[120:123], a[24:27]
ds_read_b128 v[36:39], v19 offset:2048
v_mfma_f32_16x16x32_bf16 a[28:31], v[128:131], v[124:127], a[28:31]
s_sub_u32 s67, s22, 163840
s_cselect_b32 s67, s22, s67
v_mfma_f32_16x16x32_bf16 a[32:35], v[132:135], v[96:99], a[32:35]
ds_read_b64_tr_b16 v[68:69], v21 offset:256
v_mfma_f32_16x16x32_bf16 a[36:39], v[132:135], v[100:103], a[36:39]
buffer_load_dwordx4 v232, s[32:35], s69 offen lds
v_mfma_f32_16x16x32_bf16 a[40:43], v[132:135], v[104:107], a[40:43]
ds_read_b64_tr_b16 v[70:71], v21 offset:1280
v_mfma_f32_16x16x32_bf16 a[44:47], v[132:135], v[108:111], a[44:47]
buffer_load_dword v165, v201, s[48:51], 0 offen
v_mfma_f32_16x16x32_bf16 a[48:51], v[132:135], v[112:115], a[48:51]
ds_read_b128 v[40:43], v19 offset:4096
v_mfma_f32_16x16x32_bf16 a[52:55], v[132:135], v[116:119], a[52:55]
buffer_load_dwordx4 v233, s[32:35], s69 offen offset:1024 lds
v_mfma_f32_16x16x32_bf16 a[56:59], v[132:135], v[120:123], a[56:59]
ds_read_b64_tr_b16 v[72:73], v21 offset:512
v_mfma_f32_16x16x32_bf16 a[60:63], v[132:135], v[124:127], a[60:63]
buffer_load_dword v166, v202, s[48:51], 0 offen
v_mfma_f32_16x16x32_bf16 a[64:67], v[136:139], v[96:99], a[64:67]
ds_read_b64_tr_b16 v[74:75], v21 offset:1536
v_mfma_f32_16x16x32_bf16 a[68:71], v[136:139], v[100:103], a[68:71]
buffer_load_dwordx4 v234, s[32:35], s69 offen offset:2048 lds
v_mfma_f32_16x16x32_bf16 a[72:75], v[136:139], v[104:107], a[72:75]
ds_read_b128 v[44:47], v19 offset:6144
v_mfma_f32_16x16x32_bf16 a[76:79], v[136:139], v[108:111], a[76:79]
buffer_load_dwordx4 v235, s[32:35], s69 offen offset:3072 lds
v_mfma_f32_16x16x32_bf16 a[80:83], v[136:139], v[112:115], a[80:83]
ds_read_b64_tr_b16 v[76:77], v21 offset:768
v_mfma_f32_16x16x32_bf16 a[84:87], v[136:139], v[116:119], a[84:87]
buffer_load_dword v167, v160, s[48:51], 0 offen offset:0
v_mfma_f32_16x16x32_bf16 a[88:91], v[136:139], v[120:123], a[88:91]
ds_read_b64_tr_b16 v[78:79], v21 offset:1792
v_mfma_f32_16x16x32_bf16 a[92:95], v[136:139], v[124:127], a[92:95]
s_add_u32 s69, s69, 262144
v_mfma_f32_16x16x32_bf16 a[96:99], v[140:143], v[96:99], a[96:99]
ds_read_b128 v[48:51], v19 offset:8192
v_mfma_f32_16x16x32_bf16 a[100:103], v[140:143], v[100:103], a[100:103]
s_and_b32 s69, s69, 0x7fffff
v_mfma_f32_16x16x32_bf16 a[104:107], v[140:143], v[104:107], a[104:107]
ds_read_b64_tr_b16 v[80:81], v21 offset:4096
v_mfma_f32_16x16x32_bf16 a[108:111], v[140:143], v[108:111], a[108:111]
buffer_load_dword v168, v160, s[48:51], 0 offen offset:896
v_mfma_f32_16x16x32_bf16 a[112:115], v[140:143], v[112:115], a[112:115]
ds_read_b64_tr_b16 v[82:83], v21 offset:5120
v_mfma_f32_16x16x32_bf16 a[116:119], v[140:143], v[116:119], a[116:119]
s_add_u32 m0, s67, s70
v_mfma_f32_16x16x32_bf16 a[120:123], v[140:143], v[120:123], a[120:123]
ds_read_b128 v[52:55], v19 offset:10240
v_mfma_f32_16x16x32_bf16 a[124:127], v[140:143], v[124:127], a[124:127]
buffer_load_dword v169, v160, s[48:51], 0 offen offset:1792
v_mfma_f32_16x16x32_bf16 a[128:131], v[144:147], v[96:99], a[128:131]
ds_read_b64_tr_b16 v[84:85], v21 offset:4352
v_mfma_f32_16x16x32_bf16 a[132:135], v[144:147], v[100:103], a[132:135]
s_add_u32 s22, s67, 16384
v_mfma_f32_16x16x32_bf16 a[136:139], v[144:147], v[104:107], a[136:139]
ds_read_b64_tr_b16 v[86:87], v21 offset:5376
v_mfma_f32_16x16x32_bf16 a[140:143], v[144:147], v[108:111], a[140:143]
s_sub_u32 s67, s22, 163840
s_cselect_b32 s67, s22, s67
v_mfma_f32_16x16x32_bf16 a[144:147], v[144:147], v[112:115], a[144:147]
ds_read_b128 v[56:59], v19 offset:12288
v_mfma_f32_16x16x32_bf16 a[148:151], v[144:147], v[116:119], a[148:151]
buffer_load_dword v170, v160, s[48:51], 0 offen offset:2688
v_mfma_f32_16x16x32_bf16 a[152:155], v[144:147], v[120:123], a[152:155]
ds_read_b64_tr_b16 v[88:89], v21 offset:4608
v_mfma_f32_16x16x32_bf16 a[156:159], v[144:147], v[124:127], a[156:159]
buffer_load_dwordx4 v232, s[32:35], s69 offen lds
v_mfma_f32_16x16x32_bf16 a[160:163], v[148:151], v[96:99], a[160:163]
ds_read_b64_tr_b16 v[90:91], v21 offset:5632
v_mfma_f32_16x16x32_bf16 a[164:167], v[148:151], v[100:103], a[164:167]
buffer_load_dwordx4 v233, s[32:35], s69 offen offset:1024 lds
v_mfma_f32_16x16x32_bf16 a[168:171], v[148:151], v[104:107], a[168:171]
ds_read_b128 v[60:63], v19 offset:14336
v_mfma_f32_16x16x32_bf16 a[172:175], v[148:151], v[108:111], a[172:175]
buffer_load_dword v171, v160, s[48:51], 0 offen offset:3584
v_mfma_f32_16x16x32_bf16 a[176:179], v[148:151], v[112:115], a[176:179]
ds_read_b64_tr_b16 v[92:93], v21 offset:4864
v_mfma_f32_16x16x32_bf16 a[180:183], v[148:151], v[116:119], a[180:183]
buffer_load_dwordx4 v234, s[32:35], s69 offen offset:2048 lds
v_mfma_f32_16x16x32_bf16 a[184:187], v[148:151], v[120:123], a[184:187]
ds_read_b64_tr_b16 v[94:95], v21 offset:5888
v_mfma_f32_16x16x32_bf16 a[188:191], v[148:151], v[124:127], a[188:191]
buffer_load_dword v172, v160, s[48:51], s80 offen offset:896
v_mfma_f32_16x16x32_bf16 a[192:195], v[152:155], v[96:99], a[192:195]
buffer_load_dword v173, v160, s[48:51], s80 offen offset:1792
v_mfma_f32_16x16x32_bf16 a[196:199], v[152:155], v[100:103], a[196:199]
buffer_load_dwordx4 v235, s[32:35], s69 offen offset:3072 lds
v_mfma_f32_16x16x32_bf16 a[200:203], v[152:155], v[104:107], a[200:203]
buffer_load_dword v174, v160, s[48:51], s80 offen offset:2688
v_mfma_f32_16x16x32_bf16 a[204:207], v[152:155], v[108:111], a[204:207]
s_add_u32 s69, s69, 262144
v_mfma_f32_16x16x32_bf16 a[208:211], v[152:155], v[112:115], a[208:211]
buffer_load_dwordx4 v[192:195], v161, s[56:59], 0 offen
v_mfma_f32_16x16x32_bf16 a[212:215], v[152:155], v[116:119], a[212:215]
buffer_load_dword v175, v160, s[52:55], 0 offen offset:0
v_mfma_f32_16x16x32_bf16 a[216:219], v[152:155], v[120:123], a[216:219]
buffer_load_dword v176, v160, s[52:55], 0 offen offset:896
v_mfma_f32_16x16x32_bf16 a[220:223], v[152:155], v[124:127], a[220:223]
s_and_b32 s69, s69, 0x7fffff
v_mfma_f32_16x16x32_bf16 a[224:227], v[156:159], v[96:99], a[224:227]
buffer_load_dword v177, v160, s[52:55], 0 offen offset:1792
v_mfma_f32_16x16x32_bf16 a[228:231], v[156:159], v[100:103], a[228:231]
v_add_u32 v20, s65, v237
v_mfma_f32_16x16x32_bf16 a[232:235], v[156:159], v[104:107], a[232:235]
buffer_load_dword v178, v160, s[52:55], 0 offen offset:2688
v_mfma_f32_16x16x32_bf16 a[236:239], v[156:159], v[108:111], a[236:239]
buffer_load_dword v179, v160, s[52:55], 0 offen offset:3584
v_mfma_f32_16x16x32_bf16 a[240:243], v[156:159], v[112:115], a[240:243]
buffer_load_dword v180, v160, s[52:55], s80 offen offset:896
v_mfma_f32_16x16x32_bf16 a[244:247], v[156:159], v[116:119], a[244:247]
v_add_u32 v22, s66, v238
v_mfma_f32_16x16x32_bf16 a[248:251], v[156:159], v[120:123], a[248:251]
buffer_load_dword v181, v160, s[52:55], s80 offen offset:1792
v_mfma_f32_16x16x32_bf16 a[252:255], v[156:159], v[124:127], a[252:255]
buffer_load_dword v182, v160, s[52:55], s80 offen offset:2688
buffer_load_dword v183, v160, s[44:47], 0 offen offset:0
buffer_load_dword v184, v160, s[44:47], 0 offen offset:896
buffer_load_dword v185, v160, s[44:47], 0 offen offset:1792
buffer_load_dword v186, v160, s[44:47], 0 offen offset:2688
buffer_load_dword v187, v160, s[44:47], 0 offen offset:3584
buffer_load_dword v188, v160, s[44:47], s80 offen offset:896
buffer_load_dword v189, v160, s[44:47], s80 offen offset:1792
buffer_load_dword v190, v160, s[44:47], s80 offen offset:2688
s_waitcnt lgkmcnt(0)
s_waitcnt vmcnt(48)
s_barrier
v_mfma_f32_16x16x32_bf16 a[0:3], v[64:67], v[32:35], a[0:3]
ds_read_b128 v[96:99], v20 offset:0
v_mfma_f32_16x16x32_bf16 a[4:7], v[64:67], v[36:39], a[4:7]
s_add_u32 m0, s67, s70
v_mfma_f32_16x16x32_bf16 a[8:11], v[64:67], v[40:43], a[8:11]
ds_read_b64_tr_b16 v[128:129], v22 offset:0
v_mfma_f32_16x16x32_bf16 a[12:15], v[64:67], v[44:47], a[12:15]
s_add_u32 s22, s67, 16384
v_mfma_f32_16x16x32_bf16 a[16:19], v[64:67], v[48:51], a[16:19]
ds_read_b64_tr_b16 v[130:131], v22 offset:1024
v_mfma_f32_16x16x32_bf16 a[20:23], v[64:67], v[52:55], a[20:23]
s_sub_u32 s67, s22, 163840
s_cselect_b32 s67, s22, s67
v_mfma_f32_16x16x32_bf16 a[24:27], v[64:67], v[56:59], a[24:27]
ds_read_b128 v[100:103], v20 offset:2048
v_mfma_f32_16x16x32_bf16 a[28:31], v[64:67], v[60:63], a[28:31]
buffer_load_dwordx4 v1, s[28:31], s68 offen lds
v_mfma_f32_16x16x32_bf16 a[32:35], v[68:71], v[32:35], a[32:35]
ds_read_b64_tr_b16 v[132:133], v22 offset:256
v_mfma_f32_16x16x32_bf16 a[36:39], v[68:71], v[36:39], a[36:39]
v_mfma_f32_16x16x32_bf16 a[40:43], v[68:71], v[40:43], a[40:43]
ds_read_b64_tr_b16 v[134:135], v22 offset:1280
v_mfma_f32_16x16x32_bf16 a[44:47], v[68:71], v[44:47], a[44:47]
buffer_load_dwordx4 v2, s[28:31], s68 offen offset:1024 lds
v_mfma_f32_16x16x32_bf16 a[48:51], v[68:71], v[48:51], a[48:51]
ds_read_b128 v[104:107], v20 offset:4096
v_mfma_f32_16x16x32_bf16 a[52:55], v[68:71], v[52:55], a[52:55]
buffer_load_dwordx4 v3, s[28:31], s68 offen offset:2048 lds
v_mfma_f32_16x16x32_bf16 a[56:59], v[68:71], v[56:59], a[56:59]
ds_read_b64_tr_b16 v[136:137], v22 offset:512
v_mfma_f32_16x16x32_bf16 a[60:63], v[68:71], v[60:63], a[60:63]
buffer_load_dwordx4 v4, s[28:31], s68 offen offset:3072 lds
v_mfma_f32_16x16x32_bf16 a[64:67], v[72:75], v[32:35], a[64:67]
ds_read_b64_tr_b16 v[138:139], v22 offset:1536
v_mfma_f32_16x16x32_bf16 a[68:71], v[72:75], v[36:39], a[68:71]
s_add_u32 s68, s68, 262144
v_mfma_f32_16x16x32_bf16 a[72:75], v[72:75], v[40:43], a[72:75]
ds_read_b128 v[108:111], v20 offset:6144
v_mfma_f32_16x16x32_bf16 a[76:79], v[72:75], v[44:47], a[76:79]
v_mfma_f32_16x16x32_bf16 a[80:83], v[72:75], v[48:51], a[80:83]
ds_read_b64_tr_b16 v[140:141], v22 offset:768
v_mfma_f32_16x16x32_bf16 a[84:87], v[72:75], v[52:55], a[84:87]
s_add_u32 m0, s67, s70
v_mfma_f32_16x16x32_bf16 a[88:91], v[72:75], v[56:59], a[88:91]
ds_read_b64_tr_b16 v[142:143], v22 offset:1792
v_mfma_f32_16x16x32_bf16 a[92:95], v[72:75], v[60:63], a[92:95]
s_add_u32 s22, s67, 16384
v_mfma_f32_16x16x32_bf16 a[96:99], v[76:79], v[32:35], a[96:99]
ds_read_b128 v[112:115], v20 offset:8192
v_mfma_f32_16x16x32_bf16 a[100:103], v[76:79], v[36:39], a[100:103]
s_sub_u32 s67, s22, 163840
s_cselect_b32 s67, s22, s67
v_mfma_f32_16x16x32_bf16 a[104:107], v[76:79], v[40:43], a[104:107]
ds_read_b64_tr_b16 v[144:145], v22 offset:4096
v_mfma_f32_16x16x32_bf16 a[108:111], v[76:79], v[44:47], a[108:111]
v_mfma_f32_16x16x32_bf16 a[112:115], v[76:79], v[48:51], a[112:115]
ds_read_b64_tr_b16 v[146:147], v22 offset:5120
v_mfma_f32_16x16x32_bf16 a[116:119], v[76:79], v[52:55], a[116:119]
buffer_load_dwordx4 v1, s[28:31], s68 offen lds
v_mfma_f32_16x16x32_bf16 a[120:123], v[76:79], v[56:59], a[120:123]
ds_read_b128 v[116:119], v20 offset:10240
v_mfma_f32_16x16x32_bf16 a[124:127], v[76:79], v[60:63], a[124:127]
buffer_load_dwordx4 v2, s[28:31], s68 offen offset:1024 lds
v_mfma_f32_16x16x32_bf16 a[128:131], v[80:83], v[32:35], a[128:131]
ds_read_b64_tr_b16 v[148:149], v22 offset:4352
v_mfma_f32_16x16x32_bf16 a[132:135], v[80:83], v[36:39], a[132:135]
buffer_load_dwordx4 v3, s[28:31], s68 offen offset:2048 lds
v_mfma_f32_16x16x32_bf16 a[136:139], v[80:83], v[40:43], a[136:139]
ds_read_b64_tr_b16 v[150:151], v22 offset:5376
v_mfma_f32_16x16x32_bf16 a[140:143], v[80:83], v[44:47], a[140:143]
buffer_load_dwordx4 v4, s[28:31], s68 offen offset:3072 lds
v_mfma_f32_16x16x32_bf16 a[144:147], v[80:83], v[48:51], a[144:147]
ds_read_b128 v[120:123], v20 offset:12288
v_mfma_f32_16x16x32_bf16 a[148:151], v[80:83], v[52:55], a[148:151]
v_mfma_f32_16x16x32_bf16 a[152:155], v[80:83], v[56:59], a[152:155]
ds_read_b64_tr_b16 v[152:153], v22 offset:4608
v_mfma_f32_16x16x32_bf16 a[156:159], v[80:83], v[60:63], a[156:159]
s_sub_u32 s68, s68, 262016
v_mfma_f32_16x16x32_bf16 a[160:163], v[84:87], v[32:35], a[160:163]
ds_read_b64_tr_b16 v[154:155], v22 offset:5632
v_mfma_f32_16x16x32_bf16 a[164:167], v[84:87], v[36:39], a[164:167]
s_bitset0_b32 s68, 11
v_mfma_f32_16x16x32_bf16 a[168:171], v[84:87], v[40:43], a[168:171]
ds_read_b128 v[124:127], v20 offset:14336
v_mfma_f32_16x16x32_bf16 a[172:175], v[84:87], v[44:47], a[172:175]
s_add_u32 s23, s64, 65536
v_mfma_f32_16x16x32_bf16 a[176:179], v[84:87], v[48:51], a[176:179]
ds_read_b64_tr_b16 v[156:157], v22 offset:4864
v_mfma_f32_16x16x32_bf16 a[180:183], v[84:87], v[52:55], a[180:183]
v_mfma_f32_16x16x32_bf16 a[184:187], v[84:87], v[56:59], a[184:187]
ds_read_b64_tr_b16 v[158:159], v22 offset:5888
v_mfma_f32_16x16x32_bf16 a[188:191], v[84:87], v[60:63], a[188:191]
s_sub_u32 s64, s23, 163840
s_cselect_b32 s64, s23, s64
v_mfma_f32_16x16x32_bf16 a[192:195], v[88:91], v[32:35], a[192:195]
v_mfma_f32_16x16x32_bf16 a[196:199], v[88:91], v[36:39], a[196:199]
s_add_u32 s23, s65, 65536
v_mfma_f32_16x16x32_bf16 a[200:203], v[88:91], v[40:43], a[200:203]
v_mfma_f32_16x16x32_bf16 a[204:207], v[88:91], v[44:47], a[204:207]
s_sub_u32 s65, s23, 163840
s_cselect_b32 s65, s23, s65
v_mfma_f32_16x16x32_bf16 a[208:211], v[88:91], v[48:51], a[208:211]
v_mfma_f32_16x16x32_bf16 a[212:215], v[88:91], v[52:55], a[212:215]
s_add_u32 s23, s66, 65536
v_mfma_f32_16x16x32_bf16 a[216:219], v[88:91], v[56:59], a[216:219]
v_mfma_f32_16x16x32_bf16 a[220:223], v[88:91], v[60:63], a[220:223]
v_mfma_f32_16x16x32_bf16 a[224:227], v[92:95], v[32:35], a[224:227]
v_mfma_f32_16x16x32_bf16 a[228:231], v[92:95], v[36:39], a[228:231]
s_sub_u32 s66, s23, 163840
s_cselect_b32 s66, s23, s66
v_mfma_f32_16x16x32_bf16 a[232:235], v[92:95], v[40:43], a[232:235]
v_mfma_f32_16x16x32_bf16 a[236:239], v[92:95], v[44:47], a[236:239]
v_add_u32 v19, s65, v236
v_mfma_f32_16x16x32_bf16 a[240:243], v[92:95], v[48:51], a[240:243]
v_mfma_f32_16x16x32_bf16 a[244:247], v[92:95], v[52:55], a[244:247]
v_add_u32 v21, s64, v238
v_mfma_f32_16x16x32_bf16 a[248:251], v[92:95], v[56:59], a[248:251]
v_mfma_f32_16x16x32_bf16 a[252:255], v[92:95], v[60:63], a[252:255]
s_waitcnt lgkmcnt(0)
s_waitcnt vmcnt(8)
s_barrier
v_mfma_f32_16x16x32_bf16 a[0:3], v[128:131], v[96:99], a[0:3]
ds_read_b128 v[32:35], v19 offset:0
v_lshlrev_b32 v196, 16, v192
v_mfma_f32_16x16x32_bf16 a[4:7], v[128:131], v[100:103], a[4:7]
s_add_u32 m0, s67, s70
v_and_b32 v197, 0xffff0000, v192
v_mfma_f32_16x16x32_bf16 a[8:11], v[128:131], v[104:107], a[8:11]
ds_read_b64_tr_b16 v[64:65], v21 offset:0
v_lshlrev_b32 v198, 16, v193
v_mfma_f32_16x16x32_bf16 a[12:15], v[128:131], v[108:111], a[12:15]
s_add_u32 s22, s67, 16384
v_and_b32 v199, 0xffff0000, v193
v_mfma_f32_16x16x32_bf16 a[16:19], v[128:131], v[112:115], a[16:19]
ds_read_b64_tr_b16 v[66:67], v21 offset:1024
v_lshlrev_b32 v200, 16, v194
v_mfma_f32_16x16x32_bf16 a[20:23], v[128:131], v[116:119], a[20:23]
v_and_b32 v201, 0xffff0000, v194
v_lshlrev_b32 v202, 16, v195
v_mfma_f32_16x16x32_bf16 a[24:27], v[128:131], v[120:123], a[24:27]
ds_read_b128 v[36:39], v19 offset:2048
v_and_b32 v203, 0xffff0000, v195
v_mfma_f32_16x16x32_bf16 a[28:31], v[128:131], v[124:127], a[28:31]
s_sub_u32 s67, s22, 163840
s_cselect_b32 s67, s22, s67
v_mfma_f32_16x16x32_bf16 a[32:35], v[132:135], v[96:99], a[32:35]
ds_read_b64_tr_b16 v[68:69], v21 offset:256
v_lshlrev_b32 v204, 16, v164
v_mfma_f32_16x16x32_bf16 a[36:39], v[132:135], v[100:103], a[36:39]
buffer_load_dwordx4 v232, s[32:35], s69 offen lds
v_mfma_f32_16x16x32_bf16 a[40:43], v[132:135], v[104:107], a[40:43]
ds_read_b64_tr_b16 v[70:71], v21 offset:1280
v_lshlrev_b32 v205, 16, v165
v_mfma_f32_16x16x32_bf16 a[44:47], v[132:135], v[108:111], a[44:47]
v_lshlrev_b32 v206, 16, v166
v_lshlrev_b32 v207, 16, v167
v_mfma_f32_16x16x32_bf16 a[48:51], v[132:135], v[112:115], a[48:51]
ds_read_b128 v[40:43], v19 offset:4096
v_lshlrev_b32 v208, 16, v168
v_mfma_f32_16x16x32_bf16 a[52:55], v[132:135], v[116:119], a[52:55]
buffer_load_dwordx4 v233, s[32:35], s69 offen offset:1024 lds
v_mfma_f32_16x16x32_bf16 a[56:59], v[132:135], v[120:123], a[56:59]
ds_read_b64_tr_b16 v[72:73], v21 offset:512
v_lshlrev_b32 v209, 16, v169
v_mfma_f32_16x16x32_bf16 a[60:63], v[132:135], v[124:127], a[60:63]
v_lshlrev_b32 v210, 16, v170
v_lshlrev_b32 v211, 16, v171
v_mfma_f32_16x16x32_bf16 a[64:67], v[136:139], v[96:99], a[64:67]
ds_read_b64_tr_b16 v[74:75], v21 offset:1536
v_lshlrev_b32 v212, 16, v172
v_mfma_f32_16x16x32_bf16 a[68:71], v[136:139], v[100:103], a[68:71]
buffer_load_dwordx4 v234, s[32:35], s69 offen offset:2048 lds
v_mfma_f32_16x16x32_bf16 a[72:75], v[136:139], v[104:107], a[72:75]
ds_read_b128 v[44:47], v19 offset:6144
v_lshlrev_b32 v213, 16, v173
v_mfma_f32_16x16x32_bf16 a[76:79], v[136:139], v[108:111], a[76:79]
buffer_load_dwordx4 v235, s[32:35], s69 offen offset:3072 lds
v_mfma_f32_16x16x32_bf16 a[80:83], v[136:139], v[112:115], a[80:83]
ds_read_b64_tr_b16 v[76:77], v21 offset:768
v_mfma_f32_16x16x32_bf16 a[84:87], v[136:139], v[116:119], a[84:87]
v_lshlrev_b32 v214, 16, v174
v_mul_f32 v216, v204, v199
v_mfma_f32_16x16x32_bf16 a[88:91], v[136:139], v[120:123], a[88:91]
ds_read_b64_tr_b16 v[78:79], v21 offset:1792
v_mul_f32 v217, v205, v199
v_mfma_f32_16x16x32_bf16 a[92:95], v[136:139], v[124:127], a[92:95]
s_add_u32 s69, s69, 262144
v_cvt_pk_bf16_f32 v220, v216, v217
v_mfma_f32_16x16x32_bf16 a[96:99], v[140:143], v[96:99], a[96:99]
ds_read_b128 v[48:51], v19 offset:8192
v_lshlrev_b32 v216, 16, v220
v_mfma_f32_16x16x32_bf16 a[100:103], v[140:143], v[100:103], a[100:103]
s_and_b32 s69, s69, 0x7fffff
v_and_b32 v217, 0xffff0000, v220
v_mfma_f32_16x16x32_bf16 a[104:107], v[140:143], v[104:107], a[104:107]
ds_read_b64_tr_b16 v[80:81], v21 offset:4096
v_mul_f32 v218, v205, v198
v_mfma_f32_16x16x32_bf16 a[108:111], v[140:143], v[108:111], a[108:111]
v_mul_f32 v219, v206, v198
v_cvt_pk_bf16_f32 v220, v218, v219
v_mfma_f32_16x16x32_bf16 a[112:115], v[140:143], v[112:115], a[112:115]
ds_read_b64_tr_b16 v[82:83], v21 offset:5120
v_lshlrev_b32 v218, 16, v220
v_mfma_f32_16x16x32_bf16 a[116:119], v[140:143], v[116:119], a[116:119]
s_add_u32 m0, s67, s70
v_and_b32 v219, 0xffff0000, v220
v_mfma_f32_16x16x32_bf16 a[120:123], v[140:143], v[120:123], a[120:123]
ds_read_b128 v[52:55], v19 offset:10240
v_add_f32 v216, v216, v218
v_mfma_f32_16x16x32_bf16 a[124:127], v[140:143], v[124:127], a[124:127]
v_add_f32 v217, v217, v219
v_cvt_pk_bf16_f32 v220, v216, v217
v_mfma_f32_16x16x32_bf16 a[128:131], v[144:147], v[96:99], a[128:131]
ds_read_b64_tr_b16 v[84:85], v21 offset:4352
v_lshlrev_b32 v216, 16, v220
v_mfma_f32_16x16x32_bf16 a[132:135], v[144:147], v[100:103], a[132:135]
s_add_u32 s22, s67, 16384
v_and_b32 v217, 0xffff0000, v220
v_mfma_f32_16x16x32_bf16 a[136:139], v[144:147], v[104:107], a[136:139]
ds_read_b64_tr_b16 v[86:87], v21 offset:5376
v_mul_f32 v218, v206, v197
v_mfma_f32_16x16x32_bf16 a[140:143], v[144:147], v[108:111], a[140:143]
s_sub_u32 s67, s22, 163840
s_cselect_b32 s67, s22, s67
v_mfma_f32_16x16x32_bf16 a[144:147], v[144:147], v[112:115], a[144:147]
ds_read_b128 v[56:59], v19 offset:12288
v_mul_f32 v219, v207, v197
v_mfma_f32_16x16x32_bf16 a[148:151], v[144:147], v[116:119], a[148:151]
v_cvt_pk_bf16_f32 v220, v218, v219
v_lshlrev_b32 v218, 16, v220
v_mfma_f32_16x16x32_bf16 a[152:155], v[144:147], v[120:123], a[152:155]
ds_read_b64_tr_b16 v[88:89], v21 offset:4608
v_and_b32 v219, 0xffff0000, v220
v_mfma_f32_16x16x32_bf16 a[156:159], v[144:147], v[124:127], a[156:159]
buffer_load_dwordx4 v232, s[32:35], s69 offen lds
v_mfma_f32_16x16x32_bf16 a[160:163], v[148:151], v[96:99], a[160:163]
ds_read_b64_tr_b16 v[90:91], v21 offset:5632
v_add_f32 v216, v216, v218
v_mfma_f32_16x16x32_bf16 a[164:167], v[148:151], v[100:103], a[164:167]
buffer_load_dwordx4 v233, s[32:35], s69 offen offset:1024 lds
v_mfma_f32_16x16x32_bf16 a[168:171], v[148:151], v[104:107], a[168:171]
ds_read_b128 v[60:63], v19 offset:14336
v_add_f32 v217, v217, v219
v_mfma_f32_16x16x32_bf16 a[172:175], v[148:151], v[108:111], a[172:175]
v_cvt_pk_bf16_f32 v220, v216, v217
v_lshlrev_b32 v216, 16, v220
v_mfma_f32_16x16x32_bf16 a[176:179], v[148:151], v[112:115], a[176:179]
ds_read_b64_tr_b16 v[92:93], v21 offset:4864
v_and_b32 v217, 0xffff0000, v220
v_mfma_f32_16x16x32_bf16 a[180:183], v[148:151], v[116:119], a[180:183]
buffer_load_dwordx4 v234, s[32:35], s69 offen offset:2048 lds
v_mfma_f32_16x16x32_bf16 a[184:187], v[148:151], v[120:123], a[184:187]
ds_read_b64_tr_b16 v[94:95], v21 offset:5888
v_mul_f32 v218, v207, v196
v_mfma_f32_16x16x32_bf16 a[188:191], v[148:151], v[124:127], a[188:191]
v_mul_f32 v219, v208, v196
v_cvt_pk_bf16_f32 v220, v218, v219
v_mfma_f32_16x16x32_bf16 a[192:195], v[152:155], v[96:99], a[192:195]
v_lshlrev_b32 v218, 16, v220
v_and_b32 v219, 0xffff0000, v220
v_mfma_f32_16x16x32_bf16 a[196:199], v[152:155], v[100:103], a[196:199]
buffer_load_dwordx4 v235, s[32:35], s69 offen offset:3072 lds
v_mfma_f32_16x16x32_bf16 a[200:203], v[152:155], v[104:107], a[200:203]
v_add_f32 v216, v216, v218
v_add_f32 v217, v217, v219
v_mfma_f32_16x16x32_bf16 a[204:207], v[152:155], v[108:111], a[204:207]
s_add_u32 s69, s69, 262144
v_cvt_pk_bf16_f32 v220, v216, v217
v_mfma_f32_16x16x32_bf16 a[208:211], v[152:155], v[112:115], a[208:211]
v_lshlrev_b32 v216, 16, v220
v_and_b32 v217, 0xffff0000, v220
v_mfma_f32_16x16x32_bf16 a[212:215], v[152:155], v[116:119], a[212:215]
v_lshlrev_b32 v218, 16, v175
v_mfma_f32_16x16x32_bf16 a[216:219], v[152:155], v[120:123], a[216:219]
v_lshlrev_b32 v219, 16, v176
v_mul_f32 v216, v216, v218
v_mfma_f32_16x16x32_bf16 a[220:223], v[152:155], v[124:127], a[220:223]
s_and_b32 s69, s69, 0x7fffff
v_mul_f32 v217, v217, v219
v_mfma_f32_16x16x32_bf16 a[224:227], v[156:159], v[96:99], a[224:227]
v_cvt_pk_bf16_f32 v227, v217, v216
v_mul_f32 v216, v206, v199
v_mfma_f32_16x16x32_bf16 a[228:231], v[156:159], v[100:103], a[228:231]
v_add_u32 v20, s65, v237
v_mul_f32 v217, v207, v199
v_mfma_f32_16x16x32_bf16 a[232:235], v[156:159], v[104:107], a[232:235]
v_cvt_pk_bf16_f32 v220, v216, v217
v_lshlrev_b32 v216, 16, v220
v_mfma_f32_16x16x32_bf16 a[236:239], v[156:159], v[108:111], a[236:239]
v_and_b32 v217, 0xffff0000, v220
v_mul_f32 v218, v207, v198
v_mfma_f32_16x16x32_bf16 a[240:243], v[156:159], v[112:115], a[240:243]
v_mul_f32 v219, v208, v198
v_cvt_pk_bf16_f32 v220, v218, v219
v_mfma_f32_16x16x32_bf16 a[244:247], v[156:159], v[116:119], a[244:247]
v_add_u32 v22, s66, v238
v_lshlrev_b32 v218, 16, v220
v_mfma_f32_16x16x32_bf16 a[248:251], v[156:159], v[120:123], a[248:251]
v_and_b32 v219, 0xffff0000, v220
v_add_f32 v216, v216, v218
v_mfma_f32_16x16x32_bf16 a[252:255], v[156:159], v[124:127], a[252:255]
v_add_f32 v217, v217, v219
v_cvt_pk_bf16_f32 v220, v216, v217
s_waitcnt lgkmcnt(0)
s_waitcnt vmcnt(20)
s_barrier
v_mfma_f32_16x16x32_bf16 a[0:3], v[64:67], v[32:35], a[0:3]
ds_read_b128 v[96:99], v20 offset:0
v_lshlrev_b32 v216, 16, v220
v_mfma_f32_16x16x32_bf16 a[4:7], v[64:67], v[36:39], a[4:7]
s_add_u32 m0, s67, s70
v_and_b32 v217, 0xffff0000, v220
v_mfma_f32_16x16x32_bf16 a[8:11], v[64:67], v[40:43], a[8:11]
ds_read_b64_tr_b16 v[128:129], v22 offset:0
v_mul_f32 v218, v208, v197
v_mfma_f32_16x16x32_bf16 a[12:15], v[64:67], v[44:47], a[12:15]
s_add_u32 s22, s67, 16384
v_mul_f32 v219, v209, v197
v_mfma_f32_16x16x32_bf16 a[16:19], v[64:67], v[48:51], a[16:19]
ds_read_b64_tr_b16 v[130:131], v22 offset:1024
v_cvt_pk_bf16_f32 v220, v218, v219
v_lshlrev_b32 v218, 16, v220
v_mfma_f32_16x16x32_bf16 a[20:23], v[64:67], v[52:55], a[20:23]
s_sub_u32 s67, s22, 163840
s_cselect_b32 s67, s22, s67
v_mfma_f32_16x16x32_bf16 a[24:27], v[64:67], v[56:59], a[24:27]
ds_read_b128 v[100:103], v20 offset:2048
v_and_b32 v219, 0xffff0000, v220
v_mfma_f32_16x16x32_bf16 a[28:31], v[64:67], v[60:63], a[28:31]
buffer_load_dwordx4 v1, s[28:31], s68 offen lds
v_add_f32 v216, v216, v218
v_mfma_f32_16x16x32_bf16 a[32:35], v[68:71], v[32:35], a[32:35]
ds_read_b64_tr_b16 v[132:133], v22 offset:256
v_add_f32 v217, v217, v219
v_mfma_f32_16x16x32_bf16 a[36:39], v[68:71], v[36:39], a[36:39]
v_cvt_pk_bf16_f32 v220, v216, v217
v_lshlrev_b32 v216, 16, v220
v_mfma_f32_16x16x32_bf16 a[40:43], v[68:71], v[40:43], a[40:43]
ds_read_b64_tr_b16 v[134:135], v22 offset:1280
v_and_b32 v217, 0xffff0000, v220
v_mfma_f32_16x16x32_bf16 a[44:47], v[68:71], v[44:47], a[44:47]
buffer_load_dwordx4 v2, s[28:31], s68 offen offset:1024 lds
v_mfma_f32_16x16x32_bf16 a[48:51], v[68:71], v[48:51], a[48:51]
ds_read_b128 v[104:107], v20 offset:4096
v_mul_f32 v218, v209, v196
v_mfma_f32_16x16x32_bf16 a[52:55], v[68:71], v[52:55], a[52:55]
buffer_load_dwordx4 v3, s[28:31], s68 offen offset:2048 lds
v_mul_f32 v219, v210, v196
v_mfma_f32_16x16x32_bf16 a[56:59], v[68:71], v[56:59], a[56:59]
ds_read_b64_tr_b16 v[136:137], v22 offset:512
v_cvt_pk_bf16_f32 v220, v218, v219
v_mfma_f32_16x16x32_bf16 a[60:63], v[68:71], v[60:63], a[60:63]
buffer_load_dwordx4 v4, s[28:31], s68 offen offset:3072 lds
v_lshlrev_b32 v218, 16, v220
v_mfma_f32_16x16x32_bf16 a[64:67], v[72:75], v[32:35], a[64:67]
ds_read_b64_tr_b16 v[138:139], v22 offset:1536
v_and_b32 v219, 0xffff0000, v220
v_mfma_f32_16x16x32_bf16 a[68:71], v[72:75], v[36:39], a[68:71]
s_add_u32 s68, s68, 262144
v_add_f32 v216, v216, v218
v_mfma_f32_16x16x32_bf16 a[72:75], v[72:75], v[40:43], a[72:75]
ds_read_b128 v[108:111], v20 offset:6144
v_add_f32 v217, v217, v219
v_mfma_f32_16x16x32_bf16 a[76:79], v[72:75], v[44:47], a[76:79]
v_cvt_pk_bf16_f32 v220, v216, v217
v_mfma_f32_16x16x32_bf16 a[80:83], v[72:75], v[48:51], a[80:83]
ds_read_b64_tr_b16 v[140:141], v22 offset:768
v_lshlrev_b32 v216, 16, v220
v_and_b32 v217, 0xffff0000, v220
v_mfma_f32_16x16x32_bf16 a[84:87], v[72:75], v[52:55], a[84:87]
s_add_u32 m0, s67, s70
v_lshlrev_b32 v218, 16, v177
v_mfma_f32_16x16x32_bf16 a[88:91], v[72:75], v[56:59], a[88:91]
ds_read_b64_tr_b16 v[142:143], v22 offset:1792
v_lshlrev_b32 v219, 16, v178
v_mfma_f32_16x16x32_bf16 a[92:95], v[72:75], v[60:63], a[92:95]
s_add_u32 s22, s67, 16384
v_mul_f32 v216, v216, v218
v_mfma_f32_16x16x32_bf16 a[96:99], v[76:79], v[32:35], a[96:99]
ds_read_b128 v[112:115], v20 offset:8192
v_mul_f32 v217, v217, v219
v_mfma_f32_16x16x32_bf16 a[100:103], v[76:79], v[36:39], a[100:103]
s_sub_u32 s67, s22, 163840
s_cselect_b32 s67, s22, s67
v_cvt_pk_bf16_f32 v226, v217, v216
v_mfma_f32_16x16x32_bf16 a[104:107], v[76:79], v[40:43], a[104:107]
ds_read_b64_tr_b16 v[144:145], v22 offset:4096
v_mul_f32 v216, v208, v199
v_mfma_f32_16x16x32_bf16 a[108:111], v[76:79], v[44:47], a[108:111]
v_mul_f32 v217, v209, v199
v_mfma_f32_16x16x32_bf16 a[112:115], v[76:79], v[48:51], a[112:115]
ds_read_b64_tr_b16 v[146:147], v22 offset:5120
v_cvt_pk_bf16_f32 v220, v216, v217
v_mfma_f32_16x16x32_bf16 a[116:119], v[76:79], v[52:55], a[116:119]
buffer_load_dwordx4 v1, s[28:31], s68 offen lds
v_lshlrev_b32 v216, 16, v220
v_mfma_f32_16x16x32_bf16 a[120:123], v[76:79], v[56:59], a[120:123]
ds_read_b128 v[116:119], v20 offset:10240
v_and_b32 v217, 0xffff0000, v220
v_mfma_f32_16x16x32_bf16 a[124:127], v[76:79], v[60:63], a[124:127]
buffer_load_dwordx4 v2, s[28:31], s68 offen offset:1024 lds
v_mul_f32 v218, v209, v198
v_mfma_f32_16x16x32_bf16 a[128:131], v[80:83], v[32:35], a[128:131]
ds_read_b64_tr_b16 v[148:149], v22 offset:4352
v_mul_f32 v219, v210, v198
v_mfma_f32_16x16x32_bf16 a[132:135], v[80:83], v[36:39], a[132:135]
buffer_load_dwordx4 v3, s[28:31], s68 offen offset:2048 lds
v_mfma_f32_16x16x32_bf16 a[136:139], v[80:83], v[40:43], a[136:139]
ds_read_b64_tr_b16 v[150:151], v22 offset:5376
v_cvt_pk_bf16_f32 v220, v218, v219
v_mfma_f32_16x16x32_bf16 a[140:143], v[80:83], v[44:47], a[140:143]
buffer_load_dwordx4 v4, s[28:31], s68 offen offset:3072 lds
v_lshlrev_b32 v218, 16, v220
v_mfma_f32_16x16x32_bf16 a[144:147], v[80:83], v[48:51], a[144:147]
ds_read_b128 v[120:123], v20 offset:12288
v_and_b32 v219, 0xffff0000, v220
v_mfma_f32_16x16x32_bf16 a[148:151], v[80:83], v[52:55], a[148:151]
v_add_f32 v216, v216, v218
v_add_f32 v217, v217, v219
v_mfma_f32_16x16x32_bf16 a[152:155], v[80:83], v[56:59], a[152:155]
ds_read_b64_tr_b16 v[152:153], v22 offset:4608
v_cvt_pk_bf16_f32 v220, v216, v217
v_mfma_f32_16x16x32_bf16 a[156:159], v[80:83], v[60:63], a[156:159]
s_sub_u32 s68, s68, 262016
v_lshlrev_b32 v216, 16, v220
v_mfma_f32_16x16x32_bf16 a[160:163], v[84:87], v[32:35], a[160:163]
ds_read_b64_tr_b16 v[154:155], v22 offset:5632
v_and_b32 v217, 0xffff0000, v220
v_mfma_f32_16x16x32_bf16 a[164:167], v[84:87], v[36:39], a[164:167]
s_bitset0_b32 s68, 11
v_mul_f32 v218, v210, v197
v_mfma_f32_16x16x32_bf16 a[168:171], v[84:87], v[40:43], a[168:171]
ds_read_b128 v[124:127], v20 offset:14336
v_mul_f32 v219, v211, v197
v_mfma_f32_16x16x32_bf16 a[172:175], v[84:87], v[44:47], a[172:175]
s_add_u32 s23, s64, 65536
v_cvt_pk_bf16_f32 v220, v218, v219
v_mfma_f32_16x16x32_bf16 a[176:179], v[84:87], v[48:51], a[176:179]
ds_read_b64_tr_b16 v[156:157], v22 offset:4864
v_lshlrev_b32 v218, 16, v220
v_and_b32 v219, 0xffff0000, v220
v_mfma_f32_16x16x32_bf16 a[180:183], v[84:87], v[52:55], a[180:183]
v_add_f32 v216, v216, v218
v_mfma_f32_16x16x32_bf16 a[184:187], v[84:87], v[56:59], a[184:187]
ds_read_b64_tr_b16 v[158:159], v22 offset:5888
v_add_f32 v217, v217, v219
v_mfma_f32_16x16x32_bf16 a[188:191], v[84:87], v[60:63], a[188:191]
s_sub_u32 s64, s23, 163840
s_cselect_b32 s64, s23, s64
v_cvt_pk_bf16_f32 v220, v216, v217
v_mfma_f32_16x16x32_bf16 a[192:195], v[88:91], v[32:35], a[192:195]
v_lshlrev_b32 v216, 16, v220
v_and_b32 v217, 0xffff0000, v220
v_mfma_f32_16x16x32_bf16 a[196:199], v[88:91], v[36:39], a[196:199]
s_add_u32 s23, s65, 65536
v_mul_f32 v218, v211, v196
v_mfma_f32_16x16x32_bf16 a[200:203], v[88:91], v[40:43], a[200:203]
v_mul_f32 v219, v212, v196
v_mfma_f32_16x16x32_bf16 a[204:207], v[88:91], v[44:47], a[204:207]
s_sub_u32 s65, s23, 163840
s_cselect_b32 s65, s23, s65
v_cvt_pk_bf16_f32 v220, v218, v219
v_mfma_f32_16x16x32_bf16 a[208:211], v[88:91], v[48:51], a[208:211]
v_lshlrev_b32 v218, 16, v220
v_mfma_f32_16x16x32_bf16 a[212:215], v[88:91], v[52:55], a[212:215]
s_add_u32 s23, s66, 65536
v_and_b32 v219, 0xffff0000, v220
v_add_f32 v216, v216, v218
v_mfma_f32_16x16x32_bf16 a[216:219], v[88:91], v[56:59], a[216:219]
v_add_f32 v217, v217, v219
v_mfma_f32_16x16x32_bf16 a[220:223], v[88:91], v[60:63], a[220:223]
v_cvt_pk_bf16_f32 v220, v216, v217
v_lshlrev_b32 v216, 16, v220
v_mfma_f32_16x16x32_bf16 a[224:227], v[92:95], v[32:35], a[224:227]
v_and_b32 v217, 0xffff0000, v220
v_lshlrev_b32 v218, 16, v179
v_mfma_f32_16x16x32_bf16 a[228:231], v[92:95], v[36:39], a[228:231]
s_sub_u32 s66, s23, 163840
s_cselect_b32 s66, s23, s66
v_mfma_f32_16x16x32_bf16 a[232:235], v[92:95], v[40:43], a[232:235]
v_lshlrev_b32 v219, 16, v180
v_mul_f32 v216, v216, v218
v_mfma_f32_16x16x32_bf16 a[236:239], v[92:95], v[44:47], a[236:239]
v_add_u32 v19, s65, v236
v_mul_f32 v217, v217, v219
v_mfma_f32_16x16x32_bf16 a[240:243], v[92:95], v[48:51], a[240:243]
v_cvt_pk_bf16_f32 v225, v217, v216
v_mul_f32 v216, v210, v199
v_mfma_f32_16x16x32_bf16 a[244:247], v[92:95], v[52:55], a[244:247]
v_add_u32 v21, s64, v238
v_mul_f32 v217, v211, v199
v_mfma_f32_16x16x32_bf16 a[248:251], v[92:95], v[56:59], a[248:251]
v_cvt_pk_bf16_f32 v220, v216, v217
v_mfma_f32_16x16x32_bf16 a[252:255], v[92:95], v[60:63], a[252:255]
v_lshlrev_b32 v216, 16, v220
v_and_b32 v217, 0xffff0000, v220
s_waitcnt lgkmcnt(0)
s_waitcnt vmcnt(16)
s_barrier
v_mfma_f32_16x16x32_bf16 a[0:3], v[128:131], v[96:99], a[0:3]
ds_read_b128 v[32:35], v19 offset:0
v_mul_f32 v218, v211, v198
v_mfma_f32_16x16x32_bf16 a[4:7], v[128:131], v[100:103], a[4:7]
s_add_u32 m0, s67, s70
v_mul_f32 v219, v212, v198
v_mfma_f32_16x16x32_bf16 a[8:11], v[128:131], v[104:107], a[8:11]
ds_read_b64_tr_b16 v[64:65], v21 offset:0
v_cvt_pk_bf16_f32 v220, v218, v219
v_mfma_f32_16x16x32_bf16 a[12:15], v[128:131], v[108:111], a[12:15]
s_add_u32 s22, s67, 16384
v_lshlrev_b32 v218, 16, v220
v_mfma_f32_16x16x32_bf16 a[16:19], v[128:131], v[112:115], a[16:19]
ds_read_b64_tr_b16 v[66:67], v21 offset:1024
v_and_b32 v219, 0xffff0000, v220
v_mfma_f32_16x16x32_bf16 a[20:23], v[128:131], v[116:119], a[20:23]
v_add_f32 v216, v216, v218
v_add_f32 v217, v217, v219
v_mfma_f32_16x16x32_bf16 a[24:27], v[128:131], v[120:123], a[24:27]
ds_read_b128 v[36:39], v19 offset:2048
v_cvt_pk_bf16_f32 v220, v216, v217
v_mfma_f32_16x16x32_bf16 a[28:31], v[128:131], v[124:127], a[28:31]
s_sub_u32 s67, s22, 163840
s_cselect_b32 s67, s22, s67
v_mfma_f32_16x16x32_bf16 a[32:35], v[132:135], v[96:99], a[32:35]
ds_read_b64_tr_b16 v[68:69], v21 offset:256
v_lshlrev_b32 v216, 16, v220
v_mfma_f32_16x16x32_bf16 a[36:39], v[132:135], v[100:103], a[36:39]
buffer_load_dwordx4 v232, s[32:35], s69 offen lds
v_mfma_f32_16x16x32_bf16 a[40:43], v[132:135], v[104:107], a[40:43]
ds_read_b64_tr_b16 v[70:71], v21 offset:1280
v_and_b32 v217, 0xffff0000, v220
v_mfma_f32_16x16x32_bf16 a[44:47], v[132:135], v[108:111], a[44:47]
v_mul_f32 v218, v212, v197
v_mul_f32 v219, v213, v197
v_mfma_f32_16x16x32_bf16 a[48:51], v[132:135], v[112:115], a[48:51]
ds_read_b128 v[40:43], v19 offset:4096
v_cvt_pk_bf16_f32 v220, v218, v219
v_mfma_f32_16x16x32_bf16 a[52:55], v[132:135], v[116:119], a[52:55]
buffer_load_dwordx4 v233, s[32:35], s69 offen offset:1024 lds
v_mfma_f32_16x16x32_bf16 a[56:59], v[132:135], v[120:123], a[56:59]
ds_read_b64_tr_b16 v[72:73], v21 offset:512
v_lshlrev_b32 v218, 16, v220
v_mfma_f32_16x16x32_bf16 a[60:63], v[132:135], v[124:127], a[60:63]
v_and_b32 v219, 0xffff0000, v220
v_add_f32 v216, v216, v218
v_mfma_f32_16x16x32_bf16 a[64:67], v[136:139], v[96:99], a[64:67]
ds_read_b64_tr_b16 v[74:75], v21 offset:1536
v_add_f32 v217, v217, v219
v_mfma_f32_16x16x32_bf16 a[68:71], v[136:139], v[100:103], a[68:71]
buffer_load_dwordx4 v234, s[32:35], s69 offen offset:2048 lds
v_mfma_f32_16x16x32_bf16 a[72:75], v[136:139], v[104:107], a[72:75]
ds_read_b128 v[44:47], v19 offset:6144
v_cvt_pk_bf16_f32 v220, v216, v217
v_mfma_f32_16x16x32_bf16 a[76:79], v[136:139], v[108:111], a[76:79]
buffer_load_dwordx4 v235, s[32:35], s69 offen offset:3072 lds
v_mfma_f32_16x16x32_bf16 a[80:83], v[136:139], v[112:115], a[80:83]
ds_read_b64_tr_b16 v[76:77], v21 offset:768
v_lshlrev_b32 v216, 16, v220
v_mfma_f32_16x16x32_bf16 a[84:87], v[136:139], v[116:119], a[84:87]
v_and_b32 v217, 0xffff0000, v220
v_mul_f32 v218, v213, v196
v_mfma_f32_16x16x32_bf16 a[88:91], v[136:139], v[120:123], a[88:91]
ds_read_b64_tr_b16 v[78:79], v21 offset:1792
v_mul_f32 v219, v214, v196
v_mfma_f32_16x16x32_bf16 a[92:95], v[136:139], v[124:127], a[92:95]
s_add_u32 s69, s69, 262144
v_cvt_pk_bf16_f32 v220, v218, v219
v_mfma_f32_16x16x32_bf16 a[96:99], v[140:143], v[96:99], a[96:99]
ds_read_b128 v[48:51], v19 offset:8192
v_lshlrev_b32 v218, 16, v220
v_mfma_f32_16x16x32_bf16 a[100:103], v[140:143], v[100:103], a[100:103]
s_and_b32 s69, s69, 0x7fffff
v_and_b32 v219, 0xffff0000, v220
v_mfma_f32_16x16x32_bf16 a[104:107], v[140:143], v[104:107], a[104:107]
ds_read_b64_tr_b16 v[80:81], v21 offset:4096
v_add_f32 v216, v216, v218
v_mfma_f32_16x16x32_bf16 a[108:111], v[140:143], v[108:111], a[108:111]
v_add_f32 v217, v217, v219
v_cvt_pk_bf16_f32 v220, v216, v217
v_mfma_f32_16x16x32_bf16 a[112:115], v[140:143], v[112:115], a[112:115]
ds_read_b64_tr_b16 v[82:83], v21 offset:5120
v_lshlrev_b32 v216, 16, v220
v_mfma_f32_16x16x32_bf16 a[116:119], v[140:143], v[116:119], a[116:119]
s_add_u32 m0, s67, s70
v_and_b32 v217, 0xffff0000, v220
v_mfma_f32_16x16x32_bf16 a[120:123], v[140:143], v[120:123], a[120:123]
ds_read_b128 v[52:55], v19 offset:10240
v_lshlrev_b32 v218, 16, v181
v_mfma_f32_16x16x32_bf16 a[124:127], v[140:143], v[124:127], a[124:127]
v_lshlrev_b32 v219, 16, v182
v_mul_f32 v216, v216, v218
v_mfma_f32_16x16x32_bf16 a[128:131], v[144:147], v[96:99], a[128:131]
ds_read_b64_tr_b16 v[84:85], v21 offset:4352
v_mul_f32 v217, v217, v219
v_mfma_f32_16x16x32_bf16 a[132:135], v[144:147], v[100:103], a[132:135]
s_add_u32 s22, s67, 16384
v_cvt_pk_bf16_f32 v224, v217, v216
v_mfma_f32_16x16x32_bf16 a[136:139], v[144:147], v[104:107], a[136:139]
ds_read_b64_tr_b16 v[86:87], v21 offset:5376
v_mfma_f32_16x16x32_bf16 a[140:143], v[144:147], v[108:111], a[140:143]
s_sub_u32 s67, s22, 163840
s_cselect_b32 s67, s22, s67
v_mfma_f32_16x16x32_bf16 a[144:147], v[144:147], v[112:115], a[144:147]
ds_read_b128 v[56:59], v19 offset:12288
v_mfma_f32_16x16x32_bf16 a[148:151], v[144:147], v[116:119], a[148:151]
s_mov_b32 s81, 104857600
buffer_store_dwordx4 v[224:227], v162, s[60:63], s81 offen sc1
v_mfma_f32_16x16x32_bf16 a[152:155], v[144:147], v[120:123], a[152:155]
ds_read_b64_tr_b16 v[88:89], v21 offset:4608
v_and_b32 v204, 0xffff0000, v164
v_mfma_f32_16x16x32_bf16 a[156:159], v[144:147], v[124:127], a[156:159]
buffer_load_dwordx4 v232, s[32:35], s69 offen lds
v_mfma_f32_16x16x32_bf16 a[160:163], v[148:151], v[96:99], a[160:163]
ds_read_b64_tr_b16 v[90:91], v21 offset:5632
v_and_b32 v205, 0xffff0000, v165
v_mfma_f32_16x16x32_bf16 a[164:167], v[148:151], v[100:103], a[164:167]
buffer_load_dwordx4 v233, s[32:35], s69 offen offset:1024 lds
v_mfma_f32_16x16x32_bf16 a[168:171], v[148:151], v[104:107], a[168:171]
ds_read_b128 v[60:63], v19 offset:14336
v_and_b32 v206, 0xffff0000, v166
v_mfma_f32_16x16x32_bf16 a[172:175], v[148:151], v[108:111], a[172:175]
v_and_b32 v207, 0xffff0000, v167
v_and_b32 v208, 0xffff0000, v168
v_mfma_f32_16x16x32_bf16 a[176:179], v[148:151], v[112:115], a[176:179]
ds_read_b64_tr_b16 v[92:93], v21 offset:4864
v_and_b32 v209, 0xffff0000, v169
v_mfma_f32_16x16x32_bf16 a[180:183], v[148:151], v[116:119], a[180:183]
buffer_load_dwordx4 v234, s[32:35], s69 offen offset:2048 lds
v_mfma_f32_16x16x32_bf16 a[184:187], v[148:151], v[120:123], a[184:187]
ds_read_b64_tr_b16 v[94:95], v21 offset:5888
v_and_b32 v210, 0xffff0000, v170
v_mfma_f32_16x16x32_bf16 a[188:191], v[148:151], v[124:127], a[188:191]
v_and_b32 v211, 0xffff0000, v171
v_and_b32 v212, 0xffff0000, v172
v_mfma_f32_16x16x32_bf16 a[192:195], v[152:155], v[96:99], a[192:195]
v_and_b32 v213, 0xffff0000, v173
v_and_b32 v214, 0xffff0000, v174
v_mfma_f32_16x16x32_bf16 a[196:199], v[152:155], v[100:103], a[196:199]
buffer_load_dwordx4 v235, s[32:35], s69 offen offset:3072 lds
v_mfma_f32_16x16x32_bf16 a[200:203], v[152:155], v[104:107], a[200:203]
v_mul_f32 v216, v204, v203
v_mul_f32 v217, v205, v203
v_mfma_f32_16x16x32_bf16 a[204:207], v[152:155], v[108:111], a[204:207]
s_add_u32 s69, s69, 262144
v_cvt_pk_bf16_f32 v220, v216, v217
v_mfma_f32_16x16x32_bf16 a[208:211], v[152:155], v[112:115], a[208:211]
v_lshlrev_b32 v216, 16, v220
v_and_b32 v217, 0xffff0000, v220
v_mfma_f32_16x16x32_bf16 a[212:215], v[152:155], v[116:119], a[212:215]
v_mul_f32 v218, v205, v202
v_mul_f32 v219, v206, v202
v_mfma_f32_16x16x32_bf16 a[216:219], v[152:155], v[120:123], a[216:219]
v_cvt_pk_bf16_f32 v220, v218, v219
v_lshlrev_b32 v218, 16, v220
v_mfma_f32_16x16x32_bf16 a[220:223], v[152:155], v[124:127], a[220:223]
s_and_b32 s69, s69, 0x7fffff
v_and_b32 v219, 0xffff0000, v220
v_mfma_f32_16x16x32_bf16 a[224:227], v[156:159], v[96:99], a[224:227]
v_add_f32 v216, v216, v218
v_add_f32 v217, v217, v219
v_mfma_f32_16x16x32_bf16 a[228:231], v[156:159], v[100:103], a[228:231]
v_add_u32 v20, s65, v237
v_cvt_pk_bf16_f32 v220, v216, v217
v_mfma_f32_16x16x32_bf16 a[232:235], v[156:159], v[104:107], a[232:235]
v_lshlrev_b32 v216, 16, v220
v_and_b32 v217, 0xffff0000, v220
v_mfma_f32_16x16x32_bf16 a[236:239], v[156:159], v[108:111], a[236:239]
v_mul_f32 v218, v206, v201
v_mul_f32 v219, v207, v201
v_mfma_f32_16x16x32_bf16 a[240:243], v[156:159], v[112:115], a[240:243]
v_cvt_pk_bf16_f32 v220, v218, v219
v_lshlrev_b32 v218, 16, v220
v_mfma_f32_16x16x32_bf16 a[244:247], v[156:159], v[116:119], a[244:247]
v_add_u32 v22, s66, v238
v_and_b32 v219, 0xffff0000, v220
v_mfma_f32_16x16x32_bf16 a[248:251], v[156:159], v[120:123], a[248:251]
v_add_f32 v216, v216, v218
v_add_f32 v217, v217, v219
v_mfma_f32_16x16x32_bf16 a[252:255], v[156:159], v[124:127], a[252:255]
v_cvt_pk_bf16_f32 v220, v216, v217
v_lshlrev_b32 v216, 16, v220
v_and_b32 v217, 0xffff0000, v220
s_waitcnt lgkmcnt(0)
s_waitcnt vmcnt(20)
s_barrier
v_mfma_f32_16x16x32_bf16 a[0:3], v[64:67], v[32:35], a[0:3]
ds_read_b128 v[96:99], v20 offset:0
v_mul_f32 v218, v207, v200
v_mfma_f32_16x16x32_bf16 a[4:7], v[64:67], v[36:39], a[4:7]
s_add_u32 m0, s67, s70
v_mul_f32 v219, v208, v200
v_mfma_f32_16x16x32_bf16 a[8:11], v[64:67], v[40:43], a[8:11]
ds_read_b64_tr_b16 v[128:129], v22 offset:0
v_cvt_pk_bf16_f32 v220, v218, v219
v_mfma_f32_16x16x32_bf16 a[12:15], v[64:67], v[44:47], a[12:15]
s_add_u32 s22, s67, 16384
v_lshlrev_b32 v218, 16, v220
v_and_b32 v219, 0xffff0000, v220
v_mfma_f32_16x16x32_bf16 a[16:19], v[64:67], v[48:51], a[16:19]
ds_read_b64_tr_b16 v[130:131], v22 offset:1024
v_add_f32 v216, v216, v218
v_mfma_f32_16x16x32_bf16 a[20:23], v[64:67], v[52:55], a[20:23]
s_sub_u32 s67, s22, 163840
s_cselect_b32 s67, s22, s67
v_mfma_f32_16x16x32_bf16 a[24:27], v[64:67], v[56:59], a[24:27]
ds_read_b128 v[100:103], v20 offset:2048
v_add_f32 v217, v217, v219
v_mfma_f32_16x16x32_bf16 a[28:31], v[64:67], v[60:63], a[28:31]
buffer_load_dwordx4 v1, s[28:31], s68 offen lds
v_cvt_pk_bf16_f32 v220, v216, v217
v_mfma_f32_16x16x32_bf16 a[32:35], v[68:71], v[32:35], a[32:35]
ds_read_b64_tr_b16 v[132:133], v22 offset:256
v_lshlrev_b32 v216, 16, v220
v_mfma_f32_16x16x32_bf16 a[36:39], v[68:71], v[36:39], a[36:39]
v_and_b32 v217, 0xffff0000, v220
v_and_b32 v218, 0xffff0000, v175
v_mfma_f32_16x16x32_bf16 a[40:43], v[68:71], v[40:43], a[40:43]
ds_read_b64_tr_b16 v[134:135], v22 offset:1280
v_and_b32 v219, 0xffff0000, v176
v_mfma_f32_16x16x32_bf16 a[44:47], v[68:71], v[44:47], a[44:47]
buffer_load_dwordx4 v2, s[28:31], s68 offen offset:1024 lds
v_mul_f32 v216, v216, v218
v_mfma_f32_16x16x32_bf16 a[48:51], v[68:71], v[48:51], a[48:51]
ds_read_b128 v[104:107], v20 offset:4096
v_mul_f32 v217, v217, v219
v_mfma_f32_16x16x32_bf16 a[52:55], v[68:71], v[52:55], a[52:55]
buffer_load_dwordx4 v3, s[28:31], s68 offen offset:2048 lds
v_mfma_f32_16x16x32_bf16 a[56:59], v[68:71], v[56:59], a[56:59]
ds_read_b64_tr_b16 v[136:137], v22 offset:512
v_cvt_pk_bf16_f32 v231, v217, v216
v_mfma_f32_16x16x32_bf16 a[60:63], v[68:71], v[60:63], a[60:63]
buffer_load_dwordx4 v4, s[28:31], s68 offen offset:3072 lds
v_mul_f32 v216, v206, v203
v_mfma_f32_16x16x32_bf16 a[64:67], v[72:75], v[32:35], a[64:67]
ds_read_b64_tr_b16 v[138:139], v22 offset:1536
v_mul_f32 v217, v207, v203
v_mfma_f32_16x16x32_bf16 a[68:71], v[72:75], v[36:39], a[68:71]
s_add_u32 s68, s68, 262144
v_cvt_pk_bf16_f32 v220, v216, v217
v_mfma_f32_16x16x32_bf16 a[72:75], v[72:75], v[40:43], a[72:75]
ds_read_b128 v[108:111], v20 offset:6144
v_lshlrev_b32 v216, 16, v220
v_mfma_f32_16x16x32_bf16 a[76:79], v[72:75], v[44:47], a[76:79]
v_and_b32 v217, 0xffff0000, v220
v_mul_f32 v218, v207, v202
v_mfma_f32_16x16x32_bf16 a[80:83], v[72:75], v[48:51], a[80:83]
ds_read_b64_tr_b16 v[140:141], v22 offset:768
v_mul_f32 v219, v208, v202
v_mfma_f32_16x16x32_bf16 a[84:87], v[72:75], v[52:55], a[84:87]
s_add_u32 m0, s67, s70
v_cvt_pk_bf16_f32 v220, v218, v219
v_mfma_f32_16x16x32_bf16 a[88:91], v[72:75], v[56:59], a[88:91]
ds_read_b64_tr_b16 v[142:143], v22 offset:1792
v_lshlrev_b32 v218, 16, v220
v_mfma_f32_16x16x32_bf16 a[92:95], v[72:75], v[60:63], a[92:95]
s_add_u32 s22, s67, 16384
v_and_b32 v219, 0xffff0000, v220
v_add_f32 v216, v216, v218
v_mfma_f32_16x16x32_bf16 a[96:99], v[76:79], v[32:35], a[96:99]
ds_read_b128 v[112:115], v20 offset:8192
v_add_f32 v217, v217, v219
v_mfma_f32_16x16x32_bf16 a[100:103], v[76:79], v[36:39], a[100:103]
s_sub_u32 s67, s22, 163840
s_cselect_b32 s67, s22, s67
v_mfma_f32_16x16x32_bf16 a[104:107], v[76:79], v[40:43], a[104:107]
ds_read_b64_tr_b16 v[144:145], v22 offset:4096
v_cvt_pk_bf16_f32 v220, v216, v217
v_mfma_f32_16x16x32_bf16 a[108:111], v[76:79], v[44:47], a[108:111]
v_lshlrev_b32 v216, 16, v220
v_and_b32 v217, 0xffff0000, v220
v_mfma_f32_16x16x32_bf16 a[112:115], v[76:79], v[48:51], a[112:115]
ds_read_b64_tr_b16 v[146:147], v22 offset:5120
v_mul_f32 v218, v208, v201
v_mfma_f32_16x16x32_bf16 a[116:119], v[76:79], v[52:55], a[116:119]
buffer_load_dwordx4 v1, s[28:31], s68 offen lds
v_mul_f32 v219, v209, v201
v_mfma_f32_16x16x32_bf16 a[120:123], v[76:79], v[56:59], a[120:123]
ds_read_b128 v[116:119], v20 offset:10240
v_cvt_pk_bf16_f32 v220, v218, v219
v_mfma_f32_16x16x32_bf16 a[124:127], v[76:79], v[60:63], a[124:127]
buffer_load_dwordx4 v2, s[28:31], s68 offen offset:1024 lds
v_lshlrev_b32 v218, 16, v220
v_mfma_f32_16x16x32_bf16 a[128:131], v[80:83], v[32:35], a[128:131]
ds_read_b64_tr_b16 v[148:149], v22 offset:4352
v_and_b32 v219, 0xffff0000, v220
v_mfma_f32_16x16x32_bf16 a[132:135], v[80:83], v[36:39], a[132:135]
buffer_load_dwordx4 v3, s[28:31], s68 offen offset:2048 lds
v_mfma_f32_16x16x32_bf16 a[136:139], v[80:83], v[40:43], a[136:139]
ds_read_b64_tr_b16 v[150:151], v22 offset:5376
v_add_f32 v216, v216, v218
v_mfma_f32_16x16x32_bf16 a[140:143], v[80:83], v[44:47], a[140:143]
buffer_load_dwordx4 v4, s[28:31], s68 offen offset:3072 lds
v_add_f32 v217, v217, v219
v_mfma_f32_16x16x32_bf16 a[144:147], v[80:83], v[48:51], a[144:147]
ds_read_b128 v[120:123], v20 offset:12288
v_cvt_pk_bf16_f32 v220, v216, v217
v_mfma_f32_16x16x32_bf16 a[148:151], v[80:83], v[52:55], a[148:151]
v_lshlrev_b32 v216, 16, v220
v_and_b32 v217, 0xffff0000, v220
v_mfma_f32_16x16x32_bf16 a[152:155], v[80:83], v[56:59], a[152:155]
ds_read_b64_tr_b16 v[152:153], v22 offset:4608
v_mul_f32 v218, v209, v200
v_mfma_f32_16x16x32_bf16 a[156:159], v[80:83], v[60:63], a[156:159]
s_sub_u32 s68, s68, 262016
v_mul_f32 v219, v210, v200
v_mfma_f32_16x16x32_bf16 a[160:163], v[84:87], v[32:35], a[160:163]
ds_read_b64_tr_b16 v[154:155], v22 offset:5632
v_cvt_pk_bf16_f32 v220, v218, v219
v_mfma_f32_16x16x32_bf16 a[164:167], v[84:87], v[36:39], a[164:167]
s_bitset0_b32 s68, 11
v_lshlrev_b32 v218, 16, v220
v_mfma_f32_16x16x32_bf16 a[168:171], v[84:87], v[40:43], a[168:171]
ds_read_b128 v[124:127], v20 offset:14336
v_and_b32 v219, 0xffff0000, v220
v_add_f32 v216, v216, v218
v_mfma_f32_16x16x32_bf16 a[172:175], v[84:87], v[44:47], a[172:175]
s_add_u32 s23, s64, 65536
v_add_f32 v217, v217, v219
v_mfma_f32_16x16x32_bf16 a[176:179], v[84:87], v[48:51], a[176:179]
ds_read_b64_tr_b16 v[156:157], v22 offset:4864
v_cvt_pk_bf16_f32 v220, v216, v217
v_mfma_f32_16x16x32_bf16 a[180:183], v[84:87], v[52:55], a[180:183]
v_lshlrev_b32 v216, 16, v220
v_and_b32 v217, 0xffff0000, v220
v_mfma_f32_16x16x32_bf16 a[184:187], v[84:87], v[56:59], a[184:187]
ds_read_b64_tr_b16 v[158:159], v22 offset:5888
v_and_b32 v218, 0xffff0000, v177
v_mfma_f32_16x16x32_bf16 a[188:191], v[84:87], v[60:63], a[188:191]
s_sub_u32 s64, s23, 163840
s_cselect_b32 s64, s23, s64
v_mfma_f32_16x16x32_bf16 a[192:195], v[88:91], v[32:35], a[192:195]
v_and_b32 v219, 0xffff0000, v178
v_mul_f32 v216, v216, v218
v_mfma_f32_16x16x32_bf16 a[196:199], v[88:91], v[36:39], a[196:199]
s_add_u32 s23, s65, 65536
v_mul_f32 v217, v217, v219
v_mfma_f32_16x16x32_bf16 a[200:203], v[88:91], v[40:43], a[200:203]
v_cvt_pk_bf16_f32 v230, v217, v216
v_mul_f32 v216, v208, v203
v_mfma_f32_16x16x32_bf16 a[204:207], v[88:91], v[44:47], a[204:207]
s_sub_u32 s65, s23, 163840
s_cselect_b32 s65, s23, s65
v_mfma_f32_16x16x32_bf16 a[208:211], v[88:91], v[48:51], a[208:211]
v_mul_f32 v217, v209, v203
v_cvt_pk_bf16_f32 v220, v216, v217
v_mfma_f32_16x16x32_bf16 a[212:215], v[88:91], v[52:55], a[212:215]
s_add_u32 s23, s66, 65536
v_lshlrev_b32 v216, 16, v220
v_mfma_f32_16x16x32_bf16 a[216:219], v[88:91], v[56:59], a[216:219]
v_and_b32 v217, 0xffff0000, v220
v_mul_f32 v218, v209, v202
v_mfma_f32_16x16x32_bf16 a[220:223], v[88:91], v[60:63], a[220:223]
v_mul_f32 v219, v210, v202
v_cvt_pk_bf16_f32 v220, v218, v219
v_mfma_f32_16x16x32_bf16 a[224:227], v[92:95], v[32:35], a[224:227]
v_lshlrev_b32 v218, 16, v220
v_mfma_f32_16x16x32_bf16 a[228:231], v[92:95], v[36:39], a[228:231]
s_sub_u32 s66, s23, 163840
s_cselect_b32 s66, s23, s66
v_and_b32 v219, 0xffff0000, v220
v_mfma_f32_16x16x32_bf16 a[232:235], v[92:95], v[40:43], a[232:235]
v_add_f32 v216, v216, v218
v_add_f32 v217, v217, v219
v_mfma_f32_16x16x32_bf16 a[236:239], v[92:95], v[44:47], a[236:239]
v_add_u32 v19, s65, v236
v_cvt_pk_bf16_f32 v220, v216, v217
v_mfma_f32_16x16x32_bf16 a[240:243], v[92:95], v[48:51], a[240:243]
v_lshlrev_b32 v216, 16, v220
v_mfma_f32_16x16x32_bf16 a[244:247], v[92:95], v[52:55], a[244:247]
v_add_u32 v21, s64, v238
v_and_b32 v217, 0xffff0000, v220
v_mul_f32 v218, v210, v201
v_mfma_f32_16x16x32_bf16 a[248:251], v[92:95], v[56:59], a[248:251]
v_mul_f32 v219, v211, v201
v_mfma_f32_16x16x32_bf16 a[252:255], v[92:95], v[60:63], a[252:255]
v_cvt_pk_bf16_f32 v220, v218, v219
v_lshlrev_b32 v218, 16, v220
s_waitcnt lgkmcnt(0)
s_waitcnt vmcnt(16)
s_barrier
v_mfma_f32_16x16x32_bf16 a[0:3], v[128:131], v[96:99], a[0:3]
ds_read_b128 v[32:35], v19 offset:0
v_and_b32 v219, 0xffff0000, v220
v_mfma_f32_16x16x32_bf16 a[4:7], v[128:131], v[100:103], a[4:7]
s_add_u32 m0, s67, s70
v_add_f32 v216, v216, v218
v_mfma_f32_16x16x32_bf16 a[8:11], v[128:131], v[104:107], a[8:11]
ds_read_b64_tr_b16 v[64:65], v21 offset:0
v_add_f32 v217, v217, v219
v_mfma_f32_16x16x32_bf16 a[12:15], v[128:131], v[108:111], a[12:15]
s_add_u32 s22, s67, 16384
v_cvt_pk_bf16_f32 v220, v216, v217
v_lshlrev_b32 v216, 16, v220
v_mfma_f32_16x16x32_bf16 a[16:19], v[128:131], v[112:115], a[16:19]
ds_read_b64_tr_b16 v[66:67], v21 offset:1024
v_and_b32 v217, 0xffff0000, v220
v_mfma_f32_16x16x32_bf16 a[20:23], v[128:131], v[116:119], a[20:23]
v_mul_f32 v218, v211, v200
v_mul_f32 v219, v212, v200
v_mfma_f32_16x16x32_bf16 a[24:27], v[128:131], v[120:123], a[24:27]
ds_read_b128 v[36:39], v19 offset:2048
v_cvt_pk_bf16_f32 v220, v218, v219
v_mfma_f32_16x16x32_bf16 a[28:31], v[128:131], v[124:127], a[28:31]
s_sub_u32 s67, s22, 163840
s_cselect_b32 s67, s22, s67
v_mfma_f32_16x16x32_bf16 a[32:35], v[132:135], v[96:99], a[32:35]
ds_read_b64_tr_b16 v[68:69], v21 offset:256
v_lshlrev_b32 v218, 16, v220
v_mfma_f32_16x16x32_bf16 a[36:39], v[132:135], v[100:103], a[36:39]
buffer_load_dwordx4 v232, s[32:35], s69 offen lds
v_and_b32 v219, 0xffff0000, v220
v_mfma_f32_16x16x32_bf16 a[40:43], v[132:135], v[104:107], a[40:43]
ds_read_b64_tr_b16 v[70:71], v21 offset:1280
v_add_f32 v216, v216, v218
v_mfma_f32_16x16x32_bf16 a[44:47], v[132:135], v[108:111], a[44:47]
v_add_f32 v217, v217, v219
v_cvt_pk_bf16_f32 v220, v216, v217
v_mfma_f32_16x16x32_bf16 a[48:51], v[132:135], v[112:115], a[48:51]
ds_read_b128 v[40:43], v19 offset:4096
v_lshlrev_b32 v216, 16, v220
v_mfma_f32_16x16x32_bf16 a[52:55], v[132:135], v[116:119], a[52:55]
buffer_load_dwordx4 v233, s[32:35], s69 offen offset:1024 lds
v_and_b32 v217, 0xffff0000, v220
v_mfma_f32_16x16x32_bf16 a[56:59], v[132:135], v[120:123], a[56:59]
ds_read_b64_tr_b16 v[72:73], v21 offset:512
v_and_b32 v218, 0xffff0000, v179
v_mfma_f32_16x16x32_bf16 a[60:63], v[132:135], v[124:127], a[60:63]
v_and_b32 v219, 0xffff0000, v180
v_mul_f32 v216, v216, v218
v_mfma_f32_16x16x32_bf16 a[64:67], v[136:139], v[96:99], a[64:67]
ds_read_b64_tr_b16 v[74:75], v21 offset:1536
v_mul_f32 v217, v217, v219
v_mfma_f32_16x16x32_bf16 a[68:71], v[136:139], v[100:103], a[68:71]
buffer_load_dwordx4 v234, s[32:35], s69 offen offset:2048 lds
v_mfma_f32_16x16x32_bf16 a[72:75], v[136:139], v[104:107], a[72:75]
ds_read_b128 v[44:47], v19 offset:6144
v_cvt_pk_bf16_f32 v229, v217, v216
v_mfma_f32_16x16x32_bf16 a[76:79], v[136:139], v[108:111], a[76:79]
buffer_load_dwordx4 v235, s[32:35], s69 offen offset:3072 lds
v_mul_f32 v216, v210, v203
v_mfma_f32_16x16x32_bf16 a[80:83], v[136:139], v[112:115], a[80:83]
ds_read_b64_tr_b16 v[76:77], v21 offset:768
v_mul_f32 v217, v211, v203
v_mfma_f32_16x16x32_bf16 a[84:87], v[136:139], v[116:119], a[84:87]
v_cvt_pk_bf16_f32 v220, v216, v217
v_lshlrev_b32 v216, 16, v220
v_mfma_f32_16x16x32_bf16 a[88:91], v[136:139], v[120:123], a[88:91]
ds_read_b64_tr_b16 v[78:79], v21 offset:1792
v_and_b32 v217, 0xffff0000, v220
v_mfma_f32_16x16x32_bf16 a[92:95], v[136:139], v[124:127], a[92:95]
s_add_u32 s69, s69, 262144
v_mul_f32 v218, v211, v202
v_mfma_f32_16x16x32_bf16 a[96:99], v[140:143], v[96:99], a[96:99]
ds_read_b128 v[48:51], v19 offset:8192
v_mul_f32 v219, v212, v202
v_mfma_f32_16x16x32_bf16 a[100:103], v[140:143], v[100:103], a[100:103]
s_and_b32 s69, s69, 0x7fffff
v_cvt_pk_bf16_f32 v220, v218, v219
v_lshlrev_b32 v218, 16, v220
v_mfma_f32_16x16x32_bf16 a[104:107], v[140:143], v[104:107], a[104:107]
ds_read_b64_tr_b16 v[80:81], v21 offset:4096
v_and_b32 v219, 0xffff0000, v220
v_mfma_f32_16x16x32_bf16 a[108:111], v[140:143], v[108:111], a[108:111]
v_add_f32 v216, v216, v218
v_mfma_f32_16x16x32_bf16 a[112:115], v[140:143], v[112:115], a[112:115]
ds_read_b64_tr_b16 v[82:83], v21 offset:5120
v_add_f32 v217, v217, v219
v_cvt_pk_bf16_f32 v220, v216, v217
v_mfma_f32_16x16x32_bf16 a[116:119], v[140:143], v[116:119], a[116:119]
s_add_u32 m0, s67, s70
v_lshlrev_b32 v216, 16, v220
v_mfma_f32_16x16x32_bf16 a[120:123], v[140:143], v[120:123], a[120:123]
ds_read_b128 v[52:55], v19 offset:10240
v_and_b32 v217, 0xffff0000, v220
v_mfma_f32_16x16x32_bf16 a[124:127], v[140:143], v[124:127], a[124:127]
v_mul_f32 v218, v212, v201
v_mul_f32 v219, v213, v201
v_mfma_f32_16x16x32_bf16 a[128:131], v[144:147], v[96:99], a[128:131]
ds_read_b64_tr_b16 v[84:85], v21 offset:4352
v_cvt_pk_bf16_f32 v220, v218, v219
v_mfma_f32_16x16x32_bf16 a[132:135], v[144:147], v[100:103], a[132:135]
s_add_u32 s22, s67, 16384
v_lshlrev_b32 v218, 16, v220
v_mfma_f32_16x16x32_bf16 a[136:139], v[144:147], v[104:107], a[136:139]
ds_read_b64_tr_b16 v[86:87], v21 offset:5376
v_and_b32 v219, 0xffff0000, v220
v_mfma_f32_16x16x32_bf16 a[140:143], v[144:147], v[108:111], a[140:143]
s_sub_u32 s67, s22, 163840
s_cselect_b32 s67, s22, s67
v_add_f32 v216, v216, v218
v_mfma_f32_16x16x32_bf16 a[144:147], v[144:147], v[112:115], a[144:147]
ds_read_b128 v[56:59], v19 offset:12288
v_add_f32 v217, v217, v219
v_mfma_f32_16x16x32_bf16 a[148:151], v[144:147], v[116:119], a[148:151]
v_cvt_pk_bf16_f32 v220, v216, v217
v_lshlrev_b32 v216, 16, v220
v_mfma_f32_16x16x32_bf16 a[152:155], v[144:147], v[120:123], a[152:155]
ds_read_b64_tr_b16 v[88:89], v21 offset:4608
v_and_b32 v217, 0xffff0000, v220
v_mfma_f32_16x16x32_bf16 a[156:159], v[144:147], v[124:127], a[156:159]
buffer_load_dwordx4 v232, s[32:35], s69 offen lds
v_mfma_f32_16x16x32_bf16 a[160:163], v[148:151], v[96:99], a[160:163]
ds_read_b64_tr_b16 v[90:91], v21 offset:5632
v_mul_f32 v218, v213, v200
v_mul_f32 v219, v214, v200
v_mfma_f32_16x16x32_bf16 a[164:167], v[148:151], v[100:103], a[164:167]
buffer_load_dwordx4 v233, s[32:35], s69 offen offset:1024 lds
v_mfma_f32_16x16x32_bf16 a[168:171], v[148:151], v[104:107], a[168:171]
ds_read_b128 v[60:63], v19 offset:14336
v_cvt_pk_bf16_f32 v220, v218, v219
v_mfma_f32_16x16x32_bf16 a[172:175], v[148:151], v[108:111], a[172:175]
v_lshlrev_b32 v218, 16, v220
v_and_b32 v219, 0xffff0000, v220
v_mfma_f32_16x16x32_bf16 a[176:179], v[148:151], v[112:115], a[176:179]
ds_read_b64_tr_b16 v[92:93], v21 offset:4864
v_add_f32 v216, v216, v218
v_mfma_f32_16x16x32_bf16 a[180:183], v[148:151], v[116:119], a[180:183]
buffer_load_dwordx4 v234, s[32:35], s69 offen offset:2048 lds
v_add_f32 v217, v217, v219
v_mfma_f32_16x16x32_bf16 a[184:187], v[148:151], v[120:123], a[184:187]
ds_read_b64_tr_b16 v[94:95], v21 offset:5888
v_cvt_pk_bf16_f32 v220, v216, v217
v_mfma_f32_16x16x32_bf16 a[188:191], v[148:151], v[124:127], a[188:191]
v_lshlrev_b32 v216, 16, v220
v_and_b32 v217, 0xffff0000, v220
v_mfma_f32_16x16x32_bf16 a[192:195], v[152:155], v[96:99], a[192:195]
v_and_b32 v218, 0xffff0000, v181
v_mfma_f32_16x16x32_bf16 a[196:199], v[152:155], v[100:103], a[196:199]
buffer_load_dwordx4 v235, s[32:35], s69 offen offset:3072 lds
v_and_b32 v219, 0xffff0000, v182
v_mfma_f32_16x16x32_bf16 a[200:203], v[152:155], v[104:107], a[200:203]
v_mul_f32 v216, v216, v218
v_mul_f32 v217, v217, v219
v_mfma_f32_16x16x32_bf16 a[204:207], v[152:155], v[108:111], a[204:207]
s_add_u32 s69, s69, 262144
v_cvt_pk_bf16_f32 v228, v217, v216
v_mfma_f32_16x16x32_bf16 a[208:211], v[152:155], v[112:115], a[208:211]
s_mov_b32 s81, 104861696
buffer_store_dwordx4 v[228:231], v162, s[60:63], s81 offen sc1
v_mfma_f32_16x16x32_bf16 a[212:215], v[152:155], v[116:119], a[212:215]
v_mfma_f32_16x16x32_bf16 a[216:219], v[152:155], v[120:123], a[216:219]
s_mov_b32 s82, 0x05040100
s_mov_b32 s83, 0x07060302
v_mfma_f32_16x16x32_bf16 a[220:223], v[152:155], v[124:127], a[220:223]
s_and_b32 s69, s69, 0x7fffff
v_perm_b32 v207, v183, v184, s82
v_mfma_f32_16x16x32_bf16 a[224:227], v[156:159], v[96:99], a[224:227]
v_perm_b32 v206, v185, v186, s82
v_perm_b32 v205, v187, v188, s82
v_mfma_f32_16x16x32_bf16 a[228:231], v[156:159], v[100:103], a[228:231]
v_add_u32 v20, s65, v237
v_perm_b32 v204, v189, v190, s82
v_mfma_f32_16x16x32_bf16 a[232:235], v[156:159], v[104:107], a[232:235]
s_mov_b32 s81, 109051904
buffer_store_dwordx4 v[204:207], v162, s[60:63], s81 offen sc1
v_mfma_f32_16x16x32_bf16 a[236:239], v[156:159], v[108:111], a[236:239]
v_perm_b32 v211, v183, v184, s83
v_mfma_f32_16x16x32_bf16 a[240:243], v[156:159], v[112:115], a[240:243]
v_perm_b32 v210, v185, v186, s83
v_mfma_f32_16x16x32_bf16 a[244:247], v[156:159], v[116:119], a[244:247]
v_add_u32 v22, s66, v238
v_perm_b32 v209, v187, v188, s83
v_perm_b32 v208, v189, v190, s83
v_mfma_f32_16x16x32_bf16 a[248:251], v[156:159], v[120:123], a[248:251]
s_mov_b32 s81, 109056000
buffer_store_dwordx4 v[208:211], v162, s[60:63], s81 offen sc1
v_mfma_f32_16x16x32_bf16 a[252:255], v[156:159], v[124:127], a[252:255]
F_K_LOOP:
s_waitcnt lgkmcnt(0)
s_waitcnt vmcnt(20)
s_barrier
v_mfma_f32_16x16x32_bf16 a[0:3], v[64:67], v[32:35], a[0:3]
ds_read_b128 v[96:99], v20 offset:0
v_mfma_f32_16x16x32_bf16 a[4:7], v[64:67], v[36:39], a[4:7]
s_add_u32 m0, s67, s70
v_mfma_f32_16x16x32_bf16 a[8:11], v[64:67], v[40:43], a[8:11]
ds_read_b64_tr_b16 v[128:129], v22 offset:0
v_mfma_f32_16x16x32_bf16 a[12:15], v[64:67], v[44:47], a[12:15]
s_add_u32 s22, s67, 16384
v_mfma_f32_16x16x32_bf16 a[16:19], v[64:67], v[48:51], a[16:19]
ds_read_b64_tr_b16 v[130:131], v22 offset:1024
v_mfma_f32_16x16x32_bf16 a[20:23], v[64:67], v[52:55], a[20:23]
s_sub_u32 s67, s22, 163840
s_cselect_b32 s67, s22, s67
v_mfma_f32_16x16x32_bf16 a[24:27], v[64:67], v[56:59], a[24:27]
ds_read_b128 v[100:103], v20 offset:2048
v_mfma_f32_16x16x32_bf16 a[28:31], v[64:67], v[60:63], a[28:31]
buffer_load_dwordx4 v1, s[28:31], s68 offen lds
v_mfma_f32_16x16x32_bf16 a[32:35], v[68:71], v[32:35], a[32:35]
ds_read_b64_tr_b16 v[132:133], v22 offset:256
v_mfma_f32_16x16x32_bf16 a[36:39], v[68:71], v[36:39], a[36:39]
v_mfma_f32_16x16x32_bf16 a[40:43], v[68:71], v[40:43], a[40:43]
ds_read_b64_tr_b16 v[134:135], v22 offset:1280
v_mfma_f32_16x16x32_bf16 a[44:47], v[68:71], v[44:47], a[44:47]
buffer_load_dwordx4 v2, s[28:31], s68 offen offset:1024 lds
v_mfma_f32_16x16x32_bf16 a[48:51], v[68:71], v[48:51], a[48:51]
ds_read_b128 v[104:107], v20 offset:4096
v_mfma_f32_16x16x32_bf16 a[52:55], v[68:71], v[52:55], a[52:55]
buffer_load_dwordx4 v3, s[28:31], s68 offen offset:2048 lds
v_mfma_f32_16x16x32_bf16 a[56:59], v[68:71], v[56:59], a[56:59]
ds_read_b64_tr_b16 v[136:137], v22 offset:512
v_mfma_f32_16x16x32_bf16 a[60:63], v[68:71], v[60:63], a[60:63]
buffer_load_dwordx4 v4, s[28:31], s68 offen offset:3072 lds
v_mfma_f32_16x16x32_bf16 a[64:67], v[72:75], v[32:35], a[64:67]
ds_read_b64_tr_b16 v[138:139], v22 offset:1536
v_mfma_f32_16x16x32_bf16 a[68:71], v[72:75], v[36:39], a[68:71]
s_add_u32 s68, s68, 262144
v_mfma_f32_16x16x32_bf16 a[72:75], v[72:75], v[40:43], a[72:75]
ds_read_b128 v[108:111], v20 offset:6144
v_mfma_f32_16x16x32_bf16 a[76:79], v[72:75], v[44:47], a[76:79]
v_mfma_f32_16x16x32_bf16 a[80:83], v[72:75], v[48:51], a[80:83]
ds_read_b64_tr_b16 v[140:141], v22 offset:768
v_mfma_f32_16x16x32_bf16 a[84:87], v[72:75], v[52:55], a[84:87]
s_add_u32 m0, s67, s70
v_mfma_f32_16x16x32_bf16 a[88:91], v[72:75], v[56:59], a[88:91]
ds_read_b64_tr_b16 v[142:143], v22 offset:1792
v_mfma_f32_16x16x32_bf16 a[92:95], v[72:75], v[60:63], a[92:95]
s_add_u32 s22, s67, 16384
v_mfma_f32_16x16x32_bf16 a[96:99], v[76:79], v[32:35], a[96:99]
ds_read_b128 v[112:115], v20 offset:8192
v_mfma_f32_16x16x32_bf16 a[100:103], v[76:79], v[36:39], a[100:103]
s_sub_u32 s67, s22, 163840
s_cselect_b32 s67, s22, s67
v_mfma_f32_16x16x32_bf16 a[104:107], v[76:79], v[40:43], a[104:107]
ds_read_b64_tr_b16 v[144:145], v22 offset:4096
v_mfma_f32_16x16x32_bf16 a[108:111], v[76:79], v[44:47], a[108:111]
v_mfma_f32_16x16x32_bf16 a[112:115], v[76:79], v[48:51], a[112:115]
ds_read_b64_tr_b16 v[146:147], v22 offset:5120
v_mfma_f32_16x16x32_bf16 a[116:119], v[76:79], v[52:55], a[116:119]
buffer_load_dwordx4 v1, s[28:31], s68 offen lds
v_mfma_f32_16x16x32_bf16 a[120:123], v[76:79], v[56:59], a[120:123]
ds_read_b128 v[116:119], v20 offset:10240
v_mfma_f32_16x16x32_bf16 a[124:127], v[76:79], v[60:63], a[124:127]
buffer_load_dwordx4 v2, s[28:31], s68 offen offset:1024 lds
v_mfma_f32_16x16x32_bf16 a[128:131], v[80:83], v[32:35], a[128:131]
ds_read_b64_tr_b16 v[148:149], v22 offset:4352
v_mfma_f32_16x16x32_bf16 a[132:135], v[80:83], v[36:39], a[132:135]
buffer_load_dwordx4 v3, s[28:31], s68 offen offset:2048 lds
v_mfma_f32_16x16x32_bf16 a[136:139], v[80:83], v[40:43], a[136:139]
ds_read_b64_tr_b16 v[150:151], v22 offset:5376
v_mfma_f32_16x16x32_bf16 a[140:143], v[80:83], v[44:47], a[140:143]
buffer_load_dwordx4 v4, s[28:31], s68 offen offset:3072 lds
v_mfma_f32_16x16x32_bf16 a[144:147], v[80:83], v[48:51], a[144:147]
ds_read_b128 v[120:123], v20 offset:12288
v_mfma_f32_16x16x32_bf16 a[148:151], v[80:83], v[52:55], a[148:151]
v_mfma_f32_16x16x32_bf16 a[152:155], v[80:83], v[56:59], a[152:155]
ds_read_b64_tr_b16 v[152:153], v22 offset:4608
v_mfma_f32_16x16x32_bf16 a[156:159], v[80:83], v[60:63], a[156:159]
s_sub_u32 s68, s68, 262016
v_mfma_f32_16x16x32_bf16 a[160:163], v[84:87], v[32:35], a[160:163]
ds_read_b64_tr_b16 v[154:155], v22 offset:5632
v_mfma_f32_16x16x32_bf16 a[164:167], v[84:87], v[36:39], a[164:167]
s_bitset0_b32 s68, 11
v_mfma_f32_16x16x32_bf16 a[168:171], v[84:87], v[40:43], a[168:171]
ds_read_b128 v[124:127], v20 offset:14336
v_mfma_f32_16x16x32_bf16 a[172:175], v[84:87], v[44:47], a[172:175]
s_add_u32 s23, s64, 65536
v_mfma_f32_16x16x32_bf16 a[176:179], v[84:87], v[48:51], a[176:179]
ds_read_b64_tr_b16 v[156:157], v22 offset:4864
v_mfma_f32_16x16x32_bf16 a[180:183], v[84:87], v[52:55], a[180:183]
v_mfma_f32_16x16x32_bf16 a[184:187], v[84:87], v[56:59], a[184:187]
ds_read_b64_tr_b16 v[158:159], v22 offset:5888
v_mfma_f32_16x16x32_bf16 a[188:191], v[84:87], v[60:63], a[188:191]
s_sub_u32 s64, s23, 163840
s_cselect_b32 s64, s23, s64
v_mfma_f32_16x16x32_bf16 a[192:195], v[88:91], v[32:35], a[192:195]
v_mfma_f32_16x16x32_bf16 a[196:199], v[88:91], v[36:39], a[196:199]
s_add_u32 s23, s65, 65536
v_mfma_f32_16x16x32_bf16 a[200:203], v[88:91], v[40:43], a[200:203]
v_mfma_f32_16x16x32_bf16 a[204:207], v[88:91], v[44:47], a[204:207]
s_sub_u32 s65, s23, 163840
s_cselect_b32 s65, s23, s65
v_mfma_f32_16x16x32_bf16 a[208:211], v[88:91], v[48:51], a[208:211]
v_mfma_f32_16x16x32_bf16 a[212:215], v[88:91], v[52:55], a[212:215]
s_add_u32 s23, s66, 65536
v_mfma_f32_16x16x32_bf16 a[216:219], v[88:91], v[56:59], a[216:219]
v_mfma_f32_16x16x32_bf16 a[220:223], v[88:91], v[60:63], a[220:223]
v_mfma_f32_16x16x32_bf16 a[224:227], v[92:95], v[32:35], a[224:227]
v_mfma_f32_16x16x32_bf16 a[228:231], v[92:95], v[36:39], a[228:231]
s_sub_u32 s66, s23, 163840
s_cselect_b32 s66, s23, s66
v_mfma_f32_16x16x32_bf16 a[232:235], v[92:95], v[40:43], a[232:235]
v_mfma_f32_16x16x32_bf16 a[236:239], v[92:95], v[44:47], a[236:239]
v_add_u32 v19, s65, v236
v_mfma_f32_16x16x32_bf16 a[240:243], v[92:95], v[48:51], a[240:243]
v_mfma_f32_16x16x32_bf16 a[244:247], v[92:95], v[52:55], a[244:247]
v_add_u32 v21, s64, v238
v_mfma_f32_16x16x32_bf16 a[248:251], v[92:95], v[56:59], a[248:251]
v_mfma_f32_16x16x32_bf16 a[252:255], v[92:95], v[60:63], a[252:255]
s_waitcnt lgkmcnt(0)
s_waitcnt vmcnt(16)
s_barrier
v_mfma_f32_16x16x32_bf16 a[0:3], v[128:131], v[96:99], a[0:3]
ds_read_b128 v[32:35], v19 offset:0
v_mfma_f32_16x16x32_bf16 a[4:7], v[128:131], v[100:103], a[4:7]
s_add_u32 m0, s67, s70
v_mfma_f32_16x16x32_bf16 a[8:11], v[128:131], v[104:107], a[8:11]
ds_read_b64_tr_b16 v[64:65], v21 offset:0
v_mfma_f32_16x16x32_bf16 a[12:15], v[128:131], v[108:111], a[12:15]
s_add_u32 s22, s67, 16384
v_mfma_f32_16x16x32_bf16 a[16:19], v[128:131], v[112:115], a[16:19]
ds_read_b64_tr_b16 v[66:67], v21 offset:1024
v_mfma_f32_16x16x32_bf16 a[20:23], v[128:131], v[116:119], a[20:23]
v_mfma_f32_16x16x32_bf16 a[24:27], v[128:131], v[120:123], a[24:27]
ds_read_b128 v[36:39], v19 offset:2048
v_mfma_f32_16x16x32_bf16 a[28:31], v[128:131], v[124:127], a[28:31]
s_sub_u32 s67, s22, 163840
s_cselect_b32 s67, s22, s67
v_mfma_f32_16x16x32_bf16 a[32:35], v[132:135], v[96:99], a[32:35]
ds_read_b64_tr_b16 v[68:69], v21 offset:256
v_mfma_f32_16x16x32_bf16 a[36:39], v[132:135], v[100:103], a[36:39]
buffer_load_dwordx4 v232, s[32:35], s69 offen lds
v_mfma_f32_16x16x32_bf16 a[40:43], v[132:135], v[104:107], a[40:43]
ds_read_b64_tr_b16 v[70:71], v21 offset:1280
v_mfma_f32_16x16x32_bf16 a[44:47], v[132:135], v[108:111], a[44:47]
v_mfma_f32_16x16x32_bf16 a[48:51], v[132:135], v[112:115], a[48:51]
ds_read_b128 v[40:43], v19 offset:4096
v_mfma_f32_16x16x32_bf16 a[52:55], v[132:135], v[116:119], a[52:55]
buffer_load_dwordx4 v233, s[32:35], s69 offen offset:1024 lds
v_mfma_f32_16x16x32_bf16 a[56:59], v[132:135], v[120:123], a[56:59]
ds_read_b64_tr_b16 v[72:73], v21 offset:512
v_mfma_f32_16x16x32_bf16 a[60:63], v[132:135], v[124:127], a[60:63]
v_mfma_f32_16x16x32_bf16 a[64:67], v[136:139], v[96:99], a[64:67]
ds_read_b64_tr_b16 v[74:75], v21 offset:1536
v_mfma_f32_16x16x32_bf16 a[68:71], v[136:139], v[100:103], a[68:71]
buffer_load_dwordx4 v234, s[32:35], s69 offen offset:2048 lds
v_mfma_f32_16x16x32_bf16 a[72:75], v[136:139], v[104:107], a[72:75]
ds_read_b128 v[44:47], v19 offset:6144
v_mfma_f32_16x16x32_bf16 a[76:79], v[136:139], v[108:111], a[76:79]
buffer_load_dwordx4 v235, s[32:35], s69 offen offset:3072 lds
v_mfma_f32_16x16x32_bf16 a[80:83], v[136:139], v[112:115], a[80:83]
ds_read_b64_tr_b16 v[76:77], v21 offset:768
v_mfma_f32_16x16x32_bf16 a[84:87], v[136:139], v[116:119], a[84:87]
v_mfma_f32_16x16x32_bf16 a[88:91], v[136:139], v[120:123], a[88:91]
ds_read_b64_tr_b16 v[78:79], v21 offset:1792
v_mfma_f32_16x16x32_bf16 a[92:95], v[136:139], v[124:127], a[92:95]
s_add_u32 s69, s69, 262144
v_mfma_f32_16x16x32_bf16 a[96:99], v[140:143], v[96:99], a[96:99]
ds_read_b128 v[48:51], v19 offset:8192
v_mfma_f32_16x16x32_bf16 a[100:103], v[140:143], v[100:103], a[100:103]
s_and_b32 s69, s69, 0x7fffff
v_mfma_f32_16x16x32_bf16 a[104:107], v[140:143], v[104:107], a[104:107]
ds_read_b64_tr_b16 v[80:81], v21 offset:4096
v_mfma_f32_16x16x32_bf16 a[108:111], v[140:143], v[108:111], a[108:111]
v_mfma_f32_16x16x32_bf16 a[112:115], v[140:143], v[112:115], a[112:115]
ds_read_b64_tr_b16 v[82:83], v21 offset:5120
v_mfma_f32_16x16x32_bf16 a[116:119], v[140:143], v[116:119], a[116:119]
s_add_u32 m0, s67, s70
v_mfma_f32_16x16x32_bf16 a[120:123], v[140:143], v[120:123], a[120:123]
ds_read_b128 v[52:55], v19 offset:10240
v_mfma_f32_16x16x32_bf16 a[124:127], v[140:143], v[124:127], a[124:127]
v_mfma_f32_16x16x32_bf16 a[128:131], v[144:147], v[96:99], a[128:131]
ds_read_b64_tr_b16 v[84:85], v21 offset:4352
v_mfma_f32_16x16x32_bf16 a[132:135], v[144:147], v[100:103], a[132:135]
s_add_u32 s22, s67, 16384
v_mfma_f32_16x16x32_bf16 a[136:139], v[144:147], v[104:107], a[136:139]
ds_read_b64_tr_b16 v[86:87], v21 offset:5376
v_mfma_f32_16x16x32_bf16 a[140:143], v[144:147], v[108:111], a[140:143]
s_sub_u32 s67, s22, 163840
s_cselect_b32 s67, s22, s67
v_mfma_f32_16x16x32_bf16 a[144:147], v[144:147], v[112:115], a[144:147]
ds_read_b128 v[56:59], v19 offset:12288
v_mfma_f32_16x16x32_bf16 a[148:151], v[144:147], v[116:119], a[148:151]
v_mfma_f32_16x16x32_bf16 a[152:155], v[144:147], v[120:123], a[152:155]
ds_read_b64_tr_b16 v[88:89], v21 offset:4608
v_mfma_f32_16x16x32_bf16 a[156:159], v[144:147], v[124:127], a[156:159]
buffer_load_dwordx4 v232, s[32:35], s69 offen lds
v_mfma_f32_16x16x32_bf16 a[160:163], v[148:151], v[96:99], a[160:163]
ds_read_b64_tr_b16 v[90:91], v21 offset:5632
v_mfma_f32_16x16x32_bf16 a[164:167], v[148:151], v[100:103], a[164:167]
buffer_load_dwordx4 v233, s[32:35], s69 offen offset:1024 lds
v_mfma_f32_16x16x32_bf16 a[168:171], v[148:151], v[104:107], a[168:171]
ds_read_b128 v[60:63], v19 offset:14336
v_mfma_f32_16x16x32_bf16 a[172:175], v[148:151], v[108:111], a[172:175]
v_mfma_f32_16x16x32_bf16 a[176:179], v[148:151], v[112:115], a[176:179]
ds_read_b64_tr_b16 v[92:93], v21 offset:4864
v_mfma_f32_16x16x32_bf16 a[180:183], v[148:151], v[116:119], a[180:183]
buffer_load_dwordx4 v234, s[32:35], s69 offen offset:2048 lds
v_mfma_f32_16x16x32_bf16 a[184:187], v[148:151], v[120:123], a[184:187]
ds_read_b64_tr_b16 v[94:95], v21 offset:5888
v_mfma_f32_16x16x32_bf16 a[188:191], v[148:151], v[124:127], a[188:191]
v_mfma_f32_16x16x32_bf16 a[192:195], v[152:155], v[96:99], a[192:195]
v_mfma_f32_16x16x32_bf16 a[196:199], v[152:155], v[100:103], a[196:199]
buffer_load_dwordx4 v235, s[32:35], s69 offen offset:3072 lds
v_mfma_f32_16x16x32_bf16 a[200:203], v[152:155], v[104:107], a[200:203]
v_mfma_f32_16x16x32_bf16 a[204:207], v[152:155], v[108:111], a[204:207]
s_add_u32 s69, s69, 262144
v_mfma_f32_16x16x32_bf16 a[208:211], v[152:155], v[112:115], a[208:211]
v_mfma_f32_16x16x32_bf16 a[212:215], v[152:155], v[116:119], a[212:215]
v_mfma_f32_16x16x32_bf16 a[216:219], v[152:155], v[120:123], a[216:219]
v_mfma_f32_16x16x32_bf16 a[220:223], v[152:155], v[124:127], a[220:223]
s_and_b32 s69, s69, 0x7fffff
v_mfma_f32_16x16x32_bf16 a[224:227], v[156:159], v[96:99], a[224:227]
v_mfma_f32_16x16x32_bf16 a[228:231], v[156:159], v[100:103], a[228:231]
v_add_u32 v20, s65, v237
v_mfma_f32_16x16x32_bf16 a[232:235], v[156:159], v[104:107], a[232:235]
v_mfma_f32_16x16x32_bf16 a[236:239], v[156:159], v[108:111], a[236:239]
v_mfma_f32_16x16x32_bf16 a[240:243], v[156:159], v[112:115], a[240:243]
v_mfma_f32_16x16x32_bf16 a[244:247], v[156:159], v[116:119], a[244:247]
v_add_u32 v22, s66, v238
v_mfma_f32_16x16x32_bf16 a[248:251], v[156:159], v[120:123], a[248:251]
v_mfma_f32_16x16x32_bf16 a[252:255], v[156:159], v[124:127], a[252:255]
s_cmp_eq_u32 s71, s19
s_cbranch_scc1 F_REG_K
F_REG_RET_K:
s_cmp_eq_u32 s71, 5
s_cbranch_scc1 F_WQ_K
F_WQ_RET_K:
s_add_u32 s71, s71, 1
s_cmp_lt_u32 s71, 9
s_cbranch_scc1 F_K_LOOP
.p2align 3
s_getpc_b64 s[24:25]
F_PC_A2K:
s_add_u32 s24, s24, F_QP_K-F_PC_A2K
s_addc_u32 s25, s25, 0
s_lshr_b32 s22, s14, 2
s_lshl_b32 s22, s22, 1
s_and_b32 s23, s14, 1
s_add_u32 s22, s22, s23
s_lshl_b32 s22, s22, 2
s_add_u32 s22, s22, s12
v_and_b32 v26, 7, v0
v_lshlrev_b32 v26, 6, v26
v_add_u32 v26, s22, v26
v_lshlrev_b32 v26, 7, v26
v_min_u32 v26, F_V-F_QP_K-4, v26
s_mov_b64 exec, 0xff
global_load_dword v27, v26, s[24:25]
s_mov_b64 exec, -1
s_waitcnt lgkmcnt(0)
s_waitcnt vmcnt(20)
s_barrier
v_mfma_f32_16x16x32_bf16 a[0:3], v[64:67], v[32:35], a[0:3]
ds_read_b128 v[96:99], v20 offset:0
v_mfma_f32_16x16x32_bf16 a[4:7], v[64:67], v[36:39], a[4:7]
s_add_u32 m0, s67, s70
v_mfma_f32_16x16x32_bf16 a[8:11], v[64:67], v[40:43], a[8:11]
ds_read_b64_tr_b16 v[128:129], v22 offset:0
v_mfma_f32_16x16x32_bf16 a[12:15], v[64:67], v[44:47], a[12:15]
s_add_u32 s22, s67, 16384
v_mfma_f32_16x16x32_bf16 a[16:19], v[64:67], v[48:51], a[16:19]
ds_read_b64_tr_b16 v[130:131], v22 offset:1024
v_mfma_f32_16x16x32_bf16 a[20:23], v[64:67], v[52:55], a[20:23]
s_sub_u32 s67, s22, 163840
s_cselect_b32 s67, s22, s67
v_mfma_f32_16x16x32_bf16 a[24:27], v[64:67], v[56:59], a[24:27]
ds_read_b128 v[100:103], v20 offset:2048
v_mfma_f32_16x16x32_bf16 a[28:31], v[64:67], v[60:63], a[28:31]
buffer_load_dwordx4 v1, s[28:31], s68 offen lds
v_mfma_f32_16x16x32_bf16 a[32:35], v[68:71], v[32:35], a[32:35]
ds_read_b64_tr_b16 v[132:133], v22 offset:256
v_mfma_f32_16x16x32_bf16 a[36:39], v[68:71], v[36:39], a[36:39]
v_mfma_f32_16x16x32_bf16 a[40:43], v[68:71], v[40:43], a[40:43]
ds_read_b64_tr_b16 v[134:135], v22 offset:1280
v_mfma_f32_16x16x32_bf16 a[44:47], v[68:71], v[44:47], a[44:47]
buffer_load_dwordx4 v2, s[28:31], s68 offen offset:1024 lds
v_mfma_f32_16x16x32_bf16 a[48:51], v[68:71], v[48:51], a[48:51]
ds_read_b128 v[104:107], v20 offset:4096
v_mfma_f32_16x16x32_bf16 a[52:55], v[68:71], v[52:55], a[52:55]
buffer_load_dwordx4 v3, s[28:31], s68 offen offset:2048 lds
v_mfma_f32_16x16x32_bf16 a[56:59], v[68:71], v[56:59], a[56:59]
ds_read_b64_tr_b16 v[136:137], v22 offset:512
v_mfma_f32_16x16x32_bf16 a[60:63], v[68:71], v[60:63], a[60:63]
buffer_load_dwordx4 v4, s[28:31], s68 offen offset:3072 lds
v_mfma_f32_16x16x32_bf16 a[64:67], v[72:75], v[32:35], a[64:67]
ds_read_b64_tr_b16 v[138:139], v22 offset:1536
v_mfma_f32_16x16x32_bf16 a[68:71], v[72:75], v[36:39], a[68:71]
s_add_u32 s68, s68, 262144
v_mfma_f32_16x16x32_bf16 a[72:75], v[72:75], v[40:43], a[72:75]
ds_read_b128 v[108:111], v20 offset:6144
v_mfma_f32_16x16x32_bf16 a[76:79], v[72:75], v[44:47], a[76:79]
v_mfma_f32_16x16x32_bf16 a[80:83], v[72:75], v[48:51], a[80:83]
ds_read_b64_tr_b16 v[140:141], v22 offset:768
v_mfma_f32_16x16x32_bf16 a[84:87], v[72:75], v[52:55], a[84:87]
s_add_u32 m0, s67, s70
v_mfma_f32_16x16x32_bf16 a[88:91], v[72:75], v[56:59], a[88:91]
ds_read_b64_tr_b16 v[142:143], v22 offset:1792
v_mfma_f32_16x16x32_bf16 a[92:95], v[72:75], v[60:63], a[92:95]
s_add_u32 s22, s67, 16384
v_mfma_f32_16x16x32_bf16 a[96:99], v[76:79], v[32:35], a[96:99]
ds_read_b128 v[112:115], v20 offset:8192
v_mfma_f32_16x16x32_bf16 a[100:103], v[76:79], v[36:39], a[100:103]
s_sub_u32 s67, s22, 163840
s_cselect_b32 s67, s22, s67
v_mfma_f32_16x16x32_bf16 a[104:107], v[76:79], v[40:43], a[104:107]
ds_read_b64_tr_b16 v[144:145], v22 offset:4096
v_mfma_f32_16x16x32_bf16 a[108:111], v[76:79], v[44:47], a[108:111]
v_mfma_f32_16x16x32_bf16 a[112:115], v[76:79], v[48:51], a[112:115]
ds_read_b64_tr_b16 v[146:147], v22 offset:5120
v_mfma_f32_16x16x32_bf16 a[116:119], v[76:79], v[52:55], a[116:119]
buffer_load_dwordx4 v1, s[28:31], s68 offen lds
v_mfma_f32_16x16x32_bf16 a[120:123], v[76:79], v[56:59], a[120:123]
ds_read_b128 v[116:119], v20 offset:10240
v_mfma_f32_16x16x32_bf16 a[124:127], v[76:79], v[60:63], a[124:127]
buffer_load_dwordx4 v2, s[28:31], s68 offen offset:1024 lds
v_mfma_f32_16x16x32_bf16 a[128:131], v[80:83], v[32:35], a[128:131]
ds_read_b64_tr_b16 v[148:149], v22 offset:4352
v_mfma_f32_16x16x32_bf16 a[132:135], v[80:83], v[36:39], a[132:135]
buffer_load_dwordx4 v3, s[28:31], s68 offen offset:2048 lds
v_mfma_f32_16x16x32_bf16 a[136:139], v[80:83], v[40:43], a[136:139]
ds_read_b64_tr_b16 v[150:151], v22 offset:5376
v_mfma_f32_16x16x32_bf16 a[140:143], v[80:83], v[44:47], a[140:143]
buffer_load_dwordx4 v4, s[28:31], s68 offen offset:3072 lds
v_mfma_f32_16x16x32_bf16 a[144:147], v[80:83], v[48:51], a[144:147]
ds_read_b128 v[120:123], v20 offset:12288
v_mfma_f32_16x16x32_bf16 a[148:151], v[80:83], v[52:55], a[148:151]
v_mfma_f32_16x16x32_bf16 a[152:155], v[80:83], v[56:59], a[152:155]
ds_read_b64_tr_b16 v[152:153], v22 offset:4608
v_mfma_f32_16x16x32_bf16 a[156:159], v[80:83], v[60:63], a[156:159]
s_sub_u32 s68, s68, 262016
v_mfma_f32_16x16x32_bf16 a[160:163], v[84:87], v[32:35], a[160:163]
ds_read_b64_tr_b16 v[154:155], v22 offset:5632
v_mfma_f32_16x16x32_bf16 a[164:167], v[84:87], v[36:39], a[164:167]
s_bitset0_b32 s68, 11
v_mfma_f32_16x16x32_bf16 a[168:171], v[84:87], v[40:43], a[168:171]
ds_read_b128 v[124:127], v20 offset:14336
v_mfma_f32_16x16x32_bf16 a[172:175], v[84:87], v[44:47], a[172:175]
s_add_u32 s23, s64, 65536
v_mfma_f32_16x16x32_bf16 a[176:179], v[84:87], v[48:51], a[176:179]
ds_read_b64_tr_b16 v[156:157], v22 offset:4864
v_mfma_f32_16x16x32_bf16 a[180:183], v[84:87], v[52:55], a[180:183]
v_mfma_f32_16x16x32_bf16 a[184:187], v[84:87], v[56:59], a[184:187]
ds_read_b64_tr_b16 v[158:159], v22 offset:5888
v_mfma_f32_16x16x32_bf16 a[188:191], v[84:87], v[60:63], a[188:191]
s_sub_u32 s64, s23, 163840
s_cselect_b32 s64, s23, s64
v_mfma_f32_16x16x32_bf16 a[192:195], v[88:91], v[32:35], a[192:195]
v_mfma_f32_16x16x32_bf16 a[196:199], v[88:91], v[36:39], a[196:199]
s_add_u32 s23, s65, 65536
v_mfma_f32_16x16x32_bf16 a[200:203], v[88:91], v[40:43], a[200:203]
v_mfma_f32_16x16x32_bf16 a[204:207], v[88:91], v[44:47], a[204:207]
s_sub_u32 s65, s23, 163840
s_cselect_b32 s65, s23, s65
v_mfma_f32_16x16x32_bf16 a[208:211], v[88:91], v[48:51], a[208:211]
v_mfma_f32_16x16x32_bf16 a[212:215], v[88:91], v[52:55], a[212:215]
s_add_u32 s23, s66, 65536
v_mfma_f32_16x16x32_bf16 a[216:219], v[88:91], v[56:59], a[216:219]
v_mfma_f32_16x16x32_bf16 a[220:223], v[88:91], v[60:63], a[220:223]
v_mfma_f32_16x16x32_bf16 a[224:227], v[92:95], v[32:35], a[224:227]
v_mfma_f32_16x16x32_bf16 a[228:231], v[92:95], v[36:39], a[228:231]
s_sub_u32 s66, s23, 163840
s_cselect_b32 s66, s23, s66
v_mfma_f32_16x16x32_bf16 a[232:235], v[92:95], v[40:43], a[232:235]
v_mfma_f32_16x16x32_bf16 a[236:239], v[92:95], v[44:47], a[236:239]
v_add_u32 v19, s65, v236
v_mfma_f32_16x16x32_bf16 a[240:243], v[92:95], v[48:51], a[240:243]
v_mfma_f32_16x16x32_bf16 a[244:247], v[92:95], v[52:55], a[244:247]
v_add_u32 v21, s64, v238
v_mfma_f32_16x16x32_bf16 a[248:251], v[92:95], v[56:59], a[248:251]
v_mfma_f32_16x16x32_bf16 a[252:255], v[92:95], v[60:63], a[252:255]
s_waitcnt lgkmcnt(0)
s_waitcnt vmcnt(16)
s_barrier
v_mfma_f32_16x16x32_bf16 a[0:3], v[128:131], v[96:99], a[0:3]
ds_read_b128 v[32:35], v19 offset:0
v_mfma_f32_16x16x32_bf16 a[4:7], v[128:131], v[100:103], a[4:7]
s_add_u32 m0, s67, s70
v_mfma_f32_16x16x32_bf16 a[8:11], v[128:131], v[104:107], a[8:11]
ds_read_b64_tr_b16 v[64:65], v21 offset:0
v_mfma_f32_16x16x32_bf16 a[12:15], v[128:131], v[108:111], a[12:15]
s_add_u32 s22, s67, 16384
v_mfma_f32_16x16x32_bf16 a[16:19], v[128:131], v[112:115], a[16:19]
ds_read_b64_tr_b16 v[66:67], v21 offset:1024
v_mfma_f32_16x16x32_bf16 a[20:23], v[128:131], v[116:119], a[20:23]
v_mfma_f32_16x16x32_bf16 a[24:27], v[128:131], v[120:123], a[24:27]
ds_read_b128 v[36:39], v19 offset:2048
v_mfma_f32_16x16x32_bf16 a[28:31], v[128:131], v[124:127], a[28:31]
s_sub_u32 s67, s22, 163840
s_cselect_b32 s67, s22, s67
v_mfma_f32_16x16x32_bf16 a[32:35], v[132:135], v[96:99], a[32:35]
ds_read_b64_tr_b16 v[68:69], v21 offset:256
v_mfma_f32_16x16x32_bf16 a[36:39], v[132:135], v[100:103], a[36:39]
v_mfma_f32_16x16x32_bf16 a[40:43], v[132:135], v[104:107], a[40:43]
ds_read_b64_tr_b16 v[70:71], v21 offset:1280
v_mfma_f32_16x16x32_bf16 a[44:47], v[132:135], v[108:111], a[44:47]
buffer_load_dwordx4 v232, s[32:35], s69 offen lds
v_mfma_f32_16x16x32_bf16 a[48:51], v[132:135], v[112:115], a[48:51]
ds_read_b128 v[40:43], v19 offset:4096
v_mfma_f32_16x16x32_bf16 a[52:55], v[132:135], v[116:119], a[52:55]
buffer_load_dwordx4 v233, s[32:35], s69 offen offset:1024 lds
v_mfma_f32_16x16x32_bf16 a[56:59], v[132:135], v[120:123], a[56:59]
ds_read_b64_tr_b16 v[72:73], v21 offset:512
v_mfma_f32_16x16x32_bf16 a[60:63], v[132:135], v[124:127], a[60:63]
v_mfma_f32_16x16x32_bf16 a[64:67], v[136:139], v[96:99], a[64:67]
ds_read_b64_tr_b16 v[74:75], v21 offset:1536
v_mfma_f32_16x16x32_bf16 a[68:71], v[136:139], v[100:103], a[68:71]
buffer_load_dwordx4 v234, s[32:35], s69 offen offset:2048 lds
v_mfma_f32_16x16x32_bf16 a[72:75], v[136:139], v[104:107], a[72:75]
ds_read_b128 v[44:47], v19 offset:6144
v_mfma_f32_16x16x32_bf16 a[76:79], v[136:139], v[108:111], a[76:79]
v_mfma_f32_16x16x32_bf16 a[80:83], v[136:139], v[112:115], a[80:83]
ds_read_b64_tr_b16 v[76:77], v21 offset:768
v_mfma_f32_16x16x32_bf16 a[84:87], v[136:139], v[116:119], a[84:87]
buffer_load_dwordx4 v235, s[32:35], s69 offen offset:3072 lds
v_mfma_f32_16x16x32_bf16 a[88:91], v[136:139], v[120:123], a[88:91]
ds_read_b64_tr_b16 v[78:79], v21 offset:1792
v_mfma_f32_16x16x32_bf16 a[92:95], v[136:139], v[124:127], a[92:95]
s_add_u32 s69, s69, 262144
v_mfma_f32_16x16x32_bf16 a[96:99], v[140:143], v[96:99], a[96:99]
ds_read_b128 v[48:51], v19 offset:8192
v_mfma_f32_16x16x32_bf16 a[100:103], v[140:143], v[100:103], a[100:103]
v_mfma_f32_16x16x32_bf16 a[104:107], v[140:143], v[104:107], a[104:107]
ds_read_b64_tr_b16 v[80:81], v21 offset:4096
v_mfma_f32_16x16x32_bf16 a[108:111], v[140:143], v[108:111], a[108:111]
s_and_b32 s69, s69, 0x7fffff
v_mfma_f32_16x16x32_bf16 a[112:115], v[140:143], v[112:115], a[112:115]
ds_read_b64_tr_b16 v[82:83], v21 offset:5120
v_mfma_f32_16x16x32_bf16 a[116:119], v[140:143], v[116:119], a[116:119]
v_mfma_f32_16x16x32_bf16 a[120:123], v[140:143], v[120:123], a[120:123]
ds_read_b128 v[52:55], v19 offset:10240
v_mfma_f32_16x16x32_bf16 a[124:127], v[140:143], v[124:127], a[124:127]
s_add_u32 m0, s67, s70
v_mfma_f32_16x16x32_bf16 a[128:131], v[144:147], v[96:99], a[128:131]
ds_read_b64_tr_b16 v[84:85], v21 offset:4352
v_mfma_f32_16x16x32_bf16 a[132:135], v[144:147], v[100:103], a[132:135]
s_add_u32 s22, s67, 16384
v_mfma_f32_16x16x32_bf16 a[136:139], v[144:147], v[104:107], a[136:139]
ds_read_b64_tr_b16 v[86:87], v21 offset:5376
v_mfma_f32_16x16x32_bf16 a[140:143], v[144:147], v[108:111], a[140:143]
v_mfma_f32_16x16x32_bf16 a[144:147], v[144:147], v[112:115], a[144:147]
ds_read_b128 v[56:59], v19 offset:12288
v_mfma_f32_16x16x32_bf16 a[148:151], v[144:147], v[116:119], a[148:151]
s_sub_u32 s67, s22, 163840
s_cselect_b32 s67, s22, s67
v_mfma_f32_16x16x32_bf16 a[152:155], v[144:147], v[120:123], a[152:155]
ds_read_b64_tr_b16 v[88:89], v21 offset:4608
v_mfma_f32_16x16x32_bf16 a[156:159], v[144:147], v[124:127], a[156:159]
v_mfma_f32_16x16x32_bf16 a[160:163], v[148:151], v[96:99], a[160:163]
ds_read_b64_tr_b16 v[90:91], v21 offset:5632
v_mfma_f32_16x16x32_bf16 a[164:167], v[148:151], v[100:103], a[164:167]
buffer_load_dwordx4 v5, s[40:43], s73 offen lds
v_mfma_f32_16x16x32_bf16 a[168:171], v[148:151], v[104:107], a[168:171]
ds_read_b128 v[60:63], v19 offset:14336
v_mfma_f32_16x16x32_bf16 a[172:175], v[148:151], v[108:111], a[172:175]
buffer_load_dwordx4 v6, s[40:43], s73 offen offset:1024 lds
v_mfma_f32_16x16x32_bf16 a[176:179], v[148:151], v[112:115], a[176:179]
ds_read_b64_tr_b16 v[92:93], v21 offset:4864
v_mfma_f32_16x16x32_bf16 a[180:183], v[148:151], v[116:119], a[180:183]
v_mfma_f32_16x16x32_bf16 a[184:187], v[148:151], v[120:123], a[184:187]
ds_read_b64_tr_b16 v[94:95], v21 offset:5888
v_mfma_f32_16x16x32_bf16 a[188:191], v[148:151], v[124:127], a[188:191]
buffer_load_dwordx4 v7, s[40:43], s73 offen offset:2048 lds
v_mfma_f32_16x16x32_bf16 a[192:195], v[152:155], v[96:99], a[192:195]
v_mfma_f32_16x16x32_bf16 a[196:199], v[152:155], v[100:103], a[196:199]
v_mfma_f32_16x16x32_bf16 a[200:203], v[152:155], v[104:107], a[200:203]
v_mfma_f32_16x16x32_bf16 a[204:207], v[152:155], v[108:111], a[204:207]
buffer_load_dwordx4 v8, s[40:43], s73 offen offset:3072 lds
v_mfma_f32_16x16x32_bf16 a[208:211], v[152:155], v[112:115], a[208:211]
v_mfma_f32_16x16x32_bf16 a[212:215], v[152:155], v[116:119], a[212:215]
s_add_u32 s73, s73, 262144
v_mfma_f32_16x16x32_bf16 a[216:219], v[152:155], v[120:123], a[216:219]
v_mfma_f32_16x16x32_bf16 a[220:223], v[152:155], v[124:127], a[220:223]
v_mfma_f32_16x16x32_bf16 a[224:227], v[156:159], v[96:99], a[224:227]
v_mfma_f32_16x16x32_bf16 a[228:231], v[156:159], v[100:103], a[228:231]
v_add_u32 v20, s65, v237
v_mfma_f32_16x16x32_bf16 a[232:235], v[156:159], v[104:107], a[232:235]
v_mfma_f32_16x16x32_bf16 a[236:239], v[156:159], v[108:111], a[236:239]
v_mfma_f32_16x16x32_bf16 a[240:243], v[156:159], v[112:115], a[240:243]
v_mfma_f32_16x16x32_bf16 a[244:247], v[156:159], v[116:119], a[244:247]
v_add_u32 v22, s66, v238
v_mfma_f32_16x16x32_bf16 a[248:251], v[156:159], v[120:123], a[248:251]
v_mfma_f32_16x16x32_bf16 a[252:255], v[156:159], v[124:127], a[252:255]
s_waitcnt lgkmcnt(0)
s_waitcnt vmcnt(20)
s_barrier
v_mfma_f32_16x16x32_bf16 a[0:3], v[64:67], v[32:35], a[0:3]
ds_read_b128 v[96:99], v20 offset:0
v_mfma_f32_16x16x32_bf16 a[4:7], v[64:67], v[36:39], a[4:7]
s_add_u32 m0, s67, s70
v_mfma_f32_16x16x32_bf16 a[8:11], v[64:67], v[40:43], a[8:11]
ds_read_b64_tr_b16 v[128:129], v22 offset:0
v_mfma_f32_16x16x32_bf16 a[12:15], v[64:67], v[44:47], a[12:15]
s_add_u32 s22, s67, 16384
v_mfma_f32_16x16x32_bf16 a[16:19], v[64:67], v[48:51], a[16:19]
ds_read_b64_tr_b16 v[130:131], v22 offset:1024
v_mfma_f32_16x16x32_bf16 a[20:23], v[64:67], v[52:55], a[20:23]
s_sub_u32 s67, s22, 163840
s_cselect_b32 s67, s22, s67
v_mfma_f32_16x16x32_bf16 a[24:27], v[64:67], v[56:59], a[24:27]
ds_read_b128 v[100:103], v20 offset:2048
v_mfma_f32_16x16x32_bf16 a[28:31], v[64:67], v[60:63], a[28:31]
buffer_load_dwordx4 v9, s[36:39], s72 offen lds
v_mfma_f32_16x16x32_bf16 a[32:35], v[68:71], v[32:35], a[32:35]
ds_read_b64_tr_b16 v[132:133], v22 offset:256
v_mfma_f32_16x16x32_bf16 a[36:39], v[68:71], v[36:39], a[36:39]
buffer_load_dwordx4 v10, s[36:39], s72 offen offset:1024 lds
v_mfma_f32_16x16x32_bf16 a[40:43], v[68:71], v[40:43], a[40:43]
ds_read_b64_tr_b16 v[134:135], v22 offset:1280
v_mfma_f32_16x16x32_bf16 a[44:47], v[68:71], v[44:47], a[44:47]
v_mfma_f32_16x16x32_bf16 a[48:51], v[68:71], v[48:51], a[48:51]
ds_read_b128 v[104:107], v20 offset:4096
v_mfma_f32_16x16x32_bf16 a[52:55], v[68:71], v[52:55], a[52:55]
buffer_load_dwordx4 v11, s[36:39], s72 offen offset:2048 lds
v_mfma_f32_16x16x32_bf16 a[56:59], v[68:71], v[56:59], a[56:59]
ds_read_b64_tr_b16 v[136:137], v22 offset:512
v_mfma_f32_16x16x32_bf16 a[60:63], v[68:71], v[60:63], a[60:63]
buffer_load_dwordx4 v12, s[36:39], s72 offen offset:3072 lds
v_mfma_f32_16x16x32_bf16 a[64:67], v[72:75], v[32:35], a[64:67]
ds_read_b64_tr_b16 v[138:139], v22 offset:1536
v_mfma_f32_16x16x32_bf16 a[68:71], v[72:75], v[36:39], a[68:71]
s_add_u32 s72, s72, 128
v_mfma_f32_16x16x32_bf16 a[72:75], v[72:75], v[40:43], a[72:75]
ds_read_b128 v[108:111], v20 offset:6144
v_mfma_f32_16x16x32_bf16 a[76:79], v[72:75], v[44:47], a[76:79]
s_add_u32 m0, s67, s70
v_mfma_f32_16x16x32_bf16 a[80:83], v[72:75], v[48:51], a[80:83]
ds_read_b64_tr_b16 v[140:141], v22 offset:768
v_mfma_f32_16x16x32_bf16 a[84:87], v[72:75], v[52:55], a[84:87]
v_mfma_f32_16x16x32_bf16 a[88:91], v[72:75], v[56:59], a[88:91]
ds_read_b64_tr_b16 v[142:143], v22 offset:1792
v_mfma_f32_16x16x32_bf16 a[92:95], v[72:75], v[60:63], a[92:95]
s_add_u32 s22, s67, 16384
v_mfma_f32_16x16x32_bf16 a[96:99], v[76:79], v[32:35], a[96:99]
ds_read_b128 v[112:115], v20 offset:8192
v_mfma_f32_16x16x32_bf16 a[100:103], v[76:79], v[36:39], a[100:103]
s_sub_u32 s67, s22, 163840
s_cselect_b32 s67, s22, s67
v_mfma_f32_16x16x32_bf16 a[104:107], v[76:79], v[40:43], a[104:107]
ds_read_b64_tr_b16 v[144:145], v22 offset:4096
v_mfma_f32_16x16x32_bf16 a[108:111], v[76:79], v[44:47], a[108:111]
buffer_load_dwordx4 v5, s[40:43], s73 offen lds
v_mfma_f32_16x16x32_bf16 a[112:115], v[76:79], v[48:51], a[112:115]
ds_read_b64_tr_b16 v[146:147], v22 offset:5120
v_mfma_f32_16x16x32_bf16 a[116:119], v[76:79], v[52:55], a[116:119]
buffer_load_dwordx4 v6, s[40:43], s73 offen offset:1024 lds
v_mfma_f32_16x16x32_bf16 a[120:123], v[76:79], v[56:59], a[120:123]
ds_read_b128 v[116:119], v20 offset:10240
v_mfma_f32_16x16x32_bf16 a[124:127], v[76:79], v[60:63], a[124:127]
v_mfma_f32_16x16x32_bf16 a[128:131], v[80:83], v[32:35], a[128:131]
ds_read_b64_tr_b16 v[148:149], v22 offset:4352
v_mfma_f32_16x16x32_bf16 a[132:135], v[80:83], v[36:39], a[132:135]
buffer_load_dwordx4 v7, s[40:43], s73 offen offset:2048 lds
v_mfma_f32_16x16x32_bf16 a[136:139], v[80:83], v[40:43], a[136:139]
ds_read_b64_tr_b16 v[150:151], v22 offset:5376
v_mfma_f32_16x16x32_bf16 a[140:143], v[80:83], v[44:47], a[140:143]
buffer_load_dwordx4 v8, s[40:43], s73 offen offset:3072 lds
v_mfma_f32_16x16x32_bf16 a[144:147], v[80:83], v[48:51], a[144:147]
ds_read_b128 v[120:123], v20 offset:12288
v_mfma_f32_16x16x32_bf16 a[148:151], v[80:83], v[52:55], a[148:151]
s_add_u32 s73, s73, 262144
v_mfma_f32_16x16x32_bf16 a[152:155], v[80:83], v[56:59], a[152:155]
ds_read_b64_tr_b16 v[152:153], v22 offset:4608
v_mfma_f32_16x16x32_bf16 a[156:159], v[80:83], v[60:63], a[156:159]
s_add_u32 s75, s75, 1
v_mfma_f32_16x16x32_bf16 a[160:163], v[84:87], v[32:35], a[160:163]
ds_read_b64_tr_b16 v[154:155], v22 offset:5632
v_mfma_f32_16x16x32_bf16 a[164:167], v[84:87], v[36:39], a[164:167]
s_cmp_eq_u32 s75, 7
s_cselect_b32 s72, s76, s72
s_cselect_b32 s73, s77, s73
s_cselect_b32 s75, 0, s75
v_mfma_f32_16x16x32_bf16 a[168:171], v[84:87], v[40:43], a[168:171]
ds_read_b128 v[124:127], v20 offset:14336
v_mfma_f32_16x16x32_bf16 a[172:175], v[84:87], v[44:47], a[172:175]
v_mfma_f32_16x16x32_bf16 a[176:179], v[84:87], v[48:51], a[176:179]
ds_read_b64_tr_b16 v[156:157], v22 offset:4864
v_mfma_f32_16x16x32_bf16 a[180:183], v[84:87], v[52:55], a[180:183]
s_add_u32 s23, s64, 65536
v_mfma_f32_16x16x32_bf16 a[184:187], v[84:87], v[56:59], a[184:187]
ds_read_b64_tr_b16 v[158:159], v22 offset:5888
v_mfma_f32_16x16x32_bf16 a[188:191], v[84:87], v[60:63], a[188:191]
s_sub_u32 s64, s23, 163840
s_cselect_b32 s64, s23, s64
v_mfma_f32_16x16x32_bf16 a[192:195], v[88:91], v[32:35], a[192:195]
v_mfma_f32_16x16x32_bf16 a[196:199], v[88:91], v[36:39], a[196:199]
s_add_u32 s23, s65, 65536
v_mfma_f32_16x16x32_bf16 a[200:203], v[88:91], v[40:43], a[200:203]
v_mfma_f32_16x16x32_bf16 a[204:207], v[88:91], v[44:47], a[204:207]
s_sub_u32 s65, s23, 163840
s_cselect_b32 s65, s23, s65
v_mfma_f32_16x16x32_bf16 a[208:211], v[88:91], v[48:51], a[208:211]
v_mfma_f32_16x16x32_bf16 a[212:215], v[88:91], v[52:55], a[212:215]
v_mfma_f32_16x16x32_bf16 a[216:219], v[88:91], v[56:59], a[216:219]
v_mfma_f32_16x16x32_bf16 a[220:223], v[88:91], v[60:63], a[220:223]
s_add_u32 s23, s66, 65536
v_mfma_f32_16x16x32_bf16 a[224:227], v[92:95], v[32:35], a[224:227]
v_mfma_f32_16x16x32_bf16 a[228:231], v[92:95], v[36:39], a[228:231]
s_sub_u32 s66, s23, 163840
s_cselect_b32 s66, s23, s66
v_mfma_f32_16x16x32_bf16 a[232:235], v[92:95], v[40:43], a[232:235]
v_mfma_f32_16x16x32_bf16 a[236:239], v[92:95], v[44:47], a[236:239]
v_add_u32 v19, s65, v236
v_mfma_f32_16x16x32_bf16 a[240:243], v[92:95], v[48:51], a[240:243]
v_mfma_f32_16x16x32_bf16 a[244:247], v[92:95], v[52:55], a[244:247]
v_add_u32 v21, s64, v238
v_mfma_f32_16x16x32_bf16 a[248:251], v[92:95], v[56:59], a[248:251]
v_mfma_f32_16x16x32_bf16 a[252:255], v[92:95], v[60:63], a[252:255]
s_waitcnt lgkmcnt(0)
s_waitcnt vmcnt(16)
s_barrier
v_mfma_f32_16x16x32_bf16 a[0:3], v[128:131], v[96:99], a[0:3]
ds_read_b128 v[32:35], v19 offset:0
v_mfma_f32_16x16x32_bf16 a[4:7], v[128:131], v[100:103], a[4:7]
s_add_u32 m0, s67, s70
v_mfma_f32_16x16x32_bf16 a[8:11], v[128:131], v[104:107], a[8:11]
ds_read_b64_tr_b16 v[64:65], v21 offset:0
v_mfma_f32_16x16x32_bf16 a[12:15], v[128:131], v[108:111], a[12:15]
s_add_u32 s22, s67, 16384
v_mfma_f32_16x16x32_bf16 a[16:19], v[128:131], v[112:115], a[16:19]
ds_read_b64_tr_b16 v[66:67], v21 offset:1024
v_mfma_f32_16x16x32_bf16 a[20:23], v[128:131], v[116:119], a[20:23]
v_mfma_f32_16x16x32_bf16 a[24:27], v[128:131], v[120:123], a[24:27]
ds_read_b128 v[36:39], v19 offset:2048
v_mfma_f32_16x16x32_bf16 a[28:31], v[128:131], v[124:127], a[28:31]
s_sub_u32 s67, s22, 163840
s_cselect_b32 s67, s22, s67
v_mfma_f32_16x16x32_bf16 a[32:35], v[132:135], v[96:99], a[32:35]
ds_read_b64_tr_b16 v[68:69], v21 offset:256
v_mfma_f32_16x16x32_bf16 a[36:39], v[132:135], v[100:103], a[36:39]
v_mfma_f32_16x16x32_bf16 a[40:43], v[132:135], v[104:107], a[40:43]
ds_read_b64_tr_b16 v[70:71], v21 offset:1280
v_mfma_f32_16x16x32_bf16 a[44:47], v[132:135], v[108:111], a[44:47]
buffer_load_dwordx4 v5, s[40:43], s73 offen lds
v_mfma_f32_16x16x32_bf16 a[48:51], v[132:135], v[112:115], a[48:51]
ds_read_b128 v[40:43], v19 offset:4096
v_mfma_f32_16x16x32_bf16 a[52:55], v[132:135], v[116:119], a[52:55]
v_mfma_f32_16x16x32_bf16 a[56:59], v[132:135], v[120:123], a[56:59]
ds_read_b64_tr_b16 v[72:73], v21 offset:512
v_mfma_f32_16x16x32_bf16 a[60:63], v[132:135], v[124:127], a[60:63]
buffer_load_dwordx4 v6, s[40:43], s73 offen offset:1024 lds
v_mfma_f32_16x16x32_bf16 a[64:67], v[136:139], v[96:99], a[64:67]
ds_read_b64_tr_b16 v[74:75], v21 offset:1536
v_mfma_f32_16x16x32_bf16 a[68:71], v[136:139], v[100:103], a[68:71]
buffer_load_dwordx4 v7, s[40:43], s73 offen offset:2048 lds
v_mfma_f32_16x16x32_bf16 a[72:75], v[136:139], v[104:107], a[72:75]
ds_read_b128 v[44:47], v19 offset:6144
v_mfma_f32_16x16x32_bf16 a[76:79], v[136:139], v[108:111], a[76:79]
v_mfma_f32_16x16x32_bf16 a[80:83], v[136:139], v[112:115], a[80:83]
ds_read_b64_tr_b16 v[76:77], v21 offset:768
v_mfma_f32_16x16x32_bf16 a[84:87], v[136:139], v[116:119], a[84:87]
buffer_load_dwordx4 v8, s[40:43], s73 offen offset:3072 lds
v_mfma_f32_16x16x32_bf16 a[88:91], v[136:139], v[120:123], a[88:91]
ds_read_b64_tr_b16 v[78:79], v21 offset:1792
v_mfma_f32_16x16x32_bf16 a[92:95], v[136:139], v[124:127], a[92:95]
v_mfma_f32_16x16x32_bf16 a[96:99], v[140:143], v[96:99], a[96:99]
ds_read_b128 v[48:51], v19 offset:8192
v_mfma_f32_16x16x32_bf16 a[100:103], v[140:143], v[100:103], a[100:103]
s_add_u32 s73, s73, 262144
v_mfma_f32_16x16x32_bf16 a[104:107], v[140:143], v[104:107], a[104:107]
ds_read_b64_tr_b16 v[80:81], v21 offset:4096
v_mfma_f32_16x16x32_bf16 a[108:111], v[140:143], v[108:111], a[108:111]
v_mfma_f32_16x16x32_bf16 a[112:115], v[140:143], v[112:115], a[112:115]
ds_read_b64_tr_b16 v[82:83], v21 offset:5120
v_mfma_f32_16x16x32_bf16 a[116:119], v[140:143], v[116:119], a[116:119]
s_add_u32 m0, s67, s70
v_mfma_f32_16x16x32_bf16 a[120:123], v[140:143], v[120:123], a[120:123]
ds_read_b128 v[52:55], v19 offset:10240
v_mfma_f32_16x16x32_bf16 a[124:127], v[140:143], v[124:127], a[124:127]
v_mfma_f32_16x16x32_bf16 a[128:131], v[144:147], v[96:99], a[128:131]
ds_read_b64_tr_b16 v[84:85], v21 offset:4352
v_mfma_f32_16x16x32_bf16 a[132:135], v[144:147], v[100:103], a[132:135]
s_add_u32 s22, s67, 16384
v_mfma_f32_16x16x32_bf16 a[136:139], v[144:147], v[104:107], a[136:139]
ds_read_b64_tr_b16 v[86:87], v21 offset:5376
v_mfma_f32_16x16x32_bf16 a[140:143], v[144:147], v[108:111], a[140:143]
s_sub_u32 s67, s22, 163840
s_cselect_b32 s67, s22, s67
v_mfma_f32_16x16x32_bf16 a[144:147], v[144:147], v[112:115], a[144:147]
ds_read_b128 v[56:59], v19 offset:12288
v_mfma_f32_16x16x32_bf16 a[148:151], v[144:147], v[116:119], a[148:151]
v_mfma_f32_16x16x32_bf16 a[152:155], v[144:147], v[120:123], a[152:155]
ds_read_b64_tr_b16 v[88:89], v21 offset:4608
v_mfma_f32_16x16x32_bf16 a[156:159], v[144:147], v[124:127], a[156:159]
buffer_load_dwordx4 v9, s[36:39], s72 offen lds
v_mfma_f32_16x16x32_bf16 a[160:163], v[148:151], v[96:99], a[160:163]
ds_read_b64_tr_b16 v[90:91], v21 offset:5632
v_mfma_f32_16x16x32_bf16 a[164:167], v[148:151], v[100:103], a[164:167]
v_mfma_f32_16x16x32_bf16 a[168:171], v[148:151], v[104:107], a[168:171]
ds_read_b128 v[60:63], v19 offset:14336
v_mfma_f32_16x16x32_bf16 a[172:175], v[148:151], v[108:111], a[172:175]
buffer_load_dwordx4 v10, s[36:39], s72 offen offset:1024 lds
v_mfma_f32_16x16x32_bf16 a[176:179], v[148:151], v[112:115], a[176:179]
ds_read_b64_tr_b16 v[92:93], v21 offset:4864
v_mfma_f32_16x16x32_bf16 a[180:183], v[148:151], v[116:119], a[180:183]
v_mfma_f32_16x16x32_bf16 a[184:187], v[148:151], v[120:123], a[184:187]
ds_read_b64_tr_b16 v[94:95], v21 offset:5888
v_mfma_f32_16x16x32_bf16 a[188:191], v[148:151], v[124:127], a[188:191]
buffer_load_dwordx4 v11, s[36:39], s72 offen offset:2048 lds
v_mfma_f32_16x16x32_bf16 a[192:195], v[152:155], v[96:99], a[192:195]
v_mfma_f32_16x16x32_bf16 a[196:199], v[152:155], v[100:103], a[196:199]
buffer_load_dwordx4 v12, s[36:39], s72 offen offset:3072 lds
v_mfma_f32_16x16x32_bf16 a[200:203], v[152:155], v[104:107], a[200:203]
v_mfma_f32_16x16x32_bf16 a[204:207], v[152:155], v[108:111], a[204:207]
v_mfma_f32_16x16x32_bf16 a[208:211], v[152:155], v[112:115], a[208:211]
v_mfma_f32_16x16x32_bf16 a[212:215], v[152:155], v[116:119], a[212:215]
s_add_u32 s72, s72, 128
v_mfma_f32_16x16x32_bf16 a[216:219], v[152:155], v[120:123], a[216:219]
v_mfma_f32_16x16x32_bf16 a[220:223], v[152:155], v[124:127], a[220:223]
v_mfma_f32_16x16x32_bf16 a[224:227], v[156:159], v[96:99], a[224:227]
v_mfma_f32_16x16x32_bf16 a[228:231], v[156:159], v[100:103], a[228:231]
v_add_u32 v20, s65, v237
v_mfma_f32_16x16x32_bf16 a[232:235], v[156:159], v[104:107], a[232:235]
v_mfma_f32_16x16x32_bf16 a[236:239], v[156:159], v[108:111], a[236:239]
v_mfma_f32_16x16x32_bf16 a[240:243], v[156:159], v[112:115], a[240:243]
v_mfma_f32_16x16x32_bf16 a[244:247], v[156:159], v[116:119], a[244:247]
v_add_u32 v22, s66, v238
v_mfma_f32_16x16x32_bf16 a[248:251], v[156:159], v[120:123], a[248:251]
v_mfma_f32_16x16x32_bf16 a[252:255], v[156:159], v[124:127], a[252:255]
s_waitcnt lgkmcnt(0)
s_waitcnt vmcnt(20)
s_barrier
v_mfma_f32_16x16x32_bf16 a[0:3], v[64:67], v[32:35], a[0:3]
ds_read_b128 v[96:99], v20 offset:0
v_mfma_f32_16x16x32_bf16 a[4:7], v[64:67], v[36:39], a[4:7]
s_add_u32 m0, s67, s70
v_mfma_f32_16x16x32_bf16 a[8:11], v[64:67], v[40:43], a[8:11]
ds_read_b64_tr_b16 v[128:129], v22 offset:0
v_mfma_f32_16x16x32_bf16 a[12:15], v[64:67], v[44:47], a[12:15]
s_add_u32 s22, s67, 16384
v_mfma_f32_16x16x32_bf16 a[16:19], v[64:67], v[48:51], a[16:19]
ds_read_b64_tr_b16 v[130:131], v22 offset:1024
v_mfma_f32_16x16x32_bf16 a[20:23], v[64:67], v[52:55], a[20:23]
s_sub_u32 s67, s22, 163840
s_cselect_b32 s67, s22, s67
v_mfma_f32_16x16x32_bf16 a[24:27], v[64:67], v[56:59], a[24:27]
ds_read_b128 v[100:103], v20 offset:2048
v_mfma_f32_16x16x32_bf16 a[28:31], v[64:67], v[60:63], a[28:31]
buffer_load_dwordx4 v5, s[40:43], s73 offen lds
v_mfma_f32_16x16x32_bf16 a[32:35], v[68:71], v[32:35], a[32:35]
ds_read_b64_tr_b16 v[132:133], v22 offset:256
v_mfma_f32_16x16x32_bf16 a[36:39], v[68:71], v[36:39], a[36:39]
buffer_load_dwordx4 v6, s[40:43], s73 offen offset:1024 lds
v_mfma_f32_16x16x32_bf16 a[40:43], v[68:71], v[40:43], a[40:43]
ds_read_b64_tr_b16 v[134:135], v22 offset:1280
v_mfma_f32_16x16x32_bf16 a[44:47], v[68:71], v[44:47], a[44:47]
v_mfma_f32_16x16x32_bf16 a[48:51], v[68:71], v[48:51], a[48:51]
ds_read_b128 v[104:107], v20 offset:4096
v_mfma_f32_16x16x32_bf16 a[52:55], v[68:71], v[52:55], a[52:55]
buffer_load_dwordx4 v7, s[40:43], s73 offen offset:2048 lds
v_mfma_f32_16x16x32_bf16 a[56:59], v[68:71], v[56:59], a[56:59]
ds_read_b64_tr_b16 v[136:137], v22 offset:512
v_mfma_f32_16x16x32_bf16 a[60:63], v[68:71], v[60:63], a[60:63]
buffer_load_dwordx4 v8, s[40:43], s73 offen offset:3072 lds
v_mfma_f32_16x16x32_bf16 a[64:67], v[72:75], v[32:35], a[64:67]
ds_read_b64_tr_b16 v[138:139], v22 offset:1536
v_mfma_f32_16x16x32_bf16 a[68:71], v[72:75], v[36:39], a[68:71]
s_add_u32 s73, s73, 262144
v_mfma_f32_16x16x32_bf16 a[72:75], v[72:75], v[40:43], a[72:75]
ds_read_b128 v[108:111], v20 offset:6144
v_mfma_f32_16x16x32_bf16 a[76:79], v[72:75], v[44:47], a[76:79]
s_add_u32 s75, s75, 1
v_mfma_f32_16x16x32_bf16 a[80:83], v[72:75], v[48:51], a[80:83]
ds_read_b64_tr_b16 v[140:141], v22 offset:768
v_mfma_f32_16x16x32_bf16 a[84:87], v[72:75], v[52:55], a[84:87]
v_mfma_f32_16x16x32_bf16 a[88:91], v[72:75], v[56:59], a[88:91]
ds_read_b64_tr_b16 v[142:143], v22 offset:1792
v_mfma_f32_16x16x32_bf16 a[92:95], v[72:75], v[60:63], a[92:95]
s_cmp_eq_u32 s75, 7
s_cselect_b32 s72, s76, s72
s_cselect_b32 s73, s77, s73
s_cselect_b32 s75, 0, s75
v_mfma_f32_16x16x32_bf16 a[96:99], v[76:79], v[32:35], a[96:99]
ds_read_b128 v[112:115], v20 offset:8192
v_mfma_f32_16x16x32_bf16 a[100:103], v[76:79], v[36:39], a[100:103]
s_add_u32 m0, s67, s70
v_mfma_f32_16x16x32_bf16 a[104:107], v[76:79], v[40:43], a[104:107]
ds_read_b64_tr_b16 v[144:145], v22 offset:4096
v_mfma_f32_16x16x32_bf16 a[108:111], v[76:79], v[44:47], a[108:111]
s_add_u32 s22, s67, 16384
v_mfma_f32_16x16x32_bf16 a[112:115], v[76:79], v[48:51], a[112:115]
ds_read_b64_tr_b16 v[146:147], v22 offset:5120
v_mfma_f32_16x16x32_bf16 a[116:119], v[76:79], v[52:55], a[116:119]
s_sub_u32 s67, s22, 163840
s_cselect_b32 s67, s22, s67
v_mfma_f32_16x16x32_bf16 a[120:123], v[76:79], v[56:59], a[120:123]
ds_read_b128 v[116:119], v20 offset:10240
v_mfma_f32_16x16x32_bf16 a[124:127], v[76:79], v[60:63], a[124:127]
v_mfma_f32_16x16x32_bf16 a[128:131], v[80:83], v[32:35], a[128:131]
ds_read_b64_tr_b16 v[148:149], v22 offset:4352
v_mfma_f32_16x16x32_bf16 a[132:135], v[80:83], v[36:39], a[132:135]
buffer_load_dwordx4 v5, s[40:43], s73 offen lds
v_mfma_f32_16x16x32_bf16 a[136:139], v[80:83], v[40:43], a[136:139]
ds_read_b64_tr_b16 v[150:151], v22 offset:5376
v_mfma_f32_16x16x32_bf16 a[140:143], v[80:83], v[44:47], a[140:143]
buffer_load_dwordx4 v6, s[40:43], s73 offen offset:1024 lds
v_mfma_f32_16x16x32_bf16 a[144:147], v[80:83], v[48:51], a[144:147]
ds_read_b128 v[120:123], v20 offset:12288
v_mfma_f32_16x16x32_bf16 a[148:151], v[80:83], v[52:55], a[148:151]
buffer_load_dwordx4 v7, s[40:43], s73 offen offset:2048 lds
v_mfma_f32_16x16x32_bf16 a[152:155], v[80:83], v[56:59], a[152:155]
ds_read_b64_tr_b16 v[152:153], v22 offset:4608
v_mfma_f32_16x16x32_bf16 a[156:159], v[80:83], v[60:63], a[156:159]
buffer_load_dwordx4 v8, s[40:43], s73 offen offset:3072 lds
v_mfma_f32_16x16x32_bf16 a[160:163], v[84:87], v[32:35], a[160:163]
ds_read_b64_tr_b16 v[154:155], v22 offset:5632
v_mfma_f32_16x16x32_bf16 a[164:167], v[84:87], v[36:39], a[164:167]
s_add_u32 s73, s73, 262144
v_mfma_f32_16x16x32_bf16 a[168:171], v[84:87], v[40:43], a[168:171]
ds_read_b128 v[124:127], v20 offset:14336
v_mfma_f32_16x16x32_bf16 a[172:175], v[84:87], v[44:47], a[172:175]
v_mfma_f32_16x16x32_bf16 a[176:179], v[84:87], v[48:51], a[176:179]
ds_read_b64_tr_b16 v[156:157], v22 offset:4864
v_mfma_f32_16x16x32_bf16 a[180:183], v[84:87], v[52:55], a[180:183]
s_add_u32 s23, s64, 65536
v_mfma_f32_16x16x32_bf16 a[184:187], v[84:87], v[56:59], a[184:187]
ds_read_b64_tr_b16 v[158:159], v22 offset:5888
v_mfma_f32_16x16x32_bf16 a[188:191], v[84:87], v[60:63], a[188:191]
s_sub_u32 s64, s23, 163840
s_cselect_b32 s64, s23, s64
v_mfma_f32_16x16x32_bf16 a[192:195], v[88:91], v[32:35], a[192:195]
v_mfma_f32_16x16x32_bf16 a[196:199], v[88:91], v[36:39], a[196:199]
s_add_u32 s23, s65, 65536
v_mfma_f32_16x16x32_bf16 a[200:203], v[88:91], v[40:43], a[200:203]
v_mfma_f32_16x16x32_bf16 a[204:207], v[88:91], v[44:47], a[204:207]
s_sub_u32 s65, s23, 163840
s_cselect_b32 s65, s23, s65
v_mfma_f32_16x16x32_bf16 a[208:211], v[88:91], v[48:51], a[208:211]
v_mfma_f32_16x16x32_bf16 a[212:215], v[88:91], v[52:55], a[212:215]
v_mfma_f32_16x16x32_bf16 a[216:219], v[88:91], v[56:59], a[216:219]
v_mfma_f32_16x16x32_bf16 a[220:223], v[88:91], v[60:63], a[220:223]
s_add_u32 s23, s66, 65536
v_mfma_f32_16x16x32_bf16 a[224:227], v[92:95], v[32:35], a[224:227]
v_mfma_f32_16x16x32_bf16 a[228:231], v[92:95], v[36:39], a[228:231]
s_sub_u32 s66, s23, 163840
s_cselect_b32 s66, s23, s66
v_mfma_f32_16x16x32_bf16 a[232:235], v[92:95], v[40:43], a[232:235]
v_mfma_f32_16x16x32_bf16 a[236:239], v[92:95], v[44:47], a[236:239]
v_add_u32 v19, s65, v236
v_mfma_f32_16x16x32_bf16 a[240:243], v[92:95], v[48:51], a[240:243]
v_mfma_f32_16x16x32_bf16 a[244:247], v[92:95], v[52:55], a[244:247]
v_add_u32 v21, s64, v238
v_mfma_f32_16x16x32_bf16 a[248:251], v[92:95], v[56:59], a[248:251]
v_mfma_f32_16x16x32_bf16 a[252:255], v[92:95], v[60:63], a[252:255]
s_waitcnt lgkmcnt(0)
s_waitcnt vmcnt(16)
s_barrier
v_mfma_f32_16x16x32_bf16 a[0:3], v[128:131], v[96:99], a[0:3]
v_add_u32 v26, 81920, v13
v_mfma_f32_16x16x32_bf16 a[4:7], v[128:131], v[100:103], a[4:7]
s_add_u32 m0, s67, s70
v_mfma_f32_16x16x32_bf16 a[8:11], v[128:131], v[104:107], a[8:11]
v_add_u32 v27, 65536, v17
v_mfma_f32_16x16x32_bf16 a[12:15], v[128:131], v[108:111], a[12:15]
s_add_u32 s22, s67, 16384
v_mfma_f32_16x16x32_bf16 a[16:19], v[128:131], v[112:115], a[16:19]
ds_read_b128 v[32:35], v26 offset:0
v_mfma_f32_16x16x32_bf16 a[20:23], v[128:131], v[116:119], a[20:23]
v_mfma_f32_16x16x32_bf16 a[24:27], v[128:131], v[120:123], a[24:27]
ds_read_b64_tr_b16 v[48:49], v27 offset:0
v_mfma_f32_16x16x32_bf16 a[28:31], v[128:131], v[124:127], a[28:31]
s_sub_u32 s67, s22, 163840
s_cselect_b32 s67, s22, s67
v_mfma_f32_16x16x32_bf16 a[32:35], v[132:135], v[96:99], a[32:35]
ds_read_b64_tr_b16 v[50:51], v27 offset:256
v_mfma_f32_16x16x32_bf16 a[36:39], v[132:135], v[100:103], a[36:39]
buffer_load_dwordx4 v9, s[36:39], s72 offen lds
v_mfma_f32_16x16x32_bf16 a[40:43], v[132:135], v[104:107], a[40:43]
ds_read_b128 v[36:39], v26 offset:4096
v_mfma_f32_16x16x32_bf16 a[44:47], v[132:135], v[108:111], a[44:47]
v_mfma_f32_16x16x32_bf16 a[48:51], v[132:135], v[112:115], a[48:51]
ds_read_b64_tr_b16 v[52:53], v27 offset:512
v_mfma_f32_16x16x32_bf16 a[52:55], v[132:135], v[116:119], a[52:55]
buffer_load_dwordx4 v10, s[36:39], s72 offen offset:1024 lds
v_mfma_f32_16x16x32_bf16 a[56:59], v[132:135], v[120:123], a[56:59]
ds_read_b64_tr_b16 v[54:55], v27 offset:768
v_mfma_f32_16x16x32_bf16 a[60:63], v[132:135], v[124:127], a[60:63]
v_mfma_f32_16x16x32_bf16 a[64:67], v[136:139], v[96:99], a[64:67]
ds_read_b128 v[40:43], v26 offset:8192
v_mfma_f32_16x16x32_bf16 a[68:71], v[136:139], v[100:103], a[68:71]
buffer_load_dwordx4 v11, s[36:39], s72 offen offset:2048 lds
v_mfma_f32_16x16x32_bf16 a[72:75], v[136:139], v[104:107], a[72:75]
ds_read_b128 v[44:47], v26 offset:12288
v_mfma_f32_16x16x32_bf16 a[76:79], v[136:139], v[108:111], a[76:79]
buffer_load_dwordx4 v12, s[36:39], s72 offen offset:3072 lds
v_mfma_f32_16x16x32_bf16 a[80:83], v[136:139], v[112:115], a[80:83]
v_mfma_f32_16x16x32_bf16 a[84:87], v[136:139], v[116:119], a[84:87]
v_mfma_f32_16x16x32_bf16 a[88:91], v[136:139], v[120:123], a[88:91]
v_mfma_f32_16x16x32_bf16 a[92:95], v[136:139], v[124:127], a[92:95]
s_add_u32 s72, s72, 128
v_mfma_f32_16x16x32_bf16 a[96:99], v[140:143], v[96:99], a[96:99]
v_mfma_f32_16x16x32_bf16 a[100:103], v[140:143], v[100:103], a[100:103]
s_add_u32 m0, s67, s70
v_mfma_f32_16x16x32_bf16 a[104:107], v[140:143], v[104:107], a[104:107]
v_mfma_f32_16x16x32_bf16 a[108:111], v[140:143], v[108:111], a[108:111]
v_mfma_f32_16x16x32_bf16 a[112:115], v[140:143], v[112:115], a[112:115]
v_mfma_f32_16x16x32_bf16 a[116:119], v[140:143], v[116:119], a[116:119]
s_add_u32 s22, s67, 16384
v_mfma_f32_16x16x32_bf16 a[120:123], v[140:143], v[120:123], a[120:123]
v_mfma_f32_16x16x32_bf16 a[124:127], v[140:143], v[124:127], a[124:127]
v_mfma_f32_16x16x32_bf16 a[128:131], v[144:147], v[96:99], a[128:131]
v_mfma_f32_16x16x32_bf16 a[132:135], v[144:147], v[100:103], a[132:135]
s_sub_u32 s67, s22, 163840
s_cselect_b32 s67, s22, s67
v_mfma_f32_16x16x32_bf16 a[136:139], v[144:147], v[104:107], a[136:139]
v_mfma_f32_16x16x32_bf16 a[140:143], v[144:147], v[108:111], a[140:143]
buffer_load_dwordx4 v5, s[40:43], s73 offen lds
v_mfma_f32_16x16x32_bf16 a[144:147], v[144:147], v[112:115], a[144:147]
v_mfma_f32_16x16x32_bf16 a[148:151], v[144:147], v[116:119], a[148:151]
v_mfma_f32_16x16x32_bf16 a[152:155], v[144:147], v[120:123], a[152:155]
v_mfma_f32_16x16x32_bf16 a[156:159], v[144:147], v[124:127], a[156:159]
buffer_load_dwordx4 v6, s[40:43], s73 offen offset:1024 lds
v_mfma_f32_16x16x32_bf16 a[160:163], v[148:151], v[96:99], a[160:163]
v_mfma_f32_16x16x32_bf16 a[164:167], v[148:151], v[100:103], a[164:167]
buffer_load_dwordx4 v7, s[40:43], s73 offen offset:2048 lds
v_mfma_f32_16x16x32_bf16 a[168:171], v[148:151], v[104:107], a[168:171]
v_mfma_f32_16x16x32_bf16 a[172:175], v[148:151], v[108:111], a[172:175]
v_mfma_f32_16x16x32_bf16 a[176:179], v[148:151], v[112:115], a[176:179]
v_mfma_f32_16x16x32_bf16 a[180:183], v[148:151], v[116:119], a[180:183]
buffer_load_dwordx4 v8, s[40:43], s73 offen offset:3072 lds
v_mfma_f32_16x16x32_bf16 a[184:187], v[148:151], v[120:123], a[184:187]
v_mfma_f32_16x16x32_bf16 a[188:191], v[148:151], v[124:127], a[188:191]
v_mfma_f32_16x16x32_bf16 a[192:195], v[152:155], v[96:99], a[192:195]
v_mfma_f32_16x16x32_bf16 a[196:199], v[152:155], v[100:103], a[196:199]
s_add_u32 s73, s73, 262144
v_mfma_f32_16x16x32_bf16 a[200:203], v[152:155], v[104:107], a[200:203]
v_mfma_f32_16x16x32_bf16 a[204:207], v[152:155], v[108:111], a[204:207]
s_add_u32 s75, s75, 1
v_mfma_f32_16x16x32_bf16 a[208:211], v[152:155], v[112:115], a[208:211]
v_mfma_f32_16x16x32_bf16 a[212:215], v[152:155], v[116:119], a[212:215]
v_mfma_f32_16x16x32_bf16 a[216:219], v[152:155], v[120:123], a[216:219]
v_mfma_f32_16x16x32_bf16 a[220:223], v[152:155], v[124:127], a[220:223]
s_cmp_eq_u32 s75, 7
s_cselect_b32 s72, s76, s72
s_cselect_b32 s73, s77, s73
s_cselect_b32 s75, 0, s75
v_mfma_f32_16x16x32_bf16 a[224:227], v[156:159], v[96:99], a[224:227]
v_mfma_f32_16x16x32_bf16 a[228:231], v[156:159], v[100:103], a[228:231]
v_add_u32 v20, s65, v237
v_mfma_f32_16x16x32_bf16 a[232:235], v[156:159], v[104:107], a[232:235]
v_mfma_f32_16x16x32_bf16 a[236:239], v[156:159], v[108:111], a[236:239]
v_mfma_f32_16x16x32_bf16 a[240:243], v[156:159], v[112:115], a[240:243]
v_mfma_f32_16x16x32_bf16 a[244:247], v[156:159], v[116:119], a[244:247]
v_add_u32 v22, s66, v238
v_mfma_f32_16x16x32_bf16 a[248:251], v[156:159], v[120:123], a[248:251]
v_mfma_f32_16x16x32_bf16 a[252:255], v[156:159], v[124:127], a[252:255]
F_QP_K:
s_waitcnt lgkmcnt(0)
v_mfma_f32_32x32x16_bf16 v[96:111], v[48:51], v[32:35], 0
v_add_u32 v28, 81920, v14
v_add_u32 v29, 65536, v17
s_add_u32 m0, s67, s70
s_nop 7
v_accvgpr_read_b32 v224, a128
v_accvgpr_read_b32 v225, a129
v_mfma_f32_32x32x16_bf16 v[112:127], v[48:51], v[36:39], 0
ds_read_b128 v[64:67], v28 offset:0
ds_read_b64_tr_b16 v[80:81], v29 offset:2048
s_add_u32 s22, s67, 16384
v_accvgpr_read_b32 v226, a130
v_accvgpr_read_b32 v227, a131
v_mfma_f32_32x32x16_bf16 v[128:143], v[48:51], v[40:43], 0
ds_read_b64_tr_b16 v[82:83], v29 offset:2304
ds_read_b128 v[68:71], v28 offset:4096
s_sub_u32 s67, s22, 163840
s_cselect_b32 s67, s22, s67
v_accvgpr_read_b32 v228, a160
v_accvgpr_read_b32 v229, a161
v_mfma_f32_32x32x16_bf16 v[144:159], v[48:51], v[44:47], 0
ds_read_b64_tr_b16 v[84:85], v29 offset:2560
ds_read_b64_tr_b16 v[86:87], v29 offset:2816
buffer_load_dwordx4 v5, s[40:43], s73 offen lds
v_accvgpr_read_b32 v230, a162
v_accvgpr_read_b32 v231, a163
v_mfma_f32_32x32x16_bf16 v[160:175], v[52:55], v[32:35], 0
ds_read_b128 v[72:75], v28 offset:8192
ds_read_b128 v[76:79], v28 offset:12288
buffer_load_dwordx4 v6, s[40:43], s73 offen offset:1024 lds
v_cvt_pk_bf16_f32 v240, v224, v225
v_cvt_pk_bf16_f32 v241, v226, v227
v_mfma_f32_32x32x16_bf16 v[176:191], v[52:55], v[36:39], 0
buffer_load_dwordx4 v7, s[40:43], s73 offen offset:2048 lds
v_cvt_pk_bf16_f32 v242, v228, v229
v_cvt_pk_bf16_f32 v243, v230, v231
v_mfma_f32_32x32x16_bf16 v[192:207], v[52:55], v[40:43], 0
buffer_load_dwordx4 v8, s[40:43], s73 offen offset:3072 lds
s_add_u32 s24, s74, 0
buffer_store_dwordx4 v[240:243], v239, s[4:7], s24 offen offset:2048 sc1
v_accvgpr_read_b32 v224, a132
v_mfma_f32_32x32x16_bf16 v[208:223], v[52:55], v[44:47], 0
s_add_u32 s73, s73, 262144
v_accvgpr_read_b32 v225, a133
v_accvgpr_read_b32 v226, a134
s_waitcnt lgkmcnt(0)
v_mfma_f32_32x32x16_bf16 v[96:111], v[80:83], v[64:67], v[96:111]
v_add_u32 v26, 81920, v15
v_add_u32 v27, 98304, v17
v_accvgpr_read_b32 v227, a135
v_accvgpr_read_b32 v228, a164
v_accvgpr_read_b32 v229, a165
v_mfma_f32_32x32x16_bf16 v[112:127], v[80:83], v[68:71], v[112:127]
ds_read_b128 v[32:35], v26 offset:0
ds_read_b64_tr_b16 v[48:49], v27 offset:0
v_accvgpr_read_b32 v230, a166
v_accvgpr_read_b32 v231, a167
v_mfma_f32_32x32x16_bf16 v[128:143], v[80:83], v[72:75], v[128:143]
ds_read_b64_tr_b16 v[50:51], v27 offset:256
ds_read_b128 v[36:39], v26 offset:4096
v_cvt_pk_bf16_f32 v244, v224, v225
v_cvt_pk_bf16_f32 v245, v226, v227
v_mfma_f32_32x32x16_bf16 v[144:159], v[80:83], v[76:79], v[144:159]
ds_read_b64_tr_b16 v[52:53], v27 offset:512
ds_read_b64_tr_b16 v[54:55], v27 offset:768
v_cvt_pk_bf16_f32 v246, v228, v229
v_cvt_pk_bf16_f32 v247, v230, v231
v_mfma_f32_32x32x16_bf16 v[160:175], v[84:87], v[64:67], v[160:175]
ds_read_b128 v[40:43], v26 offset:8192
ds_read_b128 v[44:47], v26 offset:12288
s_add_u32 s24, s74, 8192
buffer_store_dwordx4 v[244:247], v239, s[4:7], s24 offen offset:2048 sc1
v_accvgpr_read_b32 v224, a136
v_mfma_f32_32x32x16_bf16 v[176:191], v[84:87], v[68:71], v[176:191]
v_accvgpr_read_b32 v225, a137
v_accvgpr_read_b32 v226, a138
v_mfma_f32_32x32x16_bf16 v[192:207], v[84:87], v[72:75], v[192:207]
v_accvgpr_read_b32 v227, a139
v_accvgpr_read_b32 v228, a168
v_mfma_f32_32x32x16_bf16 v[208:223], v[84:87], v[76:79], v[208:223]
v_accvgpr_read_b32 v229, a169
v_accvgpr_read_b32 v230, a170
s_waitcnt lgkmcnt(0)
v_mfma_f32_32x32x16_bf16 v[96:111], v[48:51], v[32:35], v[96:111]
v_add_u32 v28, 81920, v16
v_add_u32 v29, 98304, v17
v_accvgpr_read_b32 v231, a171
v_cvt_pk_bf16_f32 v248, v224, v225
v_cvt_pk_bf16_f32 v249, v226, v227
v_mfma_f32_32x32x16_bf16 v[112:127], v[48:51], v[36:39], v[112:127]
ds_read_b128 v[64:67], v28 offset:0
ds_read_b64_tr_b16 v[80:81], v29 offset:2048
v_cvt_pk_bf16_f32 v250, v228, v229
v_cvt_pk_bf16_f32 v251, v230, v231
v_mfma_f32_32x32x16_bf16 v[128:143], v[48:51], v[40:43], v[128:143]
ds_read_b64_tr_b16 v[82:83], v29 offset:2304
ds_read_b128 v[68:71], v28 offset:4096
s_add_u32 s24, s74, 16384
buffer_store_dwordx4 v[248:251], v239, s[4:7], s24 offen offset:2048 sc1
v_accvgpr_read_b32 v224, a140
v_mfma_f32_32x32x16_bf16 v[144:159], v[48:51], v[44:47], v[144:159]
ds_read_b64_tr_b16 v[84:85], v29 offset:2560
ds_read_b64_tr_b16 v[86:87], v29 offset:2816
v_accvgpr_read_b32 v225, a141
v_accvgpr_read_b32 v226, a142
v_mfma_f32_32x32x16_bf16 v[160:175], v[52:55], v[32:35], v[160:175]
ds_read_b128 v[72:75], v28 offset:8192
ds_read_b128 v[76:79], v28 offset:12288
v_accvgpr_read_b32 v227, a143
v_accvgpr_read_b32 v228, a172
v_mfma_f32_32x32x16_bf16 v[176:191], v[52:55], v[36:39], v[176:191]
v_accvgpr_read_b32 v229, a173
v_accvgpr_read_b32 v230, a174
v_mfma_f32_32x32x16_bf16 v[192:207], v[52:55], v[40:43], v[192:207]
v_accvgpr_read_b32 v231, a175
v_cvt_pk_bf16_f32 v252, v224, v225
v_mfma_f32_32x32x16_bf16 v[208:223], v[52:55], v[44:47], v[208:223]
v_cvt_pk_bf16_f32 v253, v226, v227
v_cvt_pk_bf16_f32 v254, v228, v229
s_waitcnt lgkmcnt(0)
s_waitcnt vmcnt(19)
s_barrier
v_mfma_f32_32x32x16_bf16 v[96:111], v[80:83], v[64:67], v[96:111]
v_add_u32 v26, 131072, v13
v_add_u32 v27, 114688, v17
s_add_u32 m0, s67, s70
v_cvt_pk_bf16_f32 v255, v230, v231
s_add_u32 s24, s74, 24576
buffer_store_dwordx4 v[252:255], v239, s[4:7], s24 offen offset:2048 sc1
v_accvgpr_read_b32 v224, a144
v_mfma_f32_32x32x16_bf16 v[112:127], v[80:83], v[68:71], v[112:127]
ds_read_b128 v[32:35], v26 offset:0
ds_read_b64_tr_b16 v[48:49], v27 offset:0
s_add_u32 s22, s67, 16384
v_accvgpr_read_b32 v225, a145
v_accvgpr_read_b32 v226, a146
v_mfma_f32_32x32x16_bf16 v[128:143], v[80:83], v[72:75], v[128:143]
ds_read_b64_tr_b16 v[50:51], v27 offset:256
ds_read_b128 v[36:39], v26 offset:4096
s_sub_u32 s67, s22, 163840
s_cselect_b32 s67, s22, s67
v_accvgpr_read_b32 v227, a147
v_accvgpr_read_b32 v228, a176
v_mfma_f32_32x32x16_bf16 v[144:159], v[80:83], v[76:79], v[144:159]
ds_read_b64_tr_b16 v[52:53], v27 offset:512
ds_read_b64_tr_b16 v[54:55], v27 offset:768
buffer_load_dwordx4 v9, s[36:39], s72 offen lds
v_accvgpr_read_b32 v229, a177
v_accvgpr_read_b32 v230, a178
v_mfma_f32_32x32x16_bf16 v[160:175], v[84:87], v[64:67], v[160:175]
ds_read_b128 v[40:43], v26 offset:8192
ds_read_b128 v[44:47], v26 offset:12288
buffer_load_dwordx4 v10, s[36:39], s72 offen offset:1024 lds
v_accvgpr_read_b32 v231, a179
v_cvt_pk_bf16_f32 v240, v224, v225
v_mfma_f32_32x32x16_bf16 v[176:191], v[84:87], v[68:71], v[176:191]
buffer_load_dwordx4 v11, s[36:39], s72 offen offset:2048 lds
v_cvt_pk_bf16_f32 v241, v226, v227
v_cvt_pk_bf16_f32 v242, v228, v229
v_mfma_f32_32x32x16_bf16 v[192:207], v[84:87], v[72:75], v[192:207]
buffer_load_dwordx4 v12, s[36:39], s72 offen offset:3072 lds
v_cvt_pk_bf16_f32 v243, v230, v231
s_add_u32 s24, s74, 32768
buffer_store_dwordx4 v[240:243], v239, s[4:7], s24 offen offset:2048 sc1
v_mfma_f32_32x32x16_bf16 v[208:223], v[84:87], v[76:79], v[208:223]
s_add_u32 s72, s72, 128
v_accvgpr_read_b32 v224, a148
v_accvgpr_read_b32 v225, a149
s_waitcnt lgkmcnt(0)
v_mfma_f32_32x32x16_bf16 v[96:111], v[48:51], v[32:35], v[96:111]
v_add_u32 v28, 131072, v14
v_add_u32 v29, 114688, v17
s_add_u32 m0, s67, s70
s_add_u32 s22, s67, 16384
v_accvgpr_read_b32 v226, a150
v_accvgpr_read_b32 v227, a151
v_accvgpr_read_b32 v228, a180
v_mfma_f32_32x32x16_bf16 v[112:127], v[48:51], v[36:39], v[112:127]
ds_read_b128 v[64:67], v28 offset:0
ds_read_b64_tr_b16 v[80:81], v29 offset:2048
s_sub_u32 s67, s22, 163840
s_cselect_b32 s67, s22, s67
v_accvgpr_read_b32 v229, a181
v_accvgpr_read_b32 v230, a182
v_mfma_f32_32x32x16_bf16 v[128:143], v[48:51], v[40:43], v[128:143]
ds_read_b64_tr_b16 v[82:83], v29 offset:2304
ds_read_b128 v[68:71], v28 offset:4096
buffer_load_dwordx4 v5, s[40:43], s73 offen lds
v_accvgpr_read_b32 v231, a183
v_cvt_pk_bf16_f32 v244, v224, v225
v_mfma_f32_32x32x16_bf16 v[144:159], v[48:51], v[44:47], v[144:159]
ds_read_b64_tr_b16 v[84:85], v29 offset:2560
ds_read_b64_tr_b16 v[86:87], v29 offset:2816
buffer_load_dwordx4 v6, s[40:43], s73 offen offset:1024 lds
v_cvt_pk_bf16_f32 v245, v226, v227
v_cvt_pk_bf16_f32 v246, v228, v229
v_mfma_f32_32x32x16_bf16 v[160:175], v[52:55], v[32:35], v[160:175]
ds_read_b128 v[72:75], v28 offset:8192
ds_read_b128 v[76:79], v28 offset:12288
buffer_load_dwordx4 v7, s[40:43], s73 offen offset:2048 lds
buffer_load_dwordx4 v8, s[40:43], s73 offen offset:3072 lds
v_cvt_pk_bf16_f32 v247, v230, v231
s_add_u32 s24, s74, 40960
buffer_store_dwordx4 v[244:247], v239, s[4:7], s24 offen offset:2048 sc1
v_mfma_f32_32x32x16_bf16 v[176:191], v[52:55], v[36:39], v[176:191]
s_add_u32 s73, s73, 262144
v_accvgpr_read_b32 v224, a152
v_accvgpr_read_b32 v225, a153
v_mfma_f32_32x32x16_bf16 v[192:207], v[52:55], v[40:43], v[192:207]
s_add_u32 s75, s75, 1
v_accvgpr_read_b32 v226, a154
v_accvgpr_read_b32 v227, a155
v_mfma_f32_32x32x16_bf16 v[208:223], v[52:55], v[44:47], v[208:223]
s_cmp_eq_u32 s75, 7
s_cselect_b32 s72, s76, s72
s_cselect_b32 s73, s77, s73
s_cselect_b32 s75, 0, s75
v_accvgpr_read_b32 v228, a184
v_accvgpr_read_b32 v229, a185
s_waitcnt lgkmcnt(0)
v_mfma_f32_32x32x16_bf16 v[96:111], v[80:83], v[64:67], v[96:111]
v_add_u32 v26, 131072, v15
v_add_u32 v27, 147456, v17
s_add_u32 m0, s67, s70
v_accvgpr_read_b32 v230, a186
v_accvgpr_read_b32 v231, a187
v_cvt_pk_bf16_f32 v248, v224, v225
v_mfma_f32_32x32x16_bf16 v[112:127], v[80:83], v[68:71], v[112:127]
ds_read_b128 v[32:35], v26 offset:0
ds_read_b64_tr_b16 v[48:49], v27 offset:0
s_add_u32 s22, s67, 16384
v_cvt_pk_bf16_f32 v249, v226, v227
v_cvt_pk_bf16_f32 v250, v228, v229
v_mfma_f32_32x32x16_bf16 v[128:143], v[80:83], v[72:75], v[128:143]
ds_read_b64_tr_b16 v[50:51], v27 offset:256
ds_read_b128 v[36:39], v26 offset:4096
s_sub_u32 s67, s22, 163840
s_cselect_b32 s67, s22, s67
v_cvt_pk_bf16_f32 v251, v230, v231
s_add_u32 s24, s74, 49152
buffer_store_dwordx4 v[248:251], v239, s[4:7], s24 offen offset:2048 sc1
v_mfma_f32_32x32x16_bf16 v[144:159], v[80:83], v[76:79], v[144:159]
ds_read_b64_tr_b16 v[52:53], v27 offset:512
ds_read_b64_tr_b16 v[54:55], v27 offset:768
buffer_load_dwordx4 v5, s[40:43], s73 offen lds
v_accvgpr_read_b32 v224, a156
v_accvgpr_read_b32 v225, a157
v_mfma_f32_32x32x16_bf16 v[160:175], v[84:87], v[64:67], v[160:175]
ds_read_b128 v[40:43], v26 offset:8192
ds_read_b128 v[44:47], v26 offset:12288
buffer_load_dwordx4 v6, s[40:43], s73 offen offset:1024 lds
v_accvgpr_read_b32 v226, a158
v_accvgpr_read_b32 v227, a159
v_mfma_f32_32x32x16_bf16 v[176:191], v[84:87], v[68:71], v[176:191]
buffer_load_dwordx4 v7, s[40:43], s73 offen offset:2048 lds
v_accvgpr_read_b32 v228, a188
v_accvgpr_read_b32 v229, a189
v_mfma_f32_32x32x16_bf16 v[192:207], v[84:87], v[72:75], v[192:207]
buffer_load_dwordx4 v8, s[40:43], s73 offen offset:3072 lds
v_accvgpr_read_b32 v230, a190
v_accvgpr_read_b32 v231, a191
v_mfma_f32_32x32x16_bf16 v[208:223], v[84:87], v[76:79], v[208:223]
s_add_u32 s73, s73, 262144
v_cvt_pk_bf16_f32 v252, v224, v225
v_cvt_pk_bf16_f32 v253, v226, v227
s_waitcnt lgkmcnt(0)
v_mfma_f32_32x32x16_bf16 v[96:111], v[48:51], v[32:35], v[96:111]
v_add_u32 v28, 131072, v16
v_add_u32 v29, 147456, v17
v_cvt_pk_bf16_f32 v254, v228, v229
v_cvt_pk_bf16_f32 v255, v230, v231
s_add_u32 s24, s74, 57344
buffer_store_dwordx4 v[252:255], v239, s[4:7], s24 offen offset:2048 sc1
v_mfma_f32_32x32x16_bf16 v[112:127], v[48:51], v[36:39], v[112:127]
ds_read_b128 v[64:67], v28 offset:0
ds_read_b64_tr_b16 v[80:81], v29 offset:2048
v_accvgpr_read_b32 v224, a192
v_accvgpr_read_b32 v225, a193
v_mfma_f32_32x32x16_bf16 v[128:143], v[48:51], v[40:43], v[128:143]
ds_read_b64_tr_b16 v[82:83], v29 offset:2304
ds_read_b128 v[68:71], v28 offset:4096
v_accvgpr_read_b32 v226, a194
v_accvgpr_read_b32 v227, a195
v_mfma_f32_32x32x16_bf16 v[144:159], v[48:51], v[44:47], v[144:159]
ds_read_b64_tr_b16 v[84:85], v29 offset:2560
ds_read_b64_tr_b16 v[86:87], v29 offset:2816
v_accvgpr_read_b32 v228, a224
v_accvgpr_read_b32 v229, a225
v_mfma_f32_32x32x16_bf16 v[160:175], v[52:55], v[32:35], v[160:175]
ds_read_b128 v[72:75], v28 offset:8192
ds_read_b128 v[76:79], v28 offset:12288
v_accvgpr_read_b32 v230, a226
v_accvgpr_read_b32 v231, a227
v_mfma_f32_32x32x16_bf16 v[176:191], v[52:55], v[36:39], v[176:191]
v_cvt_pk_bf16_f32 v240, v224, v225
v_cvt_pk_bf16_f32 v241, v226, v227
v_mfma_f32_32x32x16_bf16 v[192:207], v[52:55], v[40:43], v[192:207]
v_cvt_pk_bf16_f32 v242, v228, v229
v_cvt_pk_bf16_f32 v243, v230, v231
v_mfma_f32_32x32x16_bf16 v[208:223], v[52:55], v[44:47], v[208:223]
s_add_u32 s24, s74, 0
buffer_store_dwordx4 v[240:243], v239, s[4:7], s24 offen offset:3072 sc1
v_accvgpr_read_b32 v224, a196
s_waitcnt lgkmcnt(0)
s_waitcnt vmcnt(25)
s_barrier
v_mfma_f32_32x32x16_bf16 v[96:111], v[80:83], v[64:67], v[96:111]
v_add_u32 v26, 16384, v13
v_add_u32 v27, 0, v17
s_add_u32 m0, s67, s70
v_accvgpr_read_b32 v225, a197
v_accvgpr_read_b32 v226, a198
v_accvgpr_read_b32 v227, a199
v_mfma_f32_32x32x16_bf16 v[112:127], v[80:83], v[68:71], v[112:127]
ds_read_b128 v[32:35], v26 offset:0
ds_read_b64_tr_b16 v[48:49], v27 offset:0
s_add_u32 s22, s67, 16384
v_accvgpr_read_b32 v228, a228
v_accvgpr_read_b32 v229, a229
v_mfma_f32_32x32x16_bf16 v[128:143], v[80:83], v[72:75], v[128:143]
ds_read_b64_tr_b16 v[50:51], v27 offset:256
ds_read_b128 v[36:39], v26 offset:4096
s_sub_u32 s67, s22, 163840
s_cselect_b32 s67, s22, s67
v_accvgpr_read_b32 v230, a230
v_accvgpr_read_b32 v231, a231
v_mfma_f32_32x32x16_bf16 v[144:159], v[80:83], v[76:79], v[144:159]
ds_read_b64_tr_b16 v[52:53], v27 offset:512
ds_read_b64_tr_b16 v[54:55], v27 offset:768
buffer_load_dwordx4 v9, s[36:39], s72 offen lds
v_cvt_pk_bf16_f32 v244, v224, v225
v_cvt_pk_bf16_f32 v245, v226, v227
v_mfma_f32_32x32x16_bf16 v[160:175], v[84:87], v[64:67], v[160:175]
ds_read_b128 v[40:43], v26 offset:8192
ds_read_b128 v[44:47], v26 offset:12288
buffer_load_dwordx4 v10, s[36:39], s72 offen offset:1024 lds
v_cvt_pk_bf16_f32 v246, v228, v229
v_cvt_pk_bf16_f32 v247, v230, v231
v_mfma_f32_32x32x16_bf16 v[176:191], v[84:87], v[68:71], v[176:191]
buffer_load_dwordx4 v11, s[36:39], s72 offen offset:2048 lds
s_add_u32 s24, s74, 8192
buffer_store_dwordx4 v[244:247], v239, s[4:7], s24 offen offset:3072 sc1
v_accvgpr_read_b32 v224, a200
v_mfma_f32_32x32x16_bf16 v[192:207], v[84:87], v[72:75], v[192:207]
buffer_load_dwordx4 v12, s[36:39], s72 offen offset:3072 lds
v_accvgpr_read_b32 v225, a201
v_accvgpr_read_b32 v226, a202
v_mfma_f32_32x32x16_bf16 v[208:223], v[84:87], v[76:79], v[208:223]
s_add_u32 s72, s72, 128
v_accvgpr_read_b32 v227, a203
v_accvgpr_read_b32 v228, a232
s_waitcnt lgkmcnt(0)
v_mfma_f32_32x32x16_bf16 v[96:111], v[48:51], v[32:35], v[96:111]
v_add_u32 v28, 16384, v14
v_add_u32 v29, 0, v17
s_add_u32 m0, s67, s70
s_add_u32 s22, s67, 16384
v_accvgpr_read_b32 v229, a233
v_accvgpr_read_b32 v230, a234
v_accvgpr_read_b32 v231, a235
v_mfma_f32_32x32x16_bf16 v[112:127], v[48:51], v[36:39], v[112:127]
ds_read_b128 v[64:67], v28 offset:0
ds_read_b64_tr_b16 v[80:81], v29 offset:2048
s_sub_u32 s67, s22, 163840
s_cselect_b32 s67, s22, s67
v_cvt_pk_bf16_f32 v248, v224, v225
v_cvt_pk_bf16_f32 v249, v226, v227
v_mfma_f32_32x32x16_bf16 v[128:143], v[48:51], v[40:43], v[128:143]
ds_read_b64_tr_b16 v[82:83], v29 offset:2304
ds_read_b128 v[68:71], v28 offset:4096
buffer_load_dwordx4 v5, s[40:43], s73 offen lds
v_cvt_pk_bf16_f32 v250, v228, v229
v_cvt_pk_bf16_f32 v251, v230, v231
v_mfma_f32_32x32x16_bf16 v[144:159], v[48:51], v[44:47], v[144:159]
ds_read_b64_tr_b16 v[84:85], v29 offset:2560
ds_read_b64_tr_b16 v[86:87], v29 offset:2816
buffer_load_dwordx4 v6, s[40:43], s73 offen offset:1024 lds
s_add_u32 s24, s74, 16384
buffer_store_dwordx4 v[248:251], v239, s[4:7], s24 offen offset:3072 sc1
v_accvgpr_read_b32 v224, a204
v_mfma_f32_32x32x16_bf16 v[160:175], v[52:55], v[32:35], v[160:175]
ds_read_b128 v[72:75], v28 offset:8192
ds_read_b128 v[76:79], v28 offset:12288
buffer_load_dwordx4 v7, s[40:43], s73 offen offset:2048 lds
buffer_load_dwordx4 v8, s[40:43], s73 offen offset:3072 lds
v_accvgpr_read_b32 v225, a205
v_accvgpr_read_b32 v226, a206
v_mfma_f32_32x32x16_bf16 v[176:191], v[52:55], v[36:39], v[176:191]
s_add_u32 s73, s73, 262144
v_accvgpr_read_b32 v227, a207
v_accvgpr_read_b32 v228, a236
v_mfma_f32_32x32x16_bf16 v[192:207], v[52:55], v[40:43], v[192:207]
s_add_u32 s75, s75, 1
v_accvgpr_read_b32 v229, a237
v_accvgpr_read_b32 v230, a238
v_mfma_f32_32x32x16_bf16 v[208:223], v[52:55], v[44:47], v[208:223]
s_cmp_eq_u32 s75, 7
s_cselect_b32 s72, s76, s72
s_cselect_b32 s73, s77, s73
s_cselect_b32 s75, 0, s75
v_accvgpr_read_b32 v231, a239
v_cvt_pk_bf16_f32 v252, v224, v225
s_waitcnt lgkmcnt(0)
v_mfma_f32_32x32x16_bf16 v[96:111], v[80:83], v[64:67], v[96:111]
v_add_u32 v26, 16384, v15
v_add_u32 v27, 32768, v17
s_add_u32 m0, s67, s70
v_cvt_pk_bf16_f32 v253, v226, v227
v_cvt_pk_bf16_f32 v254, v228, v229
v_cvt_pk_bf16_f32 v255, v230, v231
v_mfma_f32_32x32x16_bf16 v[112:127], v[80:83], v[68:71], v[112:127]
ds_read_b128 v[32:35], v26 offset:0
ds_read_b64_tr_b16 v[48:49], v27 offset:0
s_add_u32 s22, s67, 16384
s_add_u32 s24, s74, 24576
buffer_store_dwordx4 v[252:255], v239, s[4:7], s24 offen offset:3072 sc1
v_accvgpr_read_b32 v224, a208
v_mfma_f32_32x32x16_bf16 v[128:143], v[80:83], v[72:75], v[128:143]
ds_read_b64_tr_b16 v[50:51], v27 offset:256
ds_read_b128 v[36:39], v26 offset:4096
s_sub_u32 s67, s22, 163840
s_cselect_b32 s67, s22, s67
v_accvgpr_read_b32 v225, a209
v_accvgpr_read_b32 v226, a210
v_mfma_f32_32x32x16_bf16 v[144:159], v[80:83], v[76:79], v[144:159]
ds_read_b64_tr_b16 v[52:53], v27 offset:512
ds_read_b64_tr_b16 v[54:55], v27 offset:768
buffer_load_dwordx4 v5, s[40:43], s73 offen lds
v_accvgpr_read_b32 v227, a211
v_accvgpr_read_b32 v228, a240
v_mfma_f32_32x32x16_bf16 v[160:175], v[84:87], v[64:67], v[160:175]
ds_read_b128 v[40:43], v26 offset:8192
ds_read_b128 v[44:47], v26 offset:12288
buffer_load_dwordx4 v6, s[40:43], s73 offen offset:1024 lds
v_accvgpr_read_b32 v229, a241
v_accvgpr_read_b32 v230, a242
v_mfma_f32_32x32x16_bf16 v[176:191], v[84:87], v[68:71], v[176:191]
buffer_load_dwordx4 v7, s[40:43], s73 offen offset:2048 lds
v_accvgpr_read_b32 v231, a243
v_cvt_pk_bf16_f32 v240, v224, v225
v_mfma_f32_32x32x16_bf16 v[192:207], v[84:87], v[72:75], v[192:207]
buffer_load_dwordx4 v8, s[40:43], s73 offen offset:3072 lds
v_cvt_pk_bf16_f32 v241, v226, v227
v_cvt_pk_bf16_f32 v242, v228, v229
v_mfma_f32_32x32x16_bf16 v[208:223], v[84:87], v[76:79], v[208:223]
s_add_u32 s73, s73, 262144
v_cvt_pk_bf16_f32 v243, v230, v231
s_add_u32 s24, s74, 32768
buffer_store_dwordx4 v[240:243], v239, s[4:7], s24 offen offset:3072 sc1
s_waitcnt lgkmcnt(0)
v_mfma_f32_32x32x16_bf16 v[96:111], v[48:51], v[32:35], v[96:111]
v_add_u32 v28, 16384, v16
v_add_u32 v29, 32768, v17
v_accvgpr_read_b32 v224, a212
v_accvgpr_read_b32 v225, a213
v_accvgpr_read_b32 v226, a214
v_mfma_f32_32x32x16_bf16 v[112:127], v[48:51], v[36:39], v[112:127]
ds_read_b128 v[64:67], v28 offset:0
ds_read_b64_tr_b16 v[80:81], v29 offset:2048
v_accvgpr_read_b32 v227, a215
v_accvgpr_read_b32 v228, a244
v_mfma_f32_32x32x16_bf16 v[128:143], v[48:51], v[40:43], v[128:143]
ds_read_b64_tr_b16 v[82:83], v29 offset:2304
ds_read_b128 v[68:71], v28 offset:4096
v_accvgpr_read_b32 v229, a245
v_accvgpr_read_b32 v230, a246
v_mfma_f32_32x32x16_bf16 v[144:159], v[48:51], v[44:47], v[144:159]
ds_read_b64_tr_b16 v[84:85], v29 offset:2560
ds_read_b64_tr_b16 v[86:87], v29 offset:2816
v_accvgpr_read_b32 v231, a247
v_cvt_pk_bf16_f32 v244, v224, v225
v_mfma_f32_32x32x16_bf16 v[160:175], v[52:55], v[32:35], v[160:175]
ds_read_b128 v[72:75], v28 offset:8192
ds_read_b128 v[76:79], v28 offset:12288
v_cvt_pk_bf16_f32 v245, v226, v227
v_cvt_pk_bf16_f32 v246, v228, v229
v_mfma_f32_32x32x16_bf16 v[176:191], v[52:55], v[36:39], v[176:191]
v_cvt_pk_bf16_f32 v247, v230, v231
s_add_u32 s24, s74, 40960
buffer_store_dwordx4 v[244:247], v239, s[4:7], s24 offen offset:3072 sc1
v_mfma_f32_32x32x16_bf16 v[192:207], v[52:55], v[40:43], v[192:207]
v_accvgpr_read_b32 v224, a216
v_accvgpr_read_b32 v225, a217
v_mfma_f32_32x32x16_bf16 v[208:223], v[52:55], v[44:47], v[208:223]
v_accvgpr_read_b32 v226, a218
v_accvgpr_read_b32 v227, a219
s_waitcnt lgkmcnt(0)
s_waitcnt vmcnt(25)
s_barrier
v_mfma_f32_32x32x16_bf16 v[96:111], v[80:83], v[64:67], v[96:111]
v_add_u32 v26, 65536, v13
v_add_u32 v27, 49152, v17
s_add_u32 m0, s67, s70
v_accvgpr_read_b32 v228, a248
v_accvgpr_read_b32 v229, a249
v_accvgpr_read_b32 v230, a250
v_mfma_f32_32x32x16_bf16 v[112:127], v[80:83], v[68:71], v[112:127]
ds_read_b128 v[32:35], v26 offset:0
ds_read_b64_tr_b16 v[48:49], v27 offset:0
s_add_u32 s22, s67, 16384
v_accvgpr_read_b32 v231, a251
v_cvt_pk_bf16_f32 v248, v224, v225
v_mfma_f32_32x32x16_bf16 v[128:143], v[80:83], v[72:75], v[128:143]
ds_read_b64_tr_b16 v[50:51], v27 offset:256
ds_read_b128 v[36:39], v26 offset:4096
s_sub_u32 s67, s22, 163840
s_cselect_b32 s67, s22, s67
v_cvt_pk_bf16_f32 v249, v226, v227
v_cvt_pk_bf16_f32 v250, v228, v229
v_mfma_f32_32x32x16_bf16 v[144:159], v[80:83], v[76:79], v[144:159]
ds_read_b64_tr_b16 v[52:53], v27 offset:512
ds_read_b64_tr_b16 v[54:55], v27 offset:768
buffer_load_dwordx4 v9, s[36:39], s72 offen lds
v_cvt_pk_bf16_f32 v251, v230, v231
s_add_u32 s24, s74, 49152
buffer_store_dwordx4 v[248:251], v239, s[4:7], s24 offen offset:3072 sc1
v_mfma_f32_32x32x16_bf16 v[160:175], v[84:87], v[64:67], v[160:175]
ds_read_b128 v[40:43], v26 offset:8192
ds_read_b128 v[44:47], v26 offset:12288
buffer_load_dwordx4 v10, s[36:39], s72 offen offset:1024 lds
v_accvgpr_read_b32 v224, a220
v_accvgpr_read_b32 v225, a221
v_mfma_f32_32x32x16_bf16 v[176:191], v[84:87], v[68:71], v[176:191]
buffer_load_dwordx4 v11, s[36:39], s72 offen offset:2048 lds
v_accvgpr_read_b32 v226, a222
v_accvgpr_read_b32 v227, a223
v_mfma_f32_32x32x16_bf16 v[192:207], v[84:87], v[72:75], v[192:207]
buffer_load_dwordx4 v12, s[36:39], s72 offen offset:3072 lds
v_accvgpr_read_b32 v228, a252
v_accvgpr_read_b32 v229, a253
v_mfma_f32_32x32x16_bf16 v[208:223], v[84:87], v[76:79], v[208:223]
s_add_u32 s72, s72, 128
v_accvgpr_read_b32 v230, a254
v_accvgpr_read_b32 v231, a255
s_waitcnt lgkmcnt(0)
v_mfma_f32_32x32x16_bf16 v[96:111], v[48:51], v[32:35], v[96:111]
v_add_u32 v28, 65536, v14
v_add_u32 v29, 49152, v17
s_add_u32 m0, s67, s70
s_add_u32 s22, s67, 16384
v_cvt_pk_bf16_f32 v252, v224, v225
v_cvt_pk_bf16_f32 v253, v226, v227
v_cvt_pk_bf16_f32 v254, v228, v229
v_mfma_f32_32x32x16_bf16 v[112:127], v[48:51], v[36:39], v[112:127]
ds_read_b128 v[64:67], v28 offset:0
ds_read_b64_tr_b16 v[80:81], v29 offset:2048
s_sub_u32 s67, s22, 163840
s_cselect_b32 s67, s22, s67
v_cvt_pk_bf16_f32 v255, v230, v231
s_add_u32 s24, s74, 57344
buffer_store_dwordx4 v[252:255], v239, s[4:7], s24 offen offset:3072 sc1
v_mfma_f32_32x32x16_bf16 v[128:143], v[48:51], v[40:43], v[128:143]
ds_read_b64_tr_b16 v[82:83], v29 offset:2304
ds_read_b128 v[68:71], v28 offset:4096
buffer_load_dwordx4 v5, s[40:43], s73 offen lds
v_accvgpr_read_b32 v224, a0
v_accvgpr_read_b32 v225, a1
v_mfma_f32_32x32x16_bf16 v[144:159], v[48:51], v[44:47], v[144:159]
ds_read_b64_tr_b16 v[84:85], v29 offset:2560
ds_read_b64_tr_b16 v[86:87], v29 offset:2816
buffer_load_dwordx4 v6, s[40:43], s73 offen offset:1024 lds
v_accvgpr_read_b32 v226, a2
v_accvgpr_read_b32 v227, a3
v_mfma_f32_32x32x16_bf16 v[160:175], v[52:55], v[32:35], v[160:175]
ds_read_b128 v[72:75], v28 offset:8192
ds_read_b128 v[76:79], v28 offset:12288
buffer_load_dwordx4 v7, s[40:43], s73 offen offset:2048 lds
buffer_load_dwordx4 v8, s[40:43], s73 offen offset:3072 lds
v_accvgpr_read_b32 v228, a32
v_accvgpr_read_b32 v229, a33
v_mfma_f32_32x32x16_bf16 v[176:191], v[52:55], v[36:39], v[176:191]
s_add_u32 s73, s73, 262144
v_accvgpr_read_b32 v230, a34
v_accvgpr_read_b32 v231, a35
v_mfma_f32_32x32x16_bf16 v[192:207], v[52:55], v[40:43], v[192:207]
s_add_u32 s75, s75, 1
v_cvt_pk_bf16_f32 v240, v224, v225
v_cvt_pk_bf16_f32 v241, v226, v227
v_mfma_f32_32x32x16_bf16 v[208:223], v[52:55], v[44:47], v[208:223]
s_cmp_eq_u32 s75, 7
s_cselect_b32 s72, s76, s72
s_cselect_b32 s73, s77, s73
s_cselect_b32 s75, 0, s75
v_cvt_pk_bf16_f32 v242, v228, v229
v_cvt_pk_bf16_f32 v243, v230, v231
s_waitcnt lgkmcnt(0)
v_mfma_f32_32x32x16_bf16 v[96:111], v[80:83], v[64:67], v[96:111]
v_add_u32 v26, 65536, v15
v_add_u32 v27, 81920, v17
s_add_u32 m0, s67, s70
s_add_u32 s24, s74, 0
buffer_store_dwordx4 v[240:243], v239, s[4:7], s24 offen offset:0 sc1
v_accvgpr_read_b32 v224, a4
v_accvgpr_read_b32 v225, a5
v_mfma_f32_32x32x16_bf16 v[112:127], v[80:83], v[68:71], v[112:127]
ds_read_b128 v[32:35], v26 offset:0
ds_read_b64_tr_b16 v[48:49], v27 offset:0
s_add_u32 s22, s67, 16384
v_accvgpr_read_b32 v226, a6
v_accvgpr_read_b32 v227, a7
v_mfma_f32_32x32x16_bf16 v[128:143], v[80:83], v[72:75], v[128:143]
ds_read_b64_tr_b16 v[50:51], v27 offset:256
ds_read_b128 v[36:39], v26 offset:4096
s_sub_u32 s67, s22, 163840
s_cselect_b32 s67, s22, s67
v_accvgpr_read_b32 v228, a36
v_accvgpr_read_b32 v229, a37
v_mfma_f32_32x32x16_bf16 v[144:159], v[80:83], v[76:79], v[144:159]
ds_read_b64_tr_b16 v[52:53], v27 offset:512
ds_read_b64_tr_b16 v[54:55], v27 offset:768
buffer_load_dwordx4 v5, s[40:43], s73 offen lds
v_accvgpr_read_b32 v230, a38
v_accvgpr_read_b32 v231, a39
v_mfma_f32_32x32x16_bf16 v[160:175], v[84:87], v[64:67], v[160:175]
ds_read_b128 v[40:43], v26 offset:8192
ds_read_b128 v[44:47], v26 offset:12288
buffer_load_dwordx4 v6, s[40:43], s73 offen offset:1024 lds
v_cvt_pk_bf16_f32 v244, v224, v225
v_cvt_pk_bf16_f32 v245, v226, v227
v_mfma_f32_32x32x16_bf16 v[176:191], v[84:87], v[68:71], v[176:191]
buffer_load_dwordx4 v7, s[40:43], s73 offen offset:2048 lds
v_cvt_pk_bf16_f32 v246, v228, v229
v_cvt_pk_bf16_f32 v247, v230, v231
v_mfma_f32_32x32x16_bf16 v[192:207], v[84:87], v[72:75], v[192:207]
buffer_load_dwordx4 v8, s[40:43], s73 offen offset:3072 lds
s_add_u32 s24, s74, 8192
buffer_store_dwordx4 v[244:247], v239, s[4:7], s24 offen offset:0 sc1
v_accvgpr_read_b32 v224, a8
v_mfma_f32_32x32x16_bf16 v[208:223], v[84:87], v[76:79], v[208:223]
s_add_u32 s73, s73, 262144
v_accvgpr_read_b32 v225, a9
v_accvgpr_read_b32 v226, a10
s_waitcnt lgkmcnt(0)
v_mfma_f32_32x32x16_bf16 v[96:111], v[48:51], v[32:35], v[96:111]
v_add_u32 v28, 65536, v16
v_add_u32 v29, 81920, v17
v_accvgpr_read_b32 v227, a11
v_accvgpr_read_b32 v228, a40
v_accvgpr_read_b32 v229, a41
v_mfma_f32_32x32x16_bf16 v[112:127], v[48:51], v[36:39], v[112:127]
ds_read_b128 v[64:67], v28 offset:0
ds_read_b64_tr_b16 v[80:81], v29 offset:2048
v_accvgpr_read_b32 v230, a42
v_accvgpr_read_b32 v231, a43
v_mfma_f32_32x32x16_bf16 v[128:143], v[48:51], v[40:43], v[128:143]
ds_read_b64_tr_b16 v[82:83], v29 offset:2304
ds_read_b128 v[68:71], v28 offset:4096
v_cvt_pk_bf16_f32 v248, v224, v225
v_cvt_pk_bf16_f32 v249, v226, v227
v_mfma_f32_32x32x16_bf16 v[144:159], v[48:51], v[44:47], v[144:159]
ds_read_b64_tr_b16 v[84:85], v29 offset:2560
ds_read_b64_tr_b16 v[86:87], v29 offset:2816
v_cvt_pk_bf16_f32 v250, v228, v229
v_cvt_pk_bf16_f32 v251, v230, v231
v_mfma_f32_32x32x16_bf16 v[160:175], v[52:55], v[32:35], v[160:175]
ds_read_b128 v[72:75], v28 offset:8192
ds_read_b128 v[76:79], v28 offset:12288
s_add_u32 s24, s74, 16384
buffer_store_dwordx4 v[248:251], v239, s[4:7], s24 offen offset:0 sc1
v_accvgpr_read_b32 v224, a12
v_mfma_f32_32x32x16_bf16 v[176:191], v[52:55], v[36:39], v[176:191]
v_accvgpr_read_b32 v225, a13
v_accvgpr_read_b32 v226, a14
v_mfma_f32_32x32x16_bf16 v[192:207], v[52:55], v[40:43], v[192:207]
v_accvgpr_read_b32 v227, a15
v_accvgpr_read_b32 v228, a44
v_mfma_f32_32x32x16_bf16 v[208:223], v[52:55], v[44:47], v[208:223]
v_accvgpr_read_b32 v229, a45
v_accvgpr_read_b32 v230, a46
s_waitcnt lgkmcnt(0)
s_waitcnt vmcnt(24)
s_barrier
v_mfma_f32_32x32x16_bf16 v[96:111], v[80:83], v[64:67], v[96:111]
v_add_u32 v26, 114688, v13
v_add_u32 v27, 98304, v17
s_add_u32 m0, s67, s70
v_accvgpr_read_b32 v231, a47
v_cvt_pk_bf16_f32 v252, v224, v225
v_cvt_pk_bf16_f32 v253, v226, v227
v_mfma_f32_32x32x16_bf16 v[112:127], v[80:83], v[68:71], v[112:127]
ds_read_b128 v[32:35], v26 offset:0
ds_read_b64_tr_b16 v[48:49], v27 offset:0
s_add_u32 s22, s67, 16384
v_cvt_pk_bf16_f32 v254, v228, v229
v_cvt_pk_bf16_f32 v255, v230, v231
v_mfma_f32_32x32x16_bf16 v[128:143], v[80:83], v[72:75], v[128:143]
ds_read_b64_tr_b16 v[50:51], v27 offset:256
ds_read_b128 v[36:39], v26 offset:4096
s_sub_u32 s67, s22, 163840
s_cselect_b32 s67, s22, s67
s_add_u32 s24, s74, 24576
buffer_store_dwordx4 v[252:255], v239, s[4:7], s24 offen offset:0 sc1
v_accvgpr_read_b32 v224, a16
v_mfma_f32_32x32x16_bf16 v[144:159], v[80:83], v[76:79], v[144:159]
ds_read_b64_tr_b16 v[52:53], v27 offset:512
ds_read_b64_tr_b16 v[54:55], v27 offset:768
buffer_load_dwordx4 v9, s[36:39], s72 offen lds
v_accvgpr_read_b32 v225, a17
v_accvgpr_read_b32 v226, a18
v_mfma_f32_32x32x16_bf16 v[160:175], v[84:87], v[64:67], v[160:175]
ds_read_b128 v[40:43], v26 offset:8192
ds_read_b128 v[44:47], v26 offset:12288
buffer_load_dwordx4 v10, s[36:39], s72 offen offset:1024 lds
v_accvgpr_read_b32 v227, a19
v_accvgpr_read_b32 v228, a48
v_mfma_f32_32x32x16_bf16 v[176:191], v[84:87], v[68:71], v[176:191]
buffer_load_dwordx4 v11, s[36:39], s72 offen offset:2048 lds
v_accvgpr_read_b32 v229, a49
v_accvgpr_read_b32 v230, a50
v_mfma_f32_32x32x16_bf16 v[192:207], v[84:87], v[72:75], v[192:207]
buffer_load_dwordx4 v12, s[36:39], s72 offen offset:3072 lds
v_accvgpr_read_b32 v231, a51
v_cvt_pk_bf16_f32 v240, v224, v225
v_mfma_f32_32x32x16_bf16 v[208:223], v[84:87], v[76:79], v[208:223]
s_add_u32 s72, s72, 128
v_cvt_pk_bf16_f32 v241, v226, v227
v_cvt_pk_bf16_f32 v242, v228, v229
s_waitcnt lgkmcnt(0)
v_mfma_f32_32x32x16_bf16 v[96:111], v[48:51], v[32:35], v[96:111]
v_add_u32 v28, 114688, v14
v_add_u32 v29, 98304, v17
s_add_u32 m0, s67, s70
s_add_u32 s22, s67, 16384
v_cvt_pk_bf16_f32 v243, v230, v231
s_add_u32 s24, s74, 32768
buffer_store_dwordx4 v[240:243], v239, s[4:7], s24 offen offset:0 sc1
v_accvgpr_read_b32 v224, a20
v_mfma_f32_32x32x16_bf16 v[112:127], v[48:51], v[36:39], v[112:127]
ds_read_b128 v[64:67], v28 offset:0
ds_read_b64_tr_b16 v[80:81], v29 offset:2048
s_sub_u32 s67, s22, 163840
s_cselect_b32 s67, s22, s67
v_accvgpr_read_b32 v225, a21
v_accvgpr_read_b32 v226, a22
v_mfma_f32_32x32x16_bf16 v[128:143], v[48:51], v[40:43], v[128:143]
ds_read_b64_tr_b16 v[82:83], v29 offset:2304
ds_read_b128 v[68:71], v28 offset:4096
buffer_load_dwordx4 v5, s[40:43], s73 offen lds
v_accvgpr_read_b32 v227, a23
v_accvgpr_read_b32 v228, a52
v_mfma_f32_32x32x16_bf16 v[144:159], v[48:51], v[44:47], v[144:159]
ds_read_b64_tr_b16 v[84:85], v29 offset:2560
ds_read_b64_tr_b16 v[86:87], v29 offset:2816
buffer_load_dwordx4 v6, s[40:43], s73 offen offset:1024 lds
v_accvgpr_read_b32 v229, a53
v_accvgpr_read_b32 v230, a54
v_mfma_f32_32x32x16_bf16 v[160:175], v[52:55], v[32:35], v[160:175]
ds_read_b128 v[72:75], v28 offset:8192
ds_read_b128 v[76:79], v28 offset:12288
buffer_load_dwordx4 v7, s[40:43], s73 offen offset:2048 lds
buffer_load_dwordx4 v8, s[40:43], s73 offen offset:3072 lds
v_accvgpr_read_b32 v231, a55
v_cvt_pk_bf16_f32 v244, v224, v225
v_mfma_f32_32x32x16_bf16 v[176:191], v[52:55], v[36:39], v[176:191]
s_add_u32 s73, s73, 262144
v_cvt_pk_bf16_f32 v245, v226, v227
v_cvt_pk_bf16_f32 v246, v228, v229
v_mfma_f32_32x32x16_bf16 v[192:207], v[52:55], v[40:43], v[192:207]
s_add_u32 s75, s75, 1
v_cvt_pk_bf16_f32 v247, v230, v231
s_add_u32 s24, s74, 40960
buffer_store_dwordx4 v[244:247], v239, s[4:7], s24 offen offset:0 sc1
v_mfma_f32_32x32x16_bf16 v[208:223], v[52:55], v[44:47], v[208:223]
s_cmp_eq_u32 s75, 7
s_cselect_b32 s72, s76, s72
s_cselect_b32 s73, s77, s73
s_cselect_b32 s75, 0, s75
v_accvgpr_read_b32 v224, a24
v_accvgpr_read_b32 v225, a25
s_waitcnt lgkmcnt(0)
v_mfma_f32_32x32x16_bf16 v[96:111], v[80:83], v[64:67], v[96:111]
v_add_u32 v26, 114688, v15
v_add_u32 v27, 131072, v17
v_accvgpr_read_b32 v226, a26
v_accvgpr_read_b32 v227, a27
v_accvgpr_read_b32 v228, a56
v_mfma_f32_32x32x16_bf16 v[112:127], v[80:83], v[68:71], v[112:127]
ds_read_b128 v[32:35], v26 offset:0
ds_read_b64_tr_b16 v[48:49], v27 offset:0
v_accvgpr_read_b32 v229, a57
v_accvgpr_read_b32 v230, a58
v_mfma_f32_32x32x16_bf16 v[128:143], v[80:83], v[72:75], v[128:143]
ds_read_b64_tr_b16 v[50:51], v27 offset:256
ds_read_b128 v[36:39], v26 offset:4096
v_accvgpr_read_b32 v231, a59
v_cvt_pk_bf16_f32 v248, v224, v225
v_mfma_f32_32x32x16_bf16 v[144:159], v[80:83], v[76:79], v[144:159]
ds_read_b64_tr_b16 v[52:53], v27 offset:512
ds_read_b64_tr_b16 v[54:55], v27 offset:768
v_cvt_pk_bf16_f32 v249, v226, v227
v_cvt_pk_bf16_f32 v250, v228, v229
v_mfma_f32_32x32x16_bf16 v[160:175], v[84:87], v[64:67], v[160:175]
ds_read_b128 v[40:43], v26 offset:8192
ds_read_b128 v[44:47], v26 offset:12288
v_cvt_pk_bf16_f32 v251, v230, v231
s_add_u32 s24, s74, 49152
buffer_store_dwordx4 v[248:251], v239, s[4:7], s24 offen offset:0 sc1
v_mfma_f32_32x32x16_bf16 v[176:191], v[84:87], v[68:71], v[176:191]
v_accvgpr_read_b32 v224, a28
v_accvgpr_read_b32 v225, a29
v_mfma_f32_32x32x16_bf16 v[192:207], v[84:87], v[72:75], v[192:207]
v_accvgpr_read_b32 v226, a30
v_accvgpr_read_b32 v227, a31
v_mfma_f32_32x32x16_bf16 v[208:223], v[84:87], v[76:79], v[208:223]
v_accvgpr_read_b32 v228, a60
v_accvgpr_read_b32 v229, a61
s_waitcnt lgkmcnt(0)
v_mfma_f32_32x32x16_bf16 v[96:111], v[48:51], v[32:35], v[96:111]
v_add_u32 v28, 114688, v16
v_add_u32 v29, 131072, v17
v_accvgpr_read_b32 v230, a62
v_accvgpr_read_b32 v231, a63
v_cvt_pk_bf16_f32 v252, v224, v225
v_mfma_f32_32x32x16_bf16 v[112:127], v[48:51], v[36:39], v[112:127]
ds_read_b128 v[64:67], v28 offset:0
ds_read_b64_tr_b16 v[80:81], v29 offset:2048
v_cvt_pk_bf16_f32 v253, v226, v227
v_cvt_pk_bf16_f32 v254, v228, v229
v_mfma_f32_32x32x16_bf16 v[128:143], v[48:51], v[40:43], v[128:143]
ds_read_b64_tr_b16 v[82:83], v29 offset:2304
ds_read_b128 v[68:71], v28 offset:4096
v_cvt_pk_bf16_f32 v255, v230, v231
s_add_u32 s24, s74, 57344
buffer_store_dwordx4 v[252:255], v239, s[4:7], s24 offen offset:0 sc1
v_mfma_f32_32x32x16_bf16 v[144:159], v[48:51], v[44:47], v[144:159]
ds_read_b64_tr_b16 v[84:85], v29 offset:2560
ds_read_b64_tr_b16 v[86:87], v29 offset:2816
v_accvgpr_read_b32 v224, a64
v_accvgpr_read_b32 v225, a65
v_mfma_f32_32x32x16_bf16 v[160:175], v[52:55], v[32:35], v[160:175]
ds_read_b128 v[72:75], v28 offset:8192
ds_read_b128 v[76:79], v28 offset:12288
v_accvgpr_read_b32 v226, a66
v_accvgpr_read_b32 v227, a67
v_mfma_f32_32x32x16_bf16 v[176:191], v[52:55], v[36:39], v[176:191]
v_accvgpr_read_b32 v228, a96
v_accvgpr_read_b32 v229, a97
v_mfma_f32_32x32x16_bf16 v[192:207], v[52:55], v[40:43], v[192:207]
v_accvgpr_read_b32 v230, a98
v_accvgpr_read_b32 v231, a99
v_mfma_f32_32x32x16_bf16 v[208:223], v[52:55], v[44:47], v[208:223]
v_cvt_pk_bf16_f32 v240, v224, v225
v_cvt_pk_bf16_f32 v241, v226, v227
s_waitcnt lgkmcnt(0)
s_waitcnt vmcnt(20)
s_barrier
s_sub_u32 s82, s14, 4
s_lshr_b32 s22, s14, 2
s_lshl_b32 s22, s22, 1
s_and_b32 s23, s14, 1
s_add_u32 s22, s22, s23
s_cmp_eq_u32 s17, 1
s_cselect_b32 s22, 99, s22
s_cmp_lt_u32 s14, 8
s_cselect_b32 s82, s22, s82
s_sub_u32 s83, s14, 4
s_lshr_b32 s22, s14, 2
s_lshl_b32 s22, s22, 1
s_and_b32 s23, s14, 1
s_add_u32 s22, s22, s23
s_cmp_eq_u32 s17, 0
s_cselect_b32 s22, 99, s22
s_cmp_lt_u32 s14, 8
s_cselect_b32 s83, s22, s83
s_cmp_lg_u32 s82, 99
s_cselect_b32 s22, 1835008, 0
s_cselect_b32 s23, 896, 0
s_mov_b32 s28, s26
s_and_b32 s29, s27, 0xffff
s_mov_b32 s30, s22
s_mov_b32 s31, 0x20000
s_mov_b32 s32, s78
s_and_b32 s33, s79, 0xffff
s_mov_b32 s34, s23
s_mov_b32 s35, 0x20000
s_lshl_b32 s44, s82, 3
s_add_u32 s44, s44, s13
s_lshl_b32 s44, s44, 1
s_lshr_b32 s22, s12, 1
s_and_b32 s46, s12, 1
s_add_u32 s48, s44, s22
v_lshlrev_b32 v30, 2, v25
v_subrev_u32 v31, 16, v30
v_max_i32 v31, 0, v31
s_lshl_b32 s22, s48, 12
buffer_load_dwordx4 a[192:195], v31, s[28:31], s22 offen
buffer_load_dwordx4 a[196:199], v30, s[28:31], s22 offen offset:0
buffer_load_dwordx4 a[200:203], v30, s[28:31], s22 offen offset:1008
buffer_load_dwordx4 a[204:207], v30, s[28:31], s22 offen offset:1024
buffer_load_dwordx4 a[208:211], v30, s[28:31], s22 offen offset:2032
buffer_load_dwordx4 a[212:215], v30, s[28:31], s22 offen offset:2048
buffer_load_dwordx4 a[216:219], v30, s[28:31], s22 offen offset:3056
buffer_load_dwordx4 a[220:223], v30, s[28:31], s22 offen offset:3072
s_lshl_b32 s23, s48, 1
buffer_load_ushort a224, v23, s[32:35], s23 offen
v_mfma_f32_32x32x16_bf16 v[96:111], v[80:83], v[64:67], v[96:111]
v_add_u32 v26, 0, v13
v_add_u32 v27, 147456, v17
v_cvt_pk_bf16_f32 v242, v228, v229
v_cvt_pk_bf16_f32 v243, v230, v231
s_add_u32 s24, s74, 0
buffer_store_dwordx4 v[240:243], v239, s[4:7], s24 offen offset:1024 sc1
v_mfma_f32_32x32x16_bf16 v[112:127], v[80:83], v[68:71], v[112:127]
ds_read_b128 v[32:35], v26 offset:0
ds_read_b64_tr_b16 v[48:49], v27 offset:0
v_accvgpr_read_b32 v224, a68
v_accvgpr_read_b32 v225, a69
v_mfma_f32_32x32x16_bf16 v[128:143], v[80:83], v[72:75], v[128:143]
ds_read_b64_tr_b16 v[50:51], v27 offset:256
ds_read_b128 v[36:39], v26 offset:4096
v_accvgpr_read_b32 v226, a70
v_accvgpr_read_b32 v227, a71
v_mfma_f32_32x32x16_bf16 v[144:159], v[80:83], v[76:79], v[144:159]
ds_read_b64_tr_b16 v[52:53], v27 offset:512
ds_read_b64_tr_b16 v[54:55], v27 offset:768
v_accvgpr_read_b32 v228, a100
v_accvgpr_read_b32 v229, a101
v_mfma_f32_32x32x16_bf16 v[160:175], v[84:87], v[64:67], v[160:175]
ds_read_b128 v[40:43], v26 offset:8192
ds_read_b128 v[44:47], v26 offset:12288
v_accvgpr_read_b32 v230, a102
v_accvgpr_read_b32 v231, a103
v_mfma_f32_32x32x16_bf16 v[176:191], v[84:87], v[68:71], v[176:191]
v_cvt_pk_bf16_f32 v244, v224, v225
v_cvt_pk_bf16_f32 v245, v226, v227
v_mfma_f32_32x32x16_bf16 v[192:207], v[84:87], v[72:75], v[192:207]
v_cvt_pk_bf16_f32 v246, v228, v229
v_cvt_pk_bf16_f32 v247, v230, v231
v_mfma_f32_32x32x16_bf16 v[208:223], v[84:87], v[76:79], v[208:223]
s_add_u32 s24, s74, 8192
buffer_store_dwordx4 v[244:247], v239, s[4:7], s24 offen offset:1024 sc1
v_accvgpr_read_b32 v224, a72
s_waitcnt lgkmcnt(0)
v_mfma_f32_32x32x16_bf16 v[96:111], v[48:51], v[32:35], v[96:111]
v_add_u32 v28, 0, v14
v_add_u32 v29, 147456, v17
v_accvgpr_read_b32 v225, a73
v_accvgpr_read_b32 v226, a74
v_accvgpr_read_b32 v227, a75
v_mfma_f32_32x32x16_bf16 v[112:127], v[48:51], v[36:39], v[112:127]
ds_read_b128 v[64:67], v28 offset:0
ds_read_b64_tr_b16 v[80:81], v29 offset:2048
v_accvgpr_read_b32 v228, a104
v_accvgpr_read_b32 v229, a105
v_mfma_f32_32x32x16_bf16 v[128:143], v[48:51], v[40:43], v[128:143]
ds_read_b64_tr_b16 v[82:83], v29 offset:2304
ds_read_b128 v[68:71], v28 offset:4096
v_accvgpr_read_b32 v230, a106
v_accvgpr_read_b32 v231, a107
v_mfma_f32_32x32x16_bf16 v[144:159], v[48:51], v[44:47], v[144:159]
ds_read_b64_tr_b16 v[84:85], v29 offset:2560
ds_read_b64_tr_b16 v[86:87], v29 offset:2816
v_cvt_pk_bf16_f32 v248, v224, v225
v_cvt_pk_bf16_f32 v249, v226, v227
v_mfma_f32_32x32x16_bf16 v[160:175], v[52:55], v[32:35], v[160:175]
ds_read_b128 v[72:75], v28 offset:8192
ds_read_b128 v[76:79], v28 offset:12288
v_cvt_pk_bf16_f32 v250, v228, v229
v_cvt_pk_bf16_f32 v251, v230, v231
v_mfma_f32_32x32x16_bf16 v[176:191], v[52:55], v[36:39], v[176:191]
s_add_u32 s24, s74, 16384
buffer_store_dwordx4 v[248:251], v239, s[4:7], s24 offen offset:1024 sc1
v_accvgpr_read_b32 v224, a76
v_mfma_f32_32x32x16_bf16 v[192:207], v[52:55], v[40:43], v[192:207]
v_accvgpr_read_b32 v225, a77
v_accvgpr_read_b32 v226, a78
v_mfma_f32_32x32x16_bf16 v[208:223], v[52:55], v[44:47], v[208:223]
v_accvgpr_read_b32 v227, a79
v_accvgpr_read_b32 v228, a108
s_waitcnt lgkmcnt(0)
v_mfma_f32_32x32x16_bf16 v[96:111], v[80:83], v[64:67], v[96:111]
v_add_u32 v26, 0, v15
v_add_u32 v27, 16384, v17
v_accvgpr_read_b32 v229, a109
v_accvgpr_read_b32 v230, a110
v_accvgpr_read_b32 v231, a111
v_mfma_f32_32x32x16_bf16 v[112:127], v[80:83], v[68:71], v[112:127]
ds_read_b128 v[32:35], v26 offset:0
ds_read_b64_tr_b16 v[48:49], v27 offset:0
v_cvt_pk_bf16_f32 v252, v224, v225
v_cvt_pk_bf16_f32 v253, v226, v227
v_mfma_f32_32x32x16_bf16 v[128:143], v[80:83], v[72:75], v[128:143]
ds_read_b64_tr_b16 v[50:51], v27 offset:256
ds_read_b128 v[36:39], v26 offset:4096
v_cvt_pk_bf16_f32 v254, v228, v229
v_cvt_pk_bf16_f32 v255, v230, v231
v_mfma_f32_32x32x16_bf16 v[144:159], v[80:83], v[76:79], v[144:159]
ds_read_b64_tr_b16 v[52:53], v27 offset:512
ds_read_b64_tr_b16 v[54:55], v27 offset:768
s_add_u32 s24, s74, 24576
buffer_store_dwordx4 v[252:255], v239, s[4:7], s24 offen offset:1024 sc1
v_accvgpr_read_b32 v224, a80
v_mfma_f32_32x32x16_bf16 v[160:175], v[84:87], v[64:67], v[160:175]
ds_read_b128 v[40:43], v26 offset:8192
ds_read_b128 v[44:47], v26 offset:12288
v_accvgpr_read_b32 v225, a81
v_accvgpr_read_b32 v226, a82
v_mfma_f32_32x32x16_bf16 v[176:191], v[84:87], v[68:71], v[176:191]
v_accvgpr_read_b32 v227, a83
v_accvgpr_read_b32 v228, a112
v_mfma_f32_32x32x16_bf16 v[192:207], v[84:87], v[72:75], v[192:207]
v_accvgpr_read_b32 v229, a113
v_accvgpr_read_b32 v230, a114
v_mfma_f32_32x32x16_bf16 v[208:223], v[84:87], v[76:79], v[208:223]
v_accvgpr_read_b32 v231, a115
v_cvt_pk_bf16_f32 v240, v224, v225
s_waitcnt lgkmcnt(0)
v_mfma_f32_32x32x16_bf16 v[96:111], v[48:51], v[32:35], v[96:111]
v_add_u32 v28, 0, v16
v_add_u32 v29, 16384, v17
v_cvt_pk_bf16_f32 v241, v226, v227
v_cvt_pk_bf16_f32 v242, v228, v229
v_cvt_pk_bf16_f32 v243, v230, v231
v_mfma_f32_32x32x16_bf16 v[112:127], v[48:51], v[36:39], v[112:127]
ds_read_b128 v[64:67], v28 offset:0
ds_read_b64_tr_b16 v[80:81], v29 offset:2048
s_add_u32 s24, s74, 32768
buffer_store_dwordx4 v[240:243], v239, s[4:7], s24 offen offset:1024 sc1
v_accvgpr_read_b32 v224, a84
v_mfma_f32_32x32x16_bf16 v[128:143], v[48:51], v[40:43], v[128:143]
ds_read_b64_tr_b16 v[82:83], v29 offset:2304
ds_read_b128 v[68:71], v28 offset:4096
v_accvgpr_read_b32 v225, a85
v_accvgpr_read_b32 v226, a86
v_mfma_f32_32x32x16_bf16 v[144:159], v[48:51], v[44:47], v[144:159]
ds_read_b64_tr_b16 v[84:85], v29 offset:2560
ds_read_b64_tr_b16 v[86:87], v29 offset:2816
v_accvgpr_read_b32 v227, a87
v_accvgpr_read_b32 v228, a116
v_mfma_f32_32x32x16_bf16 v[160:175], v[52:55], v[32:35], v[160:175]
ds_read_b128 v[72:75], v28 offset:8192
ds_read_b128 v[76:79], v28 offset:12288
v_accvgpr_read_b32 v229, a117
v_accvgpr_read_b32 v230, a118
v_mfma_f32_32x32x16_bf16 v[176:191], v[52:55], v[36:39], v[176:191]
v_accvgpr_read_b32 v231, a119
v_cvt_pk_bf16_f32 v244, v224, v225
v_mfma_f32_32x32x16_bf16 v[192:207], v[52:55], v[40:43], v[192:207]
v_cvt_pk_bf16_f32 v245, v226, v227
v_cvt_pk_bf16_f32 v246, v228, v229
v_mfma_f32_32x32x16_bf16 v[208:223], v[52:55], v[44:47], v[208:223]
v_cvt_pk_bf16_f32 v247, v230, v231
s_add_u32 s24, s74, 40960
buffer_store_dwordx4 v[244:247], v239, s[4:7], s24 offen offset:1024 sc1
s_waitcnt lgkmcnt(0)
s_waitcnt vmcnt(9)
s_barrier
buffer_load_dword v24, v25, s[8:11], 0 offen sc1
v_mfma_f32_32x32x16_bf16 v[96:111], v[80:83], v[64:67], v[96:111]
v_add_u32 v26, 49152, v13
v_add_u32 v27, 32768, v17
v_accvgpr_read_b32 v224, a88
v_accvgpr_read_b32 v225, a89
v_accvgpr_read_b32 v226, a90
v_mfma_f32_32x32x16_bf16 v[112:127], v[80:83], v[68:71], v[112:127]
ds_read_b128 v[32:35], v26 offset:0
ds_read_b64_tr_b16 v[48:49], v27 offset:0
v_accvgpr_read_b32 v227, a91
v_accvgpr_read_b32 v228, a120
v_mfma_f32_32x32x16_bf16 v[128:143], v[80:83], v[72:75], v[128:143]
ds_read_b64_tr_b16 v[50:51], v27 offset:256
ds_read_b128 v[36:39], v26 offset:4096
v_accvgpr_read_b32 v229, a121
v_accvgpr_read_b32 v230, a122
v_mfma_f32_32x32x16_bf16 v[144:159], v[80:83], v[76:79], v[144:159]
ds_read_b64_tr_b16 v[52:53], v27 offset:512
ds_read_b64_tr_b16 v[54:55], v27 offset:768
v_accvgpr_read_b32 v231, a123
v_cvt_pk_bf16_f32 v248, v224, v225
v_mfma_f32_32x32x16_bf16 v[160:175], v[84:87], v[64:67], v[160:175]
ds_read_b128 v[40:43], v26 offset:8192
ds_read_b128 v[44:47], v26 offset:12288
v_cvt_pk_bf16_f32 v249, v226, v227
v_cvt_pk_bf16_f32 v250, v228, v229
v_mfma_f32_32x32x16_bf16 v[176:191], v[84:87], v[68:71], v[176:191]
v_cvt_pk_bf16_f32 v251, v230, v231
s_add_u32 s24, s74, 49152
buffer_store_dwordx4 v[248:251], v239, s[4:7], s24 offen offset:1024 sc1
v_mfma_f32_32x32x16_bf16 v[192:207], v[84:87], v[72:75], v[192:207]
v_accvgpr_read_b32 v224, a92
v_accvgpr_read_b32 v225, a93
v_mfma_f32_32x32x16_bf16 v[208:223], v[84:87], v[76:79], v[208:223]
v_accvgpr_read_b32 v226, a94
v_accvgpr_read_b32 v227, a95
s_waitcnt lgkmcnt(0)
v_mfma_f32_32x32x16_bf16 v[96:111], v[48:51], v[32:35], v[96:111]
v_add_u32 v28, 49152, v14
v_add_u32 v29, 32768, v17
v_accvgpr_read_b32 v228, a124
v_accvgpr_read_b32 v229, a125
v_mfma_f32_32x32x16_bf16 v[112:127], v[48:51], v[36:39], v[112:127]
ds_read_b128 v[64:67], v28 offset:0
ds_read_b64_tr_b16 v[80:81], v29 offset:2048
v_accvgpr_read_b32 v230, a126
v_mfma_f32_32x32x16_bf16 v[128:143], v[48:51], v[40:43], v[128:143]
ds_read_b64_tr_b16 v[82:83], v29 offset:2304
ds_read_b128 v[68:71], v28 offset:4096
v_accvgpr_read_b32 v231, a127
v_mfma_f32_32x32x16_bf16 v[144:159], v[48:51], v[44:47], v[144:159]
ds_read_b64_tr_b16 v[84:85], v29 offset:2560
ds_read_b64_tr_b16 v[86:87], v29 offset:2816
v_cvt_pk_bf16_f32 v252, v224, v225
v_mfma_f32_32x32x16_bf16 v[160:175], v[52:55], v[32:35], v[160:175]
ds_read_b128 v[72:75], v28 offset:8192
ds_read_b128 v[76:79], v28 offset:12288
v_cvt_pk_bf16_f32 v253, v226, v227
v_mfma_f32_32x32x16_bf16 v[176:191], v[52:55], v[36:39], v[176:191]
v_cvt_pk_bf16_f32 v254, v228, v229
v_mfma_f32_32x32x16_bf16 v[192:207], v[52:55], v[40:43], v[192:207]
v_cvt_pk_bf16_f32 v255, v230, v231
v_mfma_f32_32x32x16_bf16 v[208:223], v[52:55], v[44:47], v[208:223]
s_add_u32 s24, s74, 57344
buffer_store_dwordx4 v[252:255], v239, s[4:7], s24 offen offset:1024 sc1
s_waitcnt lgkmcnt(0)
v_mfma_f32_32x32x16_bf16 v[96:111], v[80:83], v[64:67], v[96:111]
v_add_u32 v26, 49152, v15
v_add_u32 v27, 65536, v17
v_mfma_f32_32x32x16_bf16 v[112:127], v[80:83], v[68:71], v[112:127]
ds_read_b128 v[32:35], v26 offset:0
ds_read_b64_tr_b16 v[48:49], v27 offset:0
v_mfma_f32_32x32x16_bf16 v[128:143], v[80:83], v[72:75], v[128:143]
ds_read_b64_tr_b16 v[50:51], v27 offset:256
ds_read_b128 v[36:39], v26 offset:4096
v_mfma_f32_32x32x16_bf16 v[144:159], v[80:83], v[76:79], v[144:159]
ds_read_b64_tr_b16 v[52:53], v27 offset:512
ds_read_b64_tr_b16 v[54:55], v27 offset:768
v_mfma_f32_32x32x16_bf16 v[160:175], v[84:87], v[64:67], v[160:175]
ds_read_b128 v[40:43], v26 offset:8192
ds_read_b128 v[44:47], v26 offset:12288
v_mfma_f32_32x32x16_bf16 v[176:191], v[84:87], v[68:71], v[176:191]
v_mfma_f32_32x32x16_bf16 v[192:207], v[84:87], v[72:75], v[192:207]
v_mfma_f32_32x32x16_bf16 v[208:223], v[84:87], v[76:79], v[208:223]
s_waitcnt lgkmcnt(0)
v_mfma_f32_32x32x16_bf16 v[96:111], v[48:51], v[32:35], v[96:111]
v_add_u32 v28, 49152, v16
v_add_u32 v29, 65536, v17
v_mfma_f32_32x32x16_bf16 v[112:127], v[48:51], v[36:39], v[112:127]
ds_read_b128 v[64:67], v28 offset:0
ds_read_b64_tr_b16 v[80:81], v29 offset:2048
v_mfma_f32_32x32x16_bf16 v[128:143], v[48:51], v[40:43], v[128:143]
ds_read_b64_tr_b16 v[82:83], v29 offset:2304
ds_read_b128 v[68:71], v28 offset:4096
v_mfma_f32_32x32x16_bf16 v[144:159], v[48:51], v[44:47], v[144:159]
ds_read_b64_tr_b16 v[84:85], v29 offset:2560
ds_read_b64_tr_b16 v[86:87], v29 offset:2816
v_mfma_f32_32x32x16_bf16 v[160:175], v[52:55], v[32:35], v[160:175]
ds_read_b128 v[72:75], v28 offset:8192
ds_read_b128 v[76:79], v28 offset:12288
v_mfma_f32_32x32x16_bf16 v[176:191], v[52:55], v[36:39], v[176:191]
v_mfma_f32_32x32x16_bf16 v[192:207], v[52:55], v[40:43], v[192:207]
v_mfma_f32_32x32x16_bf16 v[208:223], v[52:55], v[44:47], v[208:223]
s_waitcnt lgkmcnt(0)
v_mfma_f32_32x32x16_bf16 v[96:111], v[80:83], v[64:67], v[96:111]
v_mfma_f32_32x32x16_bf16 v[112:127], v[80:83], v[68:71], v[112:127]
v_mfma_f32_32x32x16_bf16 v[128:143], v[80:83], v[72:75], v[128:143]
v_mfma_f32_32x32x16_bf16 v[144:159], v[80:83], v[76:79], v[144:159]
v_mfma_f32_32x32x16_bf16 v[160:175], v[84:87], v[64:67], v[160:175]
v_mfma_f32_32x32x16_bf16 v[176:191], v[84:87], v[68:71], v[176:191]
v_mfma_f32_32x32x16_bf16 v[192:207], v[84:87], v[72:75], v[192:207]
v_mfma_f32_32x32x16_bf16 v[208:223], v[84:87], v[76:79], v[208:223]
s_waitcnt vmcnt(2)
F_CHK_K:
v_subrev_u32 v224, 0x01010101, v24
v_not_b32 v225, v24
v_and_b32 v224, v224, v225
v_and_b32 v224, 0x80808080, v224
v_cmp_ne_u32 vcc, 0, v224
s_cbranch_vccz F_CHK_OK_K
s_sleep 4
buffer_load_dword v24, v25, s[8:11], 0 offen sc1
s_waitcnt vmcnt(0)
s_branch F_CHK_K
F_CHK_OK_K:
s_add_u32 s22, s18, 1
s_mul_i32 s22, s22, 0x01010101
v_and_b32 v224, 0x7f7f7f7f, v24
v_cmp_eq_u32 s[24:25], s22, v224
s_lshl_b32 s23, s15, 2
s_nop 3
s_lshr_b64 s[24:25], s[24:25], s23
s_and_b32 s24, s24, 15
s_cmp_eq_u32 s24, 15
s_cselect_b32 s19, 1, 0
s_mov_b32 s19, 1
s_mov_b32 s40, s48
s_lshr_b32 s22, s12, 1
s_mul_i32 s41, s22, 45312
s_add_u32 s41, s41, 65536
s_add_u32 s42, s41, 33280
s_add_u32 s43, s42, 7680
v_and_b32 v5, 63, v0
v_lshlrev_b32 v1, 4, v5
s_lshl_b32 s22, s40, 12
s_mul_i32 s23, s46, 4194304
s_add_u32 s23, s23, s22
s_add_u32 s23, s23, 104857600
buffer_load_dwordx4 v[64:67], v1, s[4:7], s23 offen offset:0 sc1
buffer_load_dwordx4 v[68:71], v1, s[4:7], s23 offen offset:1024 sc1
buffer_load_dwordx4 v[72:75], v1, s[4:7], s23 offen offset:2048 sc1
buffer_load_dwordx4 v[76:79], v1, s[4:7], s23 offen offset:3072 sc1
s_nop 7
s_waitcnt vmcnt(4)
s_barrier
s_cmp_lg_u32 s12, 0
s_cbranch_scc1 F_FS_KVE0
s_cmp_lg_u32 s19, 0
s_cbranch_scc1 F_REL_KVE0
buffer_wbl2 sc1
s_waitcnt vmcnt(0)
F_REL_KVE0:
s_lshr_b32 s23, s14, 1
s_lshl_b32 s23, s23, 2
s_add_u32 s23, s23, s20
v_mov_b32 v224, 1
v_mov_b32 v225, 0
s_mov_b64 exec, 1
buffer_store_dword v224, v225, s[4:7], s23 offen sc1
s_mov_b64 exec, -1
F_FS_KVE0:
v_and_b32 v26, 15, v0
v_lshlrev_b32 v26, 4, v26
v_bfe_u32 v27, v0, 4, 1
v_lshlrev_b32 v27, 13, v27
v_add_u32 v26, v26, v27
v_bfe_u32 v27, v0, 5, 1
v_lshlrev_b32 v27, 8, v27
s_lshr_b32 s22, s70, 1
v_add3_u32 v27, v26, v27, s22
s_sub_u32 s22, 15, s16
s_lshl_b32 s22, s22, 16
s_lshl_b32 s23, s15, 20
s_add_u32 s25, s22, s23
v_mul_f32 v96, 0x3db8aa3b, v96
v_mul_f32 v97, 0x3db8aa3b, v97
v_cvt_pk_bf16_f32 v32, v96, v97
v_mul_f32 v98, 0x3db8aa3b, v98
v_mul_f32 v99, 0x3db8aa3b, v99
v_cvt_pk_bf16_f32 v33, v98, v99
v_mul_f32 v104, 0x3db8aa3b, v104
v_mul_f32 v105, 0x3db8aa3b, v105
v_cvt_pk_bf16_f32 v34, v104, v105
v_mul_f32 v106, 0x3db8aa3b, v106
v_mul_f32 v107, 0x3db8aa3b, v107
v_cvt_pk_bf16_f32 v35, v106, v107
ds_write_b128 v27, v[32:35] offset:0
buffer_store_dwordx4 v[32:35], v27, s[4:7], s25 offen offset:0 sc1
v_mul_f32 v100, 0x3db8aa3b, v100
v_mul_f32 v101, 0x3db8aa3b, v101
v_cvt_pk_bf16_f32 v36, v100, v101
v_mul_f32 v102, 0x3db8aa3b, v102
v_mul_f32 v103, 0x3db8aa3b, v103
v_cvt_pk_bf16_f32 v37, v102, v103
v_mul_f32 v108, 0x3db8aa3b, v108
v_mul_f32 v109, 0x3db8aa3b, v109
v_cvt_pk_bf16_f32 v38, v108, v109
v_mul_f32 v110, 0x3db8aa3b, v110
v_mul_f32 v111, 0x3db8aa3b, v111
v_cvt_pk_bf16_f32 v39, v110, v111
ds_write_b128 v27, v[36:39] offset:512
buffer_store_dwordx4 v[36:39], v27, s[4:7], s25 offen offset:512 sc1
v_mul_f32 v160, 0x3db8aa3b, v160
v_mul_f32 v161, 0x3db8aa3b, v161
v_cvt_pk_bf16_f32 v40, v160, v161
v_mul_f32 v162, 0x3db8aa3b, v162
v_mul_f32 v163, 0x3db8aa3b, v163
v_cvt_pk_bf16_f32 v41, v162, v163
v_mul_f32 v168, 0x3db8aa3b, v168
v_mul_f32 v169, 0x3db8aa3b, v169
v_cvt_pk_bf16_f32 v42, v168, v169
v_mul_f32 v170, 0x3db8aa3b, v170
v_mul_f32 v171, 0x3db8aa3b, v171
v_cvt_pk_bf16_f32 v43, v170, v171
ds_write_b128 v27, v[40:43] offset:1024
buffer_store_dwordx4 v[40:43], v27, s[4:7], s25 offen offset:1024 sc1
v_mul_f32 v164, 0x3db8aa3b, v164
v_mul_f32 v165, 0x3db8aa3b, v165
v_cvt_pk_bf16_f32 v44, v164, v165
v_mul_f32 v166, 0x3db8aa3b, v166
v_mul_f32 v167, 0x3db8aa3b, v167
v_cvt_pk_bf16_f32 v45, v166, v167
v_mul_f32 v172, 0x3db8aa3b, v172
v_mul_f32 v173, 0x3db8aa3b, v173
v_cvt_pk_bf16_f32 v46, v172, v173
v_mul_f32 v174, 0x3db8aa3b, v174
v_mul_f32 v175, 0x3db8aa3b, v175
v_cvt_pk_bf16_f32 v47, v174, v175
ds_write_b128 v27, v[44:47] offset:1536
buffer_store_dwordx4 v[44:47], v27, s[4:7], s25 offen offset:1536 sc1
v_mul_f32 v112, 0x3db8aa3b, v112
v_mul_f32 v113, 0x3db8aa3b, v113
v_cvt_pk_bf16_f32 v48, v112, v113
v_mul_f32 v114, 0x3db8aa3b, v114
v_mul_f32 v115, 0x3db8aa3b, v115
v_cvt_pk_bf16_f32 v49, v114, v115
v_mul_f32 v120, 0x3db8aa3b, v120
v_mul_f32 v121, 0x3db8aa3b, v121
v_cvt_pk_bf16_f32 v50, v120, v121
v_mul_f32 v122, 0x3db8aa3b, v122
v_mul_f32 v123, 0x3db8aa3b, v123
v_cvt_pk_bf16_f32 v51, v122, v123
ds_write_b128 v27, v[48:51] offset:16384
s_add_u32 s25, s25, 16384
buffer_store_dwordx4 v[48:51], v27, s[4:7], s25 offen offset:0 sc1
v_mul_f32 v116, 0x3db8aa3b, v116
v_mul_f32 v117, 0x3db8aa3b, v117
v_cvt_pk_bf16_f32 v52, v116, v117
v_mul_f32 v118, 0x3db8aa3b, v118
v_mul_f32 v119, 0x3db8aa3b, v119
v_cvt_pk_bf16_f32 v53, v118, v119
v_mul_f32 v124, 0x3db8aa3b, v124
v_mul_f32 v125, 0x3db8aa3b, v125
v_cvt_pk_bf16_f32 v54, v124, v125
v_mul_f32 v126, 0x3db8aa3b, v126
v_mul_f32 v127, 0x3db8aa3b, v127
v_cvt_pk_bf16_f32 v55, v126, v127
ds_write_b128 v27, v[52:55] offset:16896
buffer_store_dwordx4 v[52:55], v27, s[4:7], s25 offen offset:512 sc1
v_mul_f32 v176, 0x3db8aa3b, v176
v_mul_f32 v177, 0x3db8aa3b, v177
v_cvt_pk_bf16_f32 v56, v176, v177
v_mul_f32 v178, 0x3db8aa3b, v178
v_mul_f32 v179, 0x3db8aa3b, v179
v_cvt_pk_bf16_f32 v57, v178, v179
v_mul_f32 v184, 0x3db8aa3b, v184
v_mul_f32 v185, 0x3db8aa3b, v185
v_cvt_pk_bf16_f32 v58, v184, v185
v_mul_f32 v186, 0x3db8aa3b, v186
v_mul_f32 v187, 0x3db8aa3b, v187
v_cvt_pk_bf16_f32 v59, v186, v187
ds_write_b128 v27, v[56:59] offset:17408
buffer_store_dwordx4 v[56:59], v27, s[4:7], s25 offen offset:1024 sc1
v_mul_f32 v180, 0x3db8aa3b, v180
v_mul_f32 v181, 0x3db8aa3b, v181
v_cvt_pk_bf16_f32 v60, v180, v181
v_mul_f32 v182, 0x3db8aa3b, v182
v_mul_f32 v183, 0x3db8aa3b, v183
v_cvt_pk_bf16_f32 v61, v182, v183
v_mul_f32 v188, 0x3db8aa3b, v188
v_mul_f32 v189, 0x3db8aa3b, v189
v_cvt_pk_bf16_f32 v62, v188, v189
v_mul_f32 v190, 0x3db8aa3b, v190
v_mul_f32 v191, 0x3db8aa3b, v191
v_cvt_pk_bf16_f32 v63, v190, v191
ds_write_b128 v27, v[60:63] offset:17920
buffer_store_dwordx4 v[60:63], v27, s[4:7], s25 offen offset:1536 sc1
v_mul_f32 v128, 0x3db8aa3b, v128
v_mul_f32 v129, 0x3db8aa3b, v129
v_cvt_pk_bf16_f32 v32, v128, v129
v_mul_f32 v130, 0x3db8aa3b, v130
v_mul_f32 v131, 0x3db8aa3b, v131
v_cvt_pk_bf16_f32 v33, v130, v131
v_mul_f32 v136, 0x3db8aa3b, v136
v_mul_f32 v137, 0x3db8aa3b, v137
v_cvt_pk_bf16_f32 v34, v136, v137
v_mul_f32 v138, 0x3db8aa3b, v138
v_mul_f32 v139, 0x3db8aa3b, v139
v_cvt_pk_bf16_f32 v35, v138, v139
ds_write_b128 v27, v[32:35] offset:32768
s_add_u32 s25, s25, 16384
buffer_store_dwordx4 v[32:35], v27, s[4:7], s25 offen offset:0 sc1
v_mul_f32 v132, 0x3db8aa3b, v132
v_mul_f32 v133, 0x3db8aa3b, v133
v_cvt_pk_bf16_f32 v36, v132, v133
v_mul_f32 v134, 0x3db8aa3b, v134
v_mul_f32 v135, 0x3db8aa3b, v135
v_cvt_pk_bf16_f32 v37, v134, v135
v_mul_f32 v140, 0x3db8aa3b, v140
v_mul_f32 v141, 0x3db8aa3b, v141
v_cvt_pk_bf16_f32 v38, v140, v141
v_mul_f32 v142, 0x3db8aa3b, v142
v_mul_f32 v143, 0x3db8aa3b, v143
v_cvt_pk_bf16_f32 v39, v142, v143
ds_write_b128 v27, v[36:39] offset:33280
buffer_store_dwordx4 v[36:39], v27, s[4:7], s25 offen offset:512 sc1
v_mul_f32 v192, 0x3db8aa3b, v192
v_mul_f32 v193, 0x3db8aa3b, v193
v_cvt_pk_bf16_f32 v40, v192, v193
v_mul_f32 v194, 0x3db8aa3b, v194
v_mul_f32 v195, 0x3db8aa3b, v195
v_cvt_pk_bf16_f32 v41, v194, v195
v_mul_f32 v200, 0x3db8aa3b, v200
v_mul_f32 v201, 0x3db8aa3b, v201
v_cvt_pk_bf16_f32 v42, v200, v201
v_mul_f32 v202, 0x3db8aa3b, v202
v_mul_f32 v203, 0x3db8aa3b, v203
v_cvt_pk_bf16_f32 v43, v202, v203
ds_write_b128 v27, v[40:43] offset:33792
buffer_store_dwordx4 v[40:43], v27, s[4:7], s25 offen offset:1024 sc1
v_mul_f32 v196, 0x3db8aa3b, v196
v_mul_f32 v197, 0x3db8aa3b, v197
v_cvt_pk_bf16_f32 v44, v196, v197
v_mul_f32 v198, 0x3db8aa3b, v198
v_mul_f32 v199, 0x3db8aa3b, v199
v_cvt_pk_bf16_f32 v45, v198, v199
v_mul_f32 v204, 0x3db8aa3b, v204
v_mul_f32 v205, 0x3db8aa3b, v205
v_cvt_pk_bf16_f32 v46, v204, v205
v_mul_f32 v206, 0x3db8aa3b, v206
v_mul_f32 v207, 0x3db8aa3b, v207
v_cvt_pk_bf16_f32 v47, v206, v207
ds_write_b128 v27, v[44:47] offset:34304
buffer_store_dwordx4 v[44:47], v27, s[4:7], s25 offen offset:1536 sc1
v_mul_f32 v144, 0x3db8aa3b, v144
v_mul_f32 v145, 0x3db8aa3b, v145
v_cvt_pk_bf16_f32 v48, v144, v145
v_mul_f32 v146, 0x3db8aa3b, v146
v_mul_f32 v147, 0x3db8aa3b, v147
v_cvt_pk_bf16_f32 v49, v146, v147
v_mul_f32 v152, 0x3db8aa3b, v152
v_mul_f32 v153, 0x3db8aa3b, v153
v_cvt_pk_bf16_f32 v50, v152, v153
v_mul_f32 v154, 0x3db8aa3b, v154
v_mul_f32 v155, 0x3db8aa3b, v155
v_cvt_pk_bf16_f32 v51, v154, v155
ds_write_b128 v27, v[48:51] offset:49152
s_add_u32 s25, s25, 16384
buffer_store_dwordx4 v[48:51], v27, s[4:7], s25 offen offset:0 sc1
v_mul_f32 v148, 0x3db8aa3b, v148
v_mul_f32 v149, 0x3db8aa3b, v149
v_cvt_pk_bf16_f32 v52, v148, v149
v_mul_f32 v150, 0x3db8aa3b, v150
v_mul_f32 v151, 0x3db8aa3b, v151
v_cvt_pk_bf16_f32 v53, v150, v151
v_mul_f32 v156, 0x3db8aa3b, v156
v_mul_f32 v157, 0x3db8aa3b, v157
v_cvt_pk_bf16_f32 v54, v156, v157
v_mul_f32 v158, 0x3db8aa3b, v158
v_mul_f32 v159, 0x3db8aa3b, v159
v_cvt_pk_bf16_f32 v55, v158, v159
ds_write_b128 v27, v[52:55] offset:49664
buffer_store_dwordx4 v[52:55], v27, s[4:7], s25 offen offset:512 sc1
v_mul_f32 v208, 0x3db8aa3b, v208
v_mul_f32 v209, 0x3db8aa3b, v209
v_cvt_pk_bf16_f32 v56, v208, v209
v_mul_f32 v210, 0x3db8aa3b, v210
v_mul_f32 v211, 0x3db8aa3b, v211
v_cvt_pk_bf16_f32 v57, v210, v211
v_mul_f32 v216, 0x3db8aa3b, v216
v_mul_f32 v217, 0x3db8aa3b, v217
v_cvt_pk_bf16_f32 v58, v216, v217
v_mul_f32 v218, 0x3db8aa3b, v218
v_mul_f32 v219, 0x3db8aa3b, v219
v_cvt_pk_bf16_f32 v59, v218, v219
ds_write_b128 v27, v[56:59] offset:50176
buffer_store_dwordx4 v[56:59], v27, s[4:7], s25 offen offset:1024 sc1
v_mul_f32 v212, 0x3db8aa3b, v212
v_mul_f32 v213, 0x3db8aa3b, v213
v_cvt_pk_bf16_f32 v60, v212, v213
v_mul_f32 v214, 0x3db8aa3b, v214
v_mul_f32 v215, 0x3db8aa3b, v215
v_cvt_pk_bf16_f32 v61, v214, v215
v_mul_f32 v220, 0x3db8aa3b, v220
v_mul_f32 v221, 0x3db8aa3b, v221
v_cvt_pk_bf16_f32 v62, v220, v221
v_mul_f32 v222, 0x3db8aa3b, v222
v_mul_f32 v223, 0x3db8aa3b, v223
v_cvt_pk_bf16_f32 v63, v222, v223
ds_write_b128 v27, v[60:63] offset:50688
buffer_store_dwordx4 v[60:63], v27, s[4:7], s25 offen offset:1536 sc1
v_accvgpr_read_b32 v128, a192
v_accvgpr_read_b32 v129, a193
v_accvgpr_read_b32 v130, a194
v_accvgpr_read_b32 v131, a195
v_accvgpr_read_b32 v132, a196
v_accvgpr_read_b32 v133, a197
v_accvgpr_read_b32 v134, a198
v_accvgpr_read_b32 v135, a199
v_accvgpr_read_b32 v136, a200
v_accvgpr_read_b32 v137, a201
v_accvgpr_read_b32 v138, a202
v_accvgpr_read_b32 v139, a203
v_accvgpr_read_b32 v140, a204
v_accvgpr_read_b32 v141, a205
v_accvgpr_read_b32 v142, a206
v_accvgpr_read_b32 v143, a207
v_accvgpr_read_b32 v144, a208
v_accvgpr_read_b32 v145, a209
v_accvgpr_read_b32 v146, a210
v_accvgpr_read_b32 v147, a211
v_accvgpr_read_b32 v148, a212
v_accvgpr_read_b32 v149, a213
v_accvgpr_read_b32 v150, a214
v_accvgpr_read_b32 v151, a215
v_accvgpr_read_b32 v152, a216
v_accvgpr_read_b32 v153, a217
v_accvgpr_read_b32 v154, a218
v_accvgpr_read_b32 v155, a219
v_accvgpr_read_b32 v156, a220
v_accvgpr_read_b32 v157, a221
v_accvgpr_read_b32 v158, a222
v_accvgpr_read_b32 v159, a223
v_accvgpr_read_b32 v12, a224
s_waitcnt vmcnt(16)
s_mov_b32 s79, s74
s_mov_b32 s36, s4
s_and_b32 s37, s5, 0xffff
s_mov_b32 s38, 0
s_mov_b32 s39, 0x20000
s_waitcnt lgkmcnt(0)
s_barrier
s_lshl_b32 s22, s12, 14
v_and_b32 v26, 63, v0
v_lshlrev_b32 v26, 4, v26
v_add_u32 v26, s22, v26
ds_read_b128 a[128:131], v26 offset:0
ds_read_b128 a[132:135], v26 offset:1024
ds_read_b128 a[136:139], v26 offset:2048
ds_read_b128 a[140:143], v26 offset:3072
ds_read_b128 a[144:147], v26 offset:4096
ds_read_b128 a[148:151], v26 offset:5120
ds_read_b128 a[152:155], v26 offset:6144
ds_read_b128 a[156:159], v26 offset:7168
ds_read_b128 a[160:163], v26 offset:8192
ds_read_b128 a[164:167], v26 offset:9216
ds_read_b128 a[168:171], v26 offset:10240
ds_read_b128 a[172:175], v26 offset:11264
ds_read_b128 a[176:179], v26 offset:12288
ds_read_b128 a[180:183], v26 offset:13312
ds_read_b128 a[184:187], v26 offset:14336
ds_read_b128 a[188:191], v26 offset:15360
s_branch F_MID
F_V:
s_waitcnt lgkmcnt(0)
s_waitcnt vmcnt(8)
s_barrier
v_mfma_f32_16x16x32_bf16 a[0:3], v[32:35], v[64:67], 0
ds_read_b128 v[96:99], v20 offset:0
v_mfma_f32_16x16x32_bf16 a[4:7], v[36:39], v[64:67], 0
s_add_u32 m0, s67, s70
s_add_u32 s22, s67, 16384
v_mfma_f32_16x16x32_bf16 a[8:11], v[40:43], v[64:67], 0
ds_read_b64_tr_b16 v[128:129], v22 offset:0
v_mfma_f32_16x16x32_bf16 a[12:15], v[44:47], v[64:67], 0
s_sub_u32 s67, s22, 163840
s_cselect_b32 s67, s22, s67
buffer_load_dwordx4 v1, s[28:31], s68 offen lds
v_mfma_f32_16x16x32_bf16 a[16:19], v[48:51], v[64:67], 0
ds_read_b64_tr_b16 v[130:131], v22 offset:1024
v_mfma_f32_16x16x32_bf16 a[20:23], v[52:55], v[64:67], 0
buffer_load_dwordx4 v2, s[28:31], s68 offen offset:1024 lds
v_mfma_f32_16x16x32_bf16 a[24:27], v[56:59], v[64:67], 0
ds_read_b128 v[100:103], v20 offset:2048
v_mfma_f32_16x16x32_bf16 a[28:31], v[60:63], v[64:67], 0
buffer_load_dwordx4 v3, s[28:31], s68 offen offset:2048 lds
buffer_load_dwordx4 v4, s[28:31], s68 offen offset:3072 lds
v_mfma_f32_16x16x32_bf16 a[32:35], v[32:35], v[68:71], 0
ds_read_b64_tr_b16 v[132:133], v22 offset:256
v_mfma_f32_16x16x32_bf16 a[36:39], v[36:39], v[68:71], 0
s_sub_u32 s68, s68, 262016
s_bitset0_b32 s68, 11
v_mfma_f32_16x16x32_bf16 a[40:43], v[40:43], v[68:71], 0
ds_read_b64_tr_b16 v[134:135], v22 offset:1280
v_mfma_f32_16x16x32_bf16 a[44:47], v[44:47], v[68:71], 0
s_add_u32 m0, s67, s70
v_mfma_f32_16x16x32_bf16 a[48:51], v[48:51], v[68:71], 0
ds_read_b128 v[104:107], v20 offset:4096
v_mfma_f32_16x16x32_bf16 a[52:55], v[52:55], v[68:71], 0
s_add_u32 s22, s67, 16384
s_sub_u32 s67, s22, 163840
s_cselect_b32 s67, s22, s67
v_mfma_f32_16x16x32_bf16 a[56:59], v[56:59], v[68:71], 0
ds_read_b64_tr_b16 v[136:137], v22 offset:512
v_mfma_f32_16x16x32_bf16 a[60:63], v[60:63], v[68:71], 0
buffer_load_dwordx4 v232, s[32:35], s69 offen lds
v_mfma_f32_16x16x32_bf16 a[64:67], v[32:35], v[72:75], 0
ds_read_b64_tr_b16 v[138:139], v22 offset:1536
v_mfma_f32_16x16x32_bf16 a[68:71], v[36:39], v[72:75], 0
buffer_load_dwordx4 v233, s[32:35], s69 offen offset:1024 lds
buffer_load_dwordx4 v234, s[32:35], s69 offen offset:2048 lds
v_mfma_f32_16x16x32_bf16 a[72:75], v[40:43], v[72:75], 0
ds_read_b128 v[108:111], v20 offset:6144
v_mfma_f32_16x16x32_bf16 a[76:79], v[44:47], v[72:75], 0
buffer_load_dwordx4 v235, s[32:35], s69 offen offset:3072 lds
s_add_u32 s69, s69, 262144
v_mfma_f32_16x16x32_bf16 a[80:83], v[48:51], v[72:75], 0
ds_read_b64_tr_b16 v[140:141], v22 offset:768
v_mfma_f32_16x16x32_bf16 a[84:87], v[52:55], v[72:75], 0
s_and_b32 s69, s69, 0x7fffff
v_mfma_f32_16x16x32_bf16 a[88:91], v[56:59], v[72:75], 0
ds_read_b64_tr_b16 v[142:143], v22 offset:1792
v_mfma_f32_16x16x32_bf16 a[92:95], v[60:63], v[72:75], 0
s_add_u32 m0, s67, s70
s_add_u32 s22, s67, 16384
v_mfma_f32_16x16x32_bf16 a[96:99], v[32:35], v[76:79], 0
ds_read_b128 v[112:115], v20 offset:8192
v_mfma_f32_16x16x32_bf16 a[100:103], v[36:39], v[76:79], 0
s_sub_u32 s67, s22, 163840
s_cselect_b32 s67, s22, s67
buffer_load_dwordx4 v232, s[32:35], s69 offen lds
v_mfma_f32_16x16x32_bf16 a[104:107], v[40:43], v[76:79], 0
ds_read_b64_tr_b16 v[144:145], v22 offset:4096
v_mfma_f32_16x16x32_bf16 a[108:111], v[44:47], v[76:79], 0
buffer_load_dwordx4 v233, s[32:35], s69 offen offset:1024 lds
v_mfma_f32_16x16x32_bf16 a[112:115], v[48:51], v[76:79], 0
ds_read_b64_tr_b16 v[146:147], v22 offset:5120
v_mfma_f32_16x16x32_bf16 a[116:119], v[52:55], v[76:79], 0
buffer_load_dwordx4 v234, s[32:35], s69 offen offset:2048 lds
buffer_load_dwordx4 v235, s[32:35], s69 offen offset:3072 lds
v_mfma_f32_16x16x32_bf16 a[120:123], v[56:59], v[76:79], 0
ds_read_b128 v[116:119], v20 offset:10240
v_mfma_f32_16x16x32_bf16 a[124:127], v[60:63], v[76:79], 0
s_add_u32 s69, s69, 262144
v_mfma_f32_16x16x32_bf16 a[128:131], v[32:35], v[80:83], 0
ds_read_b64_tr_b16 v[148:149], v22 offset:4352
v_mfma_f32_16x16x32_bf16 a[132:135], v[36:39], v[80:83], 0
s_and_b32 s69, s69, 0x7fffff
s_add_u32 m0, s67, s70
v_mfma_f32_16x16x32_bf16 a[136:139], v[40:43], v[80:83], 0
ds_read_b64_tr_b16 v[150:151], v22 offset:5376
v_mfma_f32_16x16x32_bf16 a[140:143], v[44:47], v[80:83], 0
s_add_u32 s22, s67, 16384
s_sub_u32 s67, s22, 163840
s_cselect_b32 s67, s22, s67
v_mfma_f32_16x16x32_bf16 a[144:147], v[48:51], v[80:83], 0
ds_read_b128 v[120:123], v20 offset:12288
v_mfma_f32_16x16x32_bf16 a[148:151], v[52:55], v[80:83], 0
buffer_load_dwordx4 v1, s[28:31], s68 offen lds
v_mfma_f32_16x16x32_bf16 a[152:155], v[56:59], v[80:83], 0
ds_read_b64_tr_b16 v[152:153], v22 offset:4608
v_mfma_f32_16x16x32_bf16 a[156:159], v[60:63], v[80:83], 0
buffer_load_dwordx4 v2, s[28:31], s68 offen offset:1024 lds
buffer_load_dwordx4 v3, s[28:31], s68 offen offset:2048 lds
v_mfma_f32_16x16x32_bf16 a[160:163], v[32:35], v[84:87], 0
ds_read_b64_tr_b16 v[154:155], v22 offset:5632
v_mfma_f32_16x16x32_bf16 a[164:167], v[36:39], v[84:87], 0
buffer_load_dwordx4 v4, s[28:31], s68 offen offset:3072 lds
s_add_u32 s68, s68, 262144
v_mfma_f32_16x16x32_bf16 a[168:171], v[40:43], v[84:87], 0
ds_read_b128 v[124:127], v20 offset:14336
v_mfma_f32_16x16x32_bf16 a[172:175], v[44:47], v[84:87], 0
s_add_u32 m0, s67, s70
v_mfma_f32_16x16x32_bf16 a[176:179], v[48:51], v[84:87], 0
ds_read_b64_tr_b16 v[156:157], v22 offset:4864
v_mfma_f32_16x16x32_bf16 a[180:183], v[52:55], v[84:87], 0
s_add_u32 s22, s67, 16384
s_sub_u32 s67, s22, 163840
s_cselect_b32 s67, s22, s67
v_mfma_f32_16x16x32_bf16 a[184:187], v[56:59], v[84:87], 0
ds_read_b64_tr_b16 v[158:159], v22 offset:5888
v_mfma_f32_16x16x32_bf16 a[188:191], v[60:63], v[84:87], 0
buffer_load_dwordx4 v1, s[28:31], s68 offen lds
v_mfma_f32_16x16x32_bf16 a[192:195], v[32:35], v[88:91], 0
v_mfma_f32_16x16x32_bf16 a[196:199], v[36:39], v[88:91], 0
buffer_load_dwordx4 v2, s[28:31], s68 offen offset:1024 lds
buffer_load_dwordx4 v3, s[28:31], s68 offen offset:2048 lds
v_mfma_f32_16x16x32_bf16 a[200:203], v[40:43], v[88:91], 0
v_mfma_f32_16x16x32_bf16 a[204:207], v[44:47], v[88:91], 0
buffer_load_dwordx4 v4, s[28:31], s68 offen offset:3072 lds
s_sub_u32 s68, s68, 262016
v_mfma_f32_16x16x32_bf16 a[208:211], v[48:51], v[88:91], 0
v_mfma_f32_16x16x32_bf16 a[212:215], v[52:55], v[88:91], 0
s_bitset0_b32 s68, 11
v_mfma_f32_16x16x32_bf16 a[216:219], v[56:59], v[88:91], 0
v_mfma_f32_16x16x32_bf16 a[220:223], v[60:63], v[88:91], 0
s_add_u32 s23, s64, 65536
s_sub_u32 s64, s23, 163840
s_cselect_b32 s64, s23, s64
v_mfma_f32_16x16x32_bf16 a[224:227], v[32:35], v[92:95], 0
v_mfma_f32_16x16x32_bf16 a[228:231], v[36:39], v[92:95], 0
s_add_u32 s23, s65, 65536
s_sub_u32 s65, s23, 163840
s_cselect_b32 s65, s23, s65
v_mfma_f32_16x16x32_bf16 a[232:235], v[40:43], v[92:95], 0
v_mfma_f32_16x16x32_bf16 a[236:239], v[44:47], v[92:95], 0
s_add_u32 s23, s66, 65536
v_mfma_f32_16x16x32_bf16 a[240:243], v[48:51], v[92:95], 0
v_mfma_f32_16x16x32_bf16 a[244:247], v[52:55], v[92:95], 0
s_sub_u32 s66, s23, 163840
s_cselect_b32 s66, s23, s66
v_add_u32 v19, s65, v236
v_mfma_f32_16x16x32_bf16 a[248:251], v[56:59], v[92:95], 0
v_mfma_f32_16x16x32_bf16 a[252:255], v[60:63], v[92:95], 0
v_add_u32 v21, s64, v238
s_waitcnt lgkmcnt(0)
s_waitcnt vmcnt(16)
s_barrier
v_mfma_f32_16x16x32_bf16 a[0:3], v[96:99], v[128:131], a[0:3]
ds_read_b128 v[32:35], v19 offset:0
v_mfma_f32_16x16x32_bf16 a[4:7], v[100:103], v[128:131], a[4:7]
s_add_u32 m0, s67, s70
v_mfma_f32_16x16x32_bf16 a[8:11], v[104:107], v[128:131], a[8:11]
ds_read_b64_tr_b16 v[64:65], v21 offset:0
v_mfma_f32_16x16x32_bf16 a[12:15], v[108:111], v[128:131], a[12:15]
s_add_u32 s22, s67, 16384
v_mfma_f32_16x16x32_bf16 a[16:19], v[112:115], v[128:131], a[16:19]
ds_read_b64_tr_b16 v[66:67], v21 offset:1024
v_mfma_f32_16x16x32_bf16 a[20:23], v[116:119], v[128:131], a[20:23]
buffer_load_dword v164, v200, s[48:51], 0 offen
v_mfma_f32_16x16x32_bf16 a[24:27], v[120:123], v[128:131], a[24:27]
ds_read_b128 v[36:39], v19 offset:2048
v_mfma_f32_16x16x32_bf16 a[28:31], v[124:127], v[128:131], a[28:31]
s_sub_u32 s67, s22, 163840
s_cselect_b32 s67, s22, s67
v_mfma_f32_16x16x32_bf16 a[32:35], v[96:99], v[132:135], a[32:35]
ds_read_b64_tr_b16 v[68:69], v21 offset:256
v_mfma_f32_16x16x32_bf16 a[36:39], v[100:103], v[132:135], a[36:39]
buffer_load_dwordx4 v232, s[32:35], s69 offen lds
v_mfma_f32_16x16x32_bf16 a[40:43], v[104:107], v[132:135], a[40:43]
ds_read_b64_tr_b16 v[70:71], v21 offset:1280
v_mfma_f32_16x16x32_bf16 a[44:47], v[108:111], v[132:135], a[44:47]
buffer_load_dword v165, v201, s[48:51], 0 offen
v_mfma_f32_16x16x32_bf16 a[48:51], v[112:115], v[132:135], a[48:51]
ds_read_b128 v[40:43], v19 offset:4096
v_mfma_f32_16x16x32_bf16 a[52:55], v[116:119], v[132:135], a[52:55]
buffer_load_dwordx4 v233, s[32:35], s69 offen offset:1024 lds
v_mfma_f32_16x16x32_bf16 a[56:59], v[120:123], v[132:135], a[56:59]
ds_read_b64_tr_b16 v[72:73], v21 offset:512
v_mfma_f32_16x16x32_bf16 a[60:63], v[124:127], v[132:135], a[60:63]
buffer_load_dword v166, v202, s[48:51], 0 offen
v_mfma_f32_16x16x32_bf16 a[64:67], v[96:99], v[136:139], a[64:67]
ds_read_b64_tr_b16 v[74:75], v21 offset:1536
v_mfma_f32_16x16x32_bf16 a[68:71], v[100:103], v[136:139], a[68:71]
buffer_load_dwordx4 v234, s[32:35], s69 offen offset:2048 lds
v_mfma_f32_16x16x32_bf16 a[72:75], v[104:107], v[136:139], a[72:75]
ds_read_b128 v[44:47], v19 offset:6144
v_mfma_f32_16x16x32_bf16 a[76:79], v[108:111], v[136:139], a[76:79]
buffer_load_dwordx4 v235, s[32:35], s69 offen offset:3072 lds
v_mfma_f32_16x16x32_bf16 a[80:83], v[112:115], v[136:139], a[80:83]
ds_read_b64_tr_b16 v[76:77], v21 offset:768
v_mfma_f32_16x16x32_bf16 a[84:87], v[116:119], v[136:139], a[84:87]
buffer_load_dword v167, v160, s[48:51], 0 offen offset:0
v_mfma_f32_16x16x32_bf16 a[88:91], v[120:123], v[136:139], a[88:91]
ds_read_b64_tr_b16 v[78:79], v21 offset:1792
v_mfma_f32_16x16x32_bf16 a[92:95], v[124:127], v[136:139], a[92:95]
s_add_u32 s69, s69, 262144
v_mfma_f32_16x16x32_bf16 a[96:99], v[96:99], v[140:143], a[96:99]
ds_read_b128 v[48:51], v19 offset:8192
v_mfma_f32_16x16x32_bf16 a[100:103], v[100:103], v[140:143], a[100:103]
s_and_b32 s69, s69, 0x7fffff
v_mfma_f32_16x16x32_bf16 a[104:107], v[104:107], v[140:143], a[104:107]
ds_read_b64_tr_b16 v[80:81], v21 offset:4096
v_mfma_f32_16x16x32_bf16 a[108:111], v[108:111], v[140:143], a[108:111]
buffer_load_dword v168, v160, s[48:51], 0 offen offset:896
v_mfma_f32_16x16x32_bf16 a[112:115], v[112:115], v[140:143], a[112:115]
ds_read_b64_tr_b16 v[82:83], v21 offset:5120
v_mfma_f32_16x16x32_bf16 a[116:119], v[116:119], v[140:143], a[116:119]
s_add_u32 m0, s67, s70
v_mfma_f32_16x16x32_bf16 a[120:123], v[120:123], v[140:143], a[120:123]
ds_read_b128 v[52:55], v19 offset:10240
v_mfma_f32_16x16x32_bf16 a[124:127], v[124:127], v[140:143], a[124:127]
buffer_load_dword v169, v160, s[48:51], 0 offen offset:1792
v_mfma_f32_16x16x32_bf16 a[128:131], v[96:99], v[144:147], a[128:131]
ds_read_b64_tr_b16 v[84:85], v21 offset:4352
v_mfma_f32_16x16x32_bf16 a[132:135], v[100:103], v[144:147], a[132:135]
s_add_u32 s22, s67, 16384
v_mfma_f32_16x16x32_bf16 a[136:139], v[104:107], v[144:147], a[136:139]
ds_read_b64_tr_b16 v[86:87], v21 offset:5376
v_mfma_f32_16x16x32_bf16 a[140:143], v[108:111], v[144:147], a[140:143]
s_sub_u32 s67, s22, 163840
s_cselect_b32 s67, s22, s67
v_mfma_f32_16x16x32_bf16 a[144:147], v[112:115], v[144:147], a[144:147]
ds_read_b128 v[56:59], v19 offset:12288
v_mfma_f32_16x16x32_bf16 a[148:151], v[116:119], v[144:147], a[148:151]
buffer_load_dword v170, v160, s[48:51], 0 offen offset:2688
v_mfma_f32_16x16x32_bf16 a[152:155], v[120:123], v[144:147], a[152:155]
ds_read_b64_tr_b16 v[88:89], v21 offset:4608
v_mfma_f32_16x16x32_bf16 a[156:159], v[124:127], v[144:147], a[156:159]
buffer_load_dwordx4 v232, s[32:35], s69 offen lds
v_mfma_f32_16x16x32_bf16 a[160:163], v[96:99], v[148:151], a[160:163]
ds_read_b64_tr_b16 v[90:91], v21 offset:5632
v_mfma_f32_16x16x32_bf16 a[164:167], v[100:103], v[148:151], a[164:167]
buffer_load_dwordx4 v233, s[32:35], s69 offen offset:1024 lds
v_mfma_f32_16x16x32_bf16 a[168:171], v[104:107], v[148:151], a[168:171]
ds_read_b128 v[60:63], v19 offset:14336
v_mfma_f32_16x16x32_bf16 a[172:175], v[108:111], v[148:151], a[172:175]
buffer_load_dword v171, v160, s[48:51], 0 offen offset:3584
v_mfma_f32_16x16x32_bf16 a[176:179], v[112:115], v[148:151], a[176:179]
ds_read_b64_tr_b16 v[92:93], v21 offset:4864
v_mfma_f32_16x16x32_bf16 a[180:183], v[116:119], v[148:151], a[180:183]
buffer_load_dwordx4 v234, s[32:35], s69 offen offset:2048 lds
v_mfma_f32_16x16x32_bf16 a[184:187], v[120:123], v[148:151], a[184:187]
ds_read_b64_tr_b16 v[94:95], v21 offset:5888
v_mfma_f32_16x16x32_bf16 a[188:191], v[124:127], v[148:151], a[188:191]
buffer_load_dword v172, v160, s[48:51], s80 offen offset:896
v_mfma_f32_16x16x32_bf16 a[192:195], v[96:99], v[152:155], a[192:195]
buffer_load_dword v173, v160, s[48:51], s80 offen offset:1792
v_mfma_f32_16x16x32_bf16 a[196:199], v[100:103], v[152:155], a[196:199]
buffer_load_dwordx4 v235, s[32:35], s69 offen offset:3072 lds
v_mfma_f32_16x16x32_bf16 a[200:203], v[104:107], v[152:155], a[200:203]
buffer_load_dword v174, v160, s[48:51], s80 offen offset:2688
v_mfma_f32_16x16x32_bf16 a[204:207], v[108:111], v[152:155], a[204:207]
s_add_u32 s69, s69, 262144
v_mfma_f32_16x16x32_bf16 a[208:211], v[112:115], v[152:155], a[208:211]
buffer_load_dwordx4 v[192:195], v161, s[56:59], 0 offen
v_mfma_f32_16x16x32_bf16 a[212:215], v[116:119], v[152:155], a[212:215]
buffer_load_dword v175, v160, s[52:55], 0 offen offset:0
v_mfma_f32_16x16x32_bf16 a[216:219], v[120:123], v[152:155], a[216:219]
buffer_load_dword v176, v160, s[52:55], 0 offen offset:896
v_mfma_f32_16x16x32_bf16 a[220:223], v[124:127], v[152:155], a[220:223]
s_and_b32 s69, s69, 0x7fffff
v_mfma_f32_16x16x32_bf16 a[224:227], v[96:99], v[156:159], a[224:227]
buffer_load_dword v177, v160, s[52:55], 0 offen offset:1792
v_mfma_f32_16x16x32_bf16 a[228:231], v[100:103], v[156:159], a[228:231]
v_add_u32 v20, s65, v237
v_mfma_f32_16x16x32_bf16 a[232:235], v[104:107], v[156:159], a[232:235]
buffer_load_dword v178, v160, s[52:55], 0 offen offset:2688
v_mfma_f32_16x16x32_bf16 a[236:239], v[108:111], v[156:159], a[236:239]
buffer_load_dword v179, v160, s[52:55], 0 offen offset:3584
v_mfma_f32_16x16x32_bf16 a[240:243], v[112:115], v[156:159], a[240:243]
buffer_load_dword v180, v160, s[52:55], s80 offen offset:896
v_mfma_f32_16x16x32_bf16 a[244:247], v[116:119], v[156:159], a[244:247]
v_add_u32 v22, s66, v238
v_mfma_f32_16x16x32_bf16 a[248:251], v[120:123], v[156:159], a[248:251]
buffer_load_dword v181, v160, s[52:55], s80 offen offset:1792
v_mfma_f32_16x16x32_bf16 a[252:255], v[124:127], v[156:159], a[252:255]
buffer_load_dword v182, v160, s[52:55], s80 offen offset:2688
buffer_load_dword v183, v160, s[44:47], 0 offen offset:0
buffer_load_dword v184, v160, s[44:47], 0 offen offset:896
buffer_load_dword v185, v160, s[44:47], 0 offen offset:1792
buffer_load_dword v186, v160, s[44:47], 0 offen offset:2688
buffer_load_dword v187, v160, s[44:47], 0 offen offset:3584
buffer_load_dword v188, v160, s[44:47], s80 offen offset:896
buffer_load_dword v189, v160, s[44:47], s80 offen offset:1792
buffer_load_dword v190, v160, s[44:47], s80 offen offset:2688
s_waitcnt lgkmcnt(0)
s_waitcnt vmcnt(48)
s_barrier
v_mfma_f32_16x16x32_bf16 a[0:3], v[32:35], v[64:67], a[0:3]
ds_read_b128 v[96:99], v20 offset:0
v_mfma_f32_16x16x32_bf16 a[4:7], v[36:39], v[64:67], a[4:7]
s_add_u32 m0, s67, s70
v_mfma_f32_16x16x32_bf16 a[8:11], v[40:43], v[64:67], a[8:11]
ds_read_b64_tr_b16 v[128:129], v22 offset:0
v_mfma_f32_16x16x32_bf16 a[12:15], v[44:47], v[64:67], a[12:15]
s_add_u32 s22, s67, 16384
v_mfma_f32_16x16x32_bf16 a[16:19], v[48:51], v[64:67], a[16:19]
ds_read_b64_tr_b16 v[130:131], v22 offset:1024
v_mfma_f32_16x16x32_bf16 a[20:23], v[52:55], v[64:67], a[20:23]
s_sub_u32 s67, s22, 163840
s_cselect_b32 s67, s22, s67
v_mfma_f32_16x16x32_bf16 a[24:27], v[56:59], v[64:67], a[24:27]
ds_read_b128 v[100:103], v20 offset:2048
v_mfma_f32_16x16x32_bf16 a[28:31], v[60:63], v[64:67], a[28:31]
buffer_load_dwordx4 v1, s[28:31], s68 offen lds
v_mfma_f32_16x16x32_bf16 a[32:35], v[32:35], v[68:71], a[32:35]
ds_read_b64_tr_b16 v[132:133], v22 offset:256
v_mfma_f32_16x16x32_bf16 a[36:39], v[36:39], v[68:71], a[36:39]
v_mfma_f32_16x16x32_bf16 a[40:43], v[40:43], v[68:71], a[40:43]
ds_read_b64_tr_b16 v[134:135], v22 offset:1280
v_mfma_f32_16x16x32_bf16 a[44:47], v[44:47], v[68:71], a[44:47]
buffer_load_dwordx4 v2, s[28:31], s68 offen offset:1024 lds
v_mfma_f32_16x16x32_bf16 a[48:51], v[48:51], v[68:71], a[48:51]
ds_read_b128 v[104:107], v20 offset:4096
v_mfma_f32_16x16x32_bf16 a[52:55], v[52:55], v[68:71], a[52:55]
buffer_load_dwordx4 v3, s[28:31], s68 offen offset:2048 lds
v_mfma_f32_16x16x32_bf16 a[56:59], v[56:59], v[68:71], a[56:59]
ds_read_b64_tr_b16 v[136:137], v22 offset:512
v_mfma_f32_16x16x32_bf16 a[60:63], v[60:63], v[68:71], a[60:63]
buffer_load_dwordx4 v4, s[28:31], s68 offen offset:3072 lds
v_mfma_f32_16x16x32_bf16 a[64:67], v[32:35], v[72:75], a[64:67]
ds_read_b64_tr_b16 v[138:139], v22 offset:1536
v_mfma_f32_16x16x32_bf16 a[68:71], v[36:39], v[72:75], a[68:71]
s_add_u32 s68, s68, 262144
v_mfma_f32_16x16x32_bf16 a[72:75], v[40:43], v[72:75], a[72:75]
ds_read_b128 v[108:111], v20 offset:6144
v_mfma_f32_16x16x32_bf16 a[76:79], v[44:47], v[72:75], a[76:79]
v_mfma_f32_16x16x32_bf16 a[80:83], v[48:51], v[72:75], a[80:83]
ds_read_b64_tr_b16 v[140:141], v22 offset:768
v_mfma_f32_16x16x32_bf16 a[84:87], v[52:55], v[72:75], a[84:87]
s_add_u32 m0, s67, s70
v_mfma_f32_16x16x32_bf16 a[88:91], v[56:59], v[72:75], a[88:91]
ds_read_b64_tr_b16 v[142:143], v22 offset:1792
v_mfma_f32_16x16x32_bf16 a[92:95], v[60:63], v[72:75], a[92:95]
s_add_u32 s22, s67, 16384
v_mfma_f32_16x16x32_bf16 a[96:99], v[32:35], v[76:79], a[96:99]
ds_read_b128 v[112:115], v20 offset:8192
v_mfma_f32_16x16x32_bf16 a[100:103], v[36:39], v[76:79], a[100:103]
s_sub_u32 s67, s22, 163840
s_cselect_b32 s67, s22, s67
v_mfma_f32_16x16x32_bf16 a[104:107], v[40:43], v[76:79], a[104:107]
ds_read_b64_tr_b16 v[144:145], v22 offset:4096
v_mfma_f32_16x16x32_bf16 a[108:111], v[44:47], v[76:79], a[108:111]
v_mfma_f32_16x16x32_bf16 a[112:115], v[48:51], v[76:79], a[112:115]
ds_read_b64_tr_b16 v[146:147], v22 offset:5120
v_mfma_f32_16x16x32_bf16 a[116:119], v[52:55], v[76:79], a[116:119]
buffer_load_dwordx4 v1, s[28:31], s68 offen lds
v_mfma_f32_16x16x32_bf16 a[120:123], v[56:59], v[76:79], a[120:123]
ds_read_b128 v[116:119], v20 offset:10240
v_mfma_f32_16x16x32_bf16 a[124:127], v[60:63], v[76:79], a[124:127]
buffer_load_dwordx4 v2, s[28:31], s68 offen offset:1024 lds
v_mfma_f32_16x16x32_bf16 a[128:131], v[32:35], v[80:83], a[128:131]
ds_read_b64_tr_b16 v[148:149], v22 offset:4352
v_mfma_f32_16x16x32_bf16 a[132:135], v[36:39], v[80:83], a[132:135]
buffer_load_dwordx4 v3, s[28:31], s68 offen offset:2048 lds
v_mfma_f32_16x16x32_bf16 a[136:139], v[40:43], v[80:83], a[136:139]
ds_read_b64_tr_b16 v[150:151], v22 offset:5376
v_mfma_f32_16x16x32_bf16 a[140:143], v[44:47], v[80:83], a[140:143]
buffer_load_dwordx4 v4, s[28:31], s68 offen offset:3072 lds
v_mfma_f32_16x16x32_bf16 a[144:147], v[48:51], v[80:83], a[144:147]
ds_read_b128 v[120:123], v20 offset:12288
v_mfma_f32_16x16x32_bf16 a[148:151], v[52:55], v[80:83], a[148:151]
v_mfma_f32_16x16x32_bf16 a[152:155], v[56:59], v[80:83], a[152:155]
ds_read_b64_tr_b16 v[152:153], v22 offset:4608
v_mfma_f32_16x16x32_bf16 a[156:159], v[60:63], v[80:83], a[156:159]
s_sub_u32 s68, s68, 262016
v_mfma_f32_16x16x32_bf16 a[160:163], v[32:35], v[84:87], a[160:163]
ds_read_b64_tr_b16 v[154:155], v22 offset:5632
v_mfma_f32_16x16x32_bf16 a[164:167], v[36:39], v[84:87], a[164:167]
s_bitset0_b32 s68, 11
v_mfma_f32_16x16x32_bf16 a[168:171], v[40:43], v[84:87], a[168:171]
ds_read_b128 v[124:127], v20 offset:14336
v_mfma_f32_16x16x32_bf16 a[172:175], v[44:47], v[84:87], a[172:175]
s_add_u32 s23, s64, 65536
v_mfma_f32_16x16x32_bf16 a[176:179], v[48:51], v[84:87], a[176:179]
ds_read_b64_tr_b16 v[156:157], v22 offset:4864
v_mfma_f32_16x16x32_bf16 a[180:183], v[52:55], v[84:87], a[180:183]
v_mfma_f32_16x16x32_bf16 a[184:187], v[56:59], v[84:87], a[184:187]
ds_read_b64_tr_b16 v[158:159], v22 offset:5888
v_mfma_f32_16x16x32_bf16 a[188:191], v[60:63], v[84:87], a[188:191]
s_sub_u32 s64, s23, 163840
s_cselect_b32 s64, s23, s64
v_mfma_f32_16x16x32_bf16 a[192:195], v[32:35], v[88:91], a[192:195]
v_mfma_f32_16x16x32_bf16 a[196:199], v[36:39], v[88:91], a[196:199]
s_add_u32 s23, s65, 65536
v_mfma_f32_16x16x32_bf16 a[200:203], v[40:43], v[88:91], a[200:203]
v_mfma_f32_16x16x32_bf16 a[204:207], v[44:47], v[88:91], a[204:207]
s_sub_u32 s65, s23, 163840
s_cselect_b32 s65, s23, s65
v_mfma_f32_16x16x32_bf16 a[208:211], v[48:51], v[88:91], a[208:211]
v_mfma_f32_16x16x32_bf16 a[212:215], v[52:55], v[88:91], a[212:215]
s_add_u32 s23, s66, 65536
v_mfma_f32_16x16x32_bf16 a[216:219], v[56:59], v[88:91], a[216:219]
v_mfma_f32_16x16x32_bf16 a[220:223], v[60:63], v[88:91], a[220:223]
v_mfma_f32_16x16x32_bf16 a[224:227], v[32:35], v[92:95], a[224:227]
v_mfma_f32_16x16x32_bf16 a[228:231], v[36:39], v[92:95], a[228:231]
s_sub_u32 s66, s23, 163840
s_cselect_b32 s66, s23, s66
v_mfma_f32_16x16x32_bf16 a[232:235], v[40:43], v[92:95], a[232:235]
v_mfma_f32_16x16x32_bf16 a[236:239], v[44:47], v[92:95], a[236:239]
v_add_u32 v19, s65, v236
v_mfma_f32_16x16x32_bf16 a[240:243], v[48:51], v[92:95], a[240:243]
v_mfma_f32_16x16x32_bf16 a[244:247], v[52:55], v[92:95], a[244:247]
v_add_u32 v21, s64, v238
v_mfma_f32_16x16x32_bf16 a[248:251], v[56:59], v[92:95], a[248:251]
v_mfma_f32_16x16x32_bf16 a[252:255], v[60:63], v[92:95], a[252:255]
s_waitcnt lgkmcnt(0)
s_waitcnt vmcnt(8)
s_barrier
v_mfma_f32_16x16x32_bf16 a[0:3], v[96:99], v[128:131], a[0:3]
ds_read_b128 v[32:35], v19 offset:0
v_lshlrev_b32 v196, 16, v192
v_mfma_f32_16x16x32_bf16 a[4:7], v[100:103], v[128:131], a[4:7]
s_add_u32 m0, s67, s70
v_and_b32 v197, 0xffff0000, v192
v_mfma_f32_16x16x32_bf16 a[8:11], v[104:107], v[128:131], a[8:11]
ds_read_b64_tr_b16 v[64:65], v21 offset:0
v_lshlrev_b32 v198, 16, v193
v_mfma_f32_16x16x32_bf16 a[12:15], v[108:111], v[128:131], a[12:15]
s_add_u32 s22, s67, 16384
v_and_b32 v199, 0xffff0000, v193
v_mfma_f32_16x16x32_bf16 a[16:19], v[112:115], v[128:131], a[16:19]
ds_read_b64_tr_b16 v[66:67], v21 offset:1024
v_lshlrev_b32 v200, 16, v194
v_mfma_f32_16x16x32_bf16 a[20:23], v[116:119], v[128:131], a[20:23]
v_and_b32 v201, 0xffff0000, v194
v_lshlrev_b32 v202, 16, v195
v_mfma_f32_16x16x32_bf16 a[24:27], v[120:123], v[128:131], a[24:27]
ds_read_b128 v[36:39], v19 offset:2048
v_and_b32 v203, 0xffff0000, v195
v_mfma_f32_16x16x32_bf16 a[28:31], v[124:127], v[128:131], a[28:31]
s_sub_u32 s67, s22, 163840
s_cselect_b32 s67, s22, s67
v_mfma_f32_16x16x32_bf16 a[32:35], v[96:99], v[132:135], a[32:35]
ds_read_b64_tr_b16 v[68:69], v21 offset:256
v_lshlrev_b32 v204, 16, v164
v_mfma_f32_16x16x32_bf16 a[36:39], v[100:103], v[132:135], a[36:39]
buffer_load_dwordx4 v232, s[32:35], s69 offen lds
v_mfma_f32_16x16x32_bf16 a[40:43], v[104:107], v[132:135], a[40:43]
ds_read_b64_tr_b16 v[70:71], v21 offset:1280
v_lshlrev_b32 v205, 16, v165
v_mfma_f32_16x16x32_bf16 a[44:47], v[108:111], v[132:135], a[44:47]
v_lshlrev_b32 v206, 16, v166
v_lshlrev_b32 v207, 16, v167
v_mfma_f32_16x16x32_bf16 a[48:51], v[112:115], v[132:135], a[48:51]
ds_read_b128 v[40:43], v19 offset:4096
v_lshlrev_b32 v208, 16, v168
v_mfma_f32_16x16x32_bf16 a[52:55], v[116:119], v[132:135], a[52:55]
buffer_load_dwordx4 v233, s[32:35], s69 offen offset:1024 lds
v_mfma_f32_16x16x32_bf16 a[56:59], v[120:123], v[132:135], a[56:59]
ds_read_b64_tr_b16 v[72:73], v21 offset:512
v_lshlrev_b32 v209, 16, v169
v_mfma_f32_16x16x32_bf16 a[60:63], v[124:127], v[132:135], a[60:63]
v_lshlrev_b32 v210, 16, v170
v_lshlrev_b32 v211, 16, v171
v_mfma_f32_16x16x32_bf16 a[64:67], v[96:99], v[136:139], a[64:67]
ds_read_b64_tr_b16 v[74:75], v21 offset:1536
v_lshlrev_b32 v212, 16, v172
v_mfma_f32_16x16x32_bf16 a[68:71], v[100:103], v[136:139], a[68:71]
buffer_load_dwordx4 v234, s[32:35], s69 offen offset:2048 lds
v_mfma_f32_16x16x32_bf16 a[72:75], v[104:107], v[136:139], a[72:75]
ds_read_b128 v[44:47], v19 offset:6144
v_lshlrev_b32 v213, 16, v173
v_mfma_f32_16x16x32_bf16 a[76:79], v[108:111], v[136:139], a[76:79]
buffer_load_dwordx4 v235, s[32:35], s69 offen offset:3072 lds
v_mfma_f32_16x16x32_bf16 a[80:83], v[112:115], v[136:139], a[80:83]
ds_read_b64_tr_b16 v[76:77], v21 offset:768
v_mfma_f32_16x16x32_bf16 a[84:87], v[116:119], v[136:139], a[84:87]
v_lshlrev_b32 v214, 16, v174
v_mul_f32 v216, v204, v199
v_mfma_f32_16x16x32_bf16 a[88:91], v[120:123], v[136:139], a[88:91]
ds_read_b64_tr_b16 v[78:79], v21 offset:1792
v_mul_f32 v217, v205, v199
v_mfma_f32_16x16x32_bf16 a[92:95], v[124:127], v[136:139], a[92:95]
s_add_u32 s69, s69, 262144
v_cvt_pk_bf16_f32 v220, v216, v217
v_mfma_f32_16x16x32_bf16 a[96:99], v[96:99], v[140:143], a[96:99]
ds_read_b128 v[48:51], v19 offset:8192
v_lshlrev_b32 v216, 16, v220
v_mfma_f32_16x16x32_bf16 a[100:103], v[100:103], v[140:143], a[100:103]
s_and_b32 s69, s69, 0x7fffff
v_and_b32 v217, 0xffff0000, v220
v_mfma_f32_16x16x32_bf16 a[104:107], v[104:107], v[140:143], a[104:107]
ds_read_b64_tr_b16 v[80:81], v21 offset:4096
v_mul_f32 v218, v205, v198
v_mfma_f32_16x16x32_bf16 a[108:111], v[108:111], v[140:143], a[108:111]
v_mul_f32 v219, v206, v198
v_cvt_pk_bf16_f32 v220, v218, v219
v_mfma_f32_16x16x32_bf16 a[112:115], v[112:115], v[140:143], a[112:115]
ds_read_b64_tr_b16 v[82:83], v21 offset:5120
v_lshlrev_b32 v218, 16, v220
v_mfma_f32_16x16x32_bf16 a[116:119], v[116:119], v[140:143], a[116:119]
s_add_u32 m0, s67, s70
v_and_b32 v219, 0xffff0000, v220
v_mfma_f32_16x16x32_bf16 a[120:123], v[120:123], v[140:143], a[120:123]
ds_read_b128 v[52:55], v19 offset:10240
v_add_f32 v216, v216, v218
v_mfma_f32_16x16x32_bf16 a[124:127], v[124:127], v[140:143], a[124:127]
v_add_f32 v217, v217, v219
v_cvt_pk_bf16_f32 v220, v216, v217
v_mfma_f32_16x16x32_bf16 a[128:131], v[96:99], v[144:147], a[128:131]
ds_read_b64_tr_b16 v[84:85], v21 offset:4352
v_lshlrev_b32 v216, 16, v220
v_mfma_f32_16x16x32_bf16 a[132:135], v[100:103], v[144:147], a[132:135]
s_add_u32 s22, s67, 16384
v_and_b32 v217, 0xffff0000, v220
v_mfma_f32_16x16x32_bf16 a[136:139], v[104:107], v[144:147], a[136:139]
ds_read_b64_tr_b16 v[86:87], v21 offset:5376
v_mul_f32 v218, v206, v197
v_mfma_f32_16x16x32_bf16 a[140:143], v[108:111], v[144:147], a[140:143]
s_sub_u32 s67, s22, 163840
s_cselect_b32 s67, s22, s67
v_mfma_f32_16x16x32_bf16 a[144:147], v[112:115], v[144:147], a[144:147]
ds_read_b128 v[56:59], v19 offset:12288
v_mul_f32 v219, v207, v197
v_mfma_f32_16x16x32_bf16 a[148:151], v[116:119], v[144:147], a[148:151]
v_cvt_pk_bf16_f32 v220, v218, v219
v_lshlrev_b32 v218, 16, v220
v_mfma_f32_16x16x32_bf16 a[152:155], v[120:123], v[144:147], a[152:155]
ds_read_b64_tr_b16 v[88:89], v21 offset:4608
v_and_b32 v219, 0xffff0000, v220
v_mfma_f32_16x16x32_bf16 a[156:159], v[124:127], v[144:147], a[156:159]
buffer_load_dwordx4 v232, s[32:35], s69 offen lds
v_mfma_f32_16x16x32_bf16 a[160:163], v[96:99], v[148:151], a[160:163]
ds_read_b64_tr_b16 v[90:91], v21 offset:5632
v_add_f32 v216, v216, v218
v_mfma_f32_16x16x32_bf16 a[164:167], v[100:103], v[148:151], a[164:167]
buffer_load_dwordx4 v233, s[32:35], s69 offen offset:1024 lds
v_mfma_f32_16x16x32_bf16 a[168:171], v[104:107], v[148:151], a[168:171]
ds_read_b128 v[60:63], v19 offset:14336
v_add_f32 v217, v217, v219
v_mfma_f32_16x16x32_bf16 a[172:175], v[108:111], v[148:151], a[172:175]
v_cvt_pk_bf16_f32 v220, v216, v217
v_lshlrev_b32 v216, 16, v220
v_mfma_f32_16x16x32_bf16 a[176:179], v[112:115], v[148:151], a[176:179]
ds_read_b64_tr_b16 v[92:93], v21 offset:4864
v_and_b32 v217, 0xffff0000, v220
v_mfma_f32_16x16x32_bf16 a[180:183], v[116:119], v[148:151], a[180:183]
buffer_load_dwordx4 v234, s[32:35], s69 offen offset:2048 lds
v_mfma_f32_16x16x32_bf16 a[184:187], v[120:123], v[148:151], a[184:187]
ds_read_b64_tr_b16 v[94:95], v21 offset:5888
v_mul_f32 v218, v207, v196
v_mfma_f32_16x16x32_bf16 a[188:191], v[124:127], v[148:151], a[188:191]
v_mul_f32 v219, v208, v196
v_cvt_pk_bf16_f32 v220, v218, v219
v_mfma_f32_16x16x32_bf16 a[192:195], v[96:99], v[152:155], a[192:195]
v_lshlrev_b32 v218, 16, v220
v_and_b32 v219, 0xffff0000, v220
v_mfma_f32_16x16x32_bf16 a[196:199], v[100:103], v[152:155], a[196:199]
buffer_load_dwordx4 v235, s[32:35], s69 offen offset:3072 lds
v_mfma_f32_16x16x32_bf16 a[200:203], v[104:107], v[152:155], a[200:203]
v_add_f32 v216, v216, v218
v_add_f32 v217, v217, v219
v_mfma_f32_16x16x32_bf16 a[204:207], v[108:111], v[152:155], a[204:207]
s_add_u32 s69, s69, 262144
v_cvt_pk_bf16_f32 v220, v216, v217
v_mfma_f32_16x16x32_bf16 a[208:211], v[112:115], v[152:155], a[208:211]
v_lshlrev_b32 v216, 16, v220
v_and_b32 v217, 0xffff0000, v220
v_mfma_f32_16x16x32_bf16 a[212:215], v[116:119], v[152:155], a[212:215]
v_lshlrev_b32 v218, 16, v175
v_mfma_f32_16x16x32_bf16 a[216:219], v[120:123], v[152:155], a[216:219]
v_lshlrev_b32 v219, 16, v176
v_mul_f32 v216, v216, v218
v_mfma_f32_16x16x32_bf16 a[220:223], v[124:127], v[152:155], a[220:223]
s_and_b32 s69, s69, 0x7fffff
v_mul_f32 v217, v217, v219
v_mfma_f32_16x16x32_bf16 a[224:227], v[96:99], v[156:159], a[224:227]
v_cvt_pk_bf16_f32 v227, v217, v216
v_mul_f32 v216, v206, v199
v_mfma_f32_16x16x32_bf16 a[228:231], v[100:103], v[156:159], a[228:231]
v_add_u32 v20, s65, v237
v_mul_f32 v217, v207, v199
v_mfma_f32_16x16x32_bf16 a[232:235], v[104:107], v[156:159], a[232:235]
v_cvt_pk_bf16_f32 v220, v216, v217
v_lshlrev_b32 v216, 16, v220
v_mfma_f32_16x16x32_bf16 a[236:239], v[108:111], v[156:159], a[236:239]
v_and_b32 v217, 0xffff0000, v220
v_mul_f32 v218, v207, v198
v_mfma_f32_16x16x32_bf16 a[240:243], v[112:115], v[156:159], a[240:243]
v_mul_f32 v219, v208, v198
v_cvt_pk_bf16_f32 v220, v218, v219
v_mfma_f32_16x16x32_bf16 a[244:247], v[116:119], v[156:159], a[244:247]
v_add_u32 v22, s66, v238
v_lshlrev_b32 v218, 16, v220
v_mfma_f32_16x16x32_bf16 a[248:251], v[120:123], v[156:159], a[248:251]
v_and_b32 v219, 0xffff0000, v220
v_add_f32 v216, v216, v218
v_mfma_f32_16x16x32_bf16 a[252:255], v[124:127], v[156:159], a[252:255]
v_add_f32 v217, v217, v219
v_cvt_pk_bf16_f32 v220, v216, v217
s_waitcnt lgkmcnt(0)
s_waitcnt vmcnt(20)
s_barrier
v_mfma_f32_16x16x32_bf16 a[0:3], v[32:35], v[64:67], a[0:3]
ds_read_b128 v[96:99], v20 offset:0
v_lshlrev_b32 v216, 16, v220
v_mfma_f32_16x16x32_bf16 a[4:7], v[36:39], v[64:67], a[4:7]
s_add_u32 m0, s67, s70
v_and_b32 v217, 0xffff0000, v220
v_mfma_f32_16x16x32_bf16 a[8:11], v[40:43], v[64:67], a[8:11]
ds_read_b64_tr_b16 v[128:129], v22 offset:0
v_mul_f32 v218, v208, v197
v_mfma_f32_16x16x32_bf16 a[12:15], v[44:47], v[64:67], a[12:15]
s_add_u32 s22, s67, 16384
v_mul_f32 v219, v209, v197
v_mfma_f32_16x16x32_bf16 a[16:19], v[48:51], v[64:67], a[16:19]
ds_read_b64_tr_b16 v[130:131], v22 offset:1024
v_cvt_pk_bf16_f32 v220, v218, v219
v_lshlrev_b32 v218, 16, v220
v_mfma_f32_16x16x32_bf16 a[20:23], v[52:55], v[64:67], a[20:23]
s_sub_u32 s67, s22, 163840
s_cselect_b32 s67, s22, s67
v_mfma_f32_16x16x32_bf16 a[24:27], v[56:59], v[64:67], a[24:27]
ds_read_b128 v[100:103], v20 offset:2048
v_and_b32 v219, 0xffff0000, v220
v_mfma_f32_16x16x32_bf16 a[28:31], v[60:63], v[64:67], a[28:31]
buffer_load_dwordx4 v1, s[28:31], s68 offen lds
v_add_f32 v216, v216, v218
v_mfma_f32_16x16x32_bf16 a[32:35], v[32:35], v[68:71], a[32:35]
ds_read_b64_tr_b16 v[132:133], v22 offset:256
v_add_f32 v217, v217, v219
v_mfma_f32_16x16x32_bf16 a[36:39], v[36:39], v[68:71], a[36:39]
v_cvt_pk_bf16_f32 v220, v216, v217
v_lshlrev_b32 v216, 16, v220
v_mfma_f32_16x16x32_bf16 a[40:43], v[40:43], v[68:71], a[40:43]
ds_read_b64_tr_b16 v[134:135], v22 offset:1280
v_and_b32 v217, 0xffff0000, v220
v_mfma_f32_16x16x32_bf16 a[44:47], v[44:47], v[68:71], a[44:47]
buffer_load_dwordx4 v2, s[28:31], s68 offen offset:1024 lds
v_mfma_f32_16x16x32_bf16 a[48:51], v[48:51], v[68:71], a[48:51]
ds_read_b128 v[104:107], v20 offset:4096
v_mul_f32 v218, v209, v196
v_mfma_f32_16x16x32_bf16 a[52:55], v[52:55], v[68:71], a[52:55]
buffer_load_dwordx4 v3, s[28:31], s68 offen offset:2048 lds
v_mul_f32 v219, v210, v196
v_mfma_f32_16x16x32_bf16 a[56:59], v[56:59], v[68:71], a[56:59]
ds_read_b64_tr_b16 v[136:137], v22 offset:512
v_cvt_pk_bf16_f32 v220, v218, v219
v_mfma_f32_16x16x32_bf16 a[60:63], v[60:63], v[68:71], a[60:63]
buffer_load_dwordx4 v4, s[28:31], s68 offen offset:3072 lds
v_lshlrev_b32 v218, 16, v220
v_mfma_f32_16x16x32_bf16 a[64:67], v[32:35], v[72:75], a[64:67]
ds_read_b64_tr_b16 v[138:139], v22 offset:1536
v_and_b32 v219, 0xffff0000, v220
v_mfma_f32_16x16x32_bf16 a[68:71], v[36:39], v[72:75], a[68:71]
s_add_u32 s68, s68, 262144
v_add_f32 v216, v216, v218
v_mfma_f32_16x16x32_bf16 a[72:75], v[40:43], v[72:75], a[72:75]
ds_read_b128 v[108:111], v20 offset:6144
v_add_f32 v217, v217, v219
v_mfma_f32_16x16x32_bf16 a[76:79], v[44:47], v[72:75], a[76:79]
v_cvt_pk_bf16_f32 v220, v216, v217
v_mfma_f32_16x16x32_bf16 a[80:83], v[48:51], v[72:75], a[80:83]
ds_read_b64_tr_b16 v[140:141], v22 offset:768
v_lshlrev_b32 v216, 16, v220
v_and_b32 v217, 0xffff0000, v220
v_mfma_f32_16x16x32_bf16 a[84:87], v[52:55], v[72:75], a[84:87]
s_add_u32 m0, s67, s70
v_lshlrev_b32 v218, 16, v177
v_mfma_f32_16x16x32_bf16 a[88:91], v[56:59], v[72:75], a[88:91]
ds_read_b64_tr_b16 v[142:143], v22 offset:1792
v_lshlrev_b32 v219, 16, v178
v_mfma_f32_16x16x32_bf16 a[92:95], v[60:63], v[72:75], a[92:95]
s_add_u32 s22, s67, 16384
v_mul_f32 v216, v216, v218
v_mfma_f32_16x16x32_bf16 a[96:99], v[32:35], v[76:79], a[96:99]
ds_read_b128 v[112:115], v20 offset:8192
v_mul_f32 v217, v217, v219
v_mfma_f32_16x16x32_bf16 a[100:103], v[36:39], v[76:79], a[100:103]
s_sub_u32 s67, s22, 163840
s_cselect_b32 s67, s22, s67
v_cvt_pk_bf16_f32 v226, v217, v216
v_mfma_f32_16x16x32_bf16 a[104:107], v[40:43], v[76:79], a[104:107]
ds_read_b64_tr_b16 v[144:145], v22 offset:4096
v_mul_f32 v216, v208, v199
v_mfma_f32_16x16x32_bf16 a[108:111], v[44:47], v[76:79], a[108:111]
v_mul_f32 v217, v209, v199
v_mfma_f32_16x16x32_bf16 a[112:115], v[48:51], v[76:79], a[112:115]
ds_read_b64_tr_b16 v[146:147], v22 offset:5120
v_cvt_pk_bf16_f32 v220, v216, v217
v_mfma_f32_16x16x32_bf16 a[116:119], v[52:55], v[76:79], a[116:119]
buffer_load_dwordx4 v1, s[28:31], s68 offen lds
v_lshlrev_b32 v216, 16, v220
v_mfma_f32_16x16x32_bf16 a[120:123], v[56:59], v[76:79], a[120:123]
ds_read_b128 v[116:119], v20 offset:10240
v_and_b32 v217, 0xffff0000, v220
v_mfma_f32_16x16x32_bf16 a[124:127], v[60:63], v[76:79], a[124:127]
buffer_load_dwordx4 v2, s[28:31], s68 offen offset:1024 lds
v_mul_f32 v218, v209, v198
v_mfma_f32_16x16x32_bf16 a[128:131], v[32:35], v[80:83], a[128:131]
ds_read_b64_tr_b16 v[148:149], v22 offset:4352
v_mul_f32 v219, v210, v198
v_mfma_f32_16x16x32_bf16 a[132:135], v[36:39], v[80:83], a[132:135]
buffer_load_dwordx4 v3, s[28:31], s68 offen offset:2048 lds
v_mfma_f32_16x16x32_bf16 a[136:139], v[40:43], v[80:83], a[136:139]
ds_read_b64_tr_b16 v[150:151], v22 offset:5376
v_cvt_pk_bf16_f32 v220, v218, v219
v_mfma_f32_16x16x32_bf16 a[140:143], v[44:47], v[80:83], a[140:143]
buffer_load_dwordx4 v4, s[28:31], s68 offen offset:3072 lds
v_lshlrev_b32 v218, 16, v220
v_mfma_f32_16x16x32_bf16 a[144:147], v[48:51], v[80:83], a[144:147]
ds_read_b128 v[120:123], v20 offset:12288
v_and_b32 v219, 0xffff0000, v220
v_mfma_f32_16x16x32_bf16 a[148:151], v[52:55], v[80:83], a[148:151]
v_add_f32 v216, v216, v218
v_add_f32 v217, v217, v219
v_mfma_f32_16x16x32_bf16 a[152:155], v[56:59], v[80:83], a[152:155]
ds_read_b64_tr_b16 v[152:153], v22 offset:4608
v_cvt_pk_bf16_f32 v220, v216, v217
v_mfma_f32_16x16x32_bf16 a[156:159], v[60:63], v[80:83], a[156:159]
s_sub_u32 s68, s68, 262016
v_lshlrev_b32 v216, 16, v220
v_mfma_f32_16x16x32_bf16 a[160:163], v[32:35], v[84:87], a[160:163]
ds_read_b64_tr_b16 v[154:155], v22 offset:5632
v_and_b32 v217, 0xffff0000, v220
v_mfma_f32_16x16x32_bf16 a[164:167], v[36:39], v[84:87], a[164:167]
s_bitset0_b32 s68, 11
v_mul_f32 v218, v210, v197
v_mfma_f32_16x16x32_bf16 a[168:171], v[40:43], v[84:87], a[168:171]
ds_read_b128 v[124:127], v20 offset:14336
v_mul_f32 v219, v211, v197
v_mfma_f32_16x16x32_bf16 a[172:175], v[44:47], v[84:87], a[172:175]
s_add_u32 s23, s64, 65536
v_cvt_pk_bf16_f32 v220, v218, v219
v_mfma_f32_16x16x32_bf16 a[176:179], v[48:51], v[84:87], a[176:179]
ds_read_b64_tr_b16 v[156:157], v22 offset:4864
v_lshlrev_b32 v218, 16, v220
v_and_b32 v219, 0xffff0000, v220
v_mfma_f32_16x16x32_bf16 a[180:183], v[52:55], v[84:87], a[180:183]
v_add_f32 v216, v216, v218
v_mfma_f32_16x16x32_bf16 a[184:187], v[56:59], v[84:87], a[184:187]
ds_read_b64_tr_b16 v[158:159], v22 offset:5888
v_add_f32 v217, v217, v219
v_mfma_f32_16x16x32_bf16 a[188:191], v[60:63], v[84:87], a[188:191]
s_sub_u32 s64, s23, 163840
s_cselect_b32 s64, s23, s64
v_cvt_pk_bf16_f32 v220, v216, v217
v_mfma_f32_16x16x32_bf16 a[192:195], v[32:35], v[88:91], a[192:195]
v_lshlrev_b32 v216, 16, v220
v_and_b32 v217, 0xffff0000, v220
v_mfma_f32_16x16x32_bf16 a[196:199], v[36:39], v[88:91], a[196:199]
s_add_u32 s23, s65, 65536
v_mul_f32 v218, v211, v196
v_mfma_f32_16x16x32_bf16 a[200:203], v[40:43], v[88:91], a[200:203]
v_mul_f32 v219, v212, v196
v_mfma_f32_16x16x32_bf16 a[204:207], v[44:47], v[88:91], a[204:207]
s_sub_u32 s65, s23, 163840
s_cselect_b32 s65, s23, s65
v_cvt_pk_bf16_f32 v220, v218, v219
v_mfma_f32_16x16x32_bf16 a[208:211], v[48:51], v[88:91], a[208:211]
v_lshlrev_b32 v218, 16, v220
v_mfma_f32_16x16x32_bf16 a[212:215], v[52:55], v[88:91], a[212:215]
s_add_u32 s23, s66, 65536
v_and_b32 v219, 0xffff0000, v220
v_add_f32 v216, v216, v218
v_mfma_f32_16x16x32_bf16 a[216:219], v[56:59], v[88:91], a[216:219]
v_add_f32 v217, v217, v219
v_mfma_f32_16x16x32_bf16 a[220:223], v[60:63], v[88:91], a[220:223]
v_cvt_pk_bf16_f32 v220, v216, v217
v_lshlrev_b32 v216, 16, v220
v_mfma_f32_16x16x32_bf16 a[224:227], v[32:35], v[92:95], a[224:227]
v_and_b32 v217, 0xffff0000, v220
v_lshlrev_b32 v218, 16, v179
v_mfma_f32_16x16x32_bf16 a[228:231], v[36:39], v[92:95], a[228:231]
s_sub_u32 s66, s23, 163840
s_cselect_b32 s66, s23, s66
v_mfma_f32_16x16x32_bf16 a[232:235], v[40:43], v[92:95], a[232:235]
v_lshlrev_b32 v219, 16, v180
v_mul_f32 v216, v216, v218
v_mfma_f32_16x16x32_bf16 a[236:239], v[44:47], v[92:95], a[236:239]
v_add_u32 v19, s65, v236
v_mul_f32 v217, v217, v219
v_mfma_f32_16x16x32_bf16 a[240:243], v[48:51], v[92:95], a[240:243]
v_cvt_pk_bf16_f32 v225, v217, v216
v_mul_f32 v216, v210, v199
v_mfma_f32_16x16x32_bf16 a[244:247], v[52:55], v[92:95], a[244:247]
v_add_u32 v21, s64, v238
v_mul_f32 v217, v211, v199
v_mfma_f32_16x16x32_bf16 a[248:251], v[56:59], v[92:95], a[248:251]
v_cvt_pk_bf16_f32 v220, v216, v217
v_mfma_f32_16x16x32_bf16 a[252:255], v[60:63], v[92:95], a[252:255]
v_lshlrev_b32 v216, 16, v220
v_and_b32 v217, 0xffff0000, v220
s_waitcnt lgkmcnt(0)
s_waitcnt vmcnt(16)
s_barrier
v_mfma_f32_16x16x32_bf16 a[0:3], v[96:99], v[128:131], a[0:3]
ds_read_b128 v[32:35], v19 offset:0
v_mul_f32 v218, v211, v198
v_mfma_f32_16x16x32_bf16 a[4:7], v[100:103], v[128:131], a[4:7]
s_add_u32 m0, s67, s70
v_mul_f32 v219, v212, v198
v_mfma_f32_16x16x32_bf16 a[8:11], v[104:107], v[128:131], a[8:11]
ds_read_b64_tr_b16 v[64:65], v21 offset:0
v_cvt_pk_bf16_f32 v220, v218, v219
v_mfma_f32_16x16x32_bf16 a[12:15], v[108:111], v[128:131], a[12:15]
s_add_u32 s22, s67, 16384
v_lshlrev_b32 v218, 16, v220
v_mfma_f32_16x16x32_bf16 a[16:19], v[112:115], v[128:131], a[16:19]
ds_read_b64_tr_b16 v[66:67], v21 offset:1024
v_and_b32 v219, 0xffff0000, v220
v_mfma_f32_16x16x32_bf16 a[20:23], v[116:119], v[128:131], a[20:23]
v_add_f32 v216, v216, v218
v_add_f32 v217, v217, v219
v_mfma_f32_16x16x32_bf16 a[24:27], v[120:123], v[128:131], a[24:27]
ds_read_b128 v[36:39], v19 offset:2048
v_cvt_pk_bf16_f32 v220, v216, v217
v_mfma_f32_16x16x32_bf16 a[28:31], v[124:127], v[128:131], a[28:31]
s_sub_u32 s67, s22, 163840
s_cselect_b32 s67, s22, s67
v_mfma_f32_16x16x32_bf16 a[32:35], v[96:99], v[132:135], a[32:35]
ds_read_b64_tr_b16 v[68:69], v21 offset:256
v_lshlrev_b32 v216, 16, v220
v_mfma_f32_16x16x32_bf16 a[36:39], v[100:103], v[132:135], a[36:39]
buffer_load_dwordx4 v232, s[32:35], s69 offen lds
v_mfma_f32_16x16x32_bf16 a[40:43], v[104:107], v[132:135], a[40:43]
ds_read_b64_tr_b16 v[70:71], v21 offset:1280
v_and_b32 v217, 0xffff0000, v220
v_mfma_f32_16x16x32_bf16 a[44:47], v[108:111], v[132:135], a[44:47]
v_mul_f32 v218, v212, v197
v_mul_f32 v219, v213, v197
v_mfma_f32_16x16x32_bf16 a[48:51], v[112:115], v[132:135], a[48:51]
ds_read_b128 v[40:43], v19 offset:4096
v_cvt_pk_bf16_f32 v220, v218, v219
v_mfma_f32_16x16x32_bf16 a[52:55], v[116:119], v[132:135], a[52:55]
buffer_load_dwordx4 v233, s[32:35], s69 offen offset:1024 lds
v_mfma_f32_16x16x32_bf16 a[56:59], v[120:123], v[132:135], a[56:59]
ds_read_b64_tr_b16 v[72:73], v21 offset:512
v_lshlrev_b32 v218, 16, v220
v_mfma_f32_16x16x32_bf16 a[60:63], v[124:127], v[132:135], a[60:63]
v_and_b32 v219, 0xffff0000, v220
v_add_f32 v216, v216, v218
v_mfma_f32_16x16x32_bf16 a[64:67], v[96:99], v[136:139], a[64:67]
ds_read_b64_tr_b16 v[74:75], v21 offset:1536
v_add_f32 v217, v217, v219
v_mfma_f32_16x16x32_bf16 a[68:71], v[100:103], v[136:139], a[68:71]
buffer_load_dwordx4 v234, s[32:35], s69 offen offset:2048 lds
v_mfma_f32_16x16x32_bf16 a[72:75], v[104:107], v[136:139], a[72:75]
ds_read_b128 v[44:47], v19 offset:6144
v_cvt_pk_bf16_f32 v220, v216, v217
v_mfma_f32_16x16x32_bf16 a[76:79], v[108:111], v[136:139], a[76:79]
buffer_load_dwordx4 v235, s[32:35], s69 offen offset:3072 lds
v_mfma_f32_16x16x32_bf16 a[80:83], v[112:115], v[136:139], a[80:83]
ds_read_b64_tr_b16 v[76:77], v21 offset:768
v_lshlrev_b32 v216, 16, v220
v_mfma_f32_16x16x32_bf16 a[84:87], v[116:119], v[136:139], a[84:87]
v_and_b32 v217, 0xffff0000, v220
v_mul_f32 v218, v213, v196
v_mfma_f32_16x16x32_bf16 a[88:91], v[120:123], v[136:139], a[88:91]
ds_read_b64_tr_b16 v[78:79], v21 offset:1792
v_mul_f32 v219, v214, v196
v_mfma_f32_16x16x32_bf16 a[92:95], v[124:127], v[136:139], a[92:95]
s_add_u32 s69, s69, 262144
v_cvt_pk_bf16_f32 v220, v218, v219
v_mfma_f32_16x16x32_bf16 a[96:99], v[96:99], v[140:143], a[96:99]
ds_read_b128 v[48:51], v19 offset:8192
v_lshlrev_b32 v218, 16, v220
v_mfma_f32_16x16x32_bf16 a[100:103], v[100:103], v[140:143], a[100:103]
s_and_b32 s69, s69, 0x7fffff
v_and_b32 v219, 0xffff0000, v220
v_mfma_f32_16x16x32_bf16 a[104:107], v[104:107], v[140:143], a[104:107]
ds_read_b64_tr_b16 v[80:81], v21 offset:4096
v_add_f32 v216, v216, v218
v_mfma_f32_16x16x32_bf16 a[108:111], v[108:111], v[140:143], a[108:111]
v_add_f32 v217, v217, v219
v_cvt_pk_bf16_f32 v220, v216, v217
v_mfma_f32_16x16x32_bf16 a[112:115], v[112:115], v[140:143], a[112:115]
ds_read_b64_tr_b16 v[82:83], v21 offset:5120
v_lshlrev_b32 v216, 16, v220
v_mfma_f32_16x16x32_bf16 a[116:119], v[116:119], v[140:143], a[116:119]
s_add_u32 m0, s67, s70
v_and_b32 v217, 0xffff0000, v220
v_mfma_f32_16x16x32_bf16 a[120:123], v[120:123], v[140:143], a[120:123]
ds_read_b128 v[52:55], v19 offset:10240
v_lshlrev_b32 v218, 16, v181
v_mfma_f32_16x16x32_bf16 a[124:127], v[124:127], v[140:143], a[124:127]
v_lshlrev_b32 v219, 16, v182
v_mul_f32 v216, v216, v218
v_mfma_f32_16x16x32_bf16 a[128:131], v[96:99], v[144:147], a[128:131]
ds_read_b64_tr_b16 v[84:85], v21 offset:4352
v_mul_f32 v217, v217, v219
v_mfma_f32_16x16x32_bf16 a[132:135], v[100:103], v[144:147], a[132:135]
s_add_u32 s22, s67, 16384
v_cvt_pk_bf16_f32 v224, v217, v216
v_mfma_f32_16x16x32_bf16 a[136:139], v[104:107], v[144:147], a[136:139]
ds_read_b64_tr_b16 v[86:87], v21 offset:5376
v_mfma_f32_16x16x32_bf16 a[140:143], v[108:111], v[144:147], a[140:143]
s_sub_u32 s67, s22, 163840
s_cselect_b32 s67, s22, s67
v_mfma_f32_16x16x32_bf16 a[144:147], v[112:115], v[144:147], a[144:147]
ds_read_b128 v[56:59], v19 offset:12288
v_mfma_f32_16x16x32_bf16 a[148:151], v[116:119], v[144:147], a[148:151]
s_mov_b32 s81, 104857600
buffer_store_dwordx4 v[224:227], v162, s[60:63], s81 offen sc1
v_mfma_f32_16x16x32_bf16 a[152:155], v[120:123], v[144:147], a[152:155]
ds_read_b64_tr_b16 v[88:89], v21 offset:4608
v_and_b32 v204, 0xffff0000, v164
v_mfma_f32_16x16x32_bf16 a[156:159], v[124:127], v[144:147], a[156:159]
buffer_load_dwordx4 v232, s[32:35], s69 offen lds
v_mfma_f32_16x16x32_bf16 a[160:163], v[96:99], v[148:151], a[160:163]
ds_read_b64_tr_b16 v[90:91], v21 offset:5632
v_and_b32 v205, 0xffff0000, v165
v_mfma_f32_16x16x32_bf16 a[164:167], v[100:103], v[148:151], a[164:167]
buffer_load_dwordx4 v233, s[32:35], s69 offen offset:1024 lds
v_mfma_f32_16x16x32_bf16 a[168:171], v[104:107], v[148:151], a[168:171]
ds_read_b128 v[60:63], v19 offset:14336
v_and_b32 v206, 0xffff0000, v166
v_mfma_f32_16x16x32_bf16 a[172:175], v[108:111], v[148:151], a[172:175]
v_and_b32 v207, 0xffff0000, v167
v_and_b32 v208, 0xffff0000, v168
v_mfma_f32_16x16x32_bf16 a[176:179], v[112:115], v[148:151], a[176:179]
ds_read_b64_tr_b16 v[92:93], v21 offset:4864
v_and_b32 v209, 0xffff0000, v169
v_mfma_f32_16x16x32_bf16 a[180:183], v[116:119], v[148:151], a[180:183]
buffer_load_dwordx4 v234, s[32:35], s69 offen offset:2048 lds
v_mfma_f32_16x16x32_bf16 a[184:187], v[120:123], v[148:151], a[184:187]
ds_read_b64_tr_b16 v[94:95], v21 offset:5888
v_and_b32 v210, 0xffff0000, v170
v_mfma_f32_16x16x32_bf16 a[188:191], v[124:127], v[148:151], a[188:191]
v_and_b32 v211, 0xffff0000, v171
v_and_b32 v212, 0xffff0000, v172
v_mfma_f32_16x16x32_bf16 a[192:195], v[96:99], v[152:155], a[192:195]
v_and_b32 v213, 0xffff0000, v173
v_and_b32 v214, 0xffff0000, v174
v_mfma_f32_16x16x32_bf16 a[196:199], v[100:103], v[152:155], a[196:199]
buffer_load_dwordx4 v235, s[32:35], s69 offen offset:3072 lds
v_mfma_f32_16x16x32_bf16 a[200:203], v[104:107], v[152:155], a[200:203]
v_mul_f32 v216, v204, v203
v_mul_f32 v217, v205, v203
v_mfma_f32_16x16x32_bf16 a[204:207], v[108:111], v[152:155], a[204:207]
s_add_u32 s69, s69, 262144
v_cvt_pk_bf16_f32 v220, v216, v217
v_mfma_f32_16x16x32_bf16 a[208:211], v[112:115], v[152:155], a[208:211]
v_lshlrev_b32 v216, 16, v220
v_and_b32 v217, 0xffff0000, v220
v_mfma_f32_16x16x32_bf16 a[212:215], v[116:119], v[152:155], a[212:215]
v_mul_f32 v218, v205, v202
v_mul_f32 v219, v206, v202
v_mfma_f32_16x16x32_bf16 a[216:219], v[120:123], v[152:155], a[216:219]
v_cvt_pk_bf16_f32 v220, v218, v219
v_lshlrev_b32 v218, 16, v220
v_mfma_f32_16x16x32_bf16 a[220:223], v[124:127], v[152:155], a[220:223]
s_and_b32 s69, s69, 0x7fffff
v_and_b32 v219, 0xffff0000, v220
v_mfma_f32_16x16x32_bf16 a[224:227], v[96:99], v[156:159], a[224:227]
v_add_f32 v216, v216, v218
v_add_f32 v217, v217, v219
v_mfma_f32_16x16x32_bf16 a[228:231], v[100:103], v[156:159], a[228:231]
v_add_u32 v20, s65, v237
v_cvt_pk_bf16_f32 v220, v216, v217
v_mfma_f32_16x16x32_bf16 a[232:235], v[104:107], v[156:159], a[232:235]
v_lshlrev_b32 v216, 16, v220
v_and_b32 v217, 0xffff0000, v220
v_mfma_f32_16x16x32_bf16 a[236:239], v[108:111], v[156:159], a[236:239]
v_mul_f32 v218, v206, v201
v_mul_f32 v219, v207, v201
v_mfma_f32_16x16x32_bf16 a[240:243], v[112:115], v[156:159], a[240:243]
v_cvt_pk_bf16_f32 v220, v218, v219
v_lshlrev_b32 v218, 16, v220
v_mfma_f32_16x16x32_bf16 a[244:247], v[116:119], v[156:159], a[244:247]
v_add_u32 v22, s66, v238
v_and_b32 v219, 0xffff0000, v220
v_mfma_f32_16x16x32_bf16 a[248:251], v[120:123], v[156:159], a[248:251]
v_add_f32 v216, v216, v218
v_add_f32 v217, v217, v219
v_mfma_f32_16x16x32_bf16 a[252:255], v[124:127], v[156:159], a[252:255]
v_cvt_pk_bf16_f32 v220, v216, v217
v_lshlrev_b32 v216, 16, v220
v_and_b32 v217, 0xffff0000, v220
s_waitcnt lgkmcnt(0)
s_waitcnt vmcnt(20)
s_barrier
v_mfma_f32_16x16x32_bf16 a[0:3], v[32:35], v[64:67], a[0:3]
ds_read_b128 v[96:99], v20 offset:0
v_mul_f32 v218, v207, v200
v_mfma_f32_16x16x32_bf16 a[4:7], v[36:39], v[64:67], a[4:7]
s_add_u32 m0, s67, s70
v_mul_f32 v219, v208, v200
v_mfma_f32_16x16x32_bf16 a[8:11], v[40:43], v[64:67], a[8:11]
ds_read_b64_tr_b16 v[128:129], v22 offset:0
v_cvt_pk_bf16_f32 v220, v218, v219
v_mfma_f32_16x16x32_bf16 a[12:15], v[44:47], v[64:67], a[12:15]
s_add_u32 s22, s67, 16384
v_lshlrev_b32 v218, 16, v220
v_and_b32 v219, 0xffff0000, v220
v_mfma_f32_16x16x32_bf16 a[16:19], v[48:51], v[64:67], a[16:19]
ds_read_b64_tr_b16 v[130:131], v22 offset:1024
v_add_f32 v216, v216, v218
v_mfma_f32_16x16x32_bf16 a[20:23], v[52:55], v[64:67], a[20:23]
s_sub_u32 s67, s22, 163840
s_cselect_b32 s67, s22, s67
v_mfma_f32_16x16x32_bf16 a[24:27], v[56:59], v[64:67], a[24:27]
ds_read_b128 v[100:103], v20 offset:2048
v_add_f32 v217, v217, v219
v_mfma_f32_16x16x32_bf16 a[28:31], v[60:63], v[64:67], a[28:31]
buffer_load_dwordx4 v1, s[28:31], s68 offen lds
v_cvt_pk_bf16_f32 v220, v216, v217
v_mfma_f32_16x16x32_bf16 a[32:35], v[32:35], v[68:71], a[32:35]
ds_read_b64_tr_b16 v[132:133], v22 offset:256
v_lshlrev_b32 v216, 16, v220
v_mfma_f32_16x16x32_bf16 a[36:39], v[36:39], v[68:71], a[36:39]
v_and_b32 v217, 0xffff0000, v220
v_and_b32 v218, 0xffff0000, v175
v_mfma_f32_16x16x32_bf16 a[40:43], v[40:43], v[68:71], a[40:43]
ds_read_b64_tr_b16 v[134:135], v22 offset:1280
v_and_b32 v219, 0xffff0000, v176
v_mfma_f32_16x16x32_bf16 a[44:47], v[44:47], v[68:71], a[44:47]
buffer_load_dwordx4 v2, s[28:31], s68 offen offset:1024 lds
v_mul_f32 v216, v216, v218
v_mfma_f32_16x16x32_bf16 a[48:51], v[48:51], v[68:71], a[48:51]
ds_read_b128 v[104:107], v20 offset:4096
v_mul_f32 v217, v217, v219
v_mfma_f32_16x16x32_bf16 a[52:55], v[52:55], v[68:71], a[52:55]
buffer_load_dwordx4 v3, s[28:31], s68 offen offset:2048 lds
v_mfma_f32_16x16x32_bf16 a[56:59], v[56:59], v[68:71], a[56:59]
ds_read_b64_tr_b16 v[136:137], v22 offset:512
v_cvt_pk_bf16_f32 v231, v217, v216
v_mfma_f32_16x16x32_bf16 a[60:63], v[60:63], v[68:71], a[60:63]
buffer_load_dwordx4 v4, s[28:31], s68 offen offset:3072 lds
v_mul_f32 v216, v206, v203
v_mfma_f32_16x16x32_bf16 a[64:67], v[32:35], v[72:75], a[64:67]
ds_read_b64_tr_b16 v[138:139], v22 offset:1536
v_mul_f32 v217, v207, v203
v_mfma_f32_16x16x32_bf16 a[68:71], v[36:39], v[72:75], a[68:71]
s_add_u32 s68, s68, 262144
v_cvt_pk_bf16_f32 v220, v216, v217
v_mfma_f32_16x16x32_bf16 a[72:75], v[40:43], v[72:75], a[72:75]
ds_read_b128 v[108:111], v20 offset:6144
v_lshlrev_b32 v216, 16, v220
v_mfma_f32_16x16x32_bf16 a[76:79], v[44:47], v[72:75], a[76:79]
v_and_b32 v217, 0xffff0000, v220
v_mul_f32 v218, v207, v202
v_mfma_f32_16x16x32_bf16 a[80:83], v[48:51], v[72:75], a[80:83]
ds_read_b64_tr_b16 v[140:141], v22 offset:768
v_mul_f32 v219, v208, v202
v_mfma_f32_16x16x32_bf16 a[84:87], v[52:55], v[72:75], a[84:87]
s_add_u32 m0, s67, s70
v_cvt_pk_bf16_f32 v220, v218, v219
v_mfma_f32_16x16x32_bf16 a[88:91], v[56:59], v[72:75], a[88:91]
ds_read_b64_tr_b16 v[142:143], v22 offset:1792
v_lshlrev_b32 v218, 16, v220
v_mfma_f32_16x16x32_bf16 a[92:95], v[60:63], v[72:75], a[92:95]
s_add_u32 s22, s67, 16384
v_and_b32 v219, 0xffff0000, v220
v_add_f32 v216, v216, v218
v_mfma_f32_16x16x32_bf16 a[96:99], v[32:35], v[76:79], a[96:99]
ds_read_b128 v[112:115], v20 offset:8192
v_add_f32 v217, v217, v219
v_mfma_f32_16x16x32_bf16 a[100:103], v[36:39], v[76:79], a[100:103]
s_sub_u32 s67, s22, 163840
s_cselect_b32 s67, s22, s67
v_mfma_f32_16x16x32_bf16 a[104:107], v[40:43], v[76:79], a[104:107]
ds_read_b64_tr_b16 v[144:145], v22 offset:4096
v_cvt_pk_bf16_f32 v220, v216, v217
v_mfma_f32_16x16x32_bf16 a[108:111], v[44:47], v[76:79], a[108:111]
v_lshlrev_b32 v216, 16, v220
v_and_b32 v217, 0xffff0000, v220
v_mfma_f32_16x16x32_bf16 a[112:115], v[48:51], v[76:79], a[112:115]
ds_read_b64_tr_b16 v[146:147], v22 offset:5120
v_mul_f32 v218, v208, v201
v_mfma_f32_16x16x32_bf16 a[116:119], v[52:55], v[76:79], a[116:119]
buffer_load_dwordx4 v1, s[28:31], s68 offen lds
v_mul_f32 v219, v209, v201
v_mfma_f32_16x16x32_bf16 a[120:123], v[56:59], v[76:79], a[120:123]
ds_read_b128 v[116:119], v20 offset:10240
v_cvt_pk_bf16_f32 v220, v218, v219
v_mfma_f32_16x16x32_bf16 a[124:127], v[60:63], v[76:79], a[124:127]
buffer_load_dwordx4 v2, s[28:31], s68 offen offset:1024 lds
v_lshlrev_b32 v218, 16, v220
v_mfma_f32_16x16x32_bf16 a[128:131], v[32:35], v[80:83], a[128:131]
ds_read_b64_tr_b16 v[148:149], v22 offset:4352
v_and_b32 v219, 0xffff0000, v220
v_mfma_f32_16x16x32_bf16 a[132:135], v[36:39], v[80:83], a[132:135]
buffer_load_dwordx4 v3, s[28:31], s68 offen offset:2048 lds
v_mfma_f32_16x16x32_bf16 a[136:139], v[40:43], v[80:83], a[136:139]
ds_read_b64_tr_b16 v[150:151], v22 offset:5376
v_add_f32 v216, v216, v218
v_mfma_f32_16x16x32_bf16 a[140:143], v[44:47], v[80:83], a[140:143]
buffer_load_dwordx4 v4, s[28:31], s68 offen offset:3072 lds
v_add_f32 v217, v217, v219
v_mfma_f32_16x16x32_bf16 a[144:147], v[48:51], v[80:83], a[144:147]
ds_read_b128 v[120:123], v20 offset:12288
v_cvt_pk_bf16_f32 v220, v216, v217
v_mfma_f32_16x16x32_bf16 a[148:151], v[52:55], v[80:83], a[148:151]
v_lshlrev_b32 v216, 16, v220
v_and_b32 v217, 0xffff0000, v220
v_mfma_f32_16x16x32_bf16 a[152:155], v[56:59], v[80:83], a[152:155]
ds_read_b64_tr_b16 v[152:153], v22 offset:4608
v_mul_f32 v218, v209, v200
v_mfma_f32_16x16x32_bf16 a[156:159], v[60:63], v[80:83], a[156:159]
s_sub_u32 s68, s68, 262016
v_mul_f32 v219, v210, v200
v_mfma_f32_16x16x32_bf16 a[160:163], v[32:35], v[84:87], a[160:163]
ds_read_b64_tr_b16 v[154:155], v22 offset:5632
v_cvt_pk_bf16_f32 v220, v218, v219
v_mfma_f32_16x16x32_bf16 a[164:167], v[36:39], v[84:87], a[164:167]
s_bitset0_b32 s68, 11
v_lshlrev_b32 v218, 16, v220
v_mfma_f32_16x16x32_bf16 a[168:171], v[40:43], v[84:87], a[168:171]
ds_read_b128 v[124:127], v20 offset:14336
v_and_b32 v219, 0xffff0000, v220
v_add_f32 v216, v216, v218
v_mfma_f32_16x16x32_bf16 a[172:175], v[44:47], v[84:87], a[172:175]
s_add_u32 s23, s64, 65536
v_add_f32 v217, v217, v219
v_mfma_f32_16x16x32_bf16 a[176:179], v[48:51], v[84:87], a[176:179]
ds_read_b64_tr_b16 v[156:157], v22 offset:4864
v_cvt_pk_bf16_f32 v220, v216, v217
v_mfma_f32_16x16x32_bf16 a[180:183], v[52:55], v[84:87], a[180:183]
v_lshlrev_b32 v216, 16, v220
v_and_b32 v217, 0xffff0000, v220
v_mfma_f32_16x16x32_bf16 a[184:187], v[56:59], v[84:87], a[184:187]
ds_read_b64_tr_b16 v[158:159], v22 offset:5888
v_and_b32 v218, 0xffff0000, v177
v_mfma_f32_16x16x32_bf16 a[188:191], v[60:63], v[84:87], a[188:191]
s_sub_u32 s64, s23, 163840
s_cselect_b32 s64, s23, s64
v_mfma_f32_16x16x32_bf16 a[192:195], v[32:35], v[88:91], a[192:195]
v_and_b32 v219, 0xffff0000, v178
v_mul_f32 v216, v216, v218
v_mfma_f32_16x16x32_bf16 a[196:199], v[36:39], v[88:91], a[196:199]
s_add_u32 s23, s65, 65536
v_mul_f32 v217, v217, v219
v_mfma_f32_16x16x32_bf16 a[200:203], v[40:43], v[88:91], a[200:203]
v_cvt_pk_bf16_f32 v230, v217, v216
v_mul_f32 v216, v208, v203
v_mfma_f32_16x16x32_bf16 a[204:207], v[44:47], v[88:91], a[204:207]
s_sub_u32 s65, s23, 163840
s_cselect_b32 s65, s23, s65
v_mfma_f32_16x16x32_bf16 a[208:211], v[48:51], v[88:91], a[208:211]
v_mul_f32 v217, v209, v203
v_cvt_pk_bf16_f32 v220, v216, v217
v_mfma_f32_16x16x32_bf16 a[212:215], v[52:55], v[88:91], a[212:215]
s_add_u32 s23, s66, 65536
v_lshlrev_b32 v216, 16, v220
v_mfma_f32_16x16x32_bf16 a[216:219], v[56:59], v[88:91], a[216:219]
v_and_b32 v217, 0xffff0000, v220
v_mul_f32 v218, v209, v202
v_mfma_f32_16x16x32_bf16 a[220:223], v[60:63], v[88:91], a[220:223]
v_mul_f32 v219, v210, v202
v_cvt_pk_bf16_f32 v220, v218, v219
v_mfma_f32_16x16x32_bf16 a[224:227], v[32:35], v[92:95], a[224:227]
v_lshlrev_b32 v218, 16, v220
v_mfma_f32_16x16x32_bf16 a[228:231], v[36:39], v[92:95], a[228:231]
s_sub_u32 s66, s23, 163840
s_cselect_b32 s66, s23, s66
v_and_b32 v219, 0xffff0000, v220
v_mfma_f32_16x16x32_bf16 a[232:235], v[40:43], v[92:95], a[232:235]
v_add_f32 v216, v216, v218
v_add_f32 v217, v217, v219
v_mfma_f32_16x16x32_bf16 a[236:239], v[44:47], v[92:95], a[236:239]
v_add_u32 v19, s65, v236
v_cvt_pk_bf16_f32 v220, v216, v217
v_mfma_f32_16x16x32_bf16 a[240:243], v[48:51], v[92:95], a[240:243]
v_lshlrev_b32 v216, 16, v220
v_mfma_f32_16x16x32_bf16 a[244:247], v[52:55], v[92:95], a[244:247]
v_add_u32 v21, s64, v238
v_and_b32 v217, 0xffff0000, v220
v_mul_f32 v218, v210, v201
v_mfma_f32_16x16x32_bf16 a[248:251], v[56:59], v[92:95], a[248:251]
v_mul_f32 v219, v211, v201
v_mfma_f32_16x16x32_bf16 a[252:255], v[60:63], v[92:95], a[252:255]
v_cvt_pk_bf16_f32 v220, v218, v219
v_lshlrev_b32 v218, 16, v220
s_waitcnt lgkmcnt(0)
s_waitcnt vmcnt(16)
s_barrier
v_mfma_f32_16x16x32_bf16 a[0:3], v[96:99], v[128:131], a[0:3]
ds_read_b128 v[32:35], v19 offset:0
v_and_b32 v219, 0xffff0000, v220
v_mfma_f32_16x16x32_bf16 a[4:7], v[100:103], v[128:131], a[4:7]
s_add_u32 m0, s67, s70
v_add_f32 v216, v216, v218
v_mfma_f32_16x16x32_bf16 a[8:11], v[104:107], v[128:131], a[8:11]
ds_read_b64_tr_b16 v[64:65], v21 offset:0
v_add_f32 v217, v217, v219
v_mfma_f32_16x16x32_bf16 a[12:15], v[108:111], v[128:131], a[12:15]
s_add_u32 s22, s67, 16384
v_cvt_pk_bf16_f32 v220, v216, v217
v_lshlrev_b32 v216, 16, v220
v_mfma_f32_16x16x32_bf16 a[16:19], v[112:115], v[128:131], a[16:19]
ds_read_b64_tr_b16 v[66:67], v21 offset:1024
v_and_b32 v217, 0xffff0000, v220
v_mfma_f32_16x16x32_bf16 a[20:23], v[116:119], v[128:131], a[20:23]
v_mul_f32 v218, v211, v200
v_mul_f32 v219, v212, v200
v_mfma_f32_16x16x32_bf16 a[24:27], v[120:123], v[128:131], a[24:27]
ds_read_b128 v[36:39], v19 offset:2048
v_cvt_pk_bf16_f32 v220, v218, v219
v_mfma_f32_16x16x32_bf16 a[28:31], v[124:127], v[128:131], a[28:31]
s_sub_u32 s67, s22, 163840
s_cselect_b32 s67, s22, s67
v_mfma_f32_16x16x32_bf16 a[32:35], v[96:99], v[132:135], a[32:35]
ds_read_b64_tr_b16 v[68:69], v21 offset:256
v_lshlrev_b32 v218, 16, v220
v_mfma_f32_16x16x32_bf16 a[36:39], v[100:103], v[132:135], a[36:39]
buffer_load_dwordx4 v232, s[32:35], s69 offen lds
v_and_b32 v219, 0xffff0000, v220
v_mfma_f32_16x16x32_bf16 a[40:43], v[104:107], v[132:135], a[40:43]
ds_read_b64_tr_b16 v[70:71], v21 offset:1280
v_add_f32 v216, v216, v218
v_mfma_f32_16x16x32_bf16 a[44:47], v[108:111], v[132:135], a[44:47]
v_add_f32 v217, v217, v219
v_cvt_pk_bf16_f32 v220, v216, v217
v_mfma_f32_16x16x32_bf16 a[48:51], v[112:115], v[132:135], a[48:51]
ds_read_b128 v[40:43], v19 offset:4096
v_lshlrev_b32 v216, 16, v220
v_mfma_f32_16x16x32_bf16 a[52:55], v[116:119], v[132:135], a[52:55]
buffer_load_dwordx4 v233, s[32:35], s69 offen offset:1024 lds
v_and_b32 v217, 0xffff0000, v220
v_mfma_f32_16x16x32_bf16 a[56:59], v[120:123], v[132:135], a[56:59]
ds_read_b64_tr_b16 v[72:73], v21 offset:512
v_and_b32 v218, 0xffff0000, v179
v_mfma_f32_16x16x32_bf16 a[60:63], v[124:127], v[132:135], a[60:63]
v_and_b32 v219, 0xffff0000, v180
v_mul_f32 v216, v216, v218
v_mfma_f32_16x16x32_bf16 a[64:67], v[96:99], v[136:139], a[64:67]
ds_read_b64_tr_b16 v[74:75], v21 offset:1536
v_mul_f32 v217, v217, v219
v_mfma_f32_16x16x32_bf16 a[68:71], v[100:103], v[136:139], a[68:71]
buffer_load_dwordx4 v234, s[32:35], s69 offen offset:2048 lds
v_mfma_f32_16x16x32_bf16 a[72:75], v[104:107], v[136:139], a[72:75]
ds_read_b128 v[44:47], v19 offset:6144
v_cvt_pk_bf16_f32 v229, v217, v216
v_mfma_f32_16x16x32_bf16 a[76:79], v[108:111], v[136:139], a[76:79]
buffer_load_dwordx4 v235, s[32:35], s69 offen offset:3072 lds
v_mul_f32 v216, v210, v203
v_mfma_f32_16x16x32_bf16 a[80:83], v[112:115], v[136:139], a[80:83]
ds_read_b64_tr_b16 v[76:77], v21 offset:768
v_mul_f32 v217, v211, v203
v_mfma_f32_16x16x32_bf16 a[84:87], v[116:119], v[136:139], a[84:87]
v_cvt_pk_bf16_f32 v220, v216, v217
v_lshlrev_b32 v216, 16, v220
v_mfma_f32_16x16x32_bf16 a[88:91], v[120:123], v[136:139], a[88:91]
ds_read_b64_tr_b16 v[78:79], v21 offset:1792
v_and_b32 v217, 0xffff0000, v220
v_mfma_f32_16x16x32_bf16 a[92:95], v[124:127], v[136:139], a[92:95]
s_add_u32 s69, s69, 262144
v_mul_f32 v218, v211, v202
v_mfma_f32_16x16x32_bf16 a[96:99], v[96:99], v[140:143], a[96:99]
ds_read_b128 v[48:51], v19 offset:8192
v_mul_f32 v219, v212, v202
v_mfma_f32_16x16x32_bf16 a[100:103], v[100:103], v[140:143], a[100:103]
s_and_b32 s69, s69, 0x7fffff
v_cvt_pk_bf16_f32 v220, v218, v219
v_lshlrev_b32 v218, 16, v220
v_mfma_f32_16x16x32_bf16 a[104:107], v[104:107], v[140:143], a[104:107]
ds_read_b64_tr_b16 v[80:81], v21 offset:4096
v_and_b32 v219, 0xffff0000, v220
v_mfma_f32_16x16x32_bf16 a[108:111], v[108:111], v[140:143], a[108:111]
v_add_f32 v216, v216, v218
v_mfma_f32_16x16x32_bf16 a[112:115], v[112:115], v[140:143], a[112:115]
ds_read_b64_tr_b16 v[82:83], v21 offset:5120
v_add_f32 v217, v217, v219
v_cvt_pk_bf16_f32 v220, v216, v217
v_mfma_f32_16x16x32_bf16 a[116:119], v[116:119], v[140:143], a[116:119]
s_add_u32 m0, s67, s70
v_lshlrev_b32 v216, 16, v220
v_mfma_f32_16x16x32_bf16 a[120:123], v[120:123], v[140:143], a[120:123]
ds_read_b128 v[52:55], v19 offset:10240
v_and_b32 v217, 0xffff0000, v220
v_mfma_f32_16x16x32_bf16 a[124:127], v[124:127], v[140:143], a[124:127]
v_mul_f32 v218, v212, v201
v_mul_f32 v219, v213, v201
v_mfma_f32_16x16x32_bf16 a[128:131], v[96:99], v[144:147], a[128:131]
ds_read_b64_tr_b16 v[84:85], v21 offset:4352
v_cvt_pk_bf16_f32 v220, v218, v219
v_mfma_f32_16x16x32_bf16 a[132:135], v[100:103], v[144:147], a[132:135]
s_add_u32 s22, s67, 16384
v_lshlrev_b32 v218, 16, v220
v_mfma_f32_16x16x32_bf16 a[136:139], v[104:107], v[144:147], a[136:139]
ds_read_b64_tr_b16 v[86:87], v21 offset:5376
v_and_b32 v219, 0xffff0000, v220
v_mfma_f32_16x16x32_bf16 a[140:143], v[108:111], v[144:147], a[140:143]
s_sub_u32 s67, s22, 163840
s_cselect_b32 s67, s22, s67
v_add_f32 v216, v216, v218
v_mfma_f32_16x16x32_bf16 a[144:147], v[112:115], v[144:147], a[144:147]
ds_read_b128 v[56:59], v19 offset:12288
v_add_f32 v217, v217, v219
v_mfma_f32_16x16x32_bf16 a[148:151], v[116:119], v[144:147], a[148:151]
v_cvt_pk_bf16_f32 v220, v216, v217
v_lshlrev_b32 v216, 16, v220
v_mfma_f32_16x16x32_bf16 a[152:155], v[120:123], v[144:147], a[152:155]
ds_read_b64_tr_b16 v[88:89], v21 offset:4608
v_and_b32 v217, 0xffff0000, v220
v_mfma_f32_16x16x32_bf16 a[156:159], v[124:127], v[144:147], a[156:159]
buffer_load_dwordx4 v232, s[32:35], s69 offen lds
v_mfma_f32_16x16x32_bf16 a[160:163], v[96:99], v[148:151], a[160:163]
ds_read_b64_tr_b16 v[90:91], v21 offset:5632
v_mul_f32 v218, v213, v200
v_mul_f32 v219, v214, v200
v_mfma_f32_16x16x32_bf16 a[164:167], v[100:103], v[148:151], a[164:167]
buffer_load_dwordx4 v233, s[32:35], s69 offen offset:1024 lds
v_mfma_f32_16x16x32_bf16 a[168:171], v[104:107], v[148:151], a[168:171]
ds_read_b128 v[60:63], v19 offset:14336
v_cvt_pk_bf16_f32 v220, v218, v219
v_mfma_f32_16x16x32_bf16 a[172:175], v[108:111], v[148:151], a[172:175]
v_lshlrev_b32 v218, 16, v220
v_and_b32 v219, 0xffff0000, v220
v_mfma_f32_16x16x32_bf16 a[176:179], v[112:115], v[148:151], a[176:179]
ds_read_b64_tr_b16 v[92:93], v21 offset:4864
v_add_f32 v216, v216, v218
v_mfma_f32_16x16x32_bf16 a[180:183], v[116:119], v[148:151], a[180:183]
buffer_load_dwordx4 v234, s[32:35], s69 offen offset:2048 lds
v_add_f32 v217, v217, v219
v_mfma_f32_16x16x32_bf16 a[184:187], v[120:123], v[148:151], a[184:187]
ds_read_b64_tr_b16 v[94:95], v21 offset:5888
v_cvt_pk_bf16_f32 v220, v216, v217
v_mfma_f32_16x16x32_bf16 a[188:191], v[124:127], v[148:151], a[188:191]
v_lshlrev_b32 v216, 16, v220
v_and_b32 v217, 0xffff0000, v220
v_mfma_f32_16x16x32_bf16 a[192:195], v[96:99], v[152:155], a[192:195]
v_and_b32 v218, 0xffff0000, v181
v_mfma_f32_16x16x32_bf16 a[196:199], v[100:103], v[152:155], a[196:199]
buffer_load_dwordx4 v235, s[32:35], s69 offen offset:3072 lds
v_and_b32 v219, 0xffff0000, v182
v_mfma_f32_16x16x32_bf16 a[200:203], v[104:107], v[152:155], a[200:203]
v_mul_f32 v216, v216, v218
v_mul_f32 v217, v217, v219
v_mfma_f32_16x16x32_bf16 a[204:207], v[108:111], v[152:155], a[204:207]
s_add_u32 s69, s69, 262144
v_cvt_pk_bf16_f32 v228, v217, v216
v_mfma_f32_16x16x32_bf16 a[208:211], v[112:115], v[152:155], a[208:211]
s_mov_b32 s81, 104861696
buffer_store_dwordx4 v[228:231], v162, s[60:63], s81 offen sc1
v_mfma_f32_16x16x32_bf16 a[212:215], v[116:119], v[152:155], a[212:215]
v_mfma_f32_16x16x32_bf16 a[216:219], v[120:123], v[152:155], a[216:219]
s_mov_b32 s82, 0x05040100
s_mov_b32 s83, 0x07060302
v_mfma_f32_16x16x32_bf16 a[220:223], v[124:127], v[152:155], a[220:223]
s_and_b32 s69, s69, 0x7fffff
v_perm_b32 v207, v183, v184, s82
v_mfma_f32_16x16x32_bf16 a[224:227], v[96:99], v[156:159], a[224:227]
v_perm_b32 v206, v185, v186, s82
v_perm_b32 v205, v187, v188, s82
v_mfma_f32_16x16x32_bf16 a[228:231], v[100:103], v[156:159], a[228:231]
v_add_u32 v20, s65, v237
v_perm_b32 v204, v189, v190, s82
v_mfma_f32_16x16x32_bf16 a[232:235], v[104:107], v[156:159], a[232:235]
s_mov_b32 s81, 109051904
buffer_store_dwordx4 v[204:207], v162, s[60:63], s81 offen sc1
v_mfma_f32_16x16x32_bf16 a[236:239], v[108:111], v[156:159], a[236:239]
v_perm_b32 v211, v183, v184, s83
v_mfma_f32_16x16x32_bf16 a[240:243], v[112:115], v[156:159], a[240:243]
v_perm_b32 v210, v185, v186, s83
v_mfma_f32_16x16x32_bf16 a[244:247], v[116:119], v[156:159], a[244:247]
v_add_u32 v22, s66, v238
v_perm_b32 v209, v187, v188, s83
v_perm_b32 v208, v189, v190, s83
v_mfma_f32_16x16x32_bf16 a[248:251], v[120:123], v[156:159], a[248:251]
s_mov_b32 s81, 109056000
buffer_store_dwordx4 v[208:211], v162, s[60:63], s81 offen sc1
v_mfma_f32_16x16x32_bf16 a[252:255], v[124:127], v[156:159], a[252:255]
F_V_LOOP:
s_waitcnt lgkmcnt(0)
s_waitcnt vmcnt(20)
s_barrier
v_mfma_f32_16x16x32_bf16 a[0:3], v[32:35], v[64:67], a[0:3]
ds_read_b128 v[96:99], v20 offset:0
v_mfma_f32_16x16x32_bf16 a[4:7], v[36:39], v[64:67], a[4:7]
s_add_u32 m0, s67, s70
v_mfma_f32_16x16x32_bf16 a[8:11], v[40:43], v[64:67], a[8:11]
ds_read_b64_tr_b16 v[128:129], v22 offset:0
v_mfma_f32_16x16x32_bf16 a[12:15], v[44:47], v[64:67], a[12:15]
s_add_u32 s22, s67, 16384
v_mfma_f32_16x16x32_bf16 a[16:19], v[48:51], v[64:67], a[16:19]
ds_read_b64_tr_b16 v[130:131], v22 offset:1024
v_mfma_f32_16x16x32_bf16 a[20:23], v[52:55], v[64:67], a[20:23]
s_sub_u32 s67, s22, 163840
s_cselect_b32 s67, s22, s67
v_mfma_f32_16x16x32_bf16 a[24:27], v[56:59], v[64:67], a[24:27]
ds_read_b128 v[100:103], v20 offset:2048
v_mfma_f32_16x16x32_bf16 a[28:31], v[60:63], v[64:67], a[28:31]
buffer_load_dwordx4 v1, s[28:31], s68 offen lds
v_mfma_f32_16x16x32_bf16 a[32:35], v[32:35], v[68:71], a[32:35]
ds_read_b64_tr_b16 v[132:133], v22 offset:256
v_mfma_f32_16x16x32_bf16 a[36:39], v[36:39], v[68:71], a[36:39]
v_mfma_f32_16x16x32_bf16 a[40:43], v[40:43], v[68:71], a[40:43]
ds_read_b64_tr_b16 v[134:135], v22 offset:1280
v_mfma_f32_16x16x32_bf16 a[44:47], v[44:47], v[68:71], a[44:47]
buffer_load_dwordx4 v2, s[28:31], s68 offen offset:1024 lds
v_mfma_f32_16x16x32_bf16 a[48:51], v[48:51], v[68:71], a[48:51]
ds_read_b128 v[104:107], v20 offset:4096
v_mfma_f32_16x16x32_bf16 a[52:55], v[52:55], v[68:71], a[52:55]
buffer_load_dwordx4 v3, s[28:31], s68 offen offset:2048 lds
v_mfma_f32_16x16x32_bf16 a[56:59], v[56:59], v[68:71], a[56:59]
ds_read_b64_tr_b16 v[136:137], v22 offset:512
v_mfma_f32_16x16x32_bf16 a[60:63], v[60:63], v[68:71], a[60:63]
buffer_load_dwordx4 v4, s[28:31], s68 offen offset:3072 lds
v_mfma_f32_16x16x32_bf16 a[64:67], v[32:35], v[72:75], a[64:67]
ds_read_b64_tr_b16 v[138:139], v22 offset:1536
v_mfma_f32_16x16x32_bf16 a[68:71], v[36:39], v[72:75], a[68:71]
s_add_u32 s68, s68, 262144
v_mfma_f32_16x16x32_bf16 a[72:75], v[40:43], v[72:75], a[72:75]
ds_read_b128 v[108:111], v20 offset:6144
v_mfma_f32_16x16x32_bf16 a[76:79], v[44:47], v[72:75], a[76:79]
v_mfma_f32_16x16x32_bf16 a[80:83], v[48:51], v[72:75], a[80:83]
ds_read_b64_tr_b16 v[140:141], v22 offset:768
v_mfma_f32_16x16x32_bf16 a[84:87], v[52:55], v[72:75], a[84:87]
s_add_u32 m0, s67, s70
v_mfma_f32_16x16x32_bf16 a[88:91], v[56:59], v[72:75], a[88:91]
ds_read_b64_tr_b16 v[142:143], v22 offset:1792
v_mfma_f32_16x16x32_bf16 a[92:95], v[60:63], v[72:75], a[92:95]
s_add_u32 s22, s67, 16384
v_mfma_f32_16x16x32_bf16 a[96:99], v[32:35], v[76:79], a[96:99]
ds_read_b128 v[112:115], v20 offset:8192
v_mfma_f32_16x16x32_bf16 a[100:103], v[36:39], v[76:79], a[100:103]
s_sub_u32 s67, s22, 163840
s_cselect_b32 s67, s22, s67
v_mfma_f32_16x16x32_bf16 a[104:107], v[40:43], v[76:79], a[104:107]
ds_read_b64_tr_b16 v[144:145], v22 offset:4096
v_mfma_f32_16x16x32_bf16 a[108:111], v[44:47], v[76:79], a[108:111]
v_mfma_f32_16x16x32_bf16 a[112:115], v[48:51], v[76:79], a[112:115]
ds_read_b64_tr_b16 v[146:147], v22 offset:5120
v_mfma_f32_16x16x32_bf16 a[116:119], v[52:55], v[76:79], a[116:119]
buffer_load_dwordx4 v1, s[28:31], s68 offen lds
v_mfma_f32_16x16x32_bf16 a[120:123], v[56:59], v[76:79], a[120:123]
ds_read_b128 v[116:119], v20 offset:10240
v_mfma_f32_16x16x32_bf16 a[124:127], v[60:63], v[76:79], a[124:127]
buffer_load_dwordx4 v2, s[28:31], s68 offen offset:1024 lds
v_mfma_f32_16x16x32_bf16 a[128:131], v[32:35], v[80:83], a[128:131]
ds_read_b64_tr_b16 v[148:149], v22 offset:4352
v_mfma_f32_16x16x32_bf16 a[132:135], v[36:39], v[80:83], a[132:135]
buffer_load_dwordx4 v3, s[28:31], s68 offen offset:2048 lds
v_mfma_f32_16x16x32_bf16 a[136:139], v[40:43], v[80:83], a[136:139]
ds_read_b64_tr_b16 v[150:151], v22 offset:5376
v_mfma_f32_16x16x32_bf16 a[140:143], v[44:47], v[80:83], a[140:143]
buffer_load_dwordx4 v4, s[28:31], s68 offen offset:3072 lds
v_mfma_f32_16x16x32_bf16 a[144:147], v[48:51], v[80:83], a[144:147]
ds_read_b128 v[120:123], v20 offset:12288
v_mfma_f32_16x16x32_bf16 a[148:151], v[52:55], v[80:83], a[148:151]
v_mfma_f32_16x16x32_bf16 a[152:155], v[56:59], v[80:83], a[152:155]
ds_read_b64_tr_b16 v[152:153], v22 offset:4608
v_mfma_f32_16x16x32_bf16 a[156:159], v[60:63], v[80:83], a[156:159]
s_sub_u32 s68, s68, 262016
v_mfma_f32_16x16x32_bf16 a[160:163], v[32:35], v[84:87], a[160:163]
ds_read_b64_tr_b16 v[154:155], v22 offset:5632
v_mfma_f32_16x16x32_bf16 a[164:167], v[36:39], v[84:87], a[164:167]
s_bitset0_b32 s68, 11
v_mfma_f32_16x16x32_bf16 a[168:171], v[40:43], v[84:87], a[168:171]
ds_read_b128 v[124:127], v20 offset:14336
v_mfma_f32_16x16x32_bf16 a[172:175], v[44:47], v[84:87], a[172:175]
s_add_u32 s23, s64, 65536
v_mfma_f32_16x16x32_bf16 a[176:179], v[48:51], v[84:87], a[176:179]
ds_read_b64_tr_b16 v[156:157], v22 offset:4864
v_mfma_f32_16x16x32_bf16 a[180:183], v[52:55], v[84:87], a[180:183]
v_mfma_f32_16x16x32_bf16 a[184:187], v[56:59], v[84:87], a[184:187]
ds_read_b64_tr_b16 v[158:159], v22 offset:5888
v_mfma_f32_16x16x32_bf16 a[188:191], v[60:63], v[84:87], a[188:191]
s_sub_u32 s64, s23, 163840
s_cselect_b32 s64, s23, s64
v_mfma_f32_16x16x32_bf16 a[192:195], v[32:35], v[88:91], a[192:195]
v_mfma_f32_16x16x32_bf16 a[196:199], v[36:39], v[88:91], a[196:199]
s_add_u32 s23, s65, 65536
v_mfma_f32_16x16x32_bf16 a[200:203], v[40:43], v[88:91], a[200:203]
v_mfma_f32_16x16x32_bf16 a[204:207], v[44:47], v[88:91], a[204:207]
s_sub_u32 s65, s23, 163840
s_cselect_b32 s65, s23, s65
v_mfma_f32_16x16x32_bf16 a[208:211], v[48:51], v[88:91], a[208:211]
v_mfma_f32_16x16x32_bf16 a[212:215], v[52:55], v[88:91], a[212:215]
s_add_u32 s23, s66, 65536
v_mfma_f32_16x16x32_bf16 a[216:219], v[56:59], v[88:91], a[216:219]
v_mfma_f32_16x16x32_bf16 a[220:223], v[60:63], v[88:91], a[220:223]
v_mfma_f32_16x16x32_bf16 a[224:227], v[32:35], v[92:95], a[224:227]
v_mfma_f32_16x16x32_bf16 a[228:231], v[36:39], v[92:95], a[228:231]
s_sub_u32 s66, s23, 163840
s_cselect_b32 s66, s23, s66
v_mfma_f32_16x16x32_bf16 a[232:235], v[40:43], v[92:95], a[232:235]
v_mfma_f32_16x16x32_bf16 a[236:239], v[44:47], v[92:95], a[236:239]
v_add_u32 v19, s65, v236
v_mfma_f32_16x16x32_bf16 a[240:243], v[48:51], v[92:95], a[240:243]
v_mfma_f32_16x16x32_bf16 a[244:247], v[52:55], v[92:95], a[244:247]
v_add_u32 v21, s64, v238
v_mfma_f32_16x16x32_bf16 a[248:251], v[56:59], v[92:95], a[248:251]
v_mfma_f32_16x16x32_bf16 a[252:255], v[60:63], v[92:95], a[252:255]
s_waitcnt lgkmcnt(0)
s_waitcnt vmcnt(16)
s_barrier
v_mfma_f32_16x16x32_bf16 a[0:3], v[96:99], v[128:131], a[0:3]
ds_read_b128 v[32:35], v19 offset:0
v_mfma_f32_16x16x32_bf16 a[4:7], v[100:103], v[128:131], a[4:7]
s_add_u32 m0, s67, s70
v_mfma_f32_16x16x32_bf16 a[8:11], v[104:107], v[128:131], a[8:11]
ds_read_b64_tr_b16 v[64:65], v21 offset:0
v_mfma_f32_16x16x32_bf16 a[12:15], v[108:111], v[128:131], a[12:15]
s_add_u32 s22, s67, 16384
v_mfma_f32_16x16x32_bf16 a[16:19], v[112:115], v[128:131], a[16:19]
ds_read_b64_tr_b16 v[66:67], v21 offset:1024
v_mfma_f32_16x16x32_bf16 a[20:23], v[116:119], v[128:131], a[20:23]
v_mfma_f32_16x16x32_bf16 a[24:27], v[120:123], v[128:131], a[24:27]
ds_read_b128 v[36:39], v19 offset:2048
v_mfma_f32_16x16x32_bf16 a[28:31], v[124:127], v[128:131], a[28:31]
s_sub_u32 s67, s22, 163840
s_cselect_b32 s67, s22, s67
v_mfma_f32_16x16x32_bf16 a[32:35], v[96:99], v[132:135], a[32:35]
ds_read_b64_tr_b16 v[68:69], v21 offset:256
v_mfma_f32_16x16x32_bf16 a[36:39], v[100:103], v[132:135], a[36:39]
buffer_load_dwordx4 v232, s[32:35], s69 offen lds
v_mfma_f32_16x16x32_bf16 a[40:43], v[104:107], v[132:135], a[40:43]
ds_read_b64_tr_b16 v[70:71], v21 offset:1280
v_mfma_f32_16x16x32_bf16 a[44:47], v[108:111], v[132:135], a[44:47]
v_mfma_f32_16x16x32_bf16 a[48:51], v[112:115], v[132:135], a[48:51]
ds_read_b128 v[40:43], v19 offset:4096
v_mfma_f32_16x16x32_bf16 a[52:55], v[116:119], v[132:135], a[52:55]
buffer_load_dwordx4 v233, s[32:35], s69 offen offset:1024 lds
v_mfma_f32_16x16x32_bf16 a[56:59], v[120:123], v[132:135], a[56:59]
ds_read_b64_tr_b16 v[72:73], v21 offset:512
v_mfma_f32_16x16x32_bf16 a[60:63], v[124:127], v[132:135], a[60:63]
v_mfma_f32_16x16x32_bf16 a[64:67], v[96:99], v[136:139], a[64:67]
ds_read_b64_tr_b16 v[74:75], v21 offset:1536
v_mfma_f32_16x16x32_bf16 a[68:71], v[100:103], v[136:139], a[68:71]
buffer_load_dwordx4 v234, s[32:35], s69 offen offset:2048 lds
v_mfma_f32_16x16x32_bf16 a[72:75], v[104:107], v[136:139], a[72:75]
ds_read_b128 v[44:47], v19 offset:6144
v_mfma_f32_16x16x32_bf16 a[76:79], v[108:111], v[136:139], a[76:79]
buffer_load_dwordx4 v235, s[32:35], s69 offen offset:3072 lds
v_mfma_f32_16x16x32_bf16 a[80:83], v[112:115], v[136:139], a[80:83]
ds_read_b64_tr_b16 v[76:77], v21 offset:768
v_mfma_f32_16x16x32_bf16 a[84:87], v[116:119], v[136:139], a[84:87]
v_mfma_f32_16x16x32_bf16 a[88:91], v[120:123], v[136:139], a[88:91]
ds_read_b64_tr_b16 v[78:79], v21 offset:1792
v_mfma_f32_16x16x32_bf16 a[92:95], v[124:127], v[136:139], a[92:95]
s_add_u32 s69, s69, 262144
v_mfma_f32_16x16x32_bf16 a[96:99], v[96:99], v[140:143], a[96:99]
ds_read_b128 v[48:51], v19 offset:8192
v_mfma_f32_16x16x32_bf16 a[100:103], v[100:103], v[140:143], a[100:103]
s_and_b32 s69, s69, 0x7fffff
v_mfma_f32_16x16x32_bf16 a[104:107], v[104:107], v[140:143], a[104:107]
ds_read_b64_tr_b16 v[80:81], v21 offset:4096
v_mfma_f32_16x16x32_bf16 a[108:111], v[108:111], v[140:143], a[108:111]
v_mfma_f32_16x16x32_bf16 a[112:115], v[112:115], v[140:143], a[112:115]
ds_read_b64_tr_b16 v[82:83], v21 offset:5120
v_mfma_f32_16x16x32_bf16 a[116:119], v[116:119], v[140:143], a[116:119]
s_add_u32 m0, s67, s70
v_mfma_f32_16x16x32_bf16 a[120:123], v[120:123], v[140:143], a[120:123]
ds_read_b128 v[52:55], v19 offset:10240
v_mfma_f32_16x16x32_bf16 a[124:127], v[124:127], v[140:143], a[124:127]
v_mfma_f32_16x16x32_bf16 a[128:131], v[96:99], v[144:147], a[128:131]
ds_read_b64_tr_b16 v[84:85], v21 offset:4352
v_mfma_f32_16x16x32_bf16 a[132:135], v[100:103], v[144:147], a[132:135]
s_add_u32 s22, s67, 16384
v_mfma_f32_16x16x32_bf16 a[136:139], v[104:107], v[144:147], a[136:139]
ds_read_b64_tr_b16 v[86:87], v21 offset:5376
v_mfma_f32_16x16x32_bf16 a[140:143], v[108:111], v[144:147], a[140:143]
s_sub_u32 s67, s22, 163840
s_cselect_b32 s67, s22, s67
v_mfma_f32_16x16x32_bf16 a[144:147], v[112:115], v[144:147], a[144:147]
ds_read_b128 v[56:59], v19 offset:12288
v_mfma_f32_16x16x32_bf16 a[148:151], v[116:119], v[144:147], a[148:151]
v_mfma_f32_16x16x32_bf16 a[152:155], v[120:123], v[144:147], a[152:155]
ds_read_b64_tr_b16 v[88:89], v21 offset:4608
v_mfma_f32_16x16x32_bf16 a[156:159], v[124:127], v[144:147], a[156:159]
buffer_load_dwordx4 v232, s[32:35], s69 offen lds
v_mfma_f32_16x16x32_bf16 a[160:163], v[96:99], v[148:151], a[160:163]
ds_read_b64_tr_b16 v[90:91], v21 offset:5632
v_mfma_f32_16x16x32_bf16 a[164:167], v[100:103], v[148:151], a[164:167]
buffer_load_dwordx4 v233, s[32:35], s69 offen offset:1024 lds
v_mfma_f32_16x16x32_bf16 a[168:171], v[104:107], v[148:151], a[168:171]
ds_read_b128 v[60:63], v19 offset:14336
v_mfma_f32_16x16x32_bf16 a[172:175], v[108:111], v[148:151], a[172:175]
v_mfma_f32_16x16x32_bf16 a[176:179], v[112:115], v[148:151], a[176:179]
ds_read_b64_tr_b16 v[92:93], v21 offset:4864
v_mfma_f32_16x16x32_bf16 a[180:183], v[116:119], v[148:151], a[180:183]
buffer_load_dwordx4 v234, s[32:35], s69 offen offset:2048 lds
v_mfma_f32_16x16x32_bf16 a[184:187], v[120:123], v[148:151], a[184:187]
ds_read_b64_tr_b16 v[94:95], v21 offset:5888
v_mfma_f32_16x16x32_bf16 a[188:191], v[124:127], v[148:151], a[188:191]
v_mfma_f32_16x16x32_bf16 a[192:195], v[96:99], v[152:155], a[192:195]
v_mfma_f32_16x16x32_bf16 a[196:199], v[100:103], v[152:155], a[196:199]
buffer_load_dwordx4 v235, s[32:35], s69 offen offset:3072 lds
v_mfma_f32_16x16x32_bf16 a[200:203], v[104:107], v[152:155], a[200:203]
v_mfma_f32_16x16x32_bf16 a[204:207], v[108:111], v[152:155], a[204:207]
s_add_u32 s69, s69, 262144
v_mfma_f32_16x16x32_bf16 a[208:211], v[112:115], v[152:155], a[208:211]
v_mfma_f32_16x16x32_bf16 a[212:215], v[116:119], v[152:155], a[212:215]
v_mfma_f32_16x16x32_bf16 a[216:219], v[120:123], v[152:155], a[216:219]
v_mfma_f32_16x16x32_bf16 a[220:223], v[124:127], v[152:155], a[220:223]
s_and_b32 s69, s69, 0x7fffff
v_mfma_f32_16x16x32_bf16 a[224:227], v[96:99], v[156:159], a[224:227]
v_mfma_f32_16x16x32_bf16 a[228:231], v[100:103], v[156:159], a[228:231]
v_add_u32 v20, s65, v237
v_mfma_f32_16x16x32_bf16 a[232:235], v[104:107], v[156:159], a[232:235]
v_mfma_f32_16x16x32_bf16 a[236:239], v[108:111], v[156:159], a[236:239]
v_mfma_f32_16x16x32_bf16 a[240:243], v[112:115], v[156:159], a[240:243]
v_mfma_f32_16x16x32_bf16 a[244:247], v[116:119], v[156:159], a[244:247]
v_add_u32 v22, s66, v238
v_mfma_f32_16x16x32_bf16 a[248:251], v[120:123], v[156:159], a[248:251]
v_mfma_f32_16x16x32_bf16 a[252:255], v[124:127], v[156:159], a[252:255]
s_cmp_eq_u32 s71, s19
s_cbranch_scc1 F_REG_V
F_REG_RET_V:
s_cmp_eq_u32 s71, 5
s_cbranch_scc1 F_WQ_V
F_WQ_RET_V:
s_add_u32 s71, s71, 1
s_cmp_lt_u32 s71, 9
s_cbranch_scc1 F_V_LOOP
.p2align 3
s_getpc_b64 s[24:25]
F_PC_A2V:
s_add_u32 s24, s24, F_QP_V-F_PC_A2V
s_addc_u32 s25, s25, 0
s_lshr_b32 s22, s14, 2
s_lshl_b32 s22, s22, 1
s_and_b32 s23, s14, 1
s_add_u32 s22, s22, s23
s_lshl_b32 s22, s22, 2
s_add_u32 s22, s22, s12
v_and_b32 v26, 7, v0
v_lshlrev_b32 v26, 6, v26
v_add_u32 v26, s22, v26
v_lshlrev_b32 v26, 7, v26
v_min_u32 v26, F_LOOP-F_QP_V-4, v26
s_mov_b64 exec, 0xff
global_load_dword v27, v26, s[24:25]
s_mov_b64 exec, -1
s_waitcnt lgkmcnt(0)
s_waitcnt vmcnt(20)
s_barrier
v_mfma_f32_16x16x32_bf16 a[0:3], v[32:35], v[64:67], a[0:3]
ds_read_b128 v[96:99], v20 offset:0
v_mfma_f32_16x16x32_bf16 a[4:7], v[36:39], v[64:67], a[4:7]
s_add_u32 m0, s67, s70
v_mfma_f32_16x16x32_bf16 a[8:11], v[40:43], v[64:67], a[8:11]
ds_read_b64_tr_b16 v[128:129], v22 offset:0
v_mfma_f32_16x16x32_bf16 a[12:15], v[44:47], v[64:67], a[12:15]
s_add_u32 s22, s67, 16384
v_mfma_f32_16x16x32_bf16 a[16:19], v[48:51], v[64:67], a[16:19]
ds_read_b64_tr_b16 v[130:131], v22 offset:1024
v_mfma_f32_16x16x32_bf16 a[20:23], v[52:55], v[64:67], a[20:23]
s_sub_u32 s67, s22, 163840
s_cselect_b32 s67, s22, s67
v_mfma_f32_16x16x32_bf16 a[24:27], v[56:59], v[64:67], a[24:27]
ds_read_b128 v[100:103], v20 offset:2048
v_mfma_f32_16x16x32_bf16 a[28:31], v[60:63], v[64:67], a[28:31]
buffer_load_dwordx4 v1, s[28:31], s68 offen lds
v_mfma_f32_16x16x32_bf16 a[32:35], v[32:35], v[68:71], a[32:35]
ds_read_b64_tr_b16 v[132:133], v22 offset:256
v_mfma_f32_16x16x32_bf16 a[36:39], v[36:39], v[68:71], a[36:39]
v_mfma_f32_16x16x32_bf16 a[40:43], v[40:43], v[68:71], a[40:43]
ds_read_b64_tr_b16 v[134:135], v22 offset:1280
v_mfma_f32_16x16x32_bf16 a[44:47], v[44:47], v[68:71], a[44:47]
buffer_load_dwordx4 v2, s[28:31], s68 offen offset:1024 lds
v_mfma_f32_16x16x32_bf16 a[48:51], v[48:51], v[68:71], a[48:51]
ds_read_b128 v[104:107], v20 offset:4096
v_mfma_f32_16x16x32_bf16 a[52:55], v[52:55], v[68:71], a[52:55]
buffer_load_dwordx4 v3, s[28:31], s68 offen offset:2048 lds
v_mfma_f32_16x16x32_bf16 a[56:59], v[56:59], v[68:71], a[56:59]
ds_read_b64_tr_b16 v[136:137], v22 offset:512
v_mfma_f32_16x16x32_bf16 a[60:63], v[60:63], v[68:71], a[60:63]
buffer_load_dwordx4 v4, s[28:31], s68 offen offset:3072 lds
v_mfma_f32_16x16x32_bf16 a[64:67], v[32:35], v[72:75], a[64:67]
ds_read_b64_tr_b16 v[138:139], v22 offset:1536
v_mfma_f32_16x16x32_bf16 a[68:71], v[36:39], v[72:75], a[68:71]
s_add_u32 s68, s68, 262144
v_mfma_f32_16x16x32_bf16 a[72:75], v[40:43], v[72:75], a[72:75]
ds_read_b128 v[108:111], v20 offset:6144
v_mfma_f32_16x16x32_bf16 a[76:79], v[44:47], v[72:75], a[76:79]
v_mfma_f32_16x16x32_bf16 a[80:83], v[48:51], v[72:75], a[80:83]
ds_read_b64_tr_b16 v[140:141], v22 offset:768
v_mfma_f32_16x16x32_bf16 a[84:87], v[52:55], v[72:75], a[84:87]
s_add_u32 m0, s67, s70
v_mfma_f32_16x16x32_bf16 a[88:91], v[56:59], v[72:75], a[88:91]
ds_read_b64_tr_b16 v[142:143], v22 offset:1792
v_mfma_f32_16x16x32_bf16 a[92:95], v[60:63], v[72:75], a[92:95]
s_add_u32 s22, s67, 16384
v_mfma_f32_16x16x32_bf16 a[96:99], v[32:35], v[76:79], a[96:99]
ds_read_b128 v[112:115], v20 offset:8192
v_mfma_f32_16x16x32_bf16 a[100:103], v[36:39], v[76:79], a[100:103]
s_sub_u32 s67, s22, 163840
s_cselect_b32 s67, s22, s67
v_mfma_f32_16x16x32_bf16 a[104:107], v[40:43], v[76:79], a[104:107]
ds_read_b64_tr_b16 v[144:145], v22 offset:4096
v_mfma_f32_16x16x32_bf16 a[108:111], v[44:47], v[76:79], a[108:111]
v_mfma_f32_16x16x32_bf16 a[112:115], v[48:51], v[76:79], a[112:115]
ds_read_b64_tr_b16 v[146:147], v22 offset:5120
v_mfma_f32_16x16x32_bf16 a[116:119], v[52:55], v[76:79], a[116:119]
buffer_load_dwordx4 v1, s[28:31], s68 offen lds
v_mfma_f32_16x16x32_bf16 a[120:123], v[56:59], v[76:79], a[120:123]
ds_read_b128 v[116:119], v20 offset:10240
v_mfma_f32_16x16x32_bf16 a[124:127], v[60:63], v[76:79], a[124:127]
buffer_load_dwordx4 v2, s[28:31], s68 offen offset:1024 lds
v_mfma_f32_16x16x32_bf16 a[128:131], v[32:35], v[80:83], a[128:131]
ds_read_b64_tr_b16 v[148:149], v22 offset:4352
v_mfma_f32_16x16x32_bf16 a[132:135], v[36:39], v[80:83], a[132:135]
buffer_load_dwordx4 v3, s[28:31], s68 offen offset:2048 lds
v_mfma_f32_16x16x32_bf16 a[136:139], v[40:43], v[80:83], a[136:139]
ds_read_b64_tr_b16 v[150:151], v22 offset:5376
v_mfma_f32_16x16x32_bf16 a[140:143], v[44:47], v[80:83], a[140:143]
buffer_load_dwordx4 v4, s[28:31], s68 offen offset:3072 lds
v_mfma_f32_16x16x32_bf16 a[144:147], v[48:51], v[80:83], a[144:147]
ds_read_b128 v[120:123], v20 offset:12288
v_mfma_f32_16x16x32_bf16 a[148:151], v[52:55], v[80:83], a[148:151]
v_mfma_f32_16x16x32_bf16 a[152:155], v[56:59], v[80:83], a[152:155]
ds_read_b64_tr_b16 v[152:153], v22 offset:4608
v_mfma_f32_16x16x32_bf16 a[156:159], v[60:63], v[80:83], a[156:159]
s_sub_u32 s68, s68, 262016
v_mfma_f32_16x16x32_bf16 a[160:163], v[32:35], v[84:87], a[160:163]
ds_read_b64_tr_b16 v[154:155], v22 offset:5632
v_mfma_f32_16x16x32_bf16 a[164:167], v[36:39], v[84:87], a[164:167]
s_bitset0_b32 s68, 11
v_mfma_f32_16x16x32_bf16 a[168:171], v[40:43], v[84:87], a[168:171]
ds_read_b128 v[124:127], v20 offset:14336
v_mfma_f32_16x16x32_bf16 a[172:175], v[44:47], v[84:87], a[172:175]
s_add_u32 s23, s64, 65536
v_mfma_f32_16x16x32_bf16 a[176:179], v[48:51], v[84:87], a[176:179]
ds_read_b64_tr_b16 v[156:157], v22 offset:4864
v_mfma_f32_16x16x32_bf16 a[180:183], v[52:55], v[84:87], a[180:183]
v_mfma_f32_16x16x32_bf16 a[184:187], v[56:59], v[84:87], a[184:187]
ds_read_b64_tr_b16 v[158:159], v22 offset:5888
v_mfma_f32_16x16x32_bf16 a[188:191], v[60:63], v[84:87], a[188:191]
s_sub_u32 s64, s23, 163840
s_cselect_b32 s64, s23, s64
v_mfma_f32_16x16x32_bf16 a[192:195], v[32:35], v[88:91], a[192:195]
v_mfma_f32_16x16x32_bf16 a[196:199], v[36:39], v[88:91], a[196:199]
s_add_u32 s23, s65, 65536
v_mfma_f32_16x16x32_bf16 a[200:203], v[40:43], v[88:91], a[200:203]
v_mfma_f32_16x16x32_bf16 a[204:207], v[44:47], v[88:91], a[204:207]
s_sub_u32 s65, s23, 163840
s_cselect_b32 s65, s23, s65
v_mfma_f32_16x16x32_bf16 a[208:211], v[48:51], v[88:91], a[208:211]
v_mfma_f32_16x16x32_bf16 a[212:215], v[52:55], v[88:91], a[212:215]
s_add_u32 s23, s66, 65536
v_mfma_f32_16x16x32_bf16 a[216:219], v[56:59], v[88:91], a[216:219]
v_mfma_f32_16x16x32_bf16 a[220:223], v[60:63], v[88:91], a[220:223]
v_mfma_f32_16x16x32_bf16 a[224:227], v[32:35], v[92:95], a[224:227]
v_mfma_f32_16x16x32_bf16 a[228:231], v[36:39], v[92:95], a[228:231]
s_sub_u32 s66, s23, 163840
s_cselect_b32 s66, s23, s66
v_mfma_f32_16x16x32_bf16 a[232:235], v[40:43], v[92:95], a[232:235]
v_mfma_f32_16x16x32_bf16 a[236:239], v[44:47], v[92:95], a[236:239]
v_add_u32 v19, s65, v236
v_mfma_f32_16x16x32_bf16 a[240:243], v[48:51], v[92:95], a[240:243]
v_mfma_f32_16x16x32_bf16 a[244:247], v[52:55], v[92:95], a[244:247]
v_add_u32 v21, s64, v238
v_mfma_f32_16x16x32_bf16 a[248:251], v[56:59], v[92:95], a[248:251]
v_mfma_f32_16x16x32_bf16 a[252:255], v[60:63], v[92:95], a[252:255]
s_waitcnt lgkmcnt(0)
s_waitcnt vmcnt(16)
s_barrier
v_mfma_f32_16x16x32_bf16 a[0:3], v[96:99], v[128:131], a[0:3]
ds_read_b128 v[32:35], v19 offset:0
v_mfma_f32_16x16x32_bf16 a[4:7], v[100:103], v[128:131], a[4:7]
s_add_u32 m0, s67, s70
v_mfma_f32_16x16x32_bf16 a[8:11], v[104:107], v[128:131], a[8:11]
ds_read_b64_tr_b16 v[64:65], v21 offset:0
v_mfma_f32_16x16x32_bf16 a[12:15], v[108:111], v[128:131], a[12:15]
s_add_u32 s22, s67, 16384
v_mfma_f32_16x16x32_bf16 a[16:19], v[112:115], v[128:131], a[16:19]
ds_read_b64_tr_b16 v[66:67], v21 offset:1024
v_mfma_f32_16x16x32_bf16 a[20:23], v[116:119], v[128:131], a[20:23]
v_mfma_f32_16x16x32_bf16 a[24:27], v[120:123], v[128:131], a[24:27]
ds_read_b128 v[36:39], v19 offset:2048
v_mfma_f32_16x16x32_bf16 a[28:31], v[124:127], v[128:131], a[28:31]
s_sub_u32 s67, s22, 163840
s_cselect_b32 s67, s22, s67
v_mfma_f32_16x16x32_bf16 a[32:35], v[96:99], v[132:135], a[32:35]
ds_read_b64_tr_b16 v[68:69], v21 offset:256
v_mfma_f32_16x16x32_bf16 a[36:39], v[100:103], v[132:135], a[36:39]
v_mfma_f32_16x16x32_bf16 a[40:43], v[104:107], v[132:135], a[40:43]
ds_read_b64_tr_b16 v[70:71], v21 offset:1280
v_mfma_f32_16x16x32_bf16 a[44:47], v[108:111], v[132:135], a[44:47]
buffer_load_dwordx4 v232, s[32:35], s69 offen lds
v_mfma_f32_16x16x32_bf16 a[48:51], v[112:115], v[132:135], a[48:51]
ds_read_b128 v[40:43], v19 offset:4096
v_mfma_f32_16x16x32_bf16 a[52:55], v[116:119], v[132:135], a[52:55]
buffer_load_dwordx4 v233, s[32:35], s69 offen offset:1024 lds
v_mfma_f32_16x16x32_bf16 a[56:59], v[120:123], v[132:135], a[56:59]
ds_read_b64_tr_b16 v[72:73], v21 offset:512
v_mfma_f32_16x16x32_bf16 a[60:63], v[124:127], v[132:135], a[60:63]
v_mfma_f32_16x16x32_bf16 a[64:67], v[96:99], v[136:139], a[64:67]
ds_read_b64_tr_b16 v[74:75], v21 offset:1536
v_mfma_f32_16x16x32_bf16 a[68:71], v[100:103], v[136:139], a[68:71]
buffer_load_dwordx4 v234, s[32:35], s69 offen offset:2048 lds
v_mfma_f32_16x16x32_bf16 a[72:75], v[104:107], v[136:139], a[72:75]
ds_read_b128 v[44:47], v19 offset:6144
v_mfma_f32_16x16x32_bf16 a[76:79], v[108:111], v[136:139], a[76:79]
v_mfma_f32_16x16x32_bf16 a[80:83], v[112:115], v[136:139], a[80:83]
ds_read_b64_tr_b16 v[76:77], v21 offset:768
v_mfma_f32_16x16x32_bf16 a[84:87], v[116:119], v[136:139], a[84:87]
buffer_load_dwordx4 v235, s[32:35], s69 offen offset:3072 lds
v_mfma_f32_16x16x32_bf16 a[88:91], v[120:123], v[136:139], a[88:91]
ds_read_b64_tr_b16 v[78:79], v21 offset:1792
v_mfma_f32_16x16x32_bf16 a[92:95], v[124:127], v[136:139], a[92:95]
s_add_u32 s69, s69, 262144
v_mfma_f32_16x16x32_bf16 a[96:99], v[96:99], v[140:143], a[96:99]
ds_read_b128 v[48:51], v19 offset:8192
v_mfma_f32_16x16x32_bf16 a[100:103], v[100:103], v[140:143], a[100:103]
v_mfma_f32_16x16x32_bf16 a[104:107], v[104:107], v[140:143], a[104:107]
ds_read_b64_tr_b16 v[80:81], v21 offset:4096
v_mfma_f32_16x16x32_bf16 a[108:111], v[108:111], v[140:143], a[108:111]
s_and_b32 s69, s69, 0x7fffff
v_mfma_f32_16x16x32_bf16 a[112:115], v[112:115], v[140:143], a[112:115]
ds_read_b64_tr_b16 v[82:83], v21 offset:5120
v_mfma_f32_16x16x32_bf16 a[116:119], v[116:119], v[140:143], a[116:119]
v_mfma_f32_16x16x32_bf16 a[120:123], v[120:123], v[140:143], a[120:123]
ds_read_b128 v[52:55], v19 offset:10240
v_mfma_f32_16x16x32_bf16 a[124:127], v[124:127], v[140:143], a[124:127]
s_add_u32 m0, s67, s70
v_mfma_f32_16x16x32_bf16 a[128:131], v[96:99], v[144:147], a[128:131]
ds_read_b64_tr_b16 v[84:85], v21 offset:4352
v_mfma_f32_16x16x32_bf16 a[132:135], v[100:103], v[144:147], a[132:135]
s_add_u32 s22, s67, 16384
v_mfma_f32_16x16x32_bf16 a[136:139], v[104:107], v[144:147], a[136:139]
ds_read_b64_tr_b16 v[86:87], v21 offset:5376
v_mfma_f32_16x16x32_bf16 a[140:143], v[108:111], v[144:147], a[140:143]
v_mfma_f32_16x16x32_bf16 a[144:147], v[112:115], v[144:147], a[144:147]
ds_read_b128 v[56:59], v19 offset:12288
v_mfma_f32_16x16x32_bf16 a[148:151], v[116:119], v[144:147], a[148:151]
s_sub_u32 s67, s22, 163840
s_cselect_b32 s67, s22, s67
v_mfma_f32_16x16x32_bf16 a[152:155], v[120:123], v[144:147], a[152:155]
ds_read_b64_tr_b16 v[88:89], v21 offset:4608
v_mfma_f32_16x16x32_bf16 a[156:159], v[124:127], v[144:147], a[156:159]
v_mfma_f32_16x16x32_bf16 a[160:163], v[96:99], v[148:151], a[160:163]
ds_read_b64_tr_b16 v[90:91], v21 offset:5632
v_mfma_f32_16x16x32_bf16 a[164:167], v[100:103], v[148:151], a[164:167]
buffer_load_dwordx4 v5, s[40:43], s73 offen lds
v_mfma_f32_16x16x32_bf16 a[168:171], v[104:107], v[148:151], a[168:171]
ds_read_b128 v[60:63], v19 offset:14336
v_mfma_f32_16x16x32_bf16 a[172:175], v[108:111], v[148:151], a[172:175]
buffer_load_dwordx4 v6, s[40:43], s73 offen offset:1024 lds
v_mfma_f32_16x16x32_bf16 a[176:179], v[112:115], v[148:151], a[176:179]
ds_read_b64_tr_b16 v[92:93], v21 offset:4864
v_mfma_f32_16x16x32_bf16 a[180:183], v[116:119], v[148:151], a[180:183]
v_mfma_f32_16x16x32_bf16 a[184:187], v[120:123], v[148:151], a[184:187]
ds_read_b64_tr_b16 v[94:95], v21 offset:5888
v_mfma_f32_16x16x32_bf16 a[188:191], v[124:127], v[148:151], a[188:191]
buffer_load_dwordx4 v7, s[40:43], s73 offen offset:2048 lds
v_mfma_f32_16x16x32_bf16 a[192:195], v[96:99], v[152:155], a[192:195]
v_mfma_f32_16x16x32_bf16 a[196:199], v[100:103], v[152:155], a[196:199]
v_mfma_f32_16x16x32_bf16 a[200:203], v[104:107], v[152:155], a[200:203]
v_mfma_f32_16x16x32_bf16 a[204:207], v[108:111], v[152:155], a[204:207]
buffer_load_dwordx4 v8, s[40:43], s73 offen offset:3072 lds
v_mfma_f32_16x16x32_bf16 a[208:211], v[112:115], v[152:155], a[208:211]
v_mfma_f32_16x16x32_bf16 a[212:215], v[116:119], v[152:155], a[212:215]
s_add_u32 s73, s73, 262144
v_mfma_f32_16x16x32_bf16 a[216:219], v[120:123], v[152:155], a[216:219]
v_mfma_f32_16x16x32_bf16 a[220:223], v[124:127], v[152:155], a[220:223]
v_mfma_f32_16x16x32_bf16 a[224:227], v[96:99], v[156:159], a[224:227]
v_mfma_f32_16x16x32_bf16 a[228:231], v[100:103], v[156:159], a[228:231]
v_add_u32 v20, s65, v237
v_mfma_f32_16x16x32_bf16 a[232:235], v[104:107], v[156:159], a[232:235]
v_mfma_f32_16x16x32_bf16 a[236:239], v[108:111], v[156:159], a[236:239]
v_mfma_f32_16x16x32_bf16 a[240:243], v[112:115], v[156:159], a[240:243]
v_mfma_f32_16x16x32_bf16 a[244:247], v[116:119], v[156:159], a[244:247]
v_add_u32 v22, s66, v238
v_mfma_f32_16x16x32_bf16 a[248:251], v[120:123], v[156:159], a[248:251]
v_mfma_f32_16x16x32_bf16 a[252:255], v[124:127], v[156:159], a[252:255]
s_waitcnt lgkmcnt(0)
s_waitcnt vmcnt(20)
s_barrier
v_mfma_f32_16x16x32_bf16 a[0:3], v[32:35], v[64:67], a[0:3]
ds_read_b128 v[96:99], v20 offset:0
v_mfma_f32_16x16x32_bf16 a[4:7], v[36:39], v[64:67], a[4:7]
s_add_u32 m0, s67, s70
v_mfma_f32_16x16x32_bf16 a[8:11], v[40:43], v[64:67], a[8:11]
ds_read_b64_tr_b16 v[128:129], v22 offset:0
v_mfma_f32_16x16x32_bf16 a[12:15], v[44:47], v[64:67], a[12:15]
s_add_u32 s22, s67, 16384
v_mfma_f32_16x16x32_bf16 a[16:19], v[48:51], v[64:67], a[16:19]
ds_read_b64_tr_b16 v[130:131], v22 offset:1024
v_mfma_f32_16x16x32_bf16 a[20:23], v[52:55], v[64:67], a[20:23]
s_sub_u32 s67, s22, 163840
s_cselect_b32 s67, s22, s67
v_mfma_f32_16x16x32_bf16 a[24:27], v[56:59], v[64:67], a[24:27]
ds_read_b128 v[100:103], v20 offset:2048
v_mfma_f32_16x16x32_bf16 a[28:31], v[60:63], v[64:67], a[28:31]
buffer_load_dwordx4 v9, s[36:39], s72 offen lds
v_mfma_f32_16x16x32_bf16 a[32:35], v[32:35], v[68:71], a[32:35]
ds_read_b64_tr_b16 v[132:133], v22 offset:256
v_mfma_f32_16x16x32_bf16 a[36:39], v[36:39], v[68:71], a[36:39]
buffer_load_dwordx4 v10, s[36:39], s72 offen offset:1024 lds
v_mfma_f32_16x16x32_bf16 a[40:43], v[40:43], v[68:71], a[40:43]
ds_read_b64_tr_b16 v[134:135], v22 offset:1280
v_mfma_f32_16x16x32_bf16 a[44:47], v[44:47], v[68:71], a[44:47]
v_mfma_f32_16x16x32_bf16 a[48:51], v[48:51], v[68:71], a[48:51]
ds_read_b128 v[104:107], v20 offset:4096
v_mfma_f32_16x16x32_bf16 a[52:55], v[52:55], v[68:71], a[52:55]
buffer_load_dwordx4 v11, s[36:39], s72 offen offset:2048 lds
v_mfma_f32_16x16x32_bf16 a[56:59], v[56:59], v[68:71], a[56:59]
ds_read_b64_tr_b16 v[136:137], v22 offset:512
v_mfma_f32_16x16x32_bf16 a[60:63], v[60:63], v[68:71], a[60:63]
buffer_load_dwordx4 v12, s[36:39], s72 offen offset:3072 lds
v_mfma_f32_16x16x32_bf16 a[64:67], v[32:35], v[72:75], a[64:67]
ds_read_b64_tr_b16 v[138:139], v22 offset:1536
v_mfma_f32_16x16x32_bf16 a[68:71], v[36:39], v[72:75], a[68:71]
s_add_u32 s72, s72, 128
v_mfma_f32_16x16x32_bf16 a[72:75], v[40:43], v[72:75], a[72:75]
ds_read_b128 v[108:111], v20 offset:6144
v_mfma_f32_16x16x32_bf16 a[76:79], v[44:47], v[72:75], a[76:79]
s_add_u32 m0, s67, s70
v_mfma_f32_16x16x32_bf16 a[80:83], v[48:51], v[72:75], a[80:83]
ds_read_b64_tr_b16 v[140:141], v22 offset:768
v_mfma_f32_16x16x32_bf16 a[84:87], v[52:55], v[72:75], a[84:87]
v_mfma_f32_16x16x32_bf16 a[88:91], v[56:59], v[72:75], a[88:91]
ds_read_b64_tr_b16 v[142:143], v22 offset:1792
v_mfma_f32_16x16x32_bf16 a[92:95], v[60:63], v[72:75], a[92:95]
s_add_u32 s22, s67, 16384
v_mfma_f32_16x16x32_bf16 a[96:99], v[32:35], v[76:79], a[96:99]
ds_read_b128 v[112:115], v20 offset:8192
v_mfma_f32_16x16x32_bf16 a[100:103], v[36:39], v[76:79], a[100:103]
s_sub_u32 s67, s22, 163840
s_cselect_b32 s67, s22, s67
v_mfma_f32_16x16x32_bf16 a[104:107], v[40:43], v[76:79], a[104:107]
ds_read_b64_tr_b16 v[144:145], v22 offset:4096
v_mfma_f32_16x16x32_bf16 a[108:111], v[44:47], v[76:79], a[108:111]
buffer_load_dwordx4 v5, s[40:43], s73 offen lds
v_mfma_f32_16x16x32_bf16 a[112:115], v[48:51], v[76:79], a[112:115]
ds_read_b64_tr_b16 v[146:147], v22 offset:5120
v_mfma_f32_16x16x32_bf16 a[116:119], v[52:55], v[76:79], a[116:119]
buffer_load_dwordx4 v6, s[40:43], s73 offen offset:1024 lds
v_mfma_f32_16x16x32_bf16 a[120:123], v[56:59], v[76:79], a[120:123]
ds_read_b128 v[116:119], v20 offset:10240
v_mfma_f32_16x16x32_bf16 a[124:127], v[60:63], v[76:79], a[124:127]
v_mfma_f32_16x16x32_bf16 a[128:131], v[32:35], v[80:83], a[128:131]
ds_read_b64_tr_b16 v[148:149], v22 offset:4352
v_mfma_f32_16x16x32_bf16 a[132:135], v[36:39], v[80:83], a[132:135]
buffer_load_dwordx4 v7, s[40:43], s73 offen offset:2048 lds
v_mfma_f32_16x16x32_bf16 a[136:139], v[40:43], v[80:83], a[136:139]
ds_read_b64_tr_b16 v[150:151], v22 offset:5376
v_mfma_f32_16x16x32_bf16 a[140:143], v[44:47], v[80:83], a[140:143]
buffer_load_dwordx4 v8, s[40:43], s73 offen offset:3072 lds
v_mfma_f32_16x16x32_bf16 a[144:147], v[48:51], v[80:83], a[144:147]
ds_read_b128 v[120:123], v20 offset:12288
v_mfma_f32_16x16x32_bf16 a[148:151], v[52:55], v[80:83], a[148:151]
s_add_u32 s73, s73, 262144
v_mfma_f32_16x16x32_bf16 a[152:155], v[56:59], v[80:83], a[152:155]
ds_read_b64_tr_b16 v[152:153], v22 offset:4608
v_mfma_f32_16x16x32_bf16 a[156:159], v[60:63], v[80:83], a[156:159]
s_add_u32 s75, s75, 1
v_mfma_f32_16x16x32_bf16 a[160:163], v[32:35], v[84:87], a[160:163]
ds_read_b64_tr_b16 v[154:155], v22 offset:5632
v_mfma_f32_16x16x32_bf16 a[164:167], v[36:39], v[84:87], a[164:167]
s_cmp_eq_u32 s75, 7
s_cselect_b32 s72, s76, s72
s_cselect_b32 s73, s77, s73
s_cselect_b32 s75, 0, s75
v_mfma_f32_16x16x32_bf16 a[168:171], v[40:43], v[84:87], a[168:171]
ds_read_b128 v[124:127], v20 offset:14336
v_mfma_f32_16x16x32_bf16 a[172:175], v[44:47], v[84:87], a[172:175]
v_mfma_f32_16x16x32_bf16 a[176:179], v[48:51], v[84:87], a[176:179]
ds_read_b64_tr_b16 v[156:157], v22 offset:4864
v_mfma_f32_16x16x32_bf16 a[180:183], v[52:55], v[84:87], a[180:183]
s_add_u32 s23, s64, 65536
v_mfma_f32_16x16x32_bf16 a[184:187], v[56:59], v[84:87], a[184:187]
ds_read_b64_tr_b16 v[158:159], v22 offset:5888
v_mfma_f32_16x16x32_bf16 a[188:191], v[60:63], v[84:87], a[188:191]
s_sub_u32 s64, s23, 163840
s_cselect_b32 s64, s23, s64
v_mfma_f32_16x16x32_bf16 a[192:195], v[32:35], v[88:91], a[192:195]
v_mfma_f32_16x16x32_bf16 a[196:199], v[36:39], v[88:91], a[196:199]
s_add_u32 s23, s65, 65536
v_mfma_f32_16x16x32_bf16 a[200:203], v[40:43], v[88:91], a[200:203]
v_mfma_f32_16x16x32_bf16 a[204:207], v[44:47], v[88:91], a[204:207]
s_sub_u32 s65, s23, 163840
s_cselect_b32 s65, s23, s65
v_mfma_f32_16x16x32_bf16 a[208:211], v[48:51], v[88:91], a[208:211]
v_mfma_f32_16x16x32_bf16 a[212:215], v[52:55], v[88:91], a[212:215]
v_mfma_f32_16x16x32_bf16 a[216:219], v[56:59], v[88:91], a[216:219]
v_mfma_f32_16x16x32_bf16 a[220:223], v[60:63], v[88:91], a[220:223]
s_add_u32 s23, s66, 65536
v_mfma_f32_16x16x32_bf16 a[224:227], v[32:35], v[92:95], a[224:227]
v_mfma_f32_16x16x32_bf16 a[228:231], v[36:39], v[92:95], a[228:231]
s_sub_u32 s66, s23, 163840
s_cselect_b32 s66, s23, s66
v_mfma_f32_16x16x32_bf16 a[232:235], v[40:43], v[92:95], a[232:235]
v_mfma_f32_16x16x32_bf16 a[236:239], v[44:47], v[92:95], a[236:239]
v_add_u32 v19, s65, v236
v_mfma_f32_16x16x32_bf16 a[240:243], v[48:51], v[92:95], a[240:243]
v_mfma_f32_16x16x32_bf16 a[244:247], v[52:55], v[92:95], a[244:247]
v_add_u32 v21, s64, v238
v_mfma_f32_16x16x32_bf16 a[248:251], v[56:59], v[92:95], a[248:251]
v_mfma_f32_16x16x32_bf16 a[252:255], v[60:63], v[92:95], a[252:255]
s_waitcnt lgkmcnt(0)
s_waitcnt vmcnt(16)
s_barrier
v_mfma_f32_16x16x32_bf16 a[0:3], v[96:99], v[128:131], a[0:3]
ds_read_b128 v[32:35], v19 offset:0
v_mfma_f32_16x16x32_bf16 a[4:7], v[100:103], v[128:131], a[4:7]
s_add_u32 m0, s67, s70
v_mfma_f32_16x16x32_bf16 a[8:11], v[104:107], v[128:131], a[8:11]
ds_read_b64_tr_b16 v[64:65], v21 offset:0
v_mfma_f32_16x16x32_bf16 a[12:15], v[108:111], v[128:131], a[12:15]
s_add_u32 s22, s67, 16384
v_mfma_f32_16x16x32_bf16 a[16:19], v[112:115], v[128:131], a[16:19]
ds_read_b64_tr_b16 v[66:67], v21 offset:1024
v_mfma_f32_16x16x32_bf16 a[20:23], v[116:119], v[128:131], a[20:23]
v_mfma_f32_16x16x32_bf16 a[24:27], v[120:123], v[128:131], a[24:27]
ds_read_b128 v[36:39], v19 offset:2048
v_mfma_f32_16x16x32_bf16 a[28:31], v[124:127], v[128:131], a[28:31]
s_sub_u32 s67, s22, 163840
s_cselect_b32 s67, s22, s67
v_mfma_f32_16x16x32_bf16 a[32:35], v[96:99], v[132:135], a[32:35]
ds_read_b64_tr_b16 v[68:69], v21 offset:256
v_mfma_f32_16x16x32_bf16 a[36:39], v[100:103], v[132:135], a[36:39]
v_mfma_f32_16x16x32_bf16 a[40:43], v[104:107], v[132:135], a[40:43]
ds_read_b64_tr_b16 v[70:71], v21 offset:1280
v_mfma_f32_16x16x32_bf16 a[44:47], v[108:111], v[132:135], a[44:47]
buffer_load_dwordx4 v5, s[40:43], s73 offen lds
v_mfma_f32_16x16x32_bf16 a[48:51], v[112:115], v[132:135], a[48:51]
ds_read_b128 v[40:43], v19 offset:4096
v_mfma_f32_16x16x32_bf16 a[52:55], v[116:119], v[132:135], a[52:55]
v_mfma_f32_16x16x32_bf16 a[56:59], v[120:123], v[132:135], a[56:59]
ds_read_b64_tr_b16 v[72:73], v21 offset:512
v_mfma_f32_16x16x32_bf16 a[60:63], v[124:127], v[132:135], a[60:63]
buffer_load_dwordx4 v6, s[40:43], s73 offen offset:1024 lds
v_mfma_f32_16x16x32_bf16 a[64:67], v[96:99], v[136:139], a[64:67]
ds_read_b64_tr_b16 v[74:75], v21 offset:1536
v_mfma_f32_16x16x32_bf16 a[68:71], v[100:103], v[136:139], a[68:71]
buffer_load_dwordx4 v7, s[40:43], s73 offen offset:2048 lds
v_mfma_f32_16x16x32_bf16 a[72:75], v[104:107], v[136:139], a[72:75]
ds_read_b128 v[44:47], v19 offset:6144
v_mfma_f32_16x16x32_bf16 a[76:79], v[108:111], v[136:139], a[76:79]
v_mfma_f32_16x16x32_bf16 a[80:83], v[112:115], v[136:139], a[80:83]
ds_read_b64_tr_b16 v[76:77], v21 offset:768
v_mfma_f32_16x16x32_bf16 a[84:87], v[116:119], v[136:139], a[84:87]
buffer_load_dwordx4 v8, s[40:43], s73 offen offset:3072 lds
v_mfma_f32_16x16x32_bf16 a[88:91], v[120:123], v[136:139], a[88:91]
ds_read_b64_tr_b16 v[78:79], v21 offset:1792
v_mfma_f32_16x16x32_bf16 a[92:95], v[124:127], v[136:139], a[92:95]
v_mfma_f32_16x16x32_bf16 a[96:99], v[96:99], v[140:143], a[96:99]
ds_read_b128 v[48:51], v19 offset:8192
v_mfma_f32_16x16x32_bf16 a[100:103], v[100:103], v[140:143], a[100:103]
s_add_u32 s73, s73, 262144
v_mfma_f32_16x16x32_bf16 a[104:107], v[104:107], v[140:143], a[104:107]
ds_read_b64_tr_b16 v[80:81], v21 offset:4096
v_mfma_f32_16x16x32_bf16 a[108:111], v[108:111], v[140:143], a[108:111]
v_mfma_f32_16x16x32_bf16 a[112:115], v[112:115], v[140:143], a[112:115]
ds_read_b64_tr_b16 v[82:83], v21 offset:5120
v_mfma_f32_16x16x32_bf16 a[116:119], v[116:119], v[140:143], a[116:119]
s_add_u32 m0, s67, s70
v_mfma_f32_16x16x32_bf16 a[120:123], v[120:123], v[140:143], a[120:123]
ds_read_b128 v[52:55], v19 offset:10240
v_mfma_f32_16x16x32_bf16 a[124:127], v[124:127], v[140:143], a[124:127]
v_mfma_f32_16x16x32_bf16 a[128:131], v[96:99], v[144:147], a[128:131]
ds_read_b64_tr_b16 v[84:85], v21 offset:4352
v_mfma_f32_16x16x32_bf16 a[132:135], v[100:103], v[144:147], a[132:135]
s_add_u32 s22, s67, 16384
v_mfma_f32_16x16x32_bf16 a[136:139], v[104:107], v[144:147], a[136:139]
ds_read_b64_tr_b16 v[86:87], v21 offset:5376
v_mfma_f32_16x16x32_bf16 a[140:143], v[108:111], v[144:147], a[140:143]
s_sub_u32 s67, s22, 163840
s_cselect_b32 s67, s22, s67
v_mfma_f32_16x16x32_bf16 a[144:147], v[112:115], v[144:147], a[144:147]
ds_read_b128 v[56:59], v19 offset:12288
v_mfma_f32_16x16x32_bf16 a[148:151], v[116:119], v[144:147], a[148:151]
v_mfma_f32_16x16x32_bf16 a[152:155], v[120:123], v[144:147], a[152:155]
ds_read_b64_tr_b16 v[88:89], v21 offset:4608
v_mfma_f32_16x16x32_bf16 a[156:159], v[124:127], v[144:147], a[156:159]
buffer_load_dwordx4 v9, s[36:39], s72 offen lds
v_mfma_f32_16x16x32_bf16 a[160:163], v[96:99], v[148:151], a[160:163]
ds_read_b64_tr_b16 v[90:91], v21 offset:5632
v_mfma_f32_16x16x32_bf16 a[164:167], v[100:103], v[148:151], a[164:167]
v_mfma_f32_16x16x32_bf16 a[168:171], v[104:107], v[148:151], a[168:171]
ds_read_b128 v[60:63], v19 offset:14336
v_mfma_f32_16x16x32_bf16 a[172:175], v[108:111], v[148:151], a[172:175]
buffer_load_dwordx4 v10, s[36:39], s72 offen offset:1024 lds
v_mfma_f32_16x16x32_bf16 a[176:179], v[112:115], v[148:151], a[176:179]
ds_read_b64_tr_b16 v[92:93], v21 offset:4864
v_mfma_f32_16x16x32_bf16 a[180:183], v[116:119], v[148:151], a[180:183]
v_mfma_f32_16x16x32_bf16 a[184:187], v[120:123], v[148:151], a[184:187]
ds_read_b64_tr_b16 v[94:95], v21 offset:5888
v_mfma_f32_16x16x32_bf16 a[188:191], v[124:127], v[148:151], a[188:191]
buffer_load_dwordx4 v11, s[36:39], s72 offen offset:2048 lds
v_mfma_f32_16x16x32_bf16 a[192:195], v[96:99], v[152:155], a[192:195]
v_mfma_f32_16x16x32_bf16 a[196:199], v[100:103], v[152:155], a[196:199]
buffer_load_dwordx4 v12, s[36:39], s72 offen offset:3072 lds
v_mfma_f32_16x16x32_bf16 a[200:203], v[104:107], v[152:155], a[200:203]
v_mfma_f32_16x16x32_bf16 a[204:207], v[108:111], v[152:155], a[204:207]
v_mfma_f32_16x16x32_bf16 a[208:211], v[112:115], v[152:155], a[208:211]
v_mfma_f32_16x16x32_bf16 a[212:215], v[116:119], v[152:155], a[212:215]
s_add_u32 s72, s72, 128
v_mfma_f32_16x16x32_bf16 a[216:219], v[120:123], v[152:155], a[216:219]
v_mfma_f32_16x16x32_bf16 a[220:223], v[124:127], v[152:155], a[220:223]
v_mfma_f32_16x16x32_bf16 a[224:227], v[96:99], v[156:159], a[224:227]
v_mfma_f32_16x16x32_bf16 a[228:231], v[100:103], v[156:159], a[228:231]
v_add_u32 v20, s65, v237
v_mfma_f32_16x16x32_bf16 a[232:235], v[104:107], v[156:159], a[232:235]
v_mfma_f32_16x16x32_bf16 a[236:239], v[108:111], v[156:159], a[236:239]
v_mfma_f32_16x16x32_bf16 a[240:243], v[112:115], v[156:159], a[240:243]
v_mfma_f32_16x16x32_bf16 a[244:247], v[116:119], v[156:159], a[244:247]
v_add_u32 v22, s66, v238
v_mfma_f32_16x16x32_bf16 a[248:251], v[120:123], v[156:159], a[248:251]
v_mfma_f32_16x16x32_bf16 a[252:255], v[124:127], v[156:159], a[252:255]
s_waitcnt lgkmcnt(0)
s_waitcnt vmcnt(20)
s_barrier
v_mfma_f32_16x16x32_bf16 a[0:3], v[32:35], v[64:67], a[0:3]
ds_read_b128 v[96:99], v20 offset:0
v_mfma_f32_16x16x32_bf16 a[4:7], v[36:39], v[64:67], a[4:7]
s_add_u32 m0, s67, s70
v_mfma_f32_16x16x32_bf16 a[8:11], v[40:43], v[64:67], a[8:11]
ds_read_b64_tr_b16 v[128:129], v22 offset:0
v_mfma_f32_16x16x32_bf16 a[12:15], v[44:47], v[64:67], a[12:15]
s_add_u32 s22, s67, 16384
v_mfma_f32_16x16x32_bf16 a[16:19], v[48:51], v[64:67], a[16:19]
ds_read_b64_tr_b16 v[130:131], v22 offset:1024
v_mfma_f32_16x16x32_bf16 a[20:23], v[52:55], v[64:67], a[20:23]
s_sub_u32 s67, s22, 163840
s_cselect_b32 s67, s22, s67
v_mfma_f32_16x16x32_bf16 a[24:27], v[56:59], v[64:67], a[24:27]
ds_read_b128 v[100:103], v20 offset:2048
v_mfma_f32_16x16x32_bf16 a[28:31], v[60:63], v[64:67], a[28:31]
buffer_load_dwordx4 v5, s[40:43], s73 offen lds
v_mfma_f32_16x16x32_bf16 a[32:35], v[32:35], v[68:71], a[32:35]
ds_read_b64_tr_b16 v[132:133], v22 offset:256
v_mfma_f32_16x16x32_bf16 a[36:39], v[36:39], v[68:71], a[36:39]
buffer_load_dwordx4 v6, s[40:43], s73 offen offset:1024 lds
v_mfma_f32_16x16x32_bf16 a[40:43], v[40:43], v[68:71], a[40:43]
ds_read_b64_tr_b16 v[134:135], v22 offset:1280
v_mfma_f32_16x16x32_bf16 a[44:47], v[44:47], v[68:71], a[44:47]
v_mfma_f32_16x16x32_bf16 a[48:51], v[48:51], v[68:71], a[48:51]
ds_read_b128 v[104:107], v20 offset:4096
v_mfma_f32_16x16x32_bf16 a[52:55], v[52:55], v[68:71], a[52:55]
buffer_load_dwordx4 v7, s[40:43], s73 offen offset:2048 lds
v_mfma_f32_16x16x32_bf16 a[56:59], v[56:59], v[68:71], a[56:59]
ds_read_b64_tr_b16 v[136:137], v22 offset:512
v_mfma_f32_16x16x32_bf16 a[60:63], v[60:63], v[68:71], a[60:63]
buffer_load_dwordx4 v8, s[40:43], s73 offen offset:3072 lds
v_mfma_f32_16x16x32_bf16 a[64:67], v[32:35], v[72:75], a[64:67]
ds_read_b64_tr_b16 v[138:139], v22 offset:1536
v_mfma_f32_16x16x32_bf16 a[68:71], v[36:39], v[72:75], a[68:71]
s_add_u32 s73, s73, 262144
v_mfma_f32_16x16x32_bf16 a[72:75], v[40:43], v[72:75], a[72:75]
ds_read_b128 v[108:111], v20 offset:6144
v_mfma_f32_16x16x32_bf16 a[76:79], v[44:47], v[72:75], a[76:79]
s_add_u32 s75, s75, 1
v_mfma_f32_16x16x32_bf16 a[80:83], v[48:51], v[72:75], a[80:83]
ds_read_b64_tr_b16 v[140:141], v22 offset:768
v_mfma_f32_16x16x32_bf16 a[84:87], v[52:55], v[72:75], a[84:87]
v_mfma_f32_16x16x32_bf16 a[88:91], v[56:59], v[72:75], a[88:91]
ds_read_b64_tr_b16 v[142:143], v22 offset:1792
v_mfma_f32_16x16x32_bf16 a[92:95], v[60:63], v[72:75], a[92:95]
s_cmp_eq_u32 s75, 7
s_cselect_b32 s72, s76, s72
s_cselect_b32 s73, s77, s73
s_cselect_b32 s75, 0, s75
v_mfma_f32_16x16x32_bf16 a[96:99], v[32:35], v[76:79], a[96:99]
ds_read_b128 v[112:115], v20 offset:8192
v_mfma_f32_16x16x32_bf16 a[100:103], v[36:39], v[76:79], a[100:103]
s_add_u32 m0, s67, s70
v_mfma_f32_16x16x32_bf16 a[104:107], v[40:43], v[76:79], a[104:107]
ds_read_b64_tr_b16 v[144:145], v22 offset:4096
v_mfma_f32_16x16x32_bf16 a[108:111], v[44:47], v[76:79], a[108:111]
s_add_u32 s22, s67, 16384
v_mfma_f32_16x16x32_bf16 a[112:115], v[48:51], v[76:79], a[112:115]
ds_read_b64_tr_b16 v[146:147], v22 offset:5120
v_mfma_f32_16x16x32_bf16 a[116:119], v[52:55], v[76:79], a[116:119]
s_sub_u32 s67, s22, 163840
s_cselect_b32 s67, s22, s67
v_mfma_f32_16x16x32_bf16 a[120:123], v[56:59], v[76:79], a[120:123]
ds_read_b128 v[116:119], v20 offset:10240
v_mfma_f32_16x16x32_bf16 a[124:127], v[60:63], v[76:79], a[124:127]
v_mfma_f32_16x16x32_bf16 a[128:131], v[32:35], v[80:83], a[128:131]
ds_read_b64_tr_b16 v[148:149], v22 offset:4352
v_mfma_f32_16x16x32_bf16 a[132:135], v[36:39], v[80:83], a[132:135]
buffer_load_dwordx4 v5, s[40:43], s73 offen lds
v_mfma_f32_16x16x32_bf16 a[136:139], v[40:43], v[80:83], a[136:139]
ds_read_b64_tr_b16 v[150:151], v22 offset:5376
v_mfma_f32_16x16x32_bf16 a[140:143], v[44:47], v[80:83], a[140:143]
buffer_load_dwordx4 v6, s[40:43], s73 offen offset:1024 lds
v_mfma_f32_16x16x32_bf16 a[144:147], v[48:51], v[80:83], a[144:147]
ds_read_b128 v[120:123], v20 offset:12288
v_mfma_f32_16x16x32_bf16 a[148:151], v[52:55], v[80:83], a[148:151]
buffer_load_dwordx4 v7, s[40:43], s73 offen offset:2048 lds
v_mfma_f32_16x16x32_bf16 a[152:155], v[56:59], v[80:83], a[152:155]
ds_read_b64_tr_b16 v[152:153], v22 offset:4608
v_mfma_f32_16x16x32_bf16 a[156:159], v[60:63], v[80:83], a[156:159]
buffer_load_dwordx4 v8, s[40:43], s73 offen offset:3072 lds
v_mfma_f32_16x16x32_bf16 a[160:163], v[32:35], v[84:87], a[160:163]
ds_read_b64_tr_b16 v[154:155], v22 offset:5632
v_mfma_f32_16x16x32_bf16 a[164:167], v[36:39], v[84:87], a[164:167]
s_add_u32 s73, s73, 262144
v_mfma_f32_16x16x32_bf16 a[168:171], v[40:43], v[84:87], a[168:171]
ds_read_b128 v[124:127], v20 offset:14336
v_mfma_f32_16x16x32_bf16 a[172:175], v[44:47], v[84:87], a[172:175]
v_mfma_f32_16x16x32_bf16 a[176:179], v[48:51], v[84:87], a[176:179]
ds_read_b64_tr_b16 v[156:157], v22 offset:4864
v_mfma_f32_16x16x32_bf16 a[180:183], v[52:55], v[84:87], a[180:183]
s_add_u32 s23, s64, 65536
v_mfma_f32_16x16x32_bf16 a[184:187], v[56:59], v[84:87], a[184:187]
ds_read_b64_tr_b16 v[158:159], v22 offset:5888
v_mfma_f32_16x16x32_bf16 a[188:191], v[60:63], v[84:87], a[188:191]
s_sub_u32 s64, s23, 163840
s_cselect_b32 s64, s23, s64
v_mfma_f32_16x16x32_bf16 a[192:195], v[32:35], v[88:91], a[192:195]
v_mfma_f32_16x16x32_bf16 a[196:199], v[36:39], v[88:91], a[196:199]
s_add_u32 s23, s65, 65536
v_mfma_f32_16x16x32_bf16 a[200:203], v[40:43], v[88:91], a[200:203]
v_mfma_f32_16x16x32_bf16 a[204:207], v[44:47], v[88:91], a[204:207]
s_sub_u32 s65, s23, 163840
s_cselect_b32 s65, s23, s65
v_mfma_f32_16x16x32_bf16 a[208:211], v[48:51], v[88:91], a[208:211]
v_mfma_f32_16x16x32_bf16 a[212:215], v[52:55], v[88:91], a[212:215]
v_mfma_f32_16x16x32_bf16 a[216:219], v[56:59], v[88:91], a[216:219]
v_mfma_f32_16x16x32_bf16 a[220:223], v[60:63], v[88:91], a[220:223]
s_add_u32 s23, s66, 65536
v_mfma_f32_16x16x32_bf16 a[224:227], v[32:35], v[92:95], a[224:227]
v_mfma_f32_16x16x32_bf16 a[228:231], v[36:39], v[92:95], a[228:231]
s_sub_u32 s66, s23, 163840
s_cselect_b32 s66, s23, s66
v_mfma_f32_16x16x32_bf16 a[232:235], v[40:43], v[92:95], a[232:235]
v_mfma_f32_16x16x32_bf16 a[236:239], v[44:47], v[92:95], a[236:239]
v_add_u32 v19, s65, v236
v_mfma_f32_16x16x32_bf16 a[240:243], v[48:51], v[92:95], a[240:243]
v_mfma_f32_16x16x32_bf16 a[244:247], v[52:55], v[92:95], a[244:247]
v_add_u32 v21, s64, v238
v_mfma_f32_16x16x32_bf16 a[248:251], v[56:59], v[92:95], a[248:251]
v_mfma_f32_16x16x32_bf16 a[252:255], v[60:63], v[92:95], a[252:255]
s_waitcnt lgkmcnt(0)
s_waitcnt vmcnt(16)
s_barrier
v_mfma_f32_16x16x32_bf16 a[0:3], v[96:99], v[128:131], a[0:3]
v_add_u32 v26, 81920, v13
v_mfma_f32_16x16x32_bf16 a[4:7], v[100:103], v[128:131], a[4:7]
s_add_u32 m0, s67, s70
v_mfma_f32_16x16x32_bf16 a[8:11], v[104:107], v[128:131], a[8:11]
v_add_u32 v27, 65536, v17
v_mfma_f32_16x16x32_bf16 a[12:15], v[108:111], v[128:131], a[12:15]
s_add_u32 s22, s67, 16384
v_mfma_f32_16x16x32_bf16 a[16:19], v[112:115], v[128:131], a[16:19]
ds_read_b128 v[32:35], v26 offset:0
v_mfma_f32_16x16x32_bf16 a[20:23], v[116:119], v[128:131], a[20:23]
v_mfma_f32_16x16x32_bf16 a[24:27], v[120:123], v[128:131], a[24:27]
ds_read_b64_tr_b16 v[48:49], v27 offset:0
v_mfma_f32_16x16x32_bf16 a[28:31], v[124:127], v[128:131], a[28:31]
s_sub_u32 s67, s22, 163840
s_cselect_b32 s67, s22, s67
v_mfma_f32_16x16x32_bf16 a[32:35], v[96:99], v[132:135], a[32:35]
ds_read_b64_tr_b16 v[50:51], v27 offset:256
v_mfma_f32_16x16x32_bf16 a[36:39], v[100:103], v[132:135], a[36:39]
buffer_load_dwordx4 v9, s[36:39], s72 offen lds
v_mfma_f32_16x16x32_bf16 a[40:43], v[104:107], v[132:135], a[40:43]
ds_read_b128 v[36:39], v26 offset:4096
v_mfma_f32_16x16x32_bf16 a[44:47], v[108:111], v[132:135], a[44:47]
v_mfma_f32_16x16x32_bf16 a[48:51], v[112:115], v[132:135], a[48:51]
ds_read_b64_tr_b16 v[52:53], v27 offset:512
v_mfma_f32_16x16x32_bf16 a[52:55], v[116:119], v[132:135], a[52:55]
buffer_load_dwordx4 v10, s[36:39], s72 offen offset:1024 lds
v_mfma_f32_16x16x32_bf16 a[56:59], v[120:123], v[132:135], a[56:59]
ds_read_b64_tr_b16 v[54:55], v27 offset:768
v_mfma_f32_16x16x32_bf16 a[60:63], v[124:127], v[132:135], a[60:63]
v_mfma_f32_16x16x32_bf16 a[64:67], v[96:99], v[136:139], a[64:67]
ds_read_b128 v[40:43], v26 offset:8192
v_mfma_f32_16x16x32_bf16 a[68:71], v[100:103], v[136:139], a[68:71]
buffer_load_dwordx4 v11, s[36:39], s72 offen offset:2048 lds
v_mfma_f32_16x16x32_bf16 a[72:75], v[104:107], v[136:139], a[72:75]
ds_read_b128 v[44:47], v26 offset:12288
v_mfma_f32_16x16x32_bf16 a[76:79], v[108:111], v[136:139], a[76:79]
buffer_load_dwordx4 v12, s[36:39], s72 offen offset:3072 lds
v_mfma_f32_16x16x32_bf16 a[80:83], v[112:115], v[136:139], a[80:83]
v_mfma_f32_16x16x32_bf16 a[84:87], v[116:119], v[136:139], a[84:87]
v_mfma_f32_16x16x32_bf16 a[88:91], v[120:123], v[136:139], a[88:91]
v_mfma_f32_16x16x32_bf16 a[92:95], v[124:127], v[136:139], a[92:95]
s_add_u32 s72, s72, 128
v_mfma_f32_16x16x32_bf16 a[96:99], v[96:99], v[140:143], a[96:99]
v_mfma_f32_16x16x32_bf16 a[100:103], v[100:103], v[140:143], a[100:103]
s_add_u32 m0, s67, s70
v_mfma_f32_16x16x32_bf16 a[104:107], v[104:107], v[140:143], a[104:107]
v_mfma_f32_16x16x32_bf16 a[108:111], v[108:111], v[140:143], a[108:111]
v_mfma_f32_16x16x32_bf16 a[112:115], v[112:115], v[140:143], a[112:115]
v_mfma_f32_16x16x32_bf16 a[116:119], v[116:119], v[140:143], a[116:119]
s_add_u32 s22, s67, 16384
v_mfma_f32_16x16x32_bf16 a[120:123], v[120:123], v[140:143], a[120:123]
v_mfma_f32_16x16x32_bf16 a[124:127], v[124:127], v[140:143], a[124:127]
v_mfma_f32_16x16x32_bf16 a[128:131], v[96:99], v[144:147], a[128:131]
v_mfma_f32_16x16x32_bf16 a[132:135], v[100:103], v[144:147], a[132:135]
s_sub_u32 s67, s22, 163840
s_cselect_b32 s67, s22, s67
v_mfma_f32_16x16x32_bf16 a[136:139], v[104:107], v[144:147], a[136:139]
v_mfma_f32_16x16x32_bf16 a[140:143], v[108:111], v[144:147], a[140:143]
buffer_load_dwordx4 v5, s[40:43], s73 offen lds
v_mfma_f32_16x16x32_bf16 a[144:147], v[112:115], v[144:147], a[144:147]
v_mfma_f32_16x16x32_bf16 a[148:151], v[116:119], v[144:147], a[148:151]
v_mfma_f32_16x16x32_bf16 a[152:155], v[120:123], v[144:147], a[152:155]
v_mfma_f32_16x16x32_bf16 a[156:159], v[124:127], v[144:147], a[156:159]
buffer_load_dwordx4 v6, s[40:43], s73 offen offset:1024 lds
v_mfma_f32_16x16x32_bf16 a[160:163], v[96:99], v[148:151], a[160:163]
v_mfma_f32_16x16x32_bf16 a[164:167], v[100:103], v[148:151], a[164:167]
buffer_load_dwordx4 v7, s[40:43], s73 offen offset:2048 lds
v_mfma_f32_16x16x32_bf16 a[168:171], v[104:107], v[148:151], a[168:171]
v_mfma_f32_16x16x32_bf16 a[172:175], v[108:111], v[148:151], a[172:175]
v_mfma_f32_16x16x32_bf16 a[176:179], v[112:115], v[148:151], a[176:179]
v_mfma_f32_16x16x32_bf16 a[180:183], v[116:119], v[148:151], a[180:183]
buffer_load_dwordx4 v8, s[40:43], s73 offen offset:3072 lds
v_mfma_f32_16x16x32_bf16 a[184:187], v[120:123], v[148:151], a[184:187]
v_mfma_f32_16x16x32_bf16 a[188:191], v[124:127], v[148:151], a[188:191]
v_mfma_f32_16x16x32_bf16 a[192:195], v[96:99], v[152:155], a[192:195]
v_mfma_f32_16x16x32_bf16 a[196:199], v[100:103], v[152:155], a[196:199]
s_add_u32 s73, s73, 262144
v_mfma_f32_16x16x32_bf16 a[200:203], v[104:107], v[152:155], a[200:203]
v_mfma_f32_16x16x32_bf16 a[204:207], v[108:111], v[152:155], a[204:207]
s_add_u32 s75, s75, 1
v_mfma_f32_16x16x32_bf16 a[208:211], v[112:115], v[152:155], a[208:211]
v_mfma_f32_16x16x32_bf16 a[212:215], v[116:119], v[152:155], a[212:215]
v_mfma_f32_16x16x32_bf16 a[216:219], v[120:123], v[152:155], a[216:219]
v_mfma_f32_16x16x32_bf16 a[220:223], v[124:127], v[152:155], a[220:223]
s_cmp_eq_u32 s75, 7
s_cselect_b32 s72, s76, s72
s_cselect_b32 s73, s77, s73
s_cselect_b32 s75, 0, s75
v_mfma_f32_16x16x32_bf16 a[224:227], v[96:99], v[156:159], a[224:227]
v_mfma_f32_16x16x32_bf16 a[228:231], v[100:103], v[156:159], a[228:231]
v_add_u32 v20, s65, v237
v_mfma_f32_16x16x32_bf16 a[232:235], v[104:107], v[156:159], a[232:235]
v_mfma_f32_16x16x32_bf16 a[236:239], v[108:111], v[156:159], a[236:239]
v_mfma_f32_16x16x32_bf16 a[240:243], v[112:115], v[156:159], a[240:243]
v_mfma_f32_16x16x32_bf16 a[244:247], v[116:119], v[156:159], a[244:247]
v_add_u32 v22, s66, v238
v_mfma_f32_16x16x32_bf16 a[248:251], v[120:123], v[156:159], a[248:251]
v_mfma_f32_16x16x32_bf16 a[252:255], v[124:127], v[156:159], a[252:255]
F_QP_V:
s_waitcnt lgkmcnt(0)
v_mfma_f32_32x32x16_bf16 v[96:111], v[48:51], v[32:35], 0
v_add_u32 v28, 81920, v14
v_add_u32 v29, 65536, v17
s_add_u32 m0, s67, s70
s_nop 7
v_accvgpr_read_b32 v224, a128
v_accvgpr_read_b32 v225, a129
v_mfma_f32_32x32x16_bf16 v[112:127], v[48:51], v[36:39], 0
ds_read_b128 v[64:67], v28 offset:0
ds_read_b64_tr_b16 v[80:81], v29 offset:2048
s_add_u32 s22, s67, 16384
v_accvgpr_read_b32 v226, a130
v_accvgpr_read_b32 v227, a131
v_mfma_f32_32x32x16_bf16 v[128:143], v[48:51], v[40:43], 0
ds_read_b64_tr_b16 v[82:83], v29 offset:2304
ds_read_b128 v[68:71], v28 offset:4096
s_sub_u32 s67, s22, 163840
s_cselect_b32 s67, s22, s67
v_accvgpr_read_b32 v228, a132
v_accvgpr_read_b32 v229, a133
v_mfma_f32_32x32x16_bf16 v[144:159], v[48:51], v[44:47], 0
ds_read_b64_tr_b16 v[84:85], v29 offset:2560
ds_read_b64_tr_b16 v[86:87], v29 offset:2816
buffer_load_dwordx4 v5, s[40:43], s73 offen lds
v_accvgpr_read_b32 v230, a134
v_accvgpr_read_b32 v231, a135
v_mfma_f32_32x32x16_bf16 v[160:175], v[52:55], v[32:35], 0
ds_read_b128 v[72:75], v28 offset:8192
ds_read_b128 v[76:79], v28 offset:12288
buffer_load_dwordx4 v6, s[40:43], s73 offen offset:1024 lds
v_cvt_pk_bf16_f32 v240, v224, v225
v_cvt_pk_bf16_f32 v241, v226, v227
v_mfma_f32_32x32x16_bf16 v[176:191], v[52:55], v[36:39], 0
buffer_load_dwordx4 v7, s[40:43], s73 offen offset:2048 lds
v_cvt_pk_bf16_f32 v242, v228, v229
v_cvt_pk_bf16_f32 v243, v230, v231
v_mfma_f32_32x32x16_bf16 v[192:207], v[52:55], v[40:43], 0
buffer_load_dwordx4 v8, s[40:43], s73 offen offset:3072 lds
s_add_u32 s24, s74, 8192
buffer_store_dwordx4 v[240:243], v239, s[4:7], s24 offen offset:0 sc1
v_accvgpr_read_b32 v224, a160
v_mfma_f32_32x32x16_bf16 v[208:223], v[52:55], v[44:47], 0
s_add_u32 s73, s73, 262144
v_accvgpr_read_b32 v225, a161
v_accvgpr_read_b32 v226, a162
s_waitcnt lgkmcnt(0)
v_mfma_f32_32x32x16_bf16 v[96:111], v[80:83], v[64:67], v[96:111]
v_add_u32 v26, 81920, v15
v_add_u32 v27, 98304, v17
v_accvgpr_read_b32 v227, a163
v_accvgpr_read_b32 v228, a164
v_accvgpr_read_b32 v229, a165
v_mfma_f32_32x32x16_bf16 v[112:127], v[80:83], v[68:71], v[112:127]
ds_read_b128 v[32:35], v26 offset:0
ds_read_b64_tr_b16 v[48:49], v27 offset:0
v_accvgpr_read_b32 v230, a166
v_accvgpr_read_b32 v231, a167
v_mfma_f32_32x32x16_bf16 v[128:143], v[80:83], v[72:75], v[128:143]
ds_read_b64_tr_b16 v[50:51], v27 offset:256
ds_read_b128 v[36:39], v26 offset:4096
v_cvt_pk_bf16_f32 v244, v224, v225
v_cvt_pk_bf16_f32 v245, v226, v227
v_mfma_f32_32x32x16_bf16 v[144:159], v[80:83], v[76:79], v[144:159]
ds_read_b64_tr_b16 v[52:53], v27 offset:512
ds_read_b64_tr_b16 v[54:55], v27 offset:768
v_cvt_pk_bf16_f32 v246, v228, v229
v_cvt_pk_bf16_f32 v247, v230, v231
v_mfma_f32_32x32x16_bf16 v[160:175], v[84:87], v[64:67], v[160:175]
ds_read_b128 v[40:43], v26 offset:8192
ds_read_b128 v[44:47], v26 offset:12288
s_add_u32 s24, s74, 8192
buffer_store_dwordx4 v[244:247], v239, s[4:7], s24 offen offset:2048 sc1
v_accvgpr_read_b32 v224, a192
v_mfma_f32_32x32x16_bf16 v[176:191], v[84:87], v[68:71], v[176:191]
v_accvgpr_read_b32 v225, a193
v_accvgpr_read_b32 v226, a194
v_mfma_f32_32x32x16_bf16 v[192:207], v[84:87], v[72:75], v[192:207]
v_accvgpr_read_b32 v227, a195
v_accvgpr_read_b32 v228, a196
v_mfma_f32_32x32x16_bf16 v[208:223], v[84:87], v[76:79], v[208:223]
v_accvgpr_read_b32 v229, a197
v_accvgpr_read_b32 v230, a198
s_waitcnt lgkmcnt(0)
v_mfma_f32_32x32x16_bf16 v[96:111], v[48:51], v[32:35], v[96:111]
v_add_u32 v28, 81920, v16
v_add_u32 v29, 98304, v17
v_accvgpr_read_b32 v231, a199
v_cvt_pk_bf16_f32 v248, v224, v225
v_cvt_pk_bf16_f32 v249, v226, v227
v_mfma_f32_32x32x16_bf16 v[112:127], v[48:51], v[36:39], v[112:127]
ds_read_b128 v[64:67], v28 offset:0
ds_read_b64_tr_b16 v[80:81], v29 offset:2048
v_cvt_pk_bf16_f32 v250, v228, v229
v_cvt_pk_bf16_f32 v251, v230, v231
v_mfma_f32_32x32x16_bf16 v[128:143], v[48:51], v[40:43], v[128:143]
ds_read_b64_tr_b16 v[82:83], v29 offset:2304
ds_read_b128 v[68:71], v28 offset:4096
s_add_u32 s24, s74, 12288
buffer_store_dwordx4 v[248:251], v239, s[4:7], s24 offen offset:0 sc1
v_accvgpr_read_b32 v224, a224
v_mfma_f32_32x32x16_bf16 v[144:159], v[48:51], v[44:47], v[144:159]
ds_read_b64_tr_b16 v[84:85], v29 offset:2560
ds_read_b64_tr_b16 v[86:87], v29 offset:2816
v_accvgpr_read_b32 v225, a225
v_accvgpr_read_b32 v226, a226
v_mfma_f32_32x32x16_bf16 v[160:175], v[52:55], v[32:35], v[160:175]
ds_read_b128 v[72:75], v28 offset:8192
ds_read_b128 v[76:79], v28 offset:12288
v_accvgpr_read_b32 v227, a227
v_accvgpr_read_b32 v228, a228
v_mfma_f32_32x32x16_bf16 v[176:191], v[52:55], v[36:39], v[176:191]
v_accvgpr_read_b32 v229, a229
v_accvgpr_read_b32 v230, a230
v_mfma_f32_32x32x16_bf16 v[192:207], v[52:55], v[40:43], v[192:207]
v_accvgpr_read_b32 v231, a231
v_cvt_pk_bf16_f32 v252, v224, v225
v_mfma_f32_32x32x16_bf16 v[208:223], v[52:55], v[44:47], v[208:223]
v_cvt_pk_bf16_f32 v253, v226, v227
v_cvt_pk_bf16_f32 v254, v228, v229
s_waitcnt lgkmcnt(0)
s_waitcnt vmcnt(19)
s_barrier
v_mfma_f32_32x32x16_bf16 v[96:111], v[80:83], v[64:67], v[96:111]
v_add_u32 v26, 131072, v13
v_add_u32 v27, 114688, v17
s_add_u32 m0, s67, s70
v_cvt_pk_bf16_f32 v255, v230, v231
s_add_u32 s24, s74, 12288
buffer_store_dwordx4 v[252:255], v239, s[4:7], s24 offen offset:2048 sc1
v_accvgpr_read_b32 v224, a136
v_mfma_f32_32x32x16_bf16 v[112:127], v[80:83], v[68:71], v[112:127]
ds_read_b128 v[32:35], v26 offset:0
ds_read_b64_tr_b16 v[48:49], v27 offset:0
s_add_u32 s22, s67, 16384
v_accvgpr_read_b32 v225, a137
v_accvgpr_read_b32 v226, a138
v_mfma_f32_32x32x16_bf16 v[128:143], v[80:83], v[72:75], v[128:143]
ds_read_b64_tr_b16 v[50:51], v27 offset:256
ds_read_b128 v[36:39], v26 offset:4096
s_sub_u32 s67, s22, 163840
s_cselect_b32 s67, s22, s67
v_accvgpr_read_b32 v227, a139
v_accvgpr_read_b32 v228, a140
v_mfma_f32_32x32x16_bf16 v[144:159], v[80:83], v[76:79], v[144:159]
ds_read_b64_tr_b16 v[52:53], v27 offset:512
ds_read_b64_tr_b16 v[54:55], v27 offset:768
buffer_load_dwordx4 v9, s[36:39], s72 offen lds
v_accvgpr_read_b32 v229, a141
v_accvgpr_read_b32 v230, a142
v_mfma_f32_32x32x16_bf16 v[160:175], v[84:87], v[64:67], v[160:175]
ds_read_b128 v[40:43], v26 offset:8192
ds_read_b128 v[44:47], v26 offset:12288
buffer_load_dwordx4 v10, s[36:39], s72 offen offset:1024 lds
v_accvgpr_read_b32 v231, a143
v_cvt_pk_bf16_f32 v240, v224, v225
v_mfma_f32_32x32x16_bf16 v[176:191], v[84:87], v[68:71], v[176:191]
buffer_load_dwordx4 v11, s[36:39], s72 offen offset:2048 lds
v_cvt_pk_bf16_f32 v241, v226, v227
v_cvt_pk_bf16_f32 v242, v228, v229
v_mfma_f32_32x32x16_bf16 v[192:207], v[84:87], v[72:75], v[192:207]
buffer_load_dwordx4 v12, s[36:39], s72 offen offset:3072 lds
v_cvt_pk_bf16_f32 v243, v230, v231
s_add_u32 s24, s74, 8192
buffer_store_dwordx4 v[240:243], v239, s[4:7], s24 offen offset:1024 sc1
v_mfma_f32_32x32x16_bf16 v[208:223], v[84:87], v[76:79], v[208:223]
s_add_u32 s72, s72, 128
v_accvgpr_read_b32 v224, a168
v_accvgpr_read_b32 v225, a169
s_waitcnt lgkmcnt(0)
v_mfma_f32_32x32x16_bf16 v[96:111], v[48:51], v[32:35], v[96:111]
v_add_u32 v28, 131072, v14
v_add_u32 v29, 114688, v17
s_add_u32 m0, s67, s70
s_add_u32 s22, s67, 16384
v_accvgpr_read_b32 v226, a170
v_accvgpr_read_b32 v227, a171
v_accvgpr_read_b32 v228, a172
v_mfma_f32_32x32x16_bf16 v[112:127], v[48:51], v[36:39], v[112:127]
ds_read_b128 v[64:67], v28 offset:0
ds_read_b64_tr_b16 v[80:81], v29 offset:2048
s_sub_u32 s67, s22, 163840
s_cselect_b32 s67, s22, s67
v_accvgpr_read_b32 v229, a173
v_accvgpr_read_b32 v230, a174
v_mfma_f32_32x32x16_bf16 v[128:143], v[48:51], v[40:43], v[128:143]
ds_read_b64_tr_b16 v[82:83], v29 offset:2304
ds_read_b128 v[68:71], v28 offset:4096
buffer_load_dwordx4 v5, s[40:43], s73 offen lds
v_accvgpr_read_b32 v231, a175
v_cvt_pk_bf16_f32 v244, v224, v225
v_mfma_f32_32x32x16_bf16 v[144:159], v[48:51], v[44:47], v[144:159]
ds_read_b64_tr_b16 v[84:85], v29 offset:2560
ds_read_b64_tr_b16 v[86:87], v29 offset:2816
buffer_load_dwordx4 v6, s[40:43], s73 offen offset:1024 lds
v_cvt_pk_bf16_f32 v245, v226, v227
v_cvt_pk_bf16_f32 v246, v228, v229
v_mfma_f32_32x32x16_bf16 v[160:175], v[52:55], v[32:35], v[160:175]
ds_read_b128 v[72:75], v28 offset:8192
ds_read_b128 v[76:79], v28 offset:12288
buffer_load_dwordx4 v7, s[40:43], s73 offen offset:2048 lds
buffer_load_dwordx4 v8, s[40:43], s73 offen offset:3072 lds
v_cvt_pk_bf16_f32 v247, v230, v231
s_add_u32 s24, s74, 8192
buffer_store_dwordx4 v[244:247], v239, s[4:7], s24 offen offset:3072 sc1
v_mfma_f32_32x32x16_bf16 v[176:191], v[52:55], v[36:39], v[176:191]
s_add_u32 s73, s73, 262144
v_accvgpr_read_b32 v224, a200
v_accvgpr_read_b32 v225, a201
v_mfma_f32_32x32x16_bf16 v[192:207], v[52:55], v[40:43], v[192:207]
s_add_u32 s75, s75, 1
v_accvgpr_read_b32 v226, a202
v_accvgpr_read_b32 v227, a203
v_mfma_f32_32x32x16_bf16 v[208:223], v[52:55], v[44:47], v[208:223]
s_cmp_eq_u32 s75, 7
s_cselect_b32 s72, s76, s72
s_cselect_b32 s73, s77, s73
s_cselect_b32 s75, 0, s75
v_accvgpr_read_b32 v228, a204
v_accvgpr_read_b32 v229, a205
s_waitcnt lgkmcnt(0)
v_mfma_f32_32x32x16_bf16 v[96:111], v[80:83], v[64:67], v[96:111]
v_add_u32 v26, 131072, v15
v_add_u32 v27, 147456, v17
s_add_u32 m0, s67, s70
v_accvgpr_read_b32 v230, a206
v_accvgpr_read_b32 v231, a207
v_cvt_pk_bf16_f32 v248, v224, v225
v_mfma_f32_32x32x16_bf16 v[112:127], v[80:83], v[68:71], v[112:127]
ds_read_b128 v[32:35], v26 offset:0
ds_read_b64_tr_b16 v[48:49], v27 offset:0
s_add_u32 s22, s67, 16384
v_cvt_pk_bf16_f32 v249, v226, v227
v_cvt_pk_bf16_f32 v250, v228, v229
v_mfma_f32_32x32x16_bf16 v[128:143], v[80:83], v[72:75], v[128:143]
ds_read_b64_tr_b16 v[50:51], v27 offset:256
ds_read_b128 v[36:39], v26 offset:4096
s_sub_u32 s67, s22, 163840
s_cselect_b32 s67, s22, s67
v_cvt_pk_bf16_f32 v251, v230, v231
s_add_u32 s24, s74, 12288
buffer_store_dwordx4 v[248:251], v239, s[4:7], s24 offen offset:1024 sc1
v_mfma_f32_32x32x16_bf16 v[144:159], v[80:83], v[76:79], v[144:159]
ds_read_b64_tr_b16 v[52:53], v27 offset:512
ds_read_b64_tr_b16 v[54:55], v27 offset:768
buffer_load_dwordx4 v5, s[40:43], s73 offen lds
v_accvgpr_read_b32 v224, a232
v_accvgpr_read_b32 v225, a233
v_mfma_f32_32x32x16_bf16 v[160:175], v[84:87], v[64:67], v[160:175]
ds_read_b128 v[40:43], v26 offset:8192
ds_read_b128 v[44:47], v26 offset:12288
buffer_load_dwordx4 v6, s[40:43], s73 offen offset:1024 lds
v_accvgpr_read_b32 v226, a234
v_accvgpr_read_b32 v227, a235
v_mfma_f32_32x32x16_bf16 v[176:191], v[84:87], v[68:71], v[176:191]
buffer_load_dwordx4 v7, s[40:43], s73 offen offset:2048 lds
v_accvgpr_read_b32 v228, a236
v_accvgpr_read_b32 v229, a237
v_mfma_f32_32x32x16_bf16 v[192:207], v[84:87], v[72:75], v[192:207]
buffer_load_dwordx4 v8, s[40:43], s73 offen offset:3072 lds
v_accvgpr_read_b32 v230, a238
v_accvgpr_read_b32 v231, a239
v_mfma_f32_32x32x16_bf16 v[208:223], v[84:87], v[76:79], v[208:223]
s_add_u32 s73, s73, 262144
v_cvt_pk_bf16_f32 v252, v224, v225
v_cvt_pk_bf16_f32 v253, v226, v227
s_waitcnt lgkmcnt(0)
v_mfma_f32_32x32x16_bf16 v[96:111], v[48:51], v[32:35], v[96:111]
v_add_u32 v28, 131072, v16
v_add_u32 v29, 147456, v17
v_cvt_pk_bf16_f32 v254, v228, v229
v_cvt_pk_bf16_f32 v255, v230, v231
s_add_u32 s24, s74, 12288
buffer_store_dwordx4 v[252:255], v239, s[4:7], s24 offen offset:3072 sc1
v_mfma_f32_32x32x16_bf16 v[112:127], v[48:51], v[36:39], v[112:127]
ds_read_b128 v[64:67], v28 offset:0
ds_read_b64_tr_b16 v[80:81], v29 offset:2048
v_accvgpr_read_b32 v224, a144
v_accvgpr_read_b32 v225, a145
v_mfma_f32_32x32x16_bf16 v[128:143], v[48:51], v[40:43], v[128:143]
ds_read_b64_tr_b16 v[82:83], v29 offset:2304
ds_read_b128 v[68:71], v28 offset:4096
v_accvgpr_read_b32 v226, a146
v_accvgpr_read_b32 v227, a147
v_mfma_f32_32x32x16_bf16 v[144:159], v[48:51], v[44:47], v[144:159]
ds_read_b64_tr_b16 v[84:85], v29 offset:2560
ds_read_b64_tr_b16 v[86:87], v29 offset:2816
v_accvgpr_read_b32 v228, a148
v_accvgpr_read_b32 v229, a149
v_mfma_f32_32x32x16_bf16 v[160:175], v[52:55], v[32:35], v[160:175]
ds_read_b128 v[72:75], v28 offset:8192
ds_read_b128 v[76:79], v28 offset:12288
v_accvgpr_read_b32 v230, a150
v_accvgpr_read_b32 v231, a151
v_mfma_f32_32x32x16_bf16 v[176:191], v[52:55], v[36:39], v[176:191]
v_cvt_pk_bf16_f32 v240, v224, v225
v_cvt_pk_bf16_f32 v241, v226, v227
v_mfma_f32_32x32x16_bf16 v[192:207], v[52:55], v[40:43], v[192:207]
v_cvt_pk_bf16_f32 v242, v228, v229
v_cvt_pk_bf16_f32 v243, v230, v231
v_mfma_f32_32x32x16_bf16 v[208:223], v[52:55], v[44:47], v[208:223]
s_add_u32 s24, s74, 40960
buffer_store_dwordx4 v[240:243], v239, s[4:7], s24 offen offset:0 sc1
v_accvgpr_read_b32 v224, a176
s_waitcnt lgkmcnt(0)
s_waitcnt vmcnt(25)
s_barrier
v_mfma_f32_32x32x16_bf16 v[96:111], v[80:83], v[64:67], v[96:111]
v_add_u32 v26, 16384, v13
v_add_u32 v27, 0, v17
s_add_u32 m0, s67, s70
v_accvgpr_read_b32 v225, a177
v_accvgpr_read_b32 v226, a178
v_accvgpr_read_b32 v227, a179
v_mfma_f32_32x32x16_bf16 v[112:127], v[80:83], v[68:71], v[112:127]
ds_read_b128 v[32:35], v26 offset:0
ds_read_b64_tr_b16 v[48:49], v27 offset:0
s_add_u32 s22, s67, 16384
v_accvgpr_read_b32 v228, a180
v_accvgpr_read_b32 v229, a181
v_mfma_f32_32x32x16_bf16 v[128:143], v[80:83], v[72:75], v[128:143]
ds_read_b64_tr_b16 v[50:51], v27 offset:256
ds_read_b128 v[36:39], v26 offset:4096
s_sub_u32 s67, s22, 163840
s_cselect_b32 s67, s22, s67
v_accvgpr_read_b32 v230, a182
v_accvgpr_read_b32 v231, a183
v_mfma_f32_32x32x16_bf16 v[144:159], v[80:83], v[76:79], v[144:159]
ds_read_b64_tr_b16 v[52:53], v27 offset:512
ds_read_b64_tr_b16 v[54:55], v27 offset:768
buffer_load_dwordx4 v9, s[36:39], s72 offen lds
v_cvt_pk_bf16_f32 v244, v224, v225
v_cvt_pk_bf16_f32 v245, v226, v227
v_mfma_f32_32x32x16_bf16 v[160:175], v[84:87], v[64:67], v[160:175]
ds_read_b128 v[40:43], v26 offset:8192
ds_read_b128 v[44:47], v26 offset:12288
buffer_load_dwordx4 v10, s[36:39], s72 offen offset:1024 lds
v_cvt_pk_bf16_f32 v246, v228, v229
v_cvt_pk_bf16_f32 v247, v230, v231
v_mfma_f32_32x32x16_bf16 v[176:191], v[84:87], v[68:71], v[176:191]
buffer_load_dwordx4 v11, s[36:39], s72 offen offset:2048 lds
s_add_u32 s24, s74, 40960
buffer_store_dwordx4 v[244:247], v239, s[4:7], s24 offen offset:2048 sc1
v_accvgpr_read_b32 v224, a208
v_mfma_f32_32x32x16_bf16 v[192:207], v[84:87], v[72:75], v[192:207]
buffer_load_dwordx4 v12, s[36:39], s72 offen offset:3072 lds
v_accvgpr_read_b32 v225, a209
v_accvgpr_read_b32 v226, a210
v_mfma_f32_32x32x16_bf16 v[208:223], v[84:87], v[76:79], v[208:223]
s_add_u32 s72, s72, 128
v_accvgpr_read_b32 v227, a211
v_accvgpr_read_b32 v228, a212
s_waitcnt lgkmcnt(0)
v_mfma_f32_32x32x16_bf16 v[96:111], v[48:51], v[32:35], v[96:111]
v_add_u32 v28, 16384, v14
v_add_u32 v29, 0, v17
s_add_u32 m0, s67, s70
s_add_u32 s22, s67, 16384
v_accvgpr_read_b32 v229, a213
v_accvgpr_read_b32 v230, a214
v_accvgpr_read_b32 v231, a215
v_mfma_f32_32x32x16_bf16 v[112:127], v[48:51], v[36:39], v[112:127]
ds_read_b128 v[64:67], v28 offset:0
ds_read_b64_tr_b16 v[80:81], v29 offset:2048
s_sub_u32 s67, s22, 163840
s_cselect_b32 s67, s22, s67
v_cvt_pk_bf16_f32 v248, v224, v225
v_cvt_pk_bf16_f32 v249, v226, v227
v_mfma_f32_32x32x16_bf16 v[128:143], v[48:51], v[40:43], v[128:143]
ds_read_b64_tr_b16 v[82:83], v29 offset:2304
ds_read_b128 v[68:71], v28 offset:4096
buffer_load_dwordx4 v5, s[40:43], s73 offen lds
v_cvt_pk_bf16_f32 v250, v228, v229
v_cvt_pk_bf16_f32 v251, v230, v231
v_mfma_f32_32x32x16_bf16 v[144:159], v[48:51], v[44:47], v[144:159]
ds_read_b64_tr_b16 v[84:85], v29 offset:2560
ds_read_b64_tr_b16 v[86:87], v29 offset:2816
buffer_load_dwordx4 v6, s[40:43], s73 offen offset:1024 lds
s_add_u32 s24, s74, 45056
buffer_store_dwordx4 v[248:251], v239, s[4:7], s24 offen offset:0 sc1
v_accvgpr_read_b32 v224, a240
v_mfma_f32_32x32x16_bf16 v[160:175], v[52:55], v[32:35], v[160:175]
ds_read_b128 v[72:75], v28 offset:8192
ds_read_b128 v[76:79], v28 offset:12288
buffer_load_dwordx4 v7, s[40:43], s73 offen offset:2048 lds
buffer_load_dwordx4 v8, s[40:43], s73 offen offset:3072 lds
v_accvgpr_read_b32 v225, a241
v_accvgpr_read_b32 v226, a242
v_mfma_f32_32x32x16_bf16 v[176:191], v[52:55], v[36:39], v[176:191]
s_add_u32 s73, s73, 262144
v_accvgpr_read_b32 v227, a243
v_accvgpr_read_b32 v228, a244
v_mfma_f32_32x32x16_bf16 v[192:207], v[52:55], v[40:43], v[192:207]
s_add_u32 s75, s75, 1
v_accvgpr_read_b32 v229, a245
v_accvgpr_read_b32 v230, a246
v_mfma_f32_32x32x16_bf16 v[208:223], v[52:55], v[44:47], v[208:223]
s_cmp_eq_u32 s75, 7
s_cselect_b32 s72, s76, s72
s_cselect_b32 s73, s77, s73
s_cselect_b32 s75, 0, s75
v_accvgpr_read_b32 v231, a247
v_cvt_pk_bf16_f32 v252, v224, v225
s_waitcnt lgkmcnt(0)
v_mfma_f32_32x32x16_bf16 v[96:111], v[80:83], v[64:67], v[96:111]
v_add_u32 v26, 16384, v15
v_add_u32 v27, 32768, v17
s_add_u32 m0, s67, s70
v_cvt_pk_bf16_f32 v253, v226, v227
v_cvt_pk_bf16_f32 v254, v228, v229
v_cvt_pk_bf16_f32 v255, v230, v231
v_mfma_f32_32x32x16_bf16 v[112:127], v[80:83], v[68:71], v[112:127]
ds_read_b128 v[32:35], v26 offset:0
ds_read_b64_tr_b16 v[48:49], v27 offset:0
s_add_u32 s22, s67, 16384
s_add_u32 s24, s74, 45056
buffer_store_dwordx4 v[252:255], v239, s[4:7], s24 offen offset:2048 sc1
v_accvgpr_read_b32 v224, a152
v_mfma_f32_32x32x16_bf16 v[128:143], v[80:83], v[72:75], v[128:143]
ds_read_b64_tr_b16 v[50:51], v27 offset:256
ds_read_b128 v[36:39], v26 offset:4096
s_sub_u32 s67, s22, 163840
s_cselect_b32 s67, s22, s67
v_accvgpr_read_b32 v225, a153
v_accvgpr_read_b32 v226, a154
v_mfma_f32_32x32x16_bf16 v[144:159], v[80:83], v[76:79], v[144:159]
ds_read_b64_tr_b16 v[52:53], v27 offset:512
ds_read_b64_tr_b16 v[54:55], v27 offset:768
buffer_load_dwordx4 v5, s[40:43], s73 offen lds
v_accvgpr_read_b32 v227, a155
v_accvgpr_read_b32 v228, a156
v_mfma_f32_32x32x16_bf16 v[160:175], v[84:87], v[64:67], v[160:175]
ds_read_b128 v[40:43], v26 offset:8192
ds_read_b128 v[44:47], v26 offset:12288
buffer_load_dwordx4 v6, s[40:43], s73 offen offset:1024 lds
v_accvgpr_read_b32 v229, a157
v_accvgpr_read_b32 v230, a158
v_mfma_f32_32x32x16_bf16 v[176:191], v[84:87], v[68:71], v[176:191]
buffer_load_dwordx4 v7, s[40:43], s73 offen offset:2048 lds
v_accvgpr_read_b32 v231, a159
v_cvt_pk_bf16_f32 v240, v224, v225
v_mfma_f32_32x32x16_bf16 v[192:207], v[84:87], v[72:75], v[192:207]
buffer_load_dwordx4 v8, s[40:43], s73 offen offset:3072 lds
v_cvt_pk_bf16_f32 v241, v226, v227
v_cvt_pk_bf16_f32 v242, v228, v229
v_mfma_f32_32x32x16_bf16 v[208:223], v[84:87], v[76:79], v[208:223]
s_add_u32 s73, s73, 262144
v_cvt_pk_bf16_f32 v243, v230, v231
s_add_u32 s24, s74, 40960
buffer_store_dwordx4 v[240:243], v239, s[4:7], s24 offen offset:1024 sc1
s_waitcnt lgkmcnt(0)
v_mfma_f32_32x32x16_bf16 v[96:111], v[48:51], v[32:35], v[96:111]
v_add_u32 v28, 16384, v16
v_add_u32 v29, 32768, v17
v_accvgpr_read_b32 v224, a184
v_accvgpr_read_b32 v225, a185
v_accvgpr_read_b32 v226, a186
v_mfma_f32_32x32x16_bf16 v[112:127], v[48:51], v[36:39], v[112:127]
ds_read_b128 v[64:67], v28 offset:0
ds_read_b64_tr_b16 v[80:81], v29 offset:2048
v_accvgpr_read_b32 v227, a187
v_accvgpr_read_b32 v228, a188
v_mfma_f32_32x32x16_bf16 v[128:143], v[48:51], v[40:43], v[128:143]
ds_read_b64_tr_b16 v[82:83], v29 offset:2304
ds_read_b128 v[68:71], v28 offset:4096
v_accvgpr_read_b32 v229, a189
v_accvgpr_read_b32 v230, a190
v_mfma_f32_32x32x16_bf16 v[144:159], v[48:51], v[44:47], v[144:159]
ds_read_b64_tr_b16 v[84:85], v29 offset:2560
ds_read_b64_tr_b16 v[86:87], v29 offset:2816
v_accvgpr_read_b32 v231, a191
v_cvt_pk_bf16_f32 v244, v224, v225
v_mfma_f32_32x32x16_bf16 v[160:175], v[52:55], v[32:35], v[160:175]
ds_read_b128 v[72:75], v28 offset:8192
ds_read_b128 v[76:79], v28 offset:12288
v_cvt_pk_bf16_f32 v245, v226, v227
v_cvt_pk_bf16_f32 v246, v228, v229
v_mfma_f32_32x32x16_bf16 v[176:191], v[52:55], v[36:39], v[176:191]
v_cvt_pk_bf16_f32 v247, v230, v231
s_add_u32 s24, s74, 40960
buffer_store_dwordx4 v[244:247], v239, s[4:7], s24 offen offset:3072 sc1
v_mfma_f32_32x32x16_bf16 v[192:207], v[52:55], v[40:43], v[192:207]
v_accvgpr_read_b32 v224, a216
v_accvgpr_read_b32 v225, a217
v_mfma_f32_32x32x16_bf16 v[208:223], v[52:55], v[44:47], v[208:223]
v_accvgpr_read_b32 v226, a218
v_accvgpr_read_b32 v227, a219
s_waitcnt lgkmcnt(0)
s_waitcnt vmcnt(25)
s_barrier
v_mfma_f32_32x32x16_bf16 v[96:111], v[80:83], v[64:67], v[96:111]
v_add_u32 v26, 65536, v13
v_add_u32 v27, 49152, v17
s_add_u32 m0, s67, s70
v_accvgpr_read_b32 v228, a220
v_accvgpr_read_b32 v229, a221
v_accvgpr_read_b32 v230, a222
v_mfma_f32_32x32x16_bf16 v[112:127], v[80:83], v[68:71], v[112:127]
ds_read_b128 v[32:35], v26 offset:0
ds_read_b64_tr_b16 v[48:49], v27 offset:0
s_add_u32 s22, s67, 16384
v_accvgpr_read_b32 v231, a223
v_cvt_pk_bf16_f32 v248, v224, v225
v_mfma_f32_32x32x16_bf16 v[128:143], v[80:83], v[72:75], v[128:143]
ds_read_b64_tr_b16 v[50:51], v27 offset:256
ds_read_b128 v[36:39], v26 offset:4096
s_sub_u32 s67, s22, 163840
s_cselect_b32 s67, s22, s67
v_cvt_pk_bf16_f32 v249, v226, v227
v_cvt_pk_bf16_f32 v250, v228, v229
v_mfma_f32_32x32x16_bf16 v[144:159], v[80:83], v[76:79], v[144:159]
ds_read_b64_tr_b16 v[52:53], v27 offset:512
ds_read_b64_tr_b16 v[54:55], v27 offset:768
buffer_load_dwordx4 v9, s[36:39], s72 offen lds
v_cvt_pk_bf16_f32 v251, v230, v231
s_add_u32 s24, s74, 45056
buffer_store_dwordx4 v[248:251], v239, s[4:7], s24 offen offset:1024 sc1
v_mfma_f32_32x32x16_bf16 v[160:175], v[84:87], v[64:67], v[160:175]
ds_read_b128 v[40:43], v26 offset:8192
ds_read_b128 v[44:47], v26 offset:12288
buffer_load_dwordx4 v10, s[36:39], s72 offen offset:1024 lds
v_accvgpr_read_b32 v224, a248
v_accvgpr_read_b32 v225, a249
v_mfma_f32_32x32x16_bf16 v[176:191], v[84:87], v[68:71], v[176:191]
buffer_load_dwordx4 v11, s[36:39], s72 offen offset:2048 lds
v_accvgpr_read_b32 v226, a250
v_accvgpr_read_b32 v227, a251
v_mfma_f32_32x32x16_bf16 v[192:207], v[84:87], v[72:75], v[192:207]
buffer_load_dwordx4 v12, s[36:39], s72 offen offset:3072 lds
v_accvgpr_read_b32 v228, a252
v_accvgpr_read_b32 v229, a253
v_mfma_f32_32x32x16_bf16 v[208:223], v[84:87], v[76:79], v[208:223]
s_add_u32 s72, s72, 128
v_accvgpr_read_b32 v230, a254
v_accvgpr_read_b32 v231, a255
s_waitcnt lgkmcnt(0)
v_mfma_f32_32x32x16_bf16 v[96:111], v[48:51], v[32:35], v[96:111]
v_add_u32 v28, 65536, v14
v_add_u32 v29, 49152, v17
s_add_u32 m0, s67, s70
s_add_u32 s22, s67, 16384
v_cvt_pk_bf16_f32 v252, v224, v225
v_cvt_pk_bf16_f32 v253, v226, v227
v_cvt_pk_bf16_f32 v254, v228, v229
v_mfma_f32_32x32x16_bf16 v[112:127], v[48:51], v[36:39], v[112:127]
ds_read_b128 v[64:67], v28 offset:0
ds_read_b64_tr_b16 v[80:81], v29 offset:2048
s_sub_u32 s67, s22, 163840
s_cselect_b32 s67, s22, s67
v_cvt_pk_bf16_f32 v255, v230, v231
s_add_u32 s24, s74, 45056
buffer_store_dwordx4 v[252:255], v239, s[4:7], s24 offen offset:3072 sc1
v_mfma_f32_32x32x16_bf16 v[128:143], v[48:51], v[40:43], v[128:143]
ds_read_b64_tr_b16 v[82:83], v29 offset:2304
ds_read_b128 v[68:71], v28 offset:4096
buffer_load_dwordx4 v5, s[40:43], s73 offen lds
v_accvgpr_read_b32 v224, a0
v_accvgpr_read_b32 v225, a1
v_mfma_f32_32x32x16_bf16 v[144:159], v[48:51], v[44:47], v[144:159]
ds_read_b64_tr_b16 v[84:85], v29 offset:2560
ds_read_b64_tr_b16 v[86:87], v29 offset:2816
buffer_load_dwordx4 v6, s[40:43], s73 offen offset:1024 lds
v_accvgpr_read_b32 v226, a2
v_accvgpr_read_b32 v227, a3
v_mfma_f32_32x32x16_bf16 v[160:175], v[52:55], v[32:35], v[160:175]
ds_read_b128 v[72:75], v28 offset:8192
ds_read_b128 v[76:79], v28 offset:12288
buffer_load_dwordx4 v7, s[40:43], s73 offen offset:2048 lds
buffer_load_dwordx4 v8, s[40:43], s73 offen offset:3072 lds
v_accvgpr_read_b32 v228, a4
v_accvgpr_read_b32 v229, a5
v_mfma_f32_32x32x16_bf16 v[176:191], v[52:55], v[36:39], v[176:191]
s_add_u32 s73, s73, 262144
v_accvgpr_read_b32 v230, a6
v_accvgpr_read_b32 v231, a7
v_mfma_f32_32x32x16_bf16 v[192:207], v[52:55], v[40:43], v[192:207]
s_add_u32 s75, s75, 1
v_cvt_pk_bf16_f32 v240, v224, v225
v_cvt_pk_bf16_f32 v241, v226, v227
v_mfma_f32_32x32x16_bf16 v[208:223], v[52:55], v[44:47], v[208:223]
s_cmp_eq_u32 s75, 7
s_cselect_b32 s72, s76, s72
s_cselect_b32 s73, s77, s73
s_cselect_b32 s75, 0, s75
v_cvt_pk_bf16_f32 v242, v228, v229
v_cvt_pk_bf16_f32 v243, v230, v231
s_waitcnt lgkmcnt(0)
v_mfma_f32_32x32x16_bf16 v[96:111], v[80:83], v[64:67], v[96:111]
v_add_u32 v26, 65536, v15
v_add_u32 v27, 81920, v17
s_add_u32 m0, s67, s70
s_add_u32 s24, s74, 0
buffer_store_dwordx4 v[240:243], v239, s[4:7], s24 offen offset:0 sc1
v_accvgpr_read_b32 v224, a32
v_accvgpr_read_b32 v225, a33
v_mfma_f32_32x32x16_bf16 v[112:127], v[80:83], v[68:71], v[112:127]
ds_read_b128 v[32:35], v26 offset:0
ds_read_b64_tr_b16 v[48:49], v27 offset:0
s_add_u32 s22, s67, 16384
v_accvgpr_read_b32 v226, a34
v_accvgpr_read_b32 v227, a35
v_mfma_f32_32x32x16_bf16 v[128:143], v[80:83], v[72:75], v[128:143]
ds_read_b64_tr_b16 v[50:51], v27 offset:256
ds_read_b128 v[36:39], v26 offset:4096
s_sub_u32 s67, s22, 163840
s_cselect_b32 s67, s22, s67
v_accvgpr_read_b32 v228, a36
v_accvgpr_read_b32 v229, a37
v_mfma_f32_32x32x16_bf16 v[144:159], v[80:83], v[76:79], v[144:159]
ds_read_b64_tr_b16 v[52:53], v27 offset:512
ds_read_b64_tr_b16 v[54:55], v27 offset:768
buffer_load_dwordx4 v5, s[40:43], s73 offen lds
v_accvgpr_read_b32 v230, a38
v_accvgpr_read_b32 v231, a39
v_mfma_f32_32x32x16_bf16 v[160:175], v[84:87], v[64:67], v[160:175]
ds_read_b128 v[40:43], v26 offset:8192
ds_read_b128 v[44:47], v26 offset:12288
buffer_load_dwordx4 v6, s[40:43], s73 offen offset:1024 lds
v_cvt_pk_bf16_f32 v244, v224, v225
v_cvt_pk_bf16_f32 v245, v226, v227
v_mfma_f32_32x32x16_bf16 v[176:191], v[84:87], v[68:71], v[176:191]
buffer_load_dwordx4 v7, s[40:43], s73 offen offset:2048 lds
v_cvt_pk_bf16_f32 v246, v228, v229
v_cvt_pk_bf16_f32 v247, v230, v231
v_mfma_f32_32x32x16_bf16 v[192:207], v[84:87], v[72:75], v[192:207]
buffer_load_dwordx4 v8, s[40:43], s73 offen offset:3072 lds
s_add_u32 s24, s74, 0
buffer_store_dwordx4 v[244:247], v239, s[4:7], s24 offen offset:2048 sc1
v_accvgpr_read_b32 v224, a64
v_mfma_f32_32x32x16_bf16 v[208:223], v[84:87], v[76:79], v[208:223]
s_add_u32 s73, s73, 262144
v_accvgpr_read_b32 v225, a65
v_accvgpr_read_b32 v226, a66
s_waitcnt lgkmcnt(0)
v_mfma_f32_32x32x16_bf16 v[96:111], v[48:51], v[32:35], v[96:111]
v_add_u32 v28, 65536, v16
v_add_u32 v29, 81920, v17
v_accvgpr_read_b32 v227, a67
v_accvgpr_read_b32 v228, a68
v_accvgpr_read_b32 v229, a69
v_mfma_f32_32x32x16_bf16 v[112:127], v[48:51], v[36:39], v[112:127]
ds_read_b128 v[64:67], v28 offset:0
ds_read_b64_tr_b16 v[80:81], v29 offset:2048
v_accvgpr_read_b32 v230, a70
v_accvgpr_read_b32 v231, a71
v_mfma_f32_32x32x16_bf16 v[128:143], v[48:51], v[40:43], v[128:143]
ds_read_b64_tr_b16 v[82:83], v29 offset:2304
ds_read_b128 v[68:71], v28 offset:4096
v_cvt_pk_bf16_f32 v248, v224, v225
v_cvt_pk_bf16_f32 v249, v226, v227
v_mfma_f32_32x32x16_bf16 v[144:159], v[48:51], v[44:47], v[144:159]
ds_read_b64_tr_b16 v[84:85], v29 offset:2560
ds_read_b64_tr_b16 v[86:87], v29 offset:2816
v_cvt_pk_bf16_f32 v250, v228, v229
v_cvt_pk_bf16_f32 v251, v230, v231
v_mfma_f32_32x32x16_bf16 v[160:175], v[52:55], v[32:35], v[160:175]
ds_read_b128 v[72:75], v28 offset:8192
ds_read_b128 v[76:79], v28 offset:12288
s_add_u32 s24, s74, 4096
buffer_store_dwordx4 v[248:251], v239, s[4:7], s24 offen offset:0 sc1
v_accvgpr_read_b32 v224, a96
v_mfma_f32_32x32x16_bf16 v[176:191], v[52:55], v[36:39], v[176:191]
v_accvgpr_read_b32 v225, a97
v_accvgpr_read_b32 v226, a98
v_mfma_f32_32x32x16_bf16 v[192:207], v[52:55], v[40:43], v[192:207]
v_accvgpr_read_b32 v227, a99
v_accvgpr_read_b32 v228, a100
v_mfma_f32_32x32x16_bf16 v[208:223], v[52:55], v[44:47], v[208:223]
v_accvgpr_read_b32 v229, a101
v_accvgpr_read_b32 v230, a102
s_waitcnt lgkmcnt(0)
s_waitcnt vmcnt(24)
s_barrier
v_mfma_f32_32x32x16_bf16 v[96:111], v[80:83], v[64:67], v[96:111]
v_add_u32 v26, 114688, v13
v_add_u32 v27, 98304, v17
s_add_u32 m0, s67, s70
v_accvgpr_read_b32 v231, a103
v_cvt_pk_bf16_f32 v252, v224, v225
v_cvt_pk_bf16_f32 v253, v226, v227
v_mfma_f32_32x32x16_bf16 v[112:127], v[80:83], v[68:71], v[112:127]
ds_read_b128 v[32:35], v26 offset:0
ds_read_b64_tr_b16 v[48:49], v27 offset:0
s_add_u32 s22, s67, 16384
v_cvt_pk_bf16_f32 v254, v228, v229
v_cvt_pk_bf16_f32 v255, v230, v231
v_mfma_f32_32x32x16_bf16 v[128:143], v[80:83], v[72:75], v[128:143]
ds_read_b64_tr_b16 v[50:51], v27 offset:256
ds_read_b128 v[36:39], v26 offset:4096
s_sub_u32 s67, s22, 163840
s_cselect_b32 s67, s22, s67
s_add_u32 s24, s74, 4096
buffer_store_dwordx4 v[252:255], v239, s[4:7], s24 offen offset:2048 sc1
v_accvgpr_read_b32 v224, a8
v_mfma_f32_32x32x16_bf16 v[144:159], v[80:83], v[76:79], v[144:159]
ds_read_b64_tr_b16 v[52:53], v27 offset:512
ds_read_b64_tr_b16 v[54:55], v27 offset:768
buffer_load_dwordx4 v9, s[36:39], s72 offen lds
v_accvgpr_read_b32 v225, a9
v_accvgpr_read_b32 v226, a10
v_mfma_f32_32x32x16_bf16 v[160:175], v[84:87], v[64:67], v[160:175]
ds_read_b128 v[40:43], v26 offset:8192
ds_read_b128 v[44:47], v26 offset:12288
buffer_load_dwordx4 v10, s[36:39], s72 offen offset:1024 lds
v_accvgpr_read_b32 v227, a11
v_accvgpr_read_b32 v228, a12
v_mfma_f32_32x32x16_bf16 v[176:191], v[84:87], v[68:71], v[176:191]
buffer_load_dwordx4 v11, s[36:39], s72 offen offset:2048 lds
v_accvgpr_read_b32 v229, a13
v_accvgpr_read_b32 v230, a14
v_mfma_f32_32x32x16_bf16 v[192:207], v[84:87], v[72:75], v[192:207]
buffer_load_dwordx4 v12, s[36:39], s72 offen offset:3072 lds
v_accvgpr_read_b32 v231, a15
v_cvt_pk_bf16_f32 v240, v224, v225
v_mfma_f32_32x32x16_bf16 v[208:223], v[84:87], v[76:79], v[208:223]
s_add_u32 s72, s72, 128
v_cvt_pk_bf16_f32 v241, v226, v227
v_cvt_pk_bf16_f32 v242, v228, v229
s_waitcnt lgkmcnt(0)
v_mfma_f32_32x32x16_bf16 v[96:111], v[48:51], v[32:35], v[96:111]
v_add_u32 v28, 114688, v14
v_add_u32 v29, 98304, v17
s_add_u32 m0, s67, s70
s_add_u32 s22, s67, 16384
v_cvt_pk_bf16_f32 v243, v230, v231
s_add_u32 s24, s74, 0
buffer_store_dwordx4 v[240:243], v239, s[4:7], s24 offen offset:1024 sc1
v_accvgpr_read_b32 v224, a40
v_mfma_f32_32x32x16_bf16 v[112:127], v[48:51], v[36:39], v[112:127]
ds_read_b128 v[64:67], v28 offset:0
ds_read_b64_tr_b16 v[80:81], v29 offset:2048
s_sub_u32 s67, s22, 163840
s_cselect_b32 s67, s22, s67
v_accvgpr_read_b32 v225, a41
v_accvgpr_read_b32 v226, a42
v_mfma_f32_32x32x16_bf16 v[128:143], v[48:51], v[40:43], v[128:143]
ds_read_b64_tr_b16 v[82:83], v29 offset:2304
ds_read_b128 v[68:71], v28 offset:4096
buffer_load_dwordx4 v5, s[40:43], s73 offen lds
v_accvgpr_read_b32 v227, a43
v_accvgpr_read_b32 v228, a44
v_mfma_f32_32x32x16_bf16 v[144:159], v[48:51], v[44:47], v[144:159]
ds_read_b64_tr_b16 v[84:85], v29 offset:2560
ds_read_b64_tr_b16 v[86:87], v29 offset:2816
buffer_load_dwordx4 v6, s[40:43], s73 offen offset:1024 lds
v_accvgpr_read_b32 v229, a45
v_accvgpr_read_b32 v230, a46
v_mfma_f32_32x32x16_bf16 v[160:175], v[52:55], v[32:35], v[160:175]
ds_read_b128 v[72:75], v28 offset:8192
ds_read_b128 v[76:79], v28 offset:12288
buffer_load_dwordx4 v7, s[40:43], s73 offen offset:2048 lds
buffer_load_dwordx4 v8, s[40:43], s73 offen offset:3072 lds
v_accvgpr_read_b32 v231, a47
v_cvt_pk_bf16_f32 v244, v224, v225
v_mfma_f32_32x32x16_bf16 v[176:191], v[52:55], v[36:39], v[176:191]
s_add_u32 s73, s73, 262144
v_cvt_pk_bf16_f32 v245, v226, v227
v_cvt_pk_bf16_f32 v246, v228, v229
v_mfma_f32_32x32x16_bf16 v[192:207], v[52:55], v[40:43], v[192:207]
s_add_u32 s75, s75, 1
v_cvt_pk_bf16_f32 v247, v230, v231
s_add_u32 s24, s74, 0
buffer_store_dwordx4 v[244:247], v239, s[4:7], s24 offen offset:3072 sc1
v_mfma_f32_32x32x16_bf16 v[208:223], v[52:55], v[44:47], v[208:223]
s_cmp_eq_u32 s75, 7
s_cselect_b32 s72, s76, s72
s_cselect_b32 s73, s77, s73
s_cselect_b32 s75, 0, s75
v_accvgpr_read_b32 v224, a72
v_accvgpr_read_b32 v225, a73
s_waitcnt lgkmcnt(0)
v_mfma_f32_32x32x16_bf16 v[96:111], v[80:83], v[64:67], v[96:111]
v_add_u32 v26, 114688, v15
v_add_u32 v27, 131072, v17
v_accvgpr_read_b32 v226, a74
v_accvgpr_read_b32 v227, a75
v_accvgpr_read_b32 v228, a76
v_mfma_f32_32x32x16_bf16 v[112:127], v[80:83], v[68:71], v[112:127]
ds_read_b128 v[32:35], v26 offset:0
ds_read_b64_tr_b16 v[48:49], v27 offset:0
v_accvgpr_read_b32 v229, a77
v_accvgpr_read_b32 v230, a78
v_mfma_f32_32x32x16_bf16 v[128:143], v[80:83], v[72:75], v[128:143]
ds_read_b64_tr_b16 v[50:51], v27 offset:256
ds_read_b128 v[36:39], v26 offset:4096
v_accvgpr_read_b32 v231, a79
v_cvt_pk_bf16_f32 v248, v224, v225
v_mfma_f32_32x32x16_bf16 v[144:159], v[80:83], v[76:79], v[144:159]
ds_read_b64_tr_b16 v[52:53], v27 offset:512
ds_read_b64_tr_b16 v[54:55], v27 offset:768
v_cvt_pk_bf16_f32 v249, v226, v227
v_cvt_pk_bf16_f32 v250, v228, v229
v_mfma_f32_32x32x16_bf16 v[160:175], v[84:87], v[64:67], v[160:175]
ds_read_b128 v[40:43], v26 offset:8192
ds_read_b128 v[44:47], v26 offset:12288
v_cvt_pk_bf16_f32 v251, v230, v231
s_add_u32 s24, s74, 4096
buffer_store_dwordx4 v[248:251], v239, s[4:7], s24 offen offset:1024 sc1
v_mfma_f32_32x32x16_bf16 v[176:191], v[84:87], v[68:71], v[176:191]
v_accvgpr_read_b32 v224, a104
v_accvgpr_read_b32 v225, a105
v_mfma_f32_32x32x16_bf16 v[192:207], v[84:87], v[72:75], v[192:207]
v_accvgpr_read_b32 v226, a106
v_accvgpr_read_b32 v227, a107
v_mfma_f32_32x32x16_bf16 v[208:223], v[84:87], v[76:79], v[208:223]
v_accvgpr_read_b32 v228, a108
v_accvgpr_read_b32 v229, a109
s_waitcnt lgkmcnt(0)
v_mfma_f32_32x32x16_bf16 v[96:111], v[48:51], v[32:35], v[96:111]
v_add_u32 v28, 114688, v16
v_add_u32 v29, 131072, v17
v_accvgpr_read_b32 v230, a110
v_accvgpr_read_b32 v231, a111
v_cvt_pk_bf16_f32 v252, v224, v225
v_mfma_f32_32x32x16_bf16 v[112:127], v[48:51], v[36:39], v[112:127]
ds_read_b128 v[64:67], v28 offset:0
ds_read_b64_tr_b16 v[80:81], v29 offset:2048
v_cvt_pk_bf16_f32 v253, v226, v227
v_cvt_pk_bf16_f32 v254, v228, v229
v_mfma_f32_32x32x16_bf16 v[128:143], v[48:51], v[40:43], v[128:143]
ds_read_b64_tr_b16 v[82:83], v29 offset:2304
ds_read_b128 v[68:71], v28 offset:4096
v_cvt_pk_bf16_f32 v255, v230, v231
s_add_u32 s24, s74, 4096
buffer_store_dwordx4 v[252:255], v239, s[4:7], s24 offen offset:3072 sc1
v_mfma_f32_32x32x16_bf16 v[144:159], v[48:51], v[44:47], v[144:159]
ds_read_b64_tr_b16 v[84:85], v29 offset:2560
ds_read_b64_tr_b16 v[86:87], v29 offset:2816
v_accvgpr_read_b32 v224, a16
v_accvgpr_read_b32 v225, a17
v_mfma_f32_32x32x16_bf16 v[160:175], v[52:55], v[32:35], v[160:175]
ds_read_b128 v[72:75], v28 offset:8192
ds_read_b128 v[76:79], v28 offset:12288
v_accvgpr_read_b32 v226, a18
v_accvgpr_read_b32 v227, a19
v_mfma_f32_32x32x16_bf16 v[176:191], v[52:55], v[36:39], v[176:191]
v_accvgpr_read_b32 v228, a20
v_accvgpr_read_b32 v229, a21
v_mfma_f32_32x32x16_bf16 v[192:207], v[52:55], v[40:43], v[192:207]
v_accvgpr_read_b32 v230, a22
v_accvgpr_read_b32 v231, a23
v_mfma_f32_32x32x16_bf16 v[208:223], v[52:55], v[44:47], v[208:223]
v_cvt_pk_bf16_f32 v240, v224, v225
v_cvt_pk_bf16_f32 v241, v226, v227
s_waitcnt lgkmcnt(0)
s_waitcnt vmcnt(20)
s_barrier
s_sub_u32 s82, s14, 4
s_lshr_b32 s22, s14, 2
s_lshl_b32 s22, s22, 1
s_and_b32 s23, s14, 1
s_add_u32 s22, s22, s23
s_cmp_eq_u32 s17, 1
s_cselect_b32 s22, 99, s22
s_cmp_lt_u32 s14, 8
s_cselect_b32 s82, s22, s82
s_sub_u32 s83, s14, 4
s_lshr_b32 s22, s14, 2
s_lshl_b32 s22, s22, 1
s_and_b32 s23, s14, 1
s_add_u32 s22, s22, s23
s_cmp_eq_u32 s17, 0
s_cselect_b32 s22, 99, s22
s_cmp_lt_u32 s14, 8
s_cselect_b32 s83, s22, s83
s_cmp_lg_u32 s82, 99
s_cselect_b32 s22, 1835008, 0
s_cselect_b32 s23, 896, 0
s_mov_b32 s28, s26
s_and_b32 s29, s27, 0xffff
s_mov_b32 s30, s22
s_mov_b32 s31, 0x20000
s_mov_b32 s32, s78
s_and_b32 s33, s79, 0xffff
s_mov_b32 s34, s23
s_mov_b32 s35, 0x20000
s_lshl_b32 s44, s82, 3
s_add_u32 s44, s44, s13
s_lshl_b32 s44, s44, 1
s_lshr_b32 s22, s12, 1
s_and_b32 s46, s12, 1
s_add_u32 s48, s44, s22
v_lshlrev_b32 v30, 2, v25
v_subrev_u32 v31, 16, v30
v_max_i32 v31, 0, v31
s_lshl_b32 s22, s48, 12
buffer_load_dwordx4 a[128:131], v31, s[28:31], s22 offen
buffer_load_dwordx4 a[132:135], v30, s[28:31], s22 offen offset:0
buffer_load_dwordx4 a[136:139], v30, s[28:31], s22 offen offset:1008
buffer_load_dwordx4 a[140:143], v30, s[28:31], s22 offen offset:1024
buffer_load_dwordx4 a[144:147], v30, s[28:31], s22 offen offset:2032
buffer_load_dwordx4 a[148:151], v30, s[28:31], s22 offen offset:2048
buffer_load_dwordx4 a[152:155], v30, s[28:31], s22 offen offset:3056
buffer_load_dwordx4 a[156:159], v30, s[28:31], s22 offen offset:3072
s_lshl_b32 s23, s48, 1
buffer_load_ushort a160, v23, s[32:35], s23 offen
v_mfma_f32_32x32x16_bf16 v[96:111], v[80:83], v[64:67], v[96:111]
v_add_u32 v26, 0, v13
v_add_u32 v27, 147456, v17
v_cvt_pk_bf16_f32 v242, v228, v229
v_cvt_pk_bf16_f32 v243, v230, v231
s_add_u32 s24, s74, 32768
buffer_store_dwordx4 v[240:243], v239, s[4:7], s24 offen offset:0 sc1
v_mfma_f32_32x32x16_bf16 v[112:127], v[80:83], v[68:71], v[112:127]
ds_read_b128 v[32:35], v26 offset:0
ds_read_b64_tr_b16 v[48:49], v27 offset:0
v_accvgpr_read_b32 v224, a48
v_accvgpr_read_b32 v225, a49
v_mfma_f32_32x32x16_bf16 v[128:143], v[80:83], v[72:75], v[128:143]
ds_read_b64_tr_b16 v[50:51], v27 offset:256
ds_read_b128 v[36:39], v26 offset:4096
v_accvgpr_read_b32 v226, a50
v_accvgpr_read_b32 v227, a51
v_mfma_f32_32x32x16_bf16 v[144:159], v[80:83], v[76:79], v[144:159]
ds_read_b64_tr_b16 v[52:53], v27 offset:512
ds_read_b64_tr_b16 v[54:55], v27 offset:768
v_accvgpr_read_b32 v228, a52
v_accvgpr_read_b32 v229, a53
v_mfma_f32_32x32x16_bf16 v[160:175], v[84:87], v[64:67], v[160:175]
ds_read_b128 v[40:43], v26 offset:8192
ds_read_b128 v[44:47], v26 offset:12288
v_accvgpr_read_b32 v230, a54
v_accvgpr_read_b32 v231, a55
v_mfma_f32_32x32x16_bf16 v[176:191], v[84:87], v[68:71], v[176:191]
v_cvt_pk_bf16_f32 v244, v224, v225
v_cvt_pk_bf16_f32 v245, v226, v227
v_mfma_f32_32x32x16_bf16 v[192:207], v[84:87], v[72:75], v[192:207]
v_cvt_pk_bf16_f32 v246, v228, v229
v_cvt_pk_bf16_f32 v247, v230, v231
v_mfma_f32_32x32x16_bf16 v[208:223], v[84:87], v[76:79], v[208:223]
s_add_u32 s24, s74, 32768
buffer_store_dwordx4 v[244:247], v239, s[4:7], s24 offen offset:2048 sc1
v_accvgpr_read_b32 v224, a80
s_waitcnt lgkmcnt(0)
v_mfma_f32_32x32x16_bf16 v[96:111], v[48:51], v[32:35], v[96:111]
v_add_u32 v28, 0, v14
v_add_u32 v29, 147456, v17
v_accvgpr_read_b32 v225, a81
v_accvgpr_read_b32 v226, a82
v_accvgpr_read_b32 v227, a83
v_mfma_f32_32x32x16_bf16 v[112:127], v[48:51], v[36:39], v[112:127]
ds_read_b128 v[64:67], v28 offset:0
ds_read_b64_tr_b16 v[80:81], v29 offset:2048
v_accvgpr_read_b32 v228, a84
v_accvgpr_read_b32 v229, a85
v_mfma_f32_32x32x16_bf16 v[128:143], v[48:51], v[40:43], v[128:143]
ds_read_b64_tr_b16 v[82:83], v29 offset:2304
ds_read_b128 v[68:71], v28 offset:4096
v_accvgpr_read_b32 v230, a86
v_accvgpr_read_b32 v231, a87
v_mfma_f32_32x32x16_bf16 v[144:159], v[48:51], v[44:47], v[144:159]
ds_read_b64_tr_b16 v[84:85], v29 offset:2560
ds_read_b64_tr_b16 v[86:87], v29 offset:2816
v_cvt_pk_bf16_f32 v248, v224, v225
v_cvt_pk_bf16_f32 v249, v226, v227
v_mfma_f32_32x32x16_bf16 v[160:175], v[52:55], v[32:35], v[160:175]
ds_read_b128 v[72:75], v28 offset:8192
ds_read_b128 v[76:79], v28 offset:12288
v_cvt_pk_bf16_f32 v250, v228, v229
v_cvt_pk_bf16_f32 v251, v230, v231
v_mfma_f32_32x32x16_bf16 v[176:191], v[52:55], v[36:39], v[176:191]
s_add_u32 s24, s74, 36864
buffer_store_dwordx4 v[248:251], v239, s[4:7], s24 offen offset:0 sc1
v_accvgpr_read_b32 v224, a112
v_mfma_f32_32x32x16_bf16 v[192:207], v[52:55], v[40:43], v[192:207]
v_accvgpr_read_b32 v225, a113
v_accvgpr_read_b32 v226, a114
v_mfma_f32_32x32x16_bf16 v[208:223], v[52:55], v[44:47], v[208:223]
v_accvgpr_read_b32 v227, a115
v_accvgpr_read_b32 v228, a116
s_waitcnt lgkmcnt(0)
v_mfma_f32_32x32x16_bf16 v[96:111], v[80:83], v[64:67], v[96:111]
v_add_u32 v26, 0, v15
v_add_u32 v27, 16384, v17
v_accvgpr_read_b32 v229, a117
v_accvgpr_read_b32 v230, a118
v_accvgpr_read_b32 v231, a119
v_mfma_f32_32x32x16_bf16 v[112:127], v[80:83], v[68:71], v[112:127]
ds_read_b128 v[32:35], v26 offset:0
ds_read_b64_tr_b16 v[48:49], v27 offset:0
v_cvt_pk_bf16_f32 v252, v224, v225
v_cvt_pk_bf16_f32 v253, v226, v227
v_mfma_f32_32x32x16_bf16 v[128:143], v[80:83], v[72:75], v[128:143]
ds_read_b64_tr_b16 v[50:51], v27 offset:256
ds_read_b128 v[36:39], v26 offset:4096
v_cvt_pk_bf16_f32 v254, v228, v229
v_cvt_pk_bf16_f32 v255, v230, v231
v_mfma_f32_32x32x16_bf16 v[144:159], v[80:83], v[76:79], v[144:159]
ds_read_b64_tr_b16 v[52:53], v27 offset:512
ds_read_b64_tr_b16 v[54:55], v27 offset:768
s_add_u32 s24, s74, 36864
buffer_store_dwordx4 v[252:255], v239, s[4:7], s24 offen offset:2048 sc1
v_accvgpr_read_b32 v224, a24
v_mfma_f32_32x32x16_bf16 v[160:175], v[84:87], v[64:67], v[160:175]
ds_read_b128 v[40:43], v26 offset:8192
ds_read_b128 v[44:47], v26 offset:12288
v_accvgpr_read_b32 v225, a25
v_accvgpr_read_b32 v226, a26
v_mfma_f32_32x32x16_bf16 v[176:191], v[84:87], v[68:71], v[176:191]
v_accvgpr_read_b32 v227, a27
v_accvgpr_read_b32 v228, a28
v_mfma_f32_32x32x16_bf16 v[192:207], v[84:87], v[72:75], v[192:207]
v_accvgpr_read_b32 v229, a29
v_accvgpr_read_b32 v230, a30
v_mfma_f32_32x32x16_bf16 v[208:223], v[84:87], v[76:79], v[208:223]
v_accvgpr_read_b32 v231, a31
v_cvt_pk_bf16_f32 v240, v224, v225
s_waitcnt lgkmcnt(0)
v_mfma_f32_32x32x16_bf16 v[96:111], v[48:51], v[32:35], v[96:111]
v_add_u32 v28, 0, v16
v_add_u32 v29, 16384, v17
v_cvt_pk_bf16_f32 v241, v226, v227
v_cvt_pk_bf16_f32 v242, v228, v229
v_cvt_pk_bf16_f32 v243, v230, v231
v_mfma_f32_32x32x16_bf16 v[112:127], v[48:51], v[36:39], v[112:127]
ds_read_b128 v[64:67], v28 offset:0
ds_read_b64_tr_b16 v[80:81], v29 offset:2048
s_add_u32 s24, s74, 32768
buffer_store_dwordx4 v[240:243], v239, s[4:7], s24 offen offset:1024 sc1
v_accvgpr_read_b32 v224, a56
v_mfma_f32_32x32x16_bf16 v[128:143], v[48:51], v[40:43], v[128:143]
ds_read_b64_tr_b16 v[82:83], v29 offset:2304
ds_read_b128 v[68:71], v28 offset:4096
v_accvgpr_read_b32 v225, a57
v_accvgpr_read_b32 v226, a58
v_mfma_f32_32x32x16_bf16 v[144:159], v[48:51], v[44:47], v[144:159]
ds_read_b64_tr_b16 v[84:85], v29 offset:2560
ds_read_b64_tr_b16 v[86:87], v29 offset:2816
v_accvgpr_read_b32 v227, a59
v_accvgpr_read_b32 v228, a60
v_mfma_f32_32x32x16_bf16 v[160:175], v[52:55], v[32:35], v[160:175]
ds_read_b128 v[72:75], v28 offset:8192
ds_read_b128 v[76:79], v28 offset:12288
v_accvgpr_read_b32 v229, a61
v_accvgpr_read_b32 v230, a62
v_mfma_f32_32x32x16_bf16 v[176:191], v[52:55], v[36:39], v[176:191]
v_accvgpr_read_b32 v231, a63
v_cvt_pk_bf16_f32 v244, v224, v225
v_mfma_f32_32x32x16_bf16 v[192:207], v[52:55], v[40:43], v[192:207]
v_cvt_pk_bf16_f32 v245, v226, v227
v_cvt_pk_bf16_f32 v246, v228, v229
v_mfma_f32_32x32x16_bf16 v[208:223], v[52:55], v[44:47], v[208:223]
v_cvt_pk_bf16_f32 v247, v230, v231
s_add_u32 s24, s74, 32768
buffer_store_dwordx4 v[244:247], v239, s[4:7], s24 offen offset:3072 sc1
s_waitcnt lgkmcnt(0)
s_waitcnt vmcnt(9)
s_barrier
buffer_load_dword v24, v25, s[8:11], 0 offen sc1
v_mfma_f32_32x32x16_bf16 v[96:111], v[80:83], v[64:67], v[96:111]
v_add_u32 v26, 49152, v13
v_add_u32 v27, 32768, v17
v_accvgpr_read_b32 v224, a88
v_accvgpr_read_b32 v225, a89
v_accvgpr_read_b32 v226, a90
v_mfma_f32_32x32x16_bf16 v[112:127], v[80:83], v[68:71], v[112:127]
ds_read_b128 v[32:35], v26 offset:0
ds_read_b64_tr_b16 v[48:49], v27 offset:0
v_accvgpr_read_b32 v227, a91
v_accvgpr_read_b32 v228, a92
v_mfma_f32_32x32x16_bf16 v[128:143], v[80:83], v[72:75], v[128:143]
ds_read_b64_tr_b16 v[50:51], v27 offset:256
ds_read_b128 v[36:39], v26 offset:4096
v_accvgpr_read_b32 v229, a93
v_accvgpr_read_b32 v230, a94
v_mfma_f32_32x32x16_bf16 v[144:159], v[80:83], v[76:79], v[144:159]
ds_read_b64_tr_b16 v[52:53], v27 offset:512
ds_read_b64_tr_b16 v[54:55], v27 offset:768
v_accvgpr_read_b32 v231, a95
v_cvt_pk_bf16_f32 v248, v224, v225
v_mfma_f32_32x32x16_bf16 v[160:175], v[84:87], v[64:67], v[160:175]
ds_read_b128 v[40:43], v26 offset:8192
ds_read_b128 v[44:47], v26 offset:12288
v_cvt_pk_bf16_f32 v249, v226, v227
v_cvt_pk_bf16_f32 v250, v228, v229
v_mfma_f32_32x32x16_bf16 v[176:191], v[84:87], v[68:71], v[176:191]
v_cvt_pk_bf16_f32 v251, v230, v231
s_add_u32 s24, s74, 36864
buffer_store_dwordx4 v[248:251], v239, s[4:7], s24 offen offset:1024 sc1
v_mfma_f32_32x32x16_bf16 v[192:207], v[84:87], v[72:75], v[192:207]
v_accvgpr_read_b32 v224, a120
v_accvgpr_read_b32 v225, a121
v_mfma_f32_32x32x16_bf16 v[208:223], v[84:87], v[76:79], v[208:223]
v_accvgpr_read_b32 v226, a122
v_accvgpr_read_b32 v227, a123
s_waitcnt lgkmcnt(0)
v_mfma_f32_32x32x16_bf16 v[96:111], v[48:51], v[32:35], v[96:111]
v_add_u32 v28, 49152, v14
v_add_u32 v29, 32768, v17
v_accvgpr_read_b32 v228, a124
v_accvgpr_read_b32 v229, a125
v_mfma_f32_32x32x16_bf16 v[112:127], v[48:51], v[36:39], v[112:127]
ds_read_b128 v[64:67], v28 offset:0
ds_read_b64_tr_b16 v[80:81], v29 offset:2048
v_accvgpr_read_b32 v230, a126
v_mfma_f32_32x32x16_bf16 v[128:143], v[48:51], v[40:43], v[128:143]
ds_read_b64_tr_b16 v[82:83], v29 offset:2304
ds_read_b128 v[68:71], v28 offset:4096
v_accvgpr_read_b32 v231, a127
v_mfma_f32_32x32x16_bf16 v[144:159], v[48:51], v[44:47], v[144:159]
ds_read_b64_tr_b16 v[84:85], v29 offset:2560
ds_read_b64_tr_b16 v[86:87], v29 offset:2816
v_cvt_pk_bf16_f32 v252, v224, v225
v_mfma_f32_32x32x16_bf16 v[160:175], v[52:55], v[32:35], v[160:175]
ds_read_b128 v[72:75], v28 offset:8192
ds_read_b128 v[76:79], v28 offset:12288
v_cvt_pk_bf16_f32 v253, v226, v227
v_mfma_f32_32x32x16_bf16 v[176:191], v[52:55], v[36:39], v[176:191]
v_cvt_pk_bf16_f32 v254, v228, v229
v_mfma_f32_32x32x16_bf16 v[192:207], v[52:55], v[40:43], v[192:207]
v_cvt_pk_bf16_f32 v255, v230, v231
v_mfma_f32_32x32x16_bf16 v[208:223], v[52:55], v[44:47], v[208:223]
s_add_u32 s24, s74, 36864
buffer_store_dwordx4 v[252:255], v239, s[4:7], s24 offen offset:3072 sc1
s_waitcnt lgkmcnt(0)
v_mfma_f32_32x32x16_bf16 v[96:111], v[80:83], v[64:67], v[96:111]
v_add_u32 v26, 49152, v15
v_add_u32 v27, 65536, v17
v_mfma_f32_32x32x16_bf16 v[112:127], v[80:83], v[68:71], v[112:127]
ds_read_b128 v[32:35], v26 offset:0
ds_read_b64_tr_b16 v[48:49], v27 offset:0
v_mfma_f32_32x32x16_bf16 v[128:143], v[80:83], v[72:75], v[128:143]
ds_read_b64_tr_b16 v[50:51], v27 offset:256
ds_read_b128 v[36:39], v26 offset:4096
v_mfma_f32_32x32x16_bf16 v[144:159], v[80:83], v[76:79], v[144:159]
ds_read_b64_tr_b16 v[52:53], v27 offset:512
ds_read_b64_tr_b16 v[54:55], v27 offset:768
v_mfma_f32_32x32x16_bf16 v[160:175], v[84:87], v[64:67], v[160:175]
ds_read_b128 v[40:43], v26 offset:8192
ds_read_b128 v[44:47], v26 offset:12288
v_mfma_f32_32x32x16_bf16 v[176:191], v[84:87], v[68:71], v[176:191]
v_mfma_f32_32x32x16_bf16 v[192:207], v[84:87], v[72:75], v[192:207]
v_mfma_f32_32x32x16_bf16 v[208:223], v[84:87], v[76:79], v[208:223]
s_waitcnt lgkmcnt(0)
v_mfma_f32_32x32x16_bf16 v[96:111], v[48:51], v[32:35], v[96:111]
v_add_u32 v28, 49152, v16
v_add_u32 v29, 65536, v17
v_mfma_f32_32x32x16_bf16 v[112:127], v[48:51], v[36:39], v[112:127]
ds_read_b128 v[64:67], v28 offset:0
ds_read_b64_tr_b16 v[80:81], v29 offset:2048
v_mfma_f32_32x32x16_bf16 v[128:143], v[48:51], v[40:43], v[128:143]
ds_read_b64_tr_b16 v[82:83], v29 offset:2304
ds_read_b128 v[68:71], v28 offset:4096
v_mfma_f32_32x32x16_bf16 v[144:159], v[48:51], v[44:47], v[144:159]
ds_read_b64_tr_b16 v[84:85], v29 offset:2560
ds_read_b64_tr_b16 v[86:87], v29 offset:2816
v_mfma_f32_32x32x16_bf16 v[160:175], v[52:55], v[32:35], v[160:175]
ds_read_b128 v[72:75], v28 offset:8192
ds_read_b128 v[76:79], v28 offset:12288
v_mfma_f32_32x32x16_bf16 v[176:191], v[52:55], v[36:39], v[176:191]
v_mfma_f32_32x32x16_bf16 v[192:207], v[52:55], v[40:43], v[192:207]
v_mfma_f32_32x32x16_bf16 v[208:223], v[52:55], v[44:47], v[208:223]
s_waitcnt lgkmcnt(0)
v_mfma_f32_32x32x16_bf16 v[96:111], v[80:83], v[64:67], v[96:111]
v_mfma_f32_32x32x16_bf16 v[112:127], v[80:83], v[68:71], v[112:127]
v_mfma_f32_32x32x16_bf16 v[128:143], v[80:83], v[72:75], v[128:143]
v_mfma_f32_32x32x16_bf16 v[144:159], v[80:83], v[76:79], v[144:159]
v_mfma_f32_32x32x16_bf16 v[160:175], v[84:87], v[64:67], v[160:175]
v_mfma_f32_32x32x16_bf16 v[176:191], v[84:87], v[68:71], v[176:191]
v_mfma_f32_32x32x16_bf16 v[192:207], v[84:87], v[72:75], v[192:207]
v_mfma_f32_32x32x16_bf16 v[208:223], v[84:87], v[76:79], v[208:223]
s_waitcnt vmcnt(2)
F_CHK_V:
v_subrev_u32 v224, 0x01010101, v24
v_not_b32 v225, v24
v_and_b32 v224, v224, v225
v_and_b32 v224, 0x80808080, v224
v_cmp_ne_u32 vcc, 0, v224
s_cbranch_vccz F_CHK_OK_V
s_sleep 4
buffer_load_dword v24, v25, s[8:11], 0 offen sc1
s_waitcnt vmcnt(0)
s_branch F_CHK_V
F_CHK_OK_V:
s_add_u32 s22, s18, 1
s_mul_i32 s22, s22, 0x01010101
v_and_b32 v224, 0x7f7f7f7f, v24
v_cmp_eq_u32 s[24:25], s22, v224
s_lshl_b32 s23, s15, 2
s_nop 3
s_lshr_b64 s[24:25], s[24:25], s23
s_and_b32 s24, s24, 15
s_cmp_eq_u32 s24, 15
s_cselect_b32 s19, 1, 0
s_mov_b32 s19, 1
s_mov_b32 s40, s48
s_lshr_b32 s22, s12, 1
s_mul_i32 s41, s22, 45312
s_add_u32 s41, s41, 65536
s_add_u32 s42, s41, 33280
s_add_u32 s43, s42, 7680
v_and_b32 v5, 63, v0
v_lshlrev_b32 v1, 4, v5
s_lshl_b32 s22, s40, 12
s_mul_i32 s23, s46, 4194304
s_add_u32 s23, s23, s22
s_add_u32 s23, s23, 104857600
buffer_load_dwordx4 v[64:67], v1, s[4:7], s23 offen offset:0 sc1
buffer_load_dwordx4 v[68:71], v1, s[4:7], s23 offen offset:1024 sc1
buffer_load_dwordx4 v[72:75], v1, s[4:7], s23 offen offset:2048 sc1
buffer_load_dwordx4 v[76:79], v1, s[4:7], s23 offen offset:3072 sc1
s_nop 7
s_waitcnt vmcnt(4)
s_barrier
s_cmp_lg_u32 s12, 0
s_cbranch_scc1 F_FS_KVE1
s_cmp_lg_u32 s19, 0
s_cbranch_scc1 F_REL_KVE1
buffer_wbl2 sc1
s_waitcnt vmcnt(0)
F_REL_KVE1:
s_lshr_b32 s23, s14, 1
s_lshl_b32 s23, s23, 2
s_add_u32 s23, s23, s20
v_mov_b32 v224, 1
v_mov_b32 v225, 0
s_mov_b64 exec, 1
buffer_store_dword v224, v225, s[4:7], s23 offen sc1
s_mov_b64 exec, -1
F_FS_KVE1:
v_and_b32 v26, 15, v0
v_lshlrev_b32 v26, 4, v26
v_bfe_u32 v27, v0, 4, 1
v_lshlrev_b32 v27, 13, v27
v_add_u32 v26, v26, v27
v_bfe_u32 v27, v0, 5, 1
v_lshlrev_b32 v27, 8, v27
s_lshr_b32 s22, s70, 1
v_add3_u32 v27, v26, v27, s22
v_mul_f32 v96, 0x3db8aa3b, v96
v_mul_f32 v97, 0x3db8aa3b, v97
v_cvt_pk_bf16_f32 v32, v96, v97
v_mul_f32 v98, 0x3db8aa3b, v98
v_mul_f32 v99, 0x3db8aa3b, v99
v_cvt_pk_bf16_f32 v33, v98, v99
v_mul_f32 v104, 0x3db8aa3b, v104
v_mul_f32 v105, 0x3db8aa3b, v105
v_cvt_pk_bf16_f32 v34, v104, v105
v_mul_f32 v106, 0x3db8aa3b, v106
v_mul_f32 v107, 0x3db8aa3b, v107
v_cvt_pk_bf16_f32 v35, v106, v107
ds_write_b128 v27, v[32:35] offset:0
v_mul_f32 v100, 0x3db8aa3b, v100
v_mul_f32 v101, 0x3db8aa3b, v101
v_cvt_pk_bf16_f32 v36, v100, v101
v_mul_f32 v102, 0x3db8aa3b, v102
v_mul_f32 v103, 0x3db8aa3b, v103
v_cvt_pk_bf16_f32 v37, v102, v103
v_mul_f32 v108, 0x3db8aa3b, v108
v_mul_f32 v109, 0x3db8aa3b, v109
v_cvt_pk_bf16_f32 v38, v108, v109
v_mul_f32 v110, 0x3db8aa3b, v110
v_mul_f32 v111, 0x3db8aa3b, v111
v_cvt_pk_bf16_f32 v39, v110, v111
ds_write_b128 v27, v[36:39] offset:512
v_mul_f32 v160, 0x3db8aa3b, v160
v_mul_f32 v161, 0x3db8aa3b, v161
v_cvt_pk_bf16_f32 v40, v160, v161
v_mul_f32 v162, 0x3db8aa3b, v162
v_mul_f32 v163, 0x3db8aa3b, v163
v_cvt_pk_bf16_f32 v41, v162, v163
v_mul_f32 v168, 0x3db8aa3b, v168
v_mul_f32 v169, 0x3db8aa3b, v169
v_cvt_pk_bf16_f32 v42, v168, v169
v_mul_f32 v170, 0x3db8aa3b, v170
v_mul_f32 v171, 0x3db8aa3b, v171
v_cvt_pk_bf16_f32 v43, v170, v171
ds_write_b128 v27, v[40:43] offset:1024
v_mul_f32 v164, 0x3db8aa3b, v164
v_mul_f32 v165, 0x3db8aa3b, v165
v_cvt_pk_bf16_f32 v44, v164, v165
v_mul_f32 v166, 0x3db8aa3b, v166
v_mul_f32 v167, 0x3db8aa3b, v167
v_cvt_pk_bf16_f32 v45, v166, v167
v_mul_f32 v172, 0x3db8aa3b, v172
v_mul_f32 v173, 0x3db8aa3b, v173
v_cvt_pk_bf16_f32 v46, v172, v173
v_mul_f32 v174, 0x3db8aa3b, v174
v_mul_f32 v175, 0x3db8aa3b, v175
v_cvt_pk_bf16_f32 v47, v174, v175
ds_write_b128 v27, v[44:47] offset:1536
v_mul_f32 v112, 0x3db8aa3b, v112
v_mul_f32 v113, 0x3db8aa3b, v113
v_cvt_pk_bf16_f32 v48, v112, v113
v_mul_f32 v114, 0x3db8aa3b, v114
v_mul_f32 v115, 0x3db8aa3b, v115
v_cvt_pk_bf16_f32 v49, v114, v115
v_mul_f32 v120, 0x3db8aa3b, v120
v_mul_f32 v121, 0x3db8aa3b, v121
v_cvt_pk_bf16_f32 v50, v120, v121
v_mul_f32 v122, 0x3db8aa3b, v122
v_mul_f32 v123, 0x3db8aa3b, v123
v_cvt_pk_bf16_f32 v51, v122, v123
ds_write_b128 v27, v[48:51] offset:16384
v_mul_f32 v116, 0x3db8aa3b, v116
v_mul_f32 v117, 0x3db8aa3b, v117
v_cvt_pk_bf16_f32 v52, v116, v117
v_mul_f32 v118, 0x3db8aa3b, v118
v_mul_f32 v119, 0x3db8aa3b, v119
v_cvt_pk_bf16_f32 v53, v118, v119
v_mul_f32 v124, 0x3db8aa3b, v124
v_mul_f32 v125, 0x3db8aa3b, v125
v_cvt_pk_bf16_f32 v54, v124, v125
v_mul_f32 v126, 0x3db8aa3b, v126
v_mul_f32 v127, 0x3db8aa3b, v127
v_cvt_pk_bf16_f32 v55, v126, v127
ds_write_b128 v27, v[52:55] offset:16896
v_mul_f32 v176, 0x3db8aa3b, v176
v_mul_f32 v177, 0x3db8aa3b, v177
v_cvt_pk_bf16_f32 v56, v176, v177
v_mul_f32 v178, 0x3db8aa3b, v178
v_mul_f32 v179, 0x3db8aa3b, v179
v_cvt_pk_bf16_f32 v57, v178, v179
v_mul_f32 v184, 0x3db8aa3b, v184
v_mul_f32 v185, 0x3db8aa3b, v185
v_cvt_pk_bf16_f32 v58, v184, v185
v_mul_f32 v186, 0x3db8aa3b, v186
v_mul_f32 v187, 0x3db8aa3b, v187
v_cvt_pk_bf16_f32 v59, v186, v187
ds_write_b128 v27, v[56:59] offset:17408
v_mul_f32 v180, 0x3db8aa3b, v180
v_mul_f32 v181, 0x3db8aa3b, v181
v_cvt_pk_bf16_f32 v60, v180, v181
v_mul_f32 v182, 0x3db8aa3b, v182
v_mul_f32 v183, 0x3db8aa3b, v183
v_cvt_pk_bf16_f32 v61, v182, v183
v_mul_f32 v188, 0x3db8aa3b, v188
v_mul_f32 v189, 0x3db8aa3b, v189
v_cvt_pk_bf16_f32 v62, v188, v189
v_mul_f32 v190, 0x3db8aa3b, v190
v_mul_f32 v191, 0x3db8aa3b, v191
v_cvt_pk_bf16_f32 v63, v190, v191
ds_write_b128 v27, v[60:63] offset:17920
v_mul_f32 v128, 0x3db8aa3b, v128
v_mul_f32 v129, 0x3db8aa3b, v129
v_cvt_pk_bf16_f32 v32, v128, v129
v_mul_f32 v130, 0x3db8aa3b, v130
v_mul_f32 v131, 0x3db8aa3b, v131
v_cvt_pk_bf16_f32 v33, v130, v131
v_mul_f32 v136, 0x3db8aa3b, v136
v_mul_f32 v137, 0x3db8aa3b, v137
v_cvt_pk_bf16_f32 v34, v136, v137
v_mul_f32 v138, 0x3db8aa3b, v138
v_mul_f32 v139, 0x3db8aa3b, v139
v_cvt_pk_bf16_f32 v35, v138, v139
ds_write_b128 v27, v[32:35] offset:32768
v_mul_f32 v132, 0x3db8aa3b, v132
v_mul_f32 v133, 0x3db8aa3b, v133
v_cvt_pk_bf16_f32 v36, v132, v133
v_mul_f32 v134, 0x3db8aa3b, v134
v_mul_f32 v135, 0x3db8aa3b, v135
v_cvt_pk_bf16_f32 v37, v134, v135
v_mul_f32 v140, 0x3db8aa3b, v140
v_mul_f32 v141, 0x3db8aa3b, v141
v_cvt_pk_bf16_f32 v38, v140, v141
v_mul_f32 v142, 0x3db8aa3b, v142
v_mul_f32 v143, 0x3db8aa3b, v143
v_cvt_pk_bf16_f32 v39, v142, v143
ds_write_b128 v27, v[36:39] offset:33280
v_mul_f32 v192, 0x3db8aa3b, v192
v_mul_f32 v193, 0x3db8aa3b, v193
v_cvt_pk_bf16_f32 v40, v192, v193
v_mul_f32 v194, 0x3db8aa3b, v194
v_mul_f32 v195, 0x3db8aa3b, v195
v_cvt_pk_bf16_f32 v41, v194, v195
v_mul_f32 v200, 0x3db8aa3b, v200
v_mul_f32 v201, 0x3db8aa3b, v201
v_cvt_pk_bf16_f32 v42, v200, v201
v_mul_f32 v202, 0x3db8aa3b, v202
v_mul_f32 v203, 0x3db8aa3b, v203
v_cvt_pk_bf16_f32 v43, v202, v203
ds_write_b128 v27, v[40:43] offset:33792
v_mul_f32 v196, 0x3db8aa3b, v196
v_mul_f32 v197, 0x3db8aa3b, v197
v_cvt_pk_bf16_f32 v44, v196, v197
v_mul_f32 v198, 0x3db8aa3b, v198
v_mul_f32 v199, 0x3db8aa3b, v199
v_cvt_pk_bf16_f32 v45, v198, v199
v_mul_f32 v204, 0x3db8aa3b, v204
v_mul_f32 v205, 0x3db8aa3b, v205
v_cvt_pk_bf16_f32 v46, v204, v205
v_mul_f32 v206, 0x3db8aa3b, v206
v_mul_f32 v207, 0x3db8aa3b, v207
v_cvt_pk_bf16_f32 v47, v206, v207
ds_write_b128 v27, v[44:47] offset:34304
v_mul_f32 v144, 0x3db8aa3b, v144
v_mul_f32 v145, 0x3db8aa3b, v145
v_cvt_pk_bf16_f32 v48, v144, v145
v_mul_f32 v146, 0x3db8aa3b, v146
v_mul_f32 v147, 0x3db8aa3b, v147
v_cvt_pk_bf16_f32 v49, v146, v147
v_mul_f32 v152, 0x3db8aa3b, v152
v_mul_f32 v153, 0x3db8aa3b, v153
v_cvt_pk_bf16_f32 v50, v152, v153
v_mul_f32 v154, 0x3db8aa3b, v154
v_mul_f32 v155, 0x3db8aa3b, v155
v_cvt_pk_bf16_f32 v51, v154, v155
ds_write_b128 v27, v[48:51] offset:49152
v_mul_f32 v148, 0x3db8aa3b, v148
v_mul_f32 v149, 0x3db8aa3b, v149
v_cvt_pk_bf16_f32 v52, v148, v149
v_mul_f32 v150, 0x3db8aa3b, v150
v_mul_f32 v151, 0x3db8aa3b, v151
v_cvt_pk_bf16_f32 v53, v150, v151
v_mul_f32 v156, 0x3db8aa3b, v156
v_mul_f32 v157, 0x3db8aa3b, v157
v_cvt_pk_bf16_f32 v54, v156, v157
v_mul_f32 v158, 0x3db8aa3b, v158
v_mul_f32 v159, 0x3db8aa3b, v159
v_cvt_pk_bf16_f32 v55, v158, v159
ds_write_b128 v27, v[52:55] offset:49664
v_mul_f32 v208, 0x3db8aa3b, v208
v_mul_f32 v209, 0x3db8aa3b, v209
v_cvt_pk_bf16_f32 v56, v208, v209
v_mul_f32 v210, 0x3db8aa3b, v210
v_mul_f32 v211, 0x3db8aa3b, v211
v_cvt_pk_bf16_f32 v57, v210, v211
v_mul_f32 v216, 0x3db8aa3b, v216
v_mul_f32 v217, 0x3db8aa3b, v217
v_cvt_pk_bf16_f32 v58, v216, v217
v_mul_f32 v218, 0x3db8aa3b, v218
v_mul_f32 v219, 0x3db8aa3b, v219
v_cvt_pk_bf16_f32 v59, v218, v219
ds_write_b128 v27, v[56:59] offset:50176
v_mul_f32 v212, 0x3db8aa3b, v212
v_mul_f32 v213, 0x3db8aa3b, v213
v_cvt_pk_bf16_f32 v60, v212, v213
v_mul_f32 v214, 0x3db8aa3b, v214
v_mul_f32 v215, 0x3db8aa3b, v215
v_cvt_pk_bf16_f32 v61, v214, v215
v_mul_f32 v220, 0x3db8aa3b, v220
v_mul_f32 v221, 0x3db8aa3b, v221
v_cvt_pk_bf16_f32 v62, v220, v221
v_mul_f32 v222, 0x3db8aa3b, v222
v_mul_f32 v223, 0x3db8aa3b, v223
v_cvt_pk_bf16_f32 v63, v222, v223
ds_write_b128 v27, v[60:63] offset:50688
v_accvgpr_read_b32 v128, a128
v_accvgpr_read_b32 v129, a129
v_accvgpr_read_b32 v130, a130
v_accvgpr_read_b32 v131, a131
v_accvgpr_read_b32 v132, a132
v_accvgpr_read_b32 v133, a133
v_accvgpr_read_b32 v134, a134
v_accvgpr_read_b32 v135, a135
v_accvgpr_read_b32 v136, a136
v_accvgpr_read_b32 v137, a137
v_accvgpr_read_b32 v138, a138
v_accvgpr_read_b32 v139, a139
v_accvgpr_read_b32 v140, a140
v_accvgpr_read_b32 v141, a141
v_accvgpr_read_b32 v142, a142
v_accvgpr_read_b32 v143, a143
v_accvgpr_read_b32 v144, a144
v_accvgpr_read_b32 v145, a145
v_accvgpr_read_b32 v146, a146
v_accvgpr_read_b32 v147, a147
v_accvgpr_read_b32 v148, a148
v_accvgpr_read_b32 v149, a149
v_accvgpr_read_b32 v150, a150
v_accvgpr_read_b32 v151, a151
v_accvgpr_read_b32 v152, a152
v_accvgpr_read_b32 v153, a153
v_accvgpr_read_b32 v154, a154
v_accvgpr_read_b32 v155, a155
v_accvgpr_read_b32 v156, a156
v_accvgpr_read_b32 v157, a157
v_accvgpr_read_b32 v158, a158
v_accvgpr_read_b32 v159, a159
v_accvgpr_read_b32 v12, a160
s_waitcnt vmcnt(0)
s_mov_b32 s79, s74
s_mov_b32 s36, s4
s_and_b32 s37, s5, 0xffff
s_mov_b32 s38, 268435456
s_mov_b32 s39, 0x20000
s_waitcnt lgkmcnt(0)
s_barrier
s_lshl_b32 s22, s12, 14
v_and_b32 v26, 63, v0
v_lshlrev_b32 v26, 4, v26
v_add_u32 v26, s22, v26
ds_read_b128 a[192:195], v26 offset:0
ds_read_b128 a[196:199], v26 offset:1024
ds_read_b128 a[200:203], v26 offset:2048
ds_read_b128 a[204:207], v26 offset:3072
ds_read_b128 a[208:211], v26 offset:4096
ds_read_b128 a[212:215], v26 offset:5120
ds_read_b128 a[216:219], v26 offset:6144
ds_read_b128 a[220:223], v26 offset:7168
ds_read_b128 a[224:227], v26 offset:8192
ds_read_b128 a[228:231], v26 offset:9216
ds_read_b128 a[232:235], v26 offset:10240
ds_read_b128 a[236:239], v26 offset:11264
ds_read_b128 a[240:243], v26 offset:12288
ds_read_b128 a[244:247], v26 offset:13312
ds_read_b128 a[248:251], v26 offset:14336
ds_read_b128 a[252:255], v26 offset:15360
F_MID:
v_and_b32 v251, 63, v0
s_lshl_b32 s62, s12, 13
v_lshlrev_b32 v252, 4, v251
v_add_u32 v252, s62, v252
v_add_u32 v253, 4096, v252
s_lshl_b32 s23, s16, 2
s_add_u32 s23, s23, 96
s_mul_i32 s23, s23, s17
v_cmp_gt_u32 vcc, 16, v251
v_lshlrev_b32 v251, 2, v251
v_mov_b32 v250, s23
v_cndmask_b32 v251, v250, v251, vcc
s_lshl_b32 s22, s16, 1
s_sub_u32 s22, 15, s22
s_cmp_eq_u32 s17, 0
s_cselect_b32 s52, 99, s22
s_cselect_b32 s23, s22, 0
s_mov_b32 s53, 17
s_lshl_b32 s24, s15, 20
s_add_u32 s55, s24, 16777216
s_add_u32 s58, s24, 33554432
s_lshl_b32 s23, s23, 15
s_add_u32 s54, s55, s23
s_add_u32 s57, s58, s23
s_mov_b32 s56, 0
s_mov_b32 s59, 0
s_mov_b32 s60, 0
s_mov_b32 s61, 0
s_mov_b32 s67, 0
s_mov_b32 s69, 0
s_mov_b32 s64, 0x3db8aa3b
s_mov_b32 s68, 0x4b800000
s_and_b32 s72, s14, 7
s_add_u32 s72, s72, 3
s_lshl_b32 s25, s15, 3
s_add_u32 s25, s25, s16
s_mul_i32 s65, s25, 135168
s_add_u32 s65, s65, 67108864
s_mov_b32 s78, 1073741824
s_mov_b32 s74, 0
s_lshl_b32 s23, s16, 2
s_add_u32 s23, s23, 64
s_add_u32 s73, s23, s20
s_sub_u32 s22, 15, s16
s_lshl_b32 s23, s22, 16
s_add_u32 s71, s23, s24
s_add_u32 s71, s71, s62
s_cmp_eq_u32 s17, 0
s_cselect_b32 s22, s22, s16
s_lshl_b32 s22, s22, 2
s_add_u32 s22, s22, s12
s_lshl_b32 s66, s22, 18
s_lshl_b32 s22, s15, 14
s_add_u32 s66, s66, s22
s_add_u32 s66, s66, 50331648
s_add_u32 s22, s14, s12
s_and_b32 s22, s22, 1
s_add_u32 s75, s22, 9
s_lshl_b32 s76, s83, 2
s_add_u32 s76, s76, s12
s_lshl_b32 s76, s76, 15
s_cmp_eq_u32 s82, 99
s_cbranch_scc1 F_NOCONV
v_and_b32 v6, 31, v5
v_lshrrev_b32 v7, 5, v5
v_mov_b32 v80, 0
v_mov_b32 v81, 0
v_mov_b32 v82, 0
v_mov_b32 v83, 0
v_add_u32 v13, s42, v1
s_cmp_lg_u32 s46, 0
s_cbranch_scc1 F_CZ_X
ds_write_b128 v13, v[80:83] offset:5120
ds_write_b128 v13, v[80:83] offset:6144
ds_write_b128 v13, v[80:83] offset:6656
F_CZ_X:
s_xor_b32 s22, s46, 1
s_mul_i32 s22, s22, 4160
s_add_u32 s22, s22, s41
v_and_b32 v8, 3, v5
v_lshrrev_b32 v9, 2, v5
v_and_b32 v9, 3, v9
v_min_u32 v9, 2, v9
v_mul_u32_u24 v8, 8320, v8
v_lshlrev_b32 v9, 4, v9
v_add3_u32 v8, v8, v9, s22
ds_write_b128 v8, v[80:83]
v_add_u32 v13, s22, v1
v_lshrrev_b32 v14, 2, v5
v_and_b32 v10, 3, v5
v_lshlrev_b32 v10, 4, v10
s_mov_b32 s23, 68
s_cmp_eq_u32 s46, 0
s_cselect_b32 s23, 80, s23
s_cselect_b32 s25, s42, s43
s_mov_b32 s47, 0x05040302
s_cselect_b32 s47, 0x07060504, s47
v_mul_lo_u32 v14, v14, s23
v_add3_u32 v14, v14, v10, s25
s_lshl_b32 s23, s23, 4
v_cmp_eq_u32 vcc, 0, v5
s_nop 1
v_cndmask_b32 v128, v128, v80, vcc
v_cndmask_b32 v129, v129, v80, vcc
v_cndmask_b32 v130, v130, v80, vcc
v_cndmask_b32 v131, v131, v80, vcc
v_perm_b32 v160, v129, v128, s47
v_perm_b32 v161, v130, v129, s47
v_perm_b32 v162, v131, v130, s47
v_perm_b32 v163, v132, v131, s47
v_perm_b32 v164, v133, v132, s47
v_perm_b32 v165, v134, v133, s47
v_perm_b32 v166, v135, v134, s47
v_perm_b32 v168, v130, v129, s47
v_perm_b32 v169, v131, v130, s47
v_perm_b32 v170, v132, v131, s47
v_perm_b32 v171, v133, v132, s47
v_perm_b32 v172, v134, v133, s47
v_perm_b32 v173, v135, v134, s47
ds_write_b128 v13, v[160:163] offset:48
ds_write_b128 v13, v[168:171] offset:8368
ds_write_b128 v13, v[162:165] offset:16688
ds_write_b128 v13, v[170:173] offset:25008
v_perm_b32 v176, v137, v136, s47
v_perm_b32 v177, v138, v137, s47
v_perm_b32 v178, v139, v138, s47
v_perm_b32 v179, v140, v139, s47
v_perm_b32 v180, v141, v140, s47
v_perm_b32 v181, v142, v141, s47
v_perm_b32 v182, v143, v142, s47
v_perm_b32 v184, v138, v137, s47
v_perm_b32 v185, v139, v138, s47
v_perm_b32 v186, v140, v139, s47
v_perm_b32 v187, v141, v140, s47
v_perm_b32 v188, v142, v141, s47
v_perm_b32 v189, v143, v142, s47
ds_write_b128 v13, v[176:179] offset:1072
ds_write_b128 v13, v[184:187] offset:9392
ds_write_b128 v13, v[178:181] offset:17712
ds_write_b128 v13, v[186:189] offset:26032
v_perm_b32 v160, v145, v144, s47
v_perm_b32 v161, v146, v145, s47
v_perm_b32 v162, v147, v146, s47
v_perm_b32 v163, v148, v147, s47
v_perm_b32 v164, v149, v148, s47
v_perm_b32 v165, v150, v149, s47
v_perm_b32 v166, v151, v150, s47
v_perm_b32 v168, v146, v145, s47
v_perm_b32 v169, v147, v146, s47
v_perm_b32 v170, v148, v147, s47
v_perm_b32 v171, v149, v148, s47
v_perm_b32 v172, v150, v149, s47
v_perm_b32 v173, v151, v150, s47
ds_write_b128 v13, v[160:163] offset:2096
ds_write_b128 v13, v[168:171] offset:10416
ds_write_b128 v13, v[162:165] offset:18736
ds_write_b128 v13, v[170:173] offset:27056
v_perm_b32 v176, v153, v152, s47
v_perm_b32 v177, v154, v153, s47
v_perm_b32 v178, v155, v154, s47
v_perm_b32 v179, v156, v155, s47
v_perm_b32 v180, v157, v156, s47
v_perm_b32 v181, v158, v157, s47
v_perm_b32 v182, v159, v158, s47
v_perm_b32 v184, v154, v153, s47
v_perm_b32 v185, v155, v154, s47
v_perm_b32 v186, v156, v155, s47
v_perm_b32 v187, v157, v156, s47
v_perm_b32 v188, v158, v157, s47
v_perm_b32 v189, v159, v158, s47
ds_write_b128 v13, v[176:179] offset:3120
ds_write_b128 v13, v[184:187] offset:11440
ds_write_b128 v13, v[178:181] offset:19760
ds_write_b128 v13, v[186:189] offset:28080
ds_write2_b32 v14, v64, v65 offset0:0 offset1:1
ds_write2_b32 v14, v66, v67 offset0:2 offset1:3
v_add_u32 v14, s23, v14
ds_write2_b32 v14, v68, v69 offset0:0 offset1:1
ds_write2_b32 v14, v70, v71 offset0:2 offset1:3
v_add_u32 v14, s23, v14
ds_write2_b32 v14, v72, v73 offset0:0 offset1:1
ds_write2_b32 v14, v74, v75 offset0:2 offset1:3
v_add_u32 v14, s23, v14
ds_write2_b32 v14, v76, v77 offset0:0 offset1:1
ds_write2_b32 v14, v78, v79 offset0:2 offset1:3
v_and_b32 v8, 7, v6
v_mul_u32_u24 v8, 4160, v8
v_lshrrev_b32 v9, 3, v6
v_add_u32 v9, v9, v7
v_lshlrev_b32 v9, 4, v9
v_add3_u32 v8, v8, v9, s41
v_sub_u32 v9, 31, v6
v_mul_u32_u24 v9, 80, v9
v_lshlrev_b32 v10, 4, v7
v_add3_u32 v9, v9, v10, s42
s_cmp_eq_u32 s46, 0
s_cselect_b32 s22, 0, 1024
v_add_u32 v2, s22, v8
s_cselect_b32 s22, 0, 3072
v_add_u32 v4, s22, v8
s_mov_b32 s23, 1280
s_cselect_b32 s22, 2560, s23
v_add_u32 v3, s22, v9
s_cselect_b32 s22, 0, 3840
v_add_u32 v15, s22, v9
s_waitcnt vmcnt(0) lgkmcnt(0)
s_barrier
s_cmp_lg_u32 s17, 0
s_cbranch_scc1 F_NOQP
s_cmp_lg_u32 s12, 0
s_cbranch_scc1 F_FS_QP
s_cmp_lg_u32 s19, 0
s_cbranch_scc1 F_REL_QP
buffer_wbl2 sc1
s_waitcnt vmcnt(0)
F_REL_QP:
s_lshl_b32 s23, s16, 2
s_add_u32 s23, s23, 96
s_add_u32 s23, s23, s20
v_mov_b32 v224, 1
v_mov_b32 v225, 0
s_mov_b64 exec, 1
buffer_store_dword v224, v225, s[4:7], s23 offen sc1
s_mov_b64 exec, -1
F_FS_QP:
F_NOQP:
buffer_load_dword v250, v251, s[4:7], s20 offen offset:0 sc1
s_waitcnt lgkmcnt(0)
ds_read_b128 v[128:131], v2 offset:0
ds_read_b128 v[132:135], v3 offset:0
ds_read_b128 v[136:139], v2 offset:32
ds_read_b128 v[140:143], v3 offset:32
ds_read_b128 v[144:147], v2 offset:64
ds_read_b128 v[148:151], v3 offset:80
ds_read_b128 v[152:155], v2 offset:96
ds_read_b128 v[156:159], v3 offset:112
ds_read_b128 v[160:163], v2 offset:128
ds_read_b128 v[164:167], v3 offset:160
ds_read_b128 v[168:171], v2 offset:160
ds_read_b128 v[172:175], v3 offset:192
s_waitcnt lgkmcnt(10)
v_mfma_f32_32x32x16_bf16 v[96:111], v[128:131], v[132:135], 0
ds_read_b128 v[176:179], v2 offset:192
ds_read_b128 v[180:183], v3 offset:240
s_waitcnt lgkmcnt(10)
v_mfma_f32_32x32x16_bf16 v[96:111], v[136:139], v[140:143], v[96:111]
ds_read_b128 v[184:187], v2 offset:224
ds_read_b128 v[188:191], v3 offset:272
s_waitcnt lgkmcnt(10)
v_mfma_f32_32x32x16_bf16 v[96:111], v[144:147], v[148:151], v[96:111]
ds_read_b128 v[128:131], v2 offset:256
ds_read_b128 v[132:135], v3 offset:320
s_waitcnt lgkmcnt(10)
v_mfma_f32_32x32x16_bf16 v[96:111], v[152:155], v[156:159], v[96:111]
ds_read_b128 v[136:139], v2 offset:288
ds_read_b128 v[140:143], v3 offset:352
s_waitcnt lgkmcnt(10)
v_mfma_f32_32x32x16_bf16 v[96:111], v[160:163], v[164:167], v[96:111]
ds_read_b128 v[144:147], v2 offset:320
ds_read_b128 v[148:151], v3 offset:400
s_waitcnt lgkmcnt(10)
v_mfma_f32_32x32x16_bf16 v[96:111], v[168:171], v[172:175], v[96:111]
ds_read_b128 v[152:155], v2 offset:352
ds_read_b128 v[156:159], v3 offset:432
s_waitcnt lgkmcnt(10)
v_mfma_f32_32x32x16_bf16 v[96:111], v[176:179], v[180:183], v[96:111]
ds_read_b128 v[160:163], v2 offset:384
ds_read_b128 v[164:167], v3 offset:480
s_waitcnt lgkmcnt(10)
v_mfma_f32_32x32x16_bf16 v[96:111], v[184:187], v[188:191], v[96:111]
ds_read_b128 v[168:171], v2 offset:416
ds_read_b128 v[172:175], v3 offset:512
s_waitcnt lgkmcnt(10)
v_mfma_f32_32x32x16_bf16 v[96:111], v[128:131], v[132:135], v[96:111]
ds_read_b128 v[176:179], v2 offset:448
ds_read_b128 v[180:183], v3 offset:560
s_waitcnt lgkmcnt(10)
v_mfma_f32_32x32x16_bf16 v[96:111], v[136:139], v[140:143], v[96:111]
ds_read_b128 v[184:187], v2 offset:480
ds_read_b128 v[188:191], v3 offset:592
s_waitcnt lgkmcnt(10)
v_mfma_f32_32x32x16_bf16 v[96:111], v[144:147], v[148:151], v[96:111]
ds_read_b128 v[128:131], v2 offset:512
ds_read_b128 v[132:135], v3 offset:640
s_waitcnt lgkmcnt(10)
v_mfma_f32_32x32x16_bf16 v[96:111], v[152:155], v[156:159], v[96:111]
ds_read_b128 v[136:139], v2 offset:544
ds_read_b128 v[140:143], v3 offset:672
s_waitcnt lgkmcnt(10)
v_mfma_f32_32x32x16_bf16 v[96:111], v[160:163], v[164:167], v[96:111]
ds_read_b128 v[144:147], v2 offset:576
ds_read_b128 v[148:151], v3 offset:720
s_waitcnt lgkmcnt(10)
v_mfma_f32_32x32x16_bf16 v[96:111], v[168:171], v[172:175], v[96:111]
ds_read_b128 v[152:155], v2 offset:608
ds_read_b128 v[156:159], v3 offset:752
s_waitcnt lgkmcnt(10)
v_mfma_f32_32x32x16_bf16 v[96:111], v[176:179], v[180:183], v[96:111]
ds_read_b128 v[160:163], v2 offset:640
ds_read_b128 v[164:167], v3 offset:800
s_waitcnt lgkmcnt(10)
v_mfma_f32_32x32x16_bf16 v[96:111], v[184:187], v[188:191], v[96:111]
ds_read_b128 v[168:171], v2 offset:672
ds_read_b128 v[172:175], v3 offset:832
s_waitcnt lgkmcnt(10)
v_mfma_f32_32x32x16_bf16 v[96:111], v[128:131], v[132:135], v[96:111]
ds_read_b128 v[176:179], v2 offset:704
ds_read_b128 v[180:183], v3 offset:880
s_waitcnt lgkmcnt(10)
v_mfma_f32_32x32x16_bf16 v[96:111], v[136:139], v[140:143], v[96:111]
ds_read_b128 v[184:187], v2 offset:736
ds_read_b128 v[188:191], v3 offset:912
s_waitcnt lgkmcnt(10)
v_mfma_f32_32x32x16_bf16 v[96:111], v[144:147], v[148:151], v[96:111]
ds_read_b128 v[128:131], v2 offset:768
ds_read_b128 v[132:135], v3 offset:960
s_waitcnt lgkmcnt(10)
v_mfma_f32_32x32x16_bf16 v[96:111], v[152:155], v[156:159], v[96:111]
ds_read_b128 v[136:139], v2 offset:800
ds_read_b128 v[140:143], v3 offset:992
s_waitcnt lgkmcnt(10)
v_mfma_f32_32x32x16_bf16 v[96:111], v[160:163], v[164:167], v[96:111]
ds_read_b128 v[144:147], v2 offset:832
ds_read_b128 v[148:151], v3 offset:1040
s_waitcnt lgkmcnt(10)
v_mfma_f32_32x32x16_bf16 v[96:111], v[168:171], v[172:175], v[96:111]
ds_read_b128 v[152:155], v2 offset:864
ds_read_b128 v[156:159], v3 offset:1072
s_waitcnt lgkmcnt(10)
v_mfma_f32_32x32x16_bf16 v[96:111], v[176:179], v[180:183], v[96:111]
ds_read_b128 v[160:163], v2 offset:896
ds_read_b128 v[164:167], v3 offset:1120
s_waitcnt lgkmcnt(10)
v_mfma_f32_32x32x16_bf16 v[96:111], v[184:187], v[188:191], v[96:111]
ds_read_b128 v[168:171], v2 offset:928
ds_read_b128 v[172:175], v3 offset:1152
s_waitcnt lgkmcnt(10)
v_mfma_f32_32x32x16_bf16 v[96:111], v[128:131], v[132:135], v[96:111]
ds_read_b128 v[176:179], v2 offset:960
ds_read_b128 v[180:183], v3 offset:1200
s_waitcnt lgkmcnt(10)
v_mfma_f32_32x32x16_bf16 v[96:111], v[136:139], v[140:143], v[96:111]
ds_read_b128 v[184:187], v2 offset:992
ds_read_b128 v[188:191], v3 offset:1232
s_waitcnt lgkmcnt(10)
v_mfma_f32_32x32x16_bf16 v[96:111], v[144:147], v[148:151], v[96:111]
ds_read_b128 v[128:131], v2 offset:1024
ds_read_b128 v[132:135], v3 offset:1280
s_waitcnt lgkmcnt(10)
v_mfma_f32_32x32x16_bf16 v[96:111], v[152:155], v[156:159], v[96:111]
ds_read_b128 v[136:139], v2 offset:1056
ds_read_b128 v[140:143], v3 offset:1312
s_waitcnt lgkmcnt(10)
v_mfma_f32_32x32x16_bf16 v[96:111], v[160:163], v[164:167], v[96:111]
ds_read_b128 v[144:147], v2 offset:1088
ds_read_b128 v[148:151], v3 offset:1360
s_waitcnt lgkmcnt(10)
v_mfma_f32_32x32x16_bf16 v[96:111], v[168:171], v[172:175], v[96:111]
ds_read_b128 v[152:155], v2 offset:1120
ds_read_b128 v[156:159], v3 offset:1392
s_waitcnt lgkmcnt(10)
v_mfma_f32_32x32x16_bf16 v[96:111], v[176:179], v[180:183], v[96:111]
ds_read_b128 v[160:163], v2 offset:1152
ds_read_b128 v[164:167], v3 offset:1440
s_cmp_lg_u32 s69, 0
s_cbranch_scc1 F_EC_C30
s_cmp_eq_u32 s19, 0
s_cbranch_scc1 F_EC_C30
s_waitcnt vmcnt(0)
v_cmp_ne_u32 vcc, 1, v250
s_cbranch_vccz F_ECGO_C30
buffer_load_dword v250, v251, s[4:7], s20 offen offset:0 sc1
F_EC_C30:
s_waitcnt lgkmcnt(10)
v_mfma_f32_32x32x16_bf16 v[96:111], v[184:187], v[188:191], v[96:111]
ds_read_b128 v[168:171], v2 offset:1184
ds_read_b128 v[172:175], v3 offset:1472
s_waitcnt lgkmcnt(10)
v_mfma_f32_32x32x16_bf16 v[96:111], v[128:131], v[132:135], v[96:111]
ds_read_b128 v[176:179], v2 offset:1216
ds_read_b128 v[180:183], v3 offset:1520
s_waitcnt lgkmcnt(10)
v_mfma_f32_32x32x16_bf16 v[96:111], v[136:139], v[140:143], v[96:111]
ds_read_b128 v[184:187], v2 offset:1248
ds_read_b128 v[188:191], v3 offset:1552
s_waitcnt lgkmcnt(10)
v_mfma_f32_32x32x16_bf16 v[96:111], v[144:147], v[148:151], v[96:111]
ds_read_b128 v[128:131], v2 offset:1280
ds_read_b128 v[132:135], v3 offset:1600
s_waitcnt lgkmcnt(10)
v_mfma_f32_32x32x16_bf16 v[96:111], v[152:155], v[156:159], v[96:111]
ds_read_b128 v[136:139], v2 offset:1312
ds_read_b128 v[140:143], v3 offset:1632
s_waitcnt lgkmcnt(10)
v_mfma_f32_32x32x16_bf16 v[96:111], v[160:163], v[164:167], v[96:111]
ds_read_b128 v[144:147], v2 offset:1344
ds_read_b128 v[148:151], v3 offset:1680
s_waitcnt lgkmcnt(10)
v_mfma_f32_32x32x16_bf16 v[96:111], v[168:171], v[172:175], v[96:111]
ds_read_b128 v[152:155], v2 offset:1376
ds_read_b128 v[156:159], v3 offset:1712
s_waitcnt lgkmcnt(10)
v_mfma_f32_32x32x16_bf16 v[96:111], v[176:179], v[180:183], v[96:111]
ds_read_b128 v[160:163], v2 offset:1408
ds_read_b128 v[164:167], v3 offset:1760
s_waitcnt lgkmcnt(10)
v_mfma_f32_32x32x16_bf16 v[96:111], v[184:187], v[188:191], v[96:111]
ds_read_b128 v[168:171], v2 offset:1440
ds_read_b128 v[172:175], v3 offset:1792
s_waitcnt lgkmcnt(10)
v_mfma_f32_32x32x16_bf16 v[96:111], v[128:131], v[132:135], v[96:111]
ds_read_b128 v[176:179], v2 offset:1472
ds_read_b128 v[180:183], v3 offset:1840
s_waitcnt lgkmcnt(10)
v_mfma_f32_32x32x16_bf16 v[96:111], v[136:139], v[140:143], v[96:111]
ds_read_b128 v[184:187], v2 offset:1504
ds_read_b128 v[188:191], v3 offset:1872
s_waitcnt lgkmcnt(10)
v_mfma_f32_32x32x16_bf16 v[96:111], v[144:147], v[148:151], v[96:111]
ds_read_b128 v[128:131], v2 offset:1536
ds_read_b128 v[132:135], v3 offset:1920
s_waitcnt lgkmcnt(10)
v_mfma_f32_32x32x16_bf16 v[96:111], v[152:155], v[156:159], v[96:111]
ds_read_b128 v[136:139], v2 offset:1568
ds_read_b128 v[140:143], v3 offset:1952
s_waitcnt lgkmcnt(10)
v_mfma_f32_32x32x16_bf16 v[96:111], v[160:163], v[164:167], v[96:111]
ds_read_b128 v[144:147], v2 offset:1600
ds_read_b128 v[148:151], v3 offset:2000
s_waitcnt lgkmcnt(10)
v_mfma_f32_32x32x16_bf16 v[96:111], v[168:171], v[172:175], v[96:111]
ds_read_b128 v[152:155], v2 offset:1632
ds_read_b128 v[156:159], v3 offset:2032
s_waitcnt lgkmcnt(10)
v_mfma_f32_32x32x16_bf16 v[96:111], v[176:179], v[180:183], v[96:111]
ds_read_b128 v[160:163], v2 offset:1664
ds_read_b128 v[164:167], v3 offset:2080
s_waitcnt lgkmcnt(10)
v_mfma_f32_32x32x16_bf16 v[96:111], v[184:187], v[188:191], v[96:111]
ds_read_b128 v[168:171], v2 offset:1696
ds_read_b128 v[172:175], v3 offset:2112
s_waitcnt lgkmcnt(10)
v_mfma_f32_32x32x16_bf16 v[96:111], v[128:131], v[132:135], v[96:111]
ds_read_b128 v[176:179], v2 offset:1728
ds_read_b128 v[180:183], v3 offset:2160
s_waitcnt lgkmcnt(10)
v_mfma_f32_32x32x16_bf16 v[96:111], v[136:139], v[140:143], v[96:111]
ds_read_b128 v[184:187], v2 offset:1760
ds_read_b128 v[188:191], v3 offset:2192
s_waitcnt lgkmcnt(10)
v_mfma_f32_32x32x16_bf16 v[96:111], v[144:147], v[148:151], v[96:111]
ds_read_b128 v[128:131], v2 offset:1792
ds_read_b128 v[132:135], v3 offset:2240
s_waitcnt lgkmcnt(10)
v_mfma_f32_32x32x16_bf16 v[96:111], v[152:155], v[156:159], v[96:111]
ds_read_b128 v[136:139], v2 offset:1824
ds_read_b128 v[140:143], v3 offset:2272
s_waitcnt lgkmcnt(10)
v_mfma_f32_32x32x16_bf16 v[96:111], v[160:163], v[164:167], v[96:111]
ds_read_b128 v[144:147], v2 offset:1856
ds_read_b128 v[148:151], v3 offset:2320
s_waitcnt lgkmcnt(10)
v_mfma_f32_32x32x16_bf16 v[96:111], v[168:171], v[172:175], v[96:111]
ds_read_b128 v[152:155], v2 offset:1888
ds_read_b128 v[156:159], v3 offset:2352
s_waitcnt lgkmcnt(10)
v_mfma_f32_32x32x16_bf16 v[96:111], v[176:179], v[180:183], v[96:111]
ds_read_b128 v[160:163], v2 offset:1920
ds_read_b128 v[164:167], v3 offset:2400
s_waitcnt lgkmcnt(10)
v_mfma_f32_32x32x16_bf16 v[96:111], v[184:187], v[188:191], v[96:111]
ds_read_b128 v[168:171], v2 offset:1952
ds_read_b128 v[172:175], v3 offset:2432
s_waitcnt lgkmcnt(10)
v_mfma_f32_32x32x16_bf16 v[96:111], v[128:131], v[132:135], v[96:111]
ds_read_b128 v[176:179], v2 offset:1984
ds_read_b128 v[180:183], v3 offset:2480
s_waitcnt lgkmcnt(10)
v_mfma_f32_32x32x16_bf16 v[96:111], v[136:139], v[140:143], v[96:111]
ds_read_b128 v[184:187], v2 offset:2016
ds_read_b128 v[188:191], v3 offset:2512
s_waitcnt lgkmcnt(10)
v_mfma_f32_32x32x16_bf16 v[96:111], v[144:147], v[148:151], v[96:111]
ds_read_b128 v[128:131], v4 offset:0
ds_read_b128 v[132:135], v15 offset:0
s_waitcnt lgkmcnt(10)
v_mfma_f32_32x32x16_bf16 v[96:111], v[152:155], v[156:159], v[96:111]
ds_read_b128 v[136:139], v4 offset:32
ds_read_b128 v[140:143], v15 offset:32
s_waitcnt lgkmcnt(10)
v_mfma_f32_32x32x16_bf16 v[96:111], v[160:163], v[164:167], v[96:111]
ds_read_b128 v[144:147], v4 offset:64
ds_read_b128 v[148:151], v15 offset:80
s_cmp_lg_u32 s69, 0
s_cbranch_scc1 F_EC_C60
s_cmp_eq_u32 s19, 0
s_cbranch_scc1 F_EC_C60
s_waitcnt vmcnt(0)
v_cmp_ne_u32 vcc, 1, v250
s_cbranch_vccz F_ECGO_C60
buffer_load_dword v250, v251, s[4:7], s20 offen offset:0 sc1
F_EC_C60:
s_waitcnt lgkmcnt(10)
v_mfma_f32_32x32x16_bf16 v[96:111], v[168:171], v[172:175], v[96:111]
ds_read_b128 v[152:155], v4 offset:96
ds_read_b128 v[156:159], v15 offset:112
s_waitcnt lgkmcnt(10)
v_mfma_f32_32x32x16_bf16 v[96:111], v[176:179], v[180:183], v[96:111]
ds_read_b128 v[160:163], v4 offset:128
ds_read_b128 v[164:167], v15 offset:160
v_accvgpr_write_b32 a0, 0
v_accvgpr_write_b32 a1, 0
v_accvgpr_write_b32 a2, 0
v_accvgpr_write_b32 a3, 0
s_waitcnt lgkmcnt(10)
v_mfma_f32_32x32x16_bf16 v[96:111], v[184:187], v[188:191], v[96:111]
ds_read_b128 v[168:171], v4 offset:160
ds_read_b128 v[172:175], v15 offset:192
v_accvgpr_write_b32 a4, 0
v_accvgpr_write_b32 a5, 0
v_accvgpr_write_b32 a6, 0
v_accvgpr_write_b32 a7, 0
s_waitcnt lgkmcnt(10)
v_mfma_f32_32x32x16_bf16 v[112:127], v[128:131], v[132:135], 0
ds_read_b128 v[176:179], v4 offset:192
ds_read_b128 v[180:183], v15 offset:240
v_accvgpr_write_b32 a8, 0
v_accvgpr_write_b32 a9, 0
v_accvgpr_write_b32 a10, 0
v_accvgpr_write_b32 a11, 0
s_waitcnt lgkmcnt(10)
v_mfma_f32_32x32x16_bf16 v[112:127], v[136:139], v[140:143], v[112:127]
ds_read_b128 v[184:187], v4 offset:224
ds_read_b128 v[188:191], v15 offset:272
v_accvgpr_write_b32 a12, 0
v_accvgpr_write_b32 a13, 0
v_accvgpr_write_b32 a14, 0
v_accvgpr_write_b32 a15, 0
s_waitcnt lgkmcnt(10)
v_mfma_f32_32x32x16_bf16 v[112:127], v[144:147], v[148:151], v[112:127]
ds_read_b128 v[128:131], v4 offset:256
ds_read_b128 v[132:135], v15 offset:320
v_accvgpr_write_b32 a16, 0
v_accvgpr_write_b32 a17, 0
v_accvgpr_write_b32 a18, 0
v_accvgpr_write_b32 a19, 0
s_waitcnt lgkmcnt(10)
v_mfma_f32_32x32x16_bf16 v[112:127], v[152:155], v[156:159], v[112:127]
ds_read_b128 v[136:139], v4 offset:288
ds_read_b128 v[140:143], v15 offset:352
v_accvgpr_write_b32 a20, 0
v_accvgpr_write_b32 a21, 0
v_accvgpr_write_b32 a22, 0
v_accvgpr_write_b32 a23, 0
s_waitcnt lgkmcnt(10)
v_mfma_f32_32x32x16_bf16 v[112:127], v[160:163], v[164:167], v[112:127]
ds_read_b128 v[144:147], v4 offset:320
ds_read_b128 v[148:151], v15 offset:400
v_accvgpr_write_b32 a24, 0
v_accvgpr_write_b32 a25, 0
v_accvgpr_write_b32 a26, 0
v_accvgpr_write_b32 a27, 0
s_waitcnt lgkmcnt(10)
v_mfma_f32_32x32x16_bf16 v[112:127], v[168:171], v[172:175], v[112:127]
ds_read_b128 v[152:155], v4 offset:352
ds_read_b128 v[156:159], v15 offset:432
v_accvgpr_write_b32 a28, 0
v_accvgpr_write_b32 a29, 0
v_accvgpr_write_b32 a30, 0
v_accvgpr_write_b32 a31, 0
s_waitcnt lgkmcnt(10)
v_mfma_f32_32x32x16_bf16 v[112:127], v[176:179], v[180:183], v[112:127]
ds_read_b128 v[160:163], v4 offset:384
ds_read_b128 v[164:167], v15 offset:480
v_accvgpr_write_b32 a32, 0
v_accvgpr_write_b32 a33, 0
v_accvgpr_write_b32 a34, 0
v_accvgpr_write_b32 a35, 0
s_waitcnt lgkmcnt(10)
v_mfma_f32_32x32x16_bf16 v[112:127], v[184:187], v[188:191], v[112:127]
ds_read_b128 v[168:171], v4 offset:416
ds_read_b128 v[172:175], v15 offset:512
v_accvgpr_write_b32 a36, 0
v_accvgpr_write_b32 a37, 0
v_accvgpr_write_b32 a38, 0
v_accvgpr_write_b32 a39, 0
s_waitcnt lgkmcnt(10)
v_mfma_f32_32x32x16_bf16 v[112:127], v[128:131], v[132:135], v[112:127]
ds_read_b128 v[176:179], v4 offset:448
ds_read_b128 v[180:183], v15 offset:560
v_accvgpr_write_b32 a40, 0
v_accvgpr_write_b32 a41, 0
v_accvgpr_write_b32 a42, 0
v_accvgpr_write_b32 a43, 0
s_waitcnt lgkmcnt(10)
v_mfma_f32_32x32x16_bf16 v[112:127], v[136:139], v[140:143], v[112:127]
ds_read_b128 v[184:187], v4 offset:480
ds_read_b128 v[188:191], v15 offset:592
v_accvgpr_write_b32 a44, 0
v_accvgpr_write_b32 a45, 0
v_accvgpr_write_b32 a46, 0
v_accvgpr_write_b32 a47, 0
s_waitcnt lgkmcnt(10)
v_mfma_f32_32x32x16_bf16 v[112:127], v[144:147], v[148:151], v[112:127]
ds_read_b128 v[128:131], v4 offset:512
ds_read_b128 v[132:135], v15 offset:640
v_accvgpr_write_b32 a48, 0
v_accvgpr_write_b32 a49, 0
v_accvgpr_write_b32 a50, 0
v_accvgpr_write_b32 a51, 0
s_waitcnt lgkmcnt(10)
v_mfma_f32_32x32x16_bf16 v[112:127], v[152:155], v[156:159], v[112:127]
ds_read_b128 v[136:139], v4 offset:544
ds_read_b128 v[140:143], v15 offset:672
v_accvgpr_write_b32 a52, 0
v_accvgpr_write_b32 a53, 0
v_accvgpr_write_b32 a54, 0
v_accvgpr_write_b32 a55, 0
s_waitcnt lgkmcnt(10)
v_mfma_f32_32x32x16_bf16 v[112:127], v[160:163], v[164:167], v[112:127]
ds_read_b128 v[144:147], v4 offset:576
ds_read_b128 v[148:151], v15 offset:720
v_accvgpr_write_b32 a56, 0
v_accvgpr_write_b32 a57, 0
v_accvgpr_write_b32 a58, 0
v_accvgpr_write_b32 a59, 0
s_waitcnt lgkmcnt(10)
v_mfma_f32_32x32x16_bf16 v[112:127], v[168:171], v[172:175], v[112:127]
ds_read_b128 v[152:155], v4 offset:608
ds_read_b128 v[156:159], v15 offset:752
v_accvgpr_write_b32 a60, 0
v_accvgpr_write_b32 a61, 0
v_accvgpr_write_b32 a62, 0
v_accvgpr_write_b32 a63, 0
s_waitcnt lgkmcnt(10)
v_mfma_f32_32x32x16_bf16 v[112:127], v[176:179], v[180:183], v[112:127]
ds_read_b128 v[160:163], v4 offset:640
ds_read_b128 v[164:167], v15 offset:800
v_accvgpr_write_b32 a64, 0
v_accvgpr_write_b32 a65, 0
v_accvgpr_write_b32 a66, 0
v_accvgpr_write_b32 a67, 0
s_waitcnt lgkmcnt(10)
v_mfma_f32_32x32x16_bf16 v[112:127], v[184:187], v[188:191], v[112:127]
ds_read_b128 v[168:171], v4 offset:672
ds_read_b128 v[172:175], v15 offset:832
v_accvgpr_write_b32 a68, 0
v_accvgpr_write_b32 a69, 0
v_accvgpr_write_b32 a70, 0
v_accvgpr_write_b32 a71, 0
s_waitcnt lgkmcnt(10)
v_mfma_f32_32x32x16_bf16 v[112:127], v[128:131], v[132:135], v[112:127]
ds_read_b128 v[176:179], v4 offset:704
ds_read_b128 v[180:183], v15 offset:880
v_accvgpr_write_b32 a72, 0
v_accvgpr_write_b32 a73, 0
v_accvgpr_write_b32 a74, 0
v_accvgpr_write_b32 a75, 0
s_waitcnt lgkmcnt(10)
v_mfma_f32_32x32x16_bf16 v[112:127], v[136:139], v[140:143], v[112:127]
ds_read_b128 v[184:187], v4 offset:736
ds_read_b128 v[188:191], v15 offset:912
v_accvgpr_write_b32 a76, 0
v_accvgpr_write_b32 a77, 0
v_accvgpr_write_b32 a78, 0
v_accvgpr_write_b32 a79, 0
s_waitcnt lgkmcnt(10)
v_mfma_f32_32x32x16_bf16 v[112:127], v[144:147], v[148:151], v[112:127]
ds_read_b128 v[128:131], v4 offset:768
ds_read_b128 v[132:135], v15 offset:960
v_accvgpr_write_b32 a80, 0
v_accvgpr_write_b32 a81, 0
v_accvgpr_write_b32 a82, 0
v_accvgpr_write_b32 a83, 0
s_waitcnt lgkmcnt(10)
v_mfma_f32_32x32x16_bf16 v[112:127], v[152:155], v[156:159], v[112:127]
ds_read_b128 v[136:139], v4 offset:800
ds_read_b128 v[140:143], v15 offset:992
v_accvgpr_write_b32 a84, 0
v_accvgpr_write_b32 a85, 0
v_accvgpr_write_b32 a86, 0
v_accvgpr_write_b32 a87, 0
s_waitcnt lgkmcnt(10)
v_mfma_f32_32x32x16_bf16 v[112:127], v[160:163], v[164:167], v[112:127]
ds_read_b128 v[144:147], v4 offset:832
ds_read_b128 v[148:151], v15 offset:1040
v_accvgpr_write_b32 a88, 0
v_accvgpr_write_b32 a89, 0
v_accvgpr_write_b32 a90, 0
v_accvgpr_write_b32 a91, 0
s_waitcnt lgkmcnt(10)
v_mfma_f32_32x32x16_bf16 v[112:127], v[168:171], v[172:175], v[112:127]
ds_read_b128 v[152:155], v4 offset:864
ds_read_b128 v[156:159], v15 offset:1072
v_accvgpr_write_b32 a92, 0
v_accvgpr_write_b32 a93, 0
v_accvgpr_write_b32 a94, 0
v_accvgpr_write_b32 a95, 0
s_waitcnt lgkmcnt(10)
v_mfma_f32_32x32x16_bf16 v[112:127], v[176:179], v[180:183], v[112:127]
ds_read_b128 v[160:163], v4 offset:896
ds_read_b128 v[164:167], v15 offset:1120
v_accvgpr_write_b32 a96, 0
v_accvgpr_write_b32 a97, 0
v_accvgpr_write_b32 a98, 0
v_accvgpr_write_b32 a99, 0
s_waitcnt lgkmcnt(10)
v_mfma_f32_32x32x16_bf16 v[112:127], v[184:187], v[188:191], v[112:127]
ds_read_b128 v[168:171], v4 offset:928
ds_read_b128 v[172:175], v15 offset:1152
v_accvgpr_write_b32 a100, 0
v_accvgpr_write_b32 a101, 0
v_accvgpr_write_b32 a102, 0
v_accvgpr_write_b32 a103, 0
s_waitcnt lgkmcnt(10)
v_mfma_f32_32x32x16_bf16 v[112:127], v[128:131], v[132:135], v[112:127]
ds_read_b128 v[176:179], v4 offset:960
ds_read_b128 v[180:183], v15 offset:1200
v_accvgpr_write_b32 a104, 0
v_accvgpr_write_b32 a105, 0
v_accvgpr_write_b32 a106, 0
v_accvgpr_write_b32 a107, 0
s_waitcnt lgkmcnt(10)
v_mfma_f32_32x32x16_bf16 v[112:127], v[136:139], v[140:143], v[112:127]
ds_read_b128 v[184:187], v4 offset:992
ds_read_b128 v[188:191], v15 offset:1232
v_accvgpr_write_b32 a108, 0
v_accvgpr_write_b32 a109, 0
v_accvgpr_write_b32 a110, 0
v_accvgpr_write_b32 a111, 0
s_waitcnt lgkmcnt(10)
v_mfma_f32_32x32x16_bf16 v[112:127], v[144:147], v[148:151], v[112:127]
v_accvgpr_write_b32 a112, 0
v_accvgpr_write_b32 a113, 0
v_accvgpr_write_b32 a114, 0
v_accvgpr_write_b32 a115, 0
s_cmp_lg_u32 s69, 0
s_cbranch_scc1 F_EC_C90
s_cmp_eq_u32 s19, 0
s_cbranch_scc1 F_EC_C90
s_waitcnt vmcnt(0)
v_cmp_ne_u32 vcc, 1, v250
s_cbranch_vccz F_ECGO_C90
F_EC_C90:
s_waitcnt lgkmcnt(8)
v_mfma_f32_32x32x16_bf16 v[112:127], v[152:155], v[156:159], v[112:127]
v_accvgpr_write_b32 a116, 0
v_accvgpr_write_b32 a117, 0
v_accvgpr_write_b32 a118, 0
v_accvgpr_write_b32 a119, 0
s_waitcnt lgkmcnt(6)
v_mfma_f32_32x32x16_bf16 v[112:127], v[160:163], v[164:167], v[112:127]
v_accvgpr_write_b32 a120, 0
v_accvgpr_write_b32 a121, 0
v_accvgpr_write_b32 a122, 0
v_accvgpr_write_b32 a123, 0
s_waitcnt lgkmcnt(4)
v_mfma_f32_32x32x16_bf16 v[112:127], v[168:171], v[172:175], v[112:127]
v_accvgpr_write_b32 a124, 0
v_accvgpr_write_b32 a125, 0
v_accvgpr_write_b32 a126, 0
v_accvgpr_write_b32 a127, 0
s_waitcnt lgkmcnt(2)
v_mfma_f32_32x32x16_bf16 v[112:127], v[176:179], v[180:183], v[112:127]
s_waitcnt lgkmcnt(0)
v_mfma_f32_32x32x16_bf16 v[112:127], v[184:187], v[188:191], v[112:127]
v_sub_u32 v8, 63, v6
s_lshl_b32 s22, s46, 5
v_subrev_u32 v8, s22, v8
v_mul_u32_u24 v9, 80, v8
v_lshlrev_b32 v10, 3, v7
v_sub_u32 v9, v9, v10
v_add_u32 v9, s42, v9
v_mul_u32_u24 v13, 68, v8
v_sub_u32 v13, v13, v10
v_add_u32 v13, s43, v13
ds_read_b64 v[32:33], v9 offset:56
ds_read2_b32 v[48:49], v13 offset0:14 offset1:15
ds_read_b64 v[34:35], v9 offset:40
ds_read2_b32 v[50:51], v13 offset0:10 offset1:11
ds_read_b64 v[36:37], v9 offset:24
ds_read2_b32 v[52:53], v13 offset0:6 offset1:7
ds_read_b64 v[38:39], v9 offset:8
ds_read2_b32 v[54:55], v13 offset0:2 offset1:3
v_add_u32 v14, s41, v1
s_nop 7
s_cmp_lg_u32 s46, 0
s_cbranch_scc1 F_CX_X
ds_write_b128 v14, v[112:115] offset:0
ds_write_b128 v14, v[116:119] offset:4160
ds_write_b128 v14, v[120:123] offset:8320
ds_write_b128 v14, v[124:127] offset:12480
F_CX_X:
s_waitcnt lgkmcnt(0)
v_lshlrev_b32 v12, 16, v12
s_barrier
s_cmp_eq_u32 s46, 0
s_cbranch_scc1 F_CY_X
ds_read_b128 v[64:67], v14 offset:0
ds_read_b128 v[68:71], v14 offset:4160
ds_read_b128 v[72:75], v14 offset:8320
ds_read_b128 v[76:79], v14 offset:12480
v_add_f32 v96, v96, v112
v_add_f32 v97, v97, v113
v_add_f32 v98, v98, v114
v_add_f32 v99, v99, v115
v_add_f32 v100, v100, v116
v_add_f32 v101, v101, v117
v_add_f32 v102, v102, v118
v_add_f32 v103, v103, v119
v_add_f32 v104, v104, v120
v_add_f32 v105, v105, v121
v_add_f32 v106, v106, v122
v_add_f32 v107, v107, v123
v_add_f32 v108, v108, v124
v_add_f32 v109, v109, v125
v_add_f32 v110, v110, v126
v_add_f32 v111, v111, v127
s_waitcnt lgkmcnt(0)
v_add_f32 v96, v96, v64
v_add_f32 v97, v97, v65
v_add_f32 v98, v98, v66
v_add_f32 v99, v99, v67
v_add_f32 v100, v100, v68
v_add_f32 v101, v101, v69
v_add_f32 v102, v102, v70
v_add_f32 v103, v103, v71
v_add_f32 v104, v104, v72
v_add_f32 v105, v105, v73
v_add_f32 v106, v106, v74
v_add_f32 v107, v107, v75
v_add_f32 v108, v108, v76
v_add_f32 v109, v109, v77
v_add_f32 v110, v110, v78
v_add_f32 v111, v111, v79
F_CY_X:
v_lshlrev_b32 v8, 6, v6
v_lshlrev_b32 v9, 3, v7
v_add_u32 v8, v8, v9
s_lshl_b32 s45, s40, 12
s_lshl_b32 s22, s46, 11
s_add_u32 s45, s45, s22
s_add_u32 s45, s45, 113246208
v_lshlrev_b32 v16, 16, v32
v_and_b32 v17, 0xffff0000, v32
v_lshlrev_b32 v18, 16, v33
v_and_b32 v19, 0xffff0000, v33
v_mul_f32 v19, v19, v12
v_mul_f32 v18, v18, v12
v_mul_f32 v17, v17, v12
v_mul_f32 v16, v16, v12
v_cvt_pk_bf16_f32 v20, v19, v18
v_cvt_pk_bf16_f32 v21, v17, v16
v_cvt_pk_bf16_f32 v22, v96, v97
v_cvt_pk_bf16_f32 v23, v98, v99
v_lshlrev_b32 v24, 16, v20
v_and_b32 v25, 0xffff0000, v20
v_lshlrev_b32 v28, 16, v22
v_and_b32 v29, 0xffff0000, v22
v_lshlrev_b32 v26, 16, v21
v_and_b32 v27, 0xffff0000, v21
v_lshlrev_b32 v30, 16, v23
v_and_b32 v31, 0xffff0000, v23
v_add_f32 v24, v28, v24
v_add_f32 v25, v29, v25
v_add_f32 v26, v30, v26
v_add_f32 v27, v31, v27
v_cvt_pk_bf16_f32 v20, v24, v25
v_cvt_pk_bf16_f32 v21, v26, v27
v_lshlrev_b32 v24, 16, v20
v_and_b32 v25, 0xffff0000, v20
v_lshlrev_b32 v26, 16, v21
v_and_b32 v27, 0xffff0000, v21
v_lshlrev_b32 v16, 16, v48
v_and_b32 v17, 0xffff0000, v48
v_lshlrev_b32 v18, 16, v49
v_and_b32 v19, 0xffff0000, v49
v_mul_f32 v24, v19, v24
v_mul_f32 v25, v18, v25
v_mul_f32 v26, v17, v26
v_mul_f32 v27, v16, v27
v_cvt_pk_bf16_f32 v64, v24, v25
v_cvt_pk_bf16_f32 v65, v26, v27
buffer_store_dwordx2 v[64:65], v8, s[4:7], s45 offen offset:0 sc1
v_lshlrev_b32 v16, 16, v34
v_and_b32 v17, 0xffff0000, v34
v_lshlrev_b32 v18, 16, v35
v_and_b32 v19, 0xffff0000, v35
v_mul_f32 v19, v19, v12
v_mul_f32 v18, v18, v12
v_mul_f32 v17, v17, v12
v_mul_f32 v16, v16, v12
v_cvt_pk_bf16_f32 v20, v19, v18
v_cvt_pk_bf16_f32 v21, v17, v16
v_cvt_pk_bf16_f32 v22, v100, v101
v_cvt_pk_bf16_f32 v23, v102, v103
v_lshlrev_b32 v24, 16, v20
v_and_b32 v25, 0xffff0000, v20
v_lshlrev_b32 v28, 16, v22
v_and_b32 v29, 0xffff0000, v22
v_lshlrev_b32 v26, 16, v21
v_and_b32 v27, 0xffff0000, v21
v_lshlrev_b32 v30, 16, v23
v_and_b32 v31, 0xffff0000, v23
v_add_f32 v24, v28, v24
v_add_f32 v25, v29, v25
v_add_f32 v26, v30, v26
v_add_f32 v27, v31, v27
v_cvt_pk_bf16_f32 v20, v24, v25
v_cvt_pk_bf16_f32 v21, v26, v27
v_lshlrev_b32 v24, 16, v20
v_and_b32 v25, 0xffff0000, v20
v_lshlrev_b32 v26, 16, v21
v_and_b32 v27, 0xffff0000, v21
v_lshlrev_b32 v16, 16, v50
v_and_b32 v17, 0xffff0000, v50
v_lshlrev_b32 v18, 16, v51
v_and_b32 v19, 0xffff0000, v51
v_mul_f32 v24, v19, v24
v_mul_f32 v25, v18, v25
v_mul_f32 v26, v17, v26
v_mul_f32 v27, v16, v27
v_cvt_pk_bf16_f32 v66, v24, v25
v_cvt_pk_bf16_f32 v67, v26, v27
buffer_store_dwordx2 v[66:67], v8, s[4:7], s45 offen offset:16 sc1
v_lshlrev_b32 v16, 16, v36
v_and_b32 v17, 0xffff0000, v36
v_lshlrev_b32 v18, 16, v37
v_and_b32 v19, 0xffff0000, v37
v_mul_f32 v19, v19, v12
v_mul_f32 v18, v18, v12
v_mul_f32 v17, v17, v12
v_mul_f32 v16, v16, v12
v_cvt_pk_bf16_f32 v20, v19, v18
v_cvt_pk_bf16_f32 v21, v17, v16
v_cvt_pk_bf16_f32 v22, v104, v105
v_cvt_pk_bf16_f32 v23, v106, v107
v_lshlrev_b32 v24, 16, v20
v_and_b32 v25, 0xffff0000, v20
v_lshlrev_b32 v28, 16, v22
v_and_b32 v29, 0xffff0000, v22
v_lshlrev_b32 v26, 16, v21
v_and_b32 v27, 0xffff0000, v21
v_lshlrev_b32 v30, 16, v23
v_and_b32 v31, 0xffff0000, v23
v_add_f32 v24, v28, v24
v_add_f32 v25, v29, v25
v_add_f32 v26, v30, v26
v_add_f32 v27, v31, v27
v_cvt_pk_bf16_f32 v20, v24, v25
v_cvt_pk_bf16_f32 v21, v26, v27
v_lshlrev_b32 v24, 16, v20
v_and_b32 v25, 0xffff0000, v20
v_lshlrev_b32 v26, 16, v21
v_and_b32 v27, 0xffff0000, v21
v_lshlrev_b32 v16, 16, v52
v_and_b32 v17, 0xffff0000, v52
v_lshlrev_b32 v18, 16, v53
v_and_b32 v19, 0xffff0000, v53
v_mul_f32 v24, v19, v24
v_mul_f32 v25, v18, v25
v_mul_f32 v26, v17, v26
v_mul_f32 v27, v16, v27
v_cvt_pk_bf16_f32 v68, v24, v25
v_cvt_pk_bf16_f32 v69, v26, v27
buffer_store_dwordx2 v[68:69], v8, s[4:7], s45 offen offset:32 sc1
v_lshlrev_b32 v16, 16, v38
v_and_b32 v17, 0xffff0000, v38
v_lshlrev_b32 v18, 16, v39
v_and_b32 v19, 0xffff0000, v39
v_mul_f32 v19, v19, v12
v_mul_f32 v18, v18, v12
v_mul_f32 v17, v17, v12
v_mul_f32 v16, v16, v12
v_cvt_pk_bf16_f32 v20, v19, v18
v_cvt_pk_bf16_f32 v21, v17, v16
v_cvt_pk_bf16_f32 v22, v108, v109
v_cvt_pk_bf16_f32 v23, v110, v111
v_lshlrev_b32 v24, 16, v20
v_and_b32 v25, 0xffff0000, v20
v_lshlrev_b32 v28, 16, v22
v_and_b32 v29, 0xffff0000, v22
v_lshlrev_b32 v26, 16, v21
v_and_b32 v27, 0xffff0000, v21
v_lshlrev_b32 v30, 16, v23
v_and_b32 v31, 0xffff0000, v23
v_add_f32 v24, v28, v24
v_add_f32 v25, v29, v25
v_add_f32 v26, v30, v26
v_add_f32 v27, v31, v27
v_cvt_pk_bf16_f32 v20, v24, v25
v_cvt_pk_bf16_f32 v21, v26, v27
v_lshlrev_b32 v24, 16, v20
v_and_b32 v25, 0xffff0000, v20
v_lshlrev_b32 v26, 16, v21
v_and_b32 v27, 0xffff0000, v21
v_lshlrev_b32 v16, 16, v54
v_and_b32 v17, 0xffff0000, v54
v_lshlrev_b32 v18, 16, v55
v_and_b32 v19, 0xffff0000, v55
v_mul_f32 v24, v19, v24
v_mul_f32 v25, v18, v25
v_mul_f32 v26, v17, v26
v_mul_f32 v27, v16, v27
v_cvt_pk_bf16_f32 v70, v24, v25
v_cvt_pk_bf16_f32 v71, v26, v27
buffer_store_dwordx2 v[70:71], v8, s[4:7], s45 offen offset:48 sc1
s_branch F_ATT
F_ECGO_C30:
s_add_u32 m0, s60, s62
s_nop 0
buffer_load_dwordx4 v252, s[4:7], s54 offen lds
buffer_load_dwordx4 v252, s[4:7], s54 offen offset:1024 lds
buffer_load_dwordx4 v252, s[4:7], s54 offen offset:2048 lds
buffer_load_dwordx4 v252, s[4:7], s54 offen offset:3072 lds
s_add_u32 m0, m0, 4096
s_add_u32 s22, s60, 32768
s_sub_u32 s60, s22, 163840
s_cselect_b32 s60, s22, s60
buffer_load_dwordx4 v253, s[4:7], s54 offen lds
buffer_load_dwordx4 v253, s[4:7], s54 offen offset:1024 lds
buffer_load_dwordx4 v253, s[4:7], s54 offen offset:2048 lds
buffer_load_dwordx4 v253, s[4:7], s54 offen offset:3072 lds
s_add_u32 s56, s56, 1
s_add_u32 s54, s54, 32768
s_cmp_eq_u32 s56, s52
s_cselect_b32 s54, s55, s54
s_cmp_eq_u32 s56, s53
s_cselect_b32 s54, s78, s54
s_cmp_eq_u32 s17, 0
s_cbranch_scc1 F_NOQL_C30
s_cmp_eq_u32 s71, -1
s_cbranch_scc1 F_NOQL_C30
buffer_load_dwordx4 a[128:131], v252, s[4:7], s71 offen offset:0
buffer_load_dwordx4 a[132:135], v252, s[4:7], s71 offen offset:1024
buffer_load_dwordx4 a[136:139], v252, s[4:7], s71 offen offset:2048
buffer_load_dwordx4 a[140:143], v252, s[4:7], s71 offen offset:3072
s_add_u32 s71, s71, 4096
buffer_load_dwordx4 a[144:147], v252, s[4:7], s71 offen offset:0
buffer_load_dwordx4 a[148:151], v252, s[4:7], s71 offen offset:1024
buffer_load_dwordx4 a[152:155], v252, s[4:7], s71 offen offset:2048
buffer_load_dwordx4 a[156:159], v252, s[4:7], s71 offen offset:3072
s_add_u32 s71, s71, 4096
buffer_load_dwordx4 a[160:163], v252, s[4:7], s71 offen offset:0
buffer_load_dwordx4 a[164:167], v252, s[4:7], s71 offen offset:1024
buffer_load_dwordx4 a[168:171], v252, s[4:7], s71 offen offset:2048
buffer_load_dwordx4 a[172:175], v252, s[4:7], s71 offen offset:3072
s_add_u32 s71, s71, 4096
buffer_load_dwordx4 a[176:179], v252, s[4:7], s71 offen offset:0
buffer_load_dwordx4 a[180:183], v252, s[4:7], s71 offen offset:1024
buffer_load_dwordx4 a[184:187], v252, s[4:7], s71 offen offset:2048
buffer_load_dwordx4 a[188:191], v252, s[4:7], s71 offen offset:3072
F_NOQL_C30:
s_add_u32 m0, s60, s62
s_nop 0
buffer_load_dwordx4 v252, s[4:7], s54 offen lds
buffer_load_dwordx4 v252, s[4:7], s54 offen offset:1024 lds
buffer_load_dwordx4 v252, s[4:7], s54 offen offset:2048 lds
buffer_load_dwordx4 v252, s[4:7], s54 offen offset:3072 lds
s_add_u32 m0, m0, 4096
s_add_u32 s22, s60, 32768
s_sub_u32 s60, s22, 163840
s_cselect_b32 s60, s22, s60
buffer_load_dwordx4 v253, s[4:7], s54 offen lds
buffer_load_dwordx4 v253, s[4:7], s54 offen offset:1024 lds
buffer_load_dwordx4 v253, s[4:7], s54 offen offset:2048 lds
buffer_load_dwordx4 v253, s[4:7], s54 offen offset:3072 lds
s_add_u32 s56, s56, 1
s_add_u32 s54, s54, 32768
s_cmp_eq_u32 s56, s52
s_cselect_b32 s54, s55, s54
s_cmp_eq_u32 s56, s53
s_cselect_b32 s54, s78, s54
s_mov_b32 s69, 1
s_branch F_EC_C30
F_ECGO_C60:
s_add_u32 m0, s60, s62
s_nop 0
buffer_load_dwordx4 v252, s[4:7], s54 offen lds
buffer_load_dwordx4 v252, s[4:7], s54 offen offset:1024 lds
buffer_load_dwordx4 v252, s[4:7], s54 offen offset:2048 lds
buffer_load_dwordx4 v252, s[4:7], s54 offen offset:3072 lds
s_add_u32 m0, m0, 4096
s_add_u32 s22, s60, 32768
s_sub_u32 s60, s22, 163840
s_cselect_b32 s60, s22, s60
buffer_load_dwordx4 v253, s[4:7], s54 offen lds
buffer_load_dwordx4 v253, s[4:7], s54 offen offset:1024 lds
buffer_load_dwordx4 v253, s[4:7], s54 offen offset:2048 lds
buffer_load_dwordx4 v253, s[4:7], s54 offen offset:3072 lds
s_add_u32 s56, s56, 1
s_add_u32 s54, s54, 32768
s_cmp_eq_u32 s56, s52
s_cselect_b32 s54, s55, s54
s_cmp_eq_u32 s56, s53
s_cselect_b32 s54, s78, s54
s_cmp_eq_u32 s17, 0
s_cbranch_scc1 F_NOQL_C60
s_cmp_eq_u32 s71, -1
s_cbranch_scc1 F_NOQL_C60
buffer_load_dwordx4 a[128:131], v252, s[4:7], s71 offen offset:0
buffer_load_dwordx4 a[132:135], v252, s[4:7], s71 offen offset:1024
buffer_load_dwordx4 a[136:139], v252, s[4:7], s71 offen offset:2048
buffer_load_dwordx4 a[140:143], v252, s[4:7], s71 offen offset:3072
s_add_u32 s71, s71, 4096
buffer_load_dwordx4 a[144:147], v252, s[4:7], s71 offen offset:0
buffer_load_dwordx4 a[148:151], v252, s[4:7], s71 offen offset:1024
buffer_load_dwordx4 a[152:155], v252, s[4:7], s71 offen offset:2048
buffer_load_dwordx4 a[156:159], v252, s[4:7], s71 offen offset:3072
s_add_u32 s71, s71, 4096
buffer_load_dwordx4 a[160:163], v252, s[4:7], s71 offen offset:0
buffer_load_dwordx4 a[164:167], v252, s[4:7], s71 offen offset:1024
buffer_load_dwordx4 a[168:171], v252, s[4:7], s71 offen offset:2048
buffer_load_dwordx4 a[172:175], v252, s[4:7], s71 offen offset:3072
s_add_u32 s71, s71, 4096
buffer_load_dwordx4 a[176:179], v252, s[4:7], s71 offen offset:0
buffer_load_dwordx4 a[180:183], v252, s[4:7], s71 offen offset:1024
buffer_load_dwordx4 a[184:187], v252, s[4:7], s71 offen offset:2048
buffer_load_dwordx4 a[188:191], v252, s[4:7], s71 offen offset:3072
F_NOQL_C60:
s_add_u32 m0, s60, s62
s_nop 0
buffer_load_dwordx4 v252, s[4:7], s54 offen lds
buffer_load_dwordx4 v252, s[4:7], s54 offen offset:1024 lds
buffer_load_dwordx4 v252, s[4:7], s54 offen offset:2048 lds
buffer_load_dwordx4 v252, s[4:7], s54 offen offset:3072 lds
s_add_u32 m0, m0, 4096
s_add_u32 s22, s60, 32768
s_sub_u32 s60, s22, 163840
s_cselect_b32 s60, s22, s60
buffer_load_dwordx4 v253, s[4:7], s54 offen lds
buffer_load_dwordx4 v253, s[4:7], s54 offen offset:1024 lds
buffer_load_dwordx4 v253, s[4:7], s54 offen offset:2048 lds
buffer_load_dwordx4 v253, s[4:7], s54 offen offset:3072 lds
s_add_u32 s56, s56, 1
s_add_u32 s54, s54, 32768
s_cmp_eq_u32 s56, s52
s_cselect_b32 s54, s55, s54
s_cmp_eq_u32 s56, s53
s_cselect_b32 s54, s78, s54
s_mov_b32 s69, 1
s_branch F_EC_C60
F_ECGO_C90:
s_add_u32 m0, s60, s62
s_nop 0
buffer_load_dwordx4 v252, s[4:7], s54 offen lds
buffer_load_dwordx4 v252, s[4:7], s54 offen offset:1024 lds
buffer_load_dwordx4 v252, s[4:7], s54 offen offset:2048 lds
buffer_load_dwordx4 v252, s[4:7], s54 offen offset:3072 lds
s_add_u32 m0, m0, 4096
s_add_u32 s22, s60, 32768
s_sub_u32 s60, s22, 163840
s_cselect_b32 s60, s22, s60
buffer_load_dwordx4 v253, s[4:7], s54 offen lds
buffer_load_dwordx4 v253, s[4:7], s54 offen offset:1024 lds
buffer_load_dwordx4 v253, s[4:7], s54 offen offset:2048 lds
buffer_load_dwordx4 v253, s[4:7], s54 offen offset:3072 lds
s_add_u32 s56, s56, 1
s_add_u32 s54, s54, 32768
s_cmp_eq_u32 s56, s52
s_cselect_b32 s54, s55, s54
s_cmp_eq_u32 s56, s53
s_cselect_b32 s54, s78, s54
s_cmp_eq_u32 s17, 0
s_cbranch_scc1 F_NOQL_C90
s_cmp_eq_u32 s71, -1
s_cbranch_scc1 F_NOQL_C90
buffer_load_dwordx4 a[128:131], v252, s[4:7], s71 offen offset:0
buffer_load_dwordx4 a[132:135], v252, s[4:7], s71 offen offset:1024
buffer_load_dwordx4 a[136:139], v252, s[4:7], s71 offen offset:2048
buffer_load_dwordx4 a[140:143], v252, s[4:7], s71 offen offset:3072
s_add_u32 s71, s71, 4096
buffer_load_dwordx4 a[144:147], v252, s[4:7], s71 offen offset:0
buffer_load_dwordx4 a[148:151], v252, s[4:7], s71 offen offset:1024
buffer_load_dwordx4 a[152:155], v252, s[4:7], s71 offen offset:2048
buffer_load_dwordx4 a[156:159], v252, s[4:7], s71 offen offset:3072
s_add_u32 s71, s71, 4096
buffer_load_dwordx4 a[160:163], v252, s[4:7], s71 offen offset:0
buffer_load_dwordx4 a[164:167], v252, s[4:7], s71 offen offset:1024
buffer_load_dwordx4 a[168:171], v252, s[4:7], s71 offen offset:2048
buffer_load_dwordx4 a[172:175], v252, s[4:7], s71 offen offset:3072
s_add_u32 s71, s71, 4096
buffer_load_dwordx4 a[176:179], v252, s[4:7], s71 offen offset:0
buffer_load_dwordx4 a[180:183], v252, s[4:7], s71 offen offset:1024
buffer_load_dwordx4 a[184:187], v252, s[4:7], s71 offen offset:2048
buffer_load_dwordx4 a[188:191], v252, s[4:7], s71 offen offset:3072
F_NOQL_C90:
s_add_u32 m0, s60, s62
s_nop 0
buffer_load_dwordx4 v252, s[4:7], s54 offen lds
buffer_load_dwordx4 v252, s[4:7], s54 offen offset:1024 lds
buffer_load_dwordx4 v252, s[4:7], s54 offen offset:2048 lds
buffer_load_dwordx4 v252, s[4:7], s54 offen offset:3072 lds
s_add_u32 m0, m0, 4096
s_add_u32 s22, s60, 32768
s_sub_u32 s60, s22, 163840
s_cselect_b32 s60, s22, s60
buffer_load_dwordx4 v253, s[4:7], s54 offen lds
buffer_load_dwordx4 v253, s[4:7], s54 offen offset:1024 lds
buffer_load_dwordx4 v253, s[4:7], s54 offen offset:2048 lds
buffer_load_dwordx4 v253, s[4:7], s54 offen offset:3072 lds
s_add_u32 s56, s56, 1
s_add_u32 s54, s54, 32768
s_cmp_eq_u32 s56, s52
s_cselect_b32 s54, s55, s54
s_cmp_eq_u32 s56, s53
s_cselect_b32 s54, s78, s54
s_mov_b32 s69, 1
s_branch F_EC_C90
F_NOCONV:
s_nop 1
v_accvgpr_write_b32 a0, 0
v_accvgpr_write_b32 a1, 0
v_accvgpr_write_b32 a2, 0
v_accvgpr_write_b32 a3, 0
v_accvgpr_write_b32 a4, 0
v_accvgpr_write_b32 a5, 0
v_accvgpr_write_b32 a6, 0
v_accvgpr_write_b32 a7, 0
v_accvgpr_write_b32 a8, 0
v_accvgpr_write_b32 a9, 0
v_accvgpr_write_b32 a10, 0
v_accvgpr_write_b32 a11, 0
v_accvgpr_write_b32 a12, 0
v_accvgpr_write_b32 a13, 0
v_accvgpr_write_b32 a14, 0
v_accvgpr_write_b32 a15, 0
v_accvgpr_write_b32 a16, 0
v_accvgpr_write_b32 a17, 0
v_accvgpr_write_b32 a18, 0
v_accvgpr_write_b32 a19, 0
v_accvgpr_write_b32 a20, 0
v_accvgpr_write_b32 a21, 0
v_accvgpr_write_b32 a22, 0
v_accvgpr_write_b32 a23, 0
v_accvgpr_write_b32 a24, 0
v_accvgpr_write_b32 a25, 0
v_accvgpr_write_b32 a26, 0
v_accvgpr_write_b32 a27, 0
v_accvgpr_write_b32 a28, 0
v_accvgpr_write_b32 a29, 0
v_accvgpr_write_b32 a30, 0
v_accvgpr_write_b32 a31, 0
v_accvgpr_write_b32 a32, 0
v_accvgpr_write_b32 a33, 0
v_accvgpr_write_b32 a34, 0
v_accvgpr_write_b32 a35, 0
v_accvgpr_write_b32 a36, 0
v_accvgpr_write_b32 a37, 0
v_accvgpr_write_b32 a38, 0
v_accvgpr_write_b32 a39, 0
v_accvgpr_write_b32 a40, 0
v_accvgpr_write_b32 a41, 0
v_accvgpr_write_b32 a42, 0
v_accvgpr_write_b32 a43, 0
v_accvgpr_write_b32 a44, 0
v_accvgpr_write_b32 a45, 0
v_accvgpr_write_b32 a46, 0
v_accvgpr_write_b32 a47, 0
v_accvgpr_write_b32 a48, 0
v_accvgpr_write_b32 a49, 0
v_accvgpr_write_b32 a50, 0
v_accvgpr_write_b32 a51, 0
v_accvgpr_write_b32 a52, 0
v_accvgpr_write_b32 a53, 0
v_accvgpr_write_b32 a54, 0
v_accvgpr_write_b32 a55, 0
v_accvgpr_write_b32 a56, 0
v_accvgpr_write_b32 a57, 0
v_accvgpr_write_b32 a58, 0
v_accvgpr_write_b32 a59, 0
v_accvgpr_write_b32 a60, 0
v_accvgpr_write_b32 a61, 0
v_accvgpr_write_b32 a62, 0
v_accvgpr_write_b32 a63, 0
v_accvgpr_write_b32 a64, 0
v_accvgpr_write_b32 a65, 0
v_accvgpr_write_b32 a66, 0
v_accvgpr_write_b32 a67, 0
v_accvgpr_write_b32 a68, 0
v_accvgpr_write_b32 a69, 0
v_accvgpr_write_b32 a70, 0
v_accvgpr_write_b32 a71, 0
v_accvgpr_write_b32 a72, 0
v_accvgpr_write_b32 a73, 0
v_accvgpr_write_b32 a74, 0
v_accvgpr_write_b32 a75, 0
v_accvgpr_write_b32 a76, 0
v_accvgpr_write_b32 a77, 0
v_accvgpr_write_b32 a78, 0
v_accvgpr_write_b32 a79, 0
v_accvgpr_write_b32 a80, 0
v_accvgpr_write_b32 a81, 0
v_accvgpr_write_b32 a82, 0
v_accvgpr_write_b32 a83, 0
v_accvgpr_write_b32 a84, 0
v_accvgpr_write_b32 a85, 0
v_accvgpr_write_b32 a86, 0
v_accvgpr_write_b32 a87, 0
v_accvgpr_write_b32 a88, 0
v_accvgpr_write_b32 a89, 0
v_accvgpr_write_b32 a90, 0
v_accvgpr_write_b32 a91, 0
v_accvgpr_write_b32 a92, 0
v_accvgpr_write_b32 a93, 0
v_accvgpr_write_b32 a94, 0
v_accvgpr_write_b32 a95, 0
v_accvgpr_write_b32 a96, 0
v_accvgpr_write_b32 a97, 0
v_accvgpr_write_b32 a98, 0
v_accvgpr_write_b32 a99, 0
v_accvgpr_write_b32 a100, 0
v_accvgpr_write_b32 a101, 0
v_accvgpr_write_b32 a102, 0
v_accvgpr_write_b32 a103, 0
v_accvgpr_write_b32 a104, 0
v_accvgpr_write_b32 a105, 0
v_accvgpr_write_b32 a106, 0
v_accvgpr_write_b32 a107, 0
v_accvgpr_write_b32 a108, 0
v_accvgpr_write_b32 a109, 0
v_accvgpr_write_b32 a110, 0
v_accvgpr_write_b32 a111, 0
v_accvgpr_write_b32 a112, 0
v_accvgpr_write_b32 a113, 0
v_accvgpr_write_b32 a114, 0
v_accvgpr_write_b32 a115, 0
v_accvgpr_write_b32 a116, 0
v_accvgpr_write_b32 a117, 0
v_accvgpr_write_b32 a118, 0
v_accvgpr_write_b32 a119, 0
v_accvgpr_write_b32 a120, 0
v_accvgpr_write_b32 a121, 0
v_accvgpr_write_b32 a122, 0
v_accvgpr_write_b32 a123, 0
v_accvgpr_write_b32 a124, 0
v_accvgpr_write_b32 a125, 0
v_accvgpr_write_b32 a126, 0
v_accvgpr_write_b32 a127, 0
s_waitcnt lgkmcnt(0)
s_barrier
F_ATT:
s_cmp_lg_u32 s69, 0
s_cbranch_scc1 F_S1_DONE
F_S1_POLL:
buffer_load_dword v250, v251, s[4:7], s20 offen offset:0 sc1
s_waitcnt vmcnt(0)
v_cmp_ne_u32 vcc, 1, v250
s_cbranch_vccz F_S1_OK
s_sleep 2
s_branch F_S1_POLL
F_S1_OK:
s_cmp_lg_u32 s19, 0
s_cbranch_scc1 F_S1_F
buffer_inv sc1
s_waitcnt vmcnt(0)
F_S1_F:
s_add_u32 m0, s60, s62
s_nop 0
buffer_load_dwordx4 v252, s[4:7], s54 offen lds
buffer_load_dwordx4 v252, s[4:7], s54 offen offset:1024 lds
buffer_load_dwordx4 v252, s[4:7], s54 offen offset:2048 lds
buffer_load_dwordx4 v252, s[4:7], s54 offen offset:3072 lds
s_add_u32 m0, m0, 4096
s_add_u32 s22, s60, 32768
s_sub_u32 s60, s22, 163840
s_cselect_b32 s60, s22, s60
buffer_load_dwordx4 v253, s[4:7], s54 offen lds
buffer_load_dwordx4 v253, s[4:7], s54 offen offset:1024 lds
buffer_load_dwordx4 v253, s[4:7], s54 offen offset:2048 lds
buffer_load_dwordx4 v253, s[4:7], s54 offen offset:3072 lds
s_add_u32 s56, s56, 1
s_add_u32 s54, s54, 32768
s_cmp_eq_u32 s56, s52
s_cselect_b32 s54, s55, s54
s_cmp_eq_u32 s56, s53
s_cselect_b32 s54, s78, s54
s_cmp_eq_u32 s17, 0
s_cbranch_scc1 F_NOQL_BLK
s_cmp_eq_u32 s71, -1
s_cbranch_scc1 F_NOQL_BLK
buffer_load_dwordx4 a[128:131], v252, s[4:7], s71 offen offset:0
buffer_load_dwordx4 a[132:135], v252, s[4:7], s71 offen offset:1024
buffer_load_dwordx4 a[136:139], v252, s[4:7], s71 offen offset:2048
buffer_load_dwordx4 a[140:143], v252, s[4:7], s71 offen offset:3072
s_add_u32 s71, s71, 4096
buffer_load_dwordx4 a[144:147], v252, s[4:7], s71 offen offset:0
buffer_load_dwordx4 a[148:151], v252, s[4:7], s71 offen offset:1024
buffer_load_dwordx4 a[152:155], v252, s[4:7], s71 offen offset:2048
buffer_load_dwordx4 a[156:159], v252, s[4:7], s71 offen offset:3072
s_add_u32 s71, s71, 4096
buffer_load_dwordx4 a[160:163], v252, s[4:7], s71 offen offset:0
buffer_load_dwordx4 a[164:167], v252, s[4:7], s71 offen offset:1024
buffer_load_dwordx4 a[168:171], v252, s[4:7], s71 offen offset:2048
buffer_load_dwordx4 a[172:175], v252, s[4:7], s71 offen offset:3072
s_add_u32 s71, s71, 4096
buffer_load_dwordx4 a[176:179], v252, s[4:7], s71 offen offset:0
buffer_load_dwordx4 a[180:183], v252, s[4:7], s71 offen offset:1024
buffer_load_dwordx4 a[184:187], v252, s[4:7], s71 offen offset:2048
buffer_load_dwordx4 a[188:191], v252, s[4:7], s71 offen offset:3072
F_NOQL_BLK:
s_add_u32 m0, s60, s62
s_nop 0
buffer_load_dwordx4 v252, s[4:7], s54 offen lds
buffer_load_dwordx4 v252, s[4:7], s54 offen offset:1024 lds
buffer_load_dwordx4 v252, s[4:7], s54 offen offset:2048 lds
buffer_load_dwordx4 v252, s[4:7], s54 offen offset:3072 lds
s_add_u32 m0, m0, 4096
s_add_u32 s22, s60, 32768
s_sub_u32 s60, s22, 163840
s_cselect_b32 s60, s22, s60
buffer_load_dwordx4 v253, s[4:7], s54 offen lds
buffer_load_dwordx4 v253, s[4:7], s54 offen offset:1024 lds
buffer_load_dwordx4 v253, s[4:7], s54 offen offset:2048 lds
buffer_load_dwordx4 v253, s[4:7], s54 offen offset:3072 lds
s_add_u32 s56, s56, 1
s_add_u32 s54, s54, 32768
s_cmp_eq_u32 s56, s52
s_cselect_b32 s54, s55, s54
s_cmp_eq_u32 s56, s53
s_cselect_b32 s54, s78, s54
s_mov_b32 s69, 1
F_S1_DONE:
v_and_b32 v14, 63, v0
v_lshlrev_b32 v3, 4, v14
v_and_b32 v13, 15, v14
v_lshrrev_b32 v15, 4, v14
v_lshlrev_b32 v206, 9, v15
v_lshl_add_u32 v206, v13, 4, v206
v_lshlrev_b32 v15, 2, v15
v_sub_u32 v13, v13, v15
s_lshl_b32 s22, s12, 5
v_add_u32 v13, s22, v13
v_cvt_f32_i32 v13, v13
v_add_f32 v13, 0.5, v13
v_mul_f32 v10, 0x5f800000, v13
v_mov_b32 v4, v3
v_mov_b32 v194, 0
v_mov_b32 v195, 0
v_mov_b32 v192, 0
v_mov_b32 v193, 0
v_mov_b32 v208, 0
v_mov_b32 v209, 0
v_mov_b32 v210, 0
v_mov_b32 v211, 0
v_mov_b32 v212, 0
v_mov_b32 v213, 0
v_mov_b32 v214, 0
v_mov_b32 v215, 0
s_waitcnt vmcnt(4) lgkmcnt(0)
s_barrier
ds_read_b128 v[128:131], v4 offset:0
ds_read_b128 v[132:135], v4 offset:1024
ds_read_b128 v[136:139], v4 offset:2048
ds_read_b128 v[140:143], v4 offset:3072
ds_read_b128 v[144:147], v4 offset:4096
ds_read_b128 v[148:151], v4 offset:5120
ds_read_b128 v[152:155], v4 offset:6144
ds_read_b128 v[156:159], v4 offset:7168
s_waitcnt lgkmcnt(4)
v_mfma_f32_16x16x32_bf16 v[16:19], v[128:131], a[128:131], v[208:211]
s_add_u32 s23, s61, 32768
v_mfma_f32_16x16x32_bf16 v[20:23], v[128:131], a[160:163], v[212:215]
ds_read_b128 v[160:163], v4 offset:8192
v_mfma_f32_16x16x32_bf16 v[16:19], v[132:135], a[132:135], v[16:19]
s_sub_u32 s61, s23, 163840
s_cselect_b32 s61, s23, s61
v_mfma_f32_16x16x32_bf16 v[20:23], v[132:135], a[164:167], v[20:23]
ds_read_b128 v[164:167], v4 offset:9216
v_add_u32 v5, s61, v3
v_mfma_f32_16x16x32_bf16 v[16:19], v[136:139], a[136:139], v[16:19]
s_add_u32 m0, s60, s62
v_mfma_f32_16x16x32_bf16 v[20:23], v[136:139], a[168:171], v[20:23]
ds_read_b128 v[168:171], v4 offset:10240
v_mfma_f32_16x16x32_bf16 v[16:19], v[140:143], a[140:143], v[16:19]
buffer_load_dwordx4 v252, s[4:7], s57 offen lds
v_mfma_f32_16x16x32_bf16 v[20:23], v[140:143], a[172:175], v[20:23]
ds_read_b128 v[172:175], v4 offset:11264
s_waitcnt lgkmcnt(4)
v_mfma_f32_16x16x32_bf16 v[16:19], v[144:147], a[144:147], v[16:19]
buffer_load_dwordx4 v252, s[4:7], s57 offen offset:1024 lds
v_mfma_f32_16x16x32_bf16 v[20:23], v[144:147], a[176:179], v[20:23]
ds_read_b128 v[176:179], v4 offset:12288
v_mfma_f32_16x16x32_bf16 v[16:19], v[148:151], a[148:151], v[16:19]
buffer_load_dwordx4 v252, s[4:7], s57 offen offset:2048 lds
v_mfma_f32_16x16x32_bf16 v[20:23], v[148:151], a[180:183], v[20:23]
ds_read_b128 v[180:183], v4 offset:13312
v_mfma_f32_16x16x32_bf16 v[16:19], v[152:155], a[152:155], v[16:19]
buffer_load_dwordx4 v252, s[4:7], s57 offen offset:3072 lds
v_mfma_f32_16x16x32_bf16 v[20:23], v[152:155], a[184:187], v[20:23]
ds_read_b128 v[184:187], v4 offset:14336
s_add_u32 m0, m0, 4096
v_mfma_f32_16x16x32_bf16 v[16:19], v[156:159], a[156:159], v[16:19]
s_add_u32 s22, s60, 32768
v_mfma_f32_16x16x32_bf16 v[20:23], v[156:159], a[188:191], v[20:23]
ds_read_b128 v[188:191], v4 offset:15360
s_waitcnt lgkmcnt(4)
v_mfma_f32_16x16x32_bf16 v[24:27], v[160:163], a[128:131], v[208:211]
s_sub_u32 s60, s22, 163840
s_cselect_b32 s60, s22, s60
v_mfma_f32_16x16x32_bf16 v[28:31], v[160:163], a[160:163], v[212:215]
ds_read_b128 v[128:131], v4 offset:16384
v_mfma_f32_16x16x32_bf16 v[24:27], v[164:167], a[132:135], v[24:27]
buffer_load_dwordx4 v253, s[4:7], s57 offen lds
v_mfma_f32_16x16x32_bf16 v[28:31], v[164:167], a[164:167], v[28:31]
ds_read_b128 v[132:135], v4 offset:17408
v_mfma_f32_16x16x32_bf16 v[24:27], v[168:171], a[136:139], v[24:27]
buffer_load_dwordx4 v253, s[4:7], s57 offen offset:1024 lds
v_mfma_f32_16x16x32_bf16 v[28:31], v[168:171], a[168:171], v[28:31]
ds_read_b128 v[136:139], v4 offset:18432
v_mfma_f32_16x16x32_bf16 v[24:27], v[172:175], a[140:143], v[24:27]
buffer_load_dwordx4 v253, s[4:7], s57 offen offset:2048 lds
v_mfma_f32_16x16x32_bf16 v[28:31], v[172:175], a[172:175], v[28:31]
ds_read_b128 v[140:143], v4 offset:19456
s_waitcnt lgkmcnt(4)
v_mfma_f32_16x16x32_bf16 v[24:27], v[176:179], a[144:147], v[24:27]
buffer_load_dwordx4 v253, s[4:7], s57 offen offset:3072 lds
v_mfma_f32_16x16x32_bf16 v[28:31], v[176:179], a[176:179], v[28:31]
ds_read_b128 v[144:147], v4 offset:20480
s_add_u32 s59, s59, 1
v_mfma_f32_16x16x32_bf16 v[24:27], v[180:183], a[148:151], v[24:27]
s_add_u32 s57, s57, 32768
v_mfma_f32_16x16x32_bf16 v[28:31], v[180:183], a[180:183], v[28:31]
ds_read_b128 v[148:151], v4 offset:21504
v_mfma_f32_16x16x32_bf16 v[24:27], v[184:187], a[152:155], v[24:27]
s_cmp_eq_u32 s59, s52
s_cselect_b32 s57, s58, s57
v_mfma_f32_16x16x32_bf16 v[28:31], v[184:187], a[184:187], v[28:31]
ds_read_b128 v[152:155], v4 offset:22528
v_mfma_f32_16x16x32_bf16 v[24:27], v[188:191], a[156:159], v[24:27]
s_cmp_ge_u32 s59, s53
s_cselect_b32 s57, 1073741824, s57
v_mfma_f32_16x16x32_bf16 v[28:31], v[188:191], a[188:191], v[28:31]
ds_read_b128 v[156:159], v4 offset:23552
s_waitcnt lgkmcnt(4)
v_mfma_f32_16x16x32_bf16 v[32:35], v[128:131], a[128:131], v[208:211]
s_add_u32 m0, s60, s62
v_mfma_f32_16x16x32_bf16 v[36:39], v[128:131], a[160:163], v[212:215]
ds_read_b128 v[160:163], v4 offset:24576
v_mfma_f32_16x16x32_bf16 v[32:35], v[132:135], a[132:135], v[32:35]
buffer_load_dwordx4 v252, s[4:7], s54 offen lds
v_mfma_f32_16x16x32_bf16 v[36:39], v[132:135], a[164:167], v[36:39]
ds_read_b128 v[164:167], v4 offset:25600
v_mfma_f32_16x16x32_bf16 v[32:35], v[136:139], a[136:139], v[32:35]
buffer_load_dwordx4 v252, s[4:7], s54 offen offset:1024 lds
v_mfma_f32_16x16x32_bf16 v[36:39], v[136:139], a[168:171], v[36:39]
ds_read_b128 v[168:171], v4 offset:26624
v_mfma_f32_16x16x32_bf16 v[32:35], v[140:143], a[140:143], v[32:35]
buffer_load_dwordx4 v252, s[4:7], s54 offen offset:2048 lds
v_mfma_f32_16x16x32_bf16 v[36:39], v[140:143], a[172:175], v[36:39]
ds_read_b128 v[172:175], v4 offset:27648
s_waitcnt lgkmcnt(4)
v_mfma_f32_16x16x32_bf16 v[32:35], v[144:147], a[144:147], v[32:35]
buffer_load_dwordx4 v252, s[4:7], s54 offen offset:3072 lds
v_mfma_f32_16x16x32_bf16 v[36:39], v[144:147], a[176:179], v[36:39]
ds_read_b128 v[176:179], v4 offset:28672
s_add_u32 m0, m0, 4096
v_mfma_f32_16x16x32_bf16 v[32:35], v[148:151], a[148:151], v[32:35]
s_add_u32 s22, s60, 32768
v_mfma_f32_16x16x32_bf16 v[36:39], v[148:151], a[180:183], v[36:39]
ds_read_b128 v[180:183], v4 offset:29696
v_mfma_f32_16x16x32_bf16 v[32:35], v[152:155], a[152:155], v[32:35]
s_sub_u32 s60, s22, 163840
s_cselect_b32 s60, s22, s60
v_mfma_f32_16x16x32_bf16 v[36:39], v[152:155], a[184:187], v[36:39]
ds_read_b128 v[184:187], v4 offset:30720
buffer_load_dwordx4 v253, s[4:7], s54 offen lds
buffer_load_dwordx4 v253, s[4:7], s54 offen offset:1024 lds
buffer_load_dwordx4 v253, s[4:7], s54 offen offset:2048 lds
buffer_load_dwordx4 v253, s[4:7], s54 offen offset:3072 lds
s_add_u32 s56, s56, 1
s_add_u32 s54, s54, 32768
s_cmp_eq_u32 s56, s52
s_cselect_b32 s54, s55, s54
s_cmp_eq_u32 s56, s53
s_cselect_b32 s54, s78, s54
v_mfma_f32_16x16x32_bf16 v[32:35], v[156:159], a[156:159], v[32:35]
v_mfma_f32_16x16x32_bf16 v[36:39], v[156:159], a[188:191], v[36:39]
ds_read_b128 v[188:191], v4 offset:31744
s_waitcnt lgkmcnt(4)
v_mfma_f32_16x16x32_bf16 v[40:43], v[160:163], a[128:131], v[208:211]
v_mfma_f32_16x16x32_bf16 v[44:47], v[160:163], a[160:163], v[212:215]
s_waitcnt vmcnt(16)
s_barrier
ds_read_b128 v[128:131], v5 offset:0
v_mfma_f32_16x16x32_bf16 v[40:43], v[164:167], a[132:135], v[40:43]
v_mfma_f32_16x16x32_bf16 v[44:47], v[164:167], a[164:167], v[44:47]
ds_read_b128 v[132:135], v5 offset:1024
v_mfma_f32_16x16x32_bf16 v[40:43], v[168:171], a[136:139], v[40:43]
v_mfma_f32_16x16x32_bf16 v[44:47], v[168:171], a[168:171], v[44:47]
ds_read_b128 v[136:139], v5 offset:2048
v_mfma_f32_16x16x32_bf16 v[40:43], v[172:175], a[140:143], v[40:43]
v_mfma_f32_16x16x32_bf16 v[44:47], v[172:175], a[172:175], v[44:47]
ds_read_b128 v[140:143], v5 offset:3072
s_waitcnt lgkmcnt(4)
v_mfma_f32_16x16x32_bf16 v[40:43], v[176:179], a[144:147], v[40:43]
v_mfma_f32_16x16x32_bf16 v[44:47], v[176:179], a[176:179], v[44:47]
ds_read_b128 v[144:147], v5 offset:4096
v_mfma_f32_16x16x32_bf16 v[40:43], v[180:183], a[148:151], v[40:43]
v_mfma_f32_16x16x32_bf16 v[44:47], v[180:183], a[180:183], v[44:47]
ds_read_b128 v[148:151], v5 offset:5120
v_mfma_f32_16x16x32_bf16 v[40:43], v[184:187], a[152:155], v[40:43]
v_mfma_f32_16x16x32_bf16 v[44:47], v[184:187], a[184:187], v[44:47]
ds_read_b128 v[152:155], v5 offset:6144
v_mfma_f32_16x16x32_bf16 v[40:43], v[188:191], a[156:159], v[40:43]
v_mfma_f32_16x16x32_bf16 v[44:47], v[188:191], a[188:191], v[44:47]
ds_read_b128 v[156:159], v5 offset:7168
v_mov_b32 v4, v5
s_nop 15
v_max3_f32 v13, v16, v17, v18
v_max3_f32 v13, v13, v19, v24
v_max3_f32 v13, v13, v25, v26
v_max3_f32 v13, v13, v27, v32
v_max3_f32 v13, v13, v33, v34
v_max3_f32 v13, v13, v35, v40
v_max3_f32 v13, v13, v41, v42
v_max_f32 v13, v13, v43
v_mov_b32 v15, v13
s_nop 1
v_permlane32_swap_b32 v15, v13
s_nop 1
v_max_f32 v13, v13, v15
v_mov_b32 v15, v13
s_nop 1
v_permlane16_swap_b32 v15, v13
s_nop 1
v_max_f32 v13, v13, v15
v_max3_f32 v14, v20, v21, v22
v_max3_f32 v14, v14, v23, v28
v_max3_f32 v14, v14, v29, v30
v_max3_f32 v14, v14, v31, v36
v_max3_f32 v14, v14, v37, v38
v_max3_f32 v14, v14, v39, v44
v_max3_f32 v14, v14, v45, v46
v_max_f32 v14, v14, v47
v_mov_b32 v15, v14
s_nop 1
v_permlane32_swap_b32 v15, v14
s_nop 1
v_max_f32 v14, v14, v15
v_mov_b32 v15, v14
s_nop 1
v_permlane16_swap_b32 v15, v14
s_nop 1
v_max_f32 v14, v14, v15
v_add_f32 v192, v192, v13
v_sub_f32 v208, 0, v192
v_sub_f32 v209, 0, v192
v_sub_f32 v210, 0, v192
v_sub_f32 v211, 0, v192
v_add_f32 v193, v193, v14
v_sub_f32 v212, 0, v193
v_sub_f32 v213, 0, v193
v_sub_f32 v214, 0, v193
v_sub_f32 v215, 0, v193
v_sub_f32 v16, v16, v13
v_sub_f32 v17, v17, v13
v_sub_f32 v18, v18, v13
v_sub_f32 v19, v19, v13
v_sub_f32 v20, v20, v14
v_sub_f32 v21, v21, v14
v_sub_f32 v22, v22, v14
v_sub_f32 v23, v23, v14
v_sub_f32 v24, v24, v13
v_sub_f32 v25, v25, v13
v_sub_f32 v26, v26, v13
v_sub_f32 v27, v27, v13
v_sub_f32 v28, v28, v14
v_sub_f32 v29, v29, v14
v_sub_f32 v30, v30, v14
v_sub_f32 v31, v31, v14
v_sub_f32 v32, v32, v13
v_sub_f32 v33, v33, v13
v_sub_f32 v34, v34, v13
v_sub_f32 v35, v35, v13
v_sub_f32 v36, v36, v14
v_sub_f32 v37, v37, v14
v_sub_f32 v38, v38, v14
v_sub_f32 v39, v39, v14
v_sub_f32 v40, v40, v13
v_sub_f32 v41, v41, v13
v_sub_f32 v42, v42, v13
v_sub_f32 v43, v43, v13
v_sub_f32 v44, v44, v14
v_sub_f32 v45, v45, v14
v_sub_f32 v46, v46, v14
v_sub_f32 v47, v47, v14
s_load_dwordx2 s[46:47], s[0:1], 40
s_load_dwordx2 s[48:49], s[0:1], 96
.p2align 3
s_getpc_b64 s[24:25]
F_PC_B:
s_add_u32 s24, s24, F_LOOP-F_PC_B
s_addc_u32 s25, s25, 0
s_mov_b32 s22, s14
s_lshl_b32 s22, s22, 2
s_add_u32 s22, s22, s12
v_and_b32 v236, 7, v0
v_lshlrev_b32 v236, 7, v236
v_add_u32 v236, s22, v236
v_lshlrev_b32 v236, 7, v236
v_min_u32 v236, F_END-F_LOOP-4, v236
s_mov_b64 exec, 0xff
global_load_dword v237, v236, s[24:25]
s_mov_b64 exec, -1
v_exp_f32 v112, v16
v_exp_f32 v113, v17
v_exp_f32 v114, v18
v_exp_f32 v115, v19
v_add_f32 v196, v112, v113
v_cvt_pk_bf16_f32 v80, v112, v113
v_add_f32 v196, v196, v114
v_add_f32 v196, v196, v115
v_cvt_pk_bf16_f32 v81, v114, v115
v_exp_f32 v116, v20
v_exp_f32 v117, v21
v_exp_f32 v118, v22
v_exp_f32 v119, v23
v_add_f32 v197, v116, v117
v_cvt_pk_bf16_f32 v84, v116, v117
v_add_f32 v197, v197, v118
v_add_f32 v197, v197, v119
v_cvt_pk_bf16_f32 v85, v118, v119
v_exp_f32 v112, v24
v_exp_f32 v113, v25
v_exp_f32 v114, v26
v_exp_f32 v115, v27
v_add_f32 v196, v196, v112
v_add_f32 v196, v196, v113
v_cvt_pk_bf16_f32 v82, v112, v113
v_add_f32 v196, v196, v114
v_add_f32 v196, v196, v115
v_cvt_pk_bf16_f32 v83, v114, v115
v_exp_f32 v116, v28
v_exp_f32 v117, v29
v_exp_f32 v118, v30
v_exp_f32 v119, v31
v_add_f32 v197, v197, v116
v_add_f32 v197, v197, v117
v_cvt_pk_bf16_f32 v86, v116, v117
v_add_f32 v197, v197, v118
v_add_f32 v197, v197, v119
v_cvt_pk_bf16_f32 v87, v118, v119
v_and_b32 v244, 63, v0
v_bfe_u32 v245, v244, 1, 3
v_mul_u32_u24 v245, 896, v245
v_lshrrev_b32 v246, 4, v244
v_lshlrev_b32 v246, 5, v246
v_and_b32 v247, 1, v244
v_lshlrev_b32 v247, 4, v247
v_add3_u32 v240, v245, v246, v247
v_add_u32 v241, 6144, v240
v_add_u32 v242, 12288, v240
v_add_u32 v243, 18432, v240
s_lshl_b32 s22, s15, 2
s_add_u32 s22, s22, s12
s_mul_i32 s36, s22, 57344
s_sub_u32 s22, 15, s16
s_cmp_eq_u32 s17, 0
s_cselect_b32 s22, s22, s16
s_lshl_b32 s22, s22, 4
s_add_u32 s22, s22, s15
s_mul_i32 s37, s22, 114688
s_mul_i32 s22, s12, 28672
s_add_u32 s37, s37, s22
s_add_u32 s37, s37, 117440512
s_waitcnt lgkmcnt(0)
s_mov_b32 s28, s46
s_and_b32 s29, s47, 0xffff
s_mov_b32 s30, 3670016
s_mov_b32 s31, 0x20000
s_mov_b32 s32, s48
s_and_b32 s33, s49, 0xffff
s_mov_b32 s34, 3670016
s_mov_b32 s35, 0x20000
s_mov_b32 s63, 1
s_mov_b32 s60, 32768
s_mov_b32 s76, 0
s_mov_b32 s75, 131072
s_lshl_b32 s77, 5, s52
s_or_b32 s77, s77, 98304
s_sub_u32 s22, s52, 1
s_lshl_b32 s80, 3, s22
s_or_b32 s80, s80, 45056
s_bitset1_b32 s80, s72
s_cmp_eq_u32 s52, 1
s_cbranch_scc1 F_QSW_0
F_QSW_RET_0:
F_LOOP:
s_waitcnt lgkmcnt(4)
v_mfma_f32_16x16x32_bf16 v[48:51], v[128:131], a[128:131], v[208:211]
v_exp_f32 v120, v32
v_mfma_f32_16x16x32_bf16 v[52:55], v[128:131], a[160:163], v[212:215]
ds_read_b128 v[160:163], v4 offset:8192
s_add_u32 s23, s60, 32768
v_mfma_f32_16x16x32_bf16 v[48:51], v[132:135], a[132:135], v[48:51]
s_sub_u32 s61, s23, 163840
s_cselect_b32 s61, s23, s61
v_mfma_f32_16x16x32_bf16 v[52:55], v[132:135], a[164:167], v[52:55]
ds_read_b128 v[164:167], v4 offset:9216
v_add_u32 v5, s61, v3
v_mfma_f32_16x16x32_bf16 v[48:51], v[136:139], a[136:139], v[48:51]
v_exp_f32 v121, v33
v_mfma_f32_16x16x32_bf16 v[52:55], v[136:139], a[168:171], v[52:55]
ds_read_b128 v[168:171], v4 offset:10240
s_add_u32 m0, s75, s62
v_mfma_f32_16x16x32_bf16 v[48:51], v[140:143], a[140:143], v[48:51]
buffer_load_dwordx4 v252, s[4:7], s57 offen lds
v_mfma_f32_16x16x32_bf16 v[52:55], v[140:143], a[172:175], v[52:55]
ds_read_b128 v[172:175], v4 offset:11264
s_waitcnt lgkmcnt(4)
v_mfma_f32_16x16x32_bf16 v[48:51], v[144:147], a[144:147], v[48:51]
buffer_load_dwordx4 v252, s[4:7], s57 offen offset:1024 lds
v_mfma_f32_16x16x32_bf16 v[52:55], v[144:147], a[176:179], v[52:55]
ds_read_b128 v[176:179], v4 offset:12288
v_mfma_f32_16x16x32_bf16 v[48:51], v[148:151], a[148:151], v[48:51]
v_exp_f32 v122, v34
v_mfma_f32_16x16x32_bf16 v[52:55], v[148:151], a[180:183], v[52:55]
ds_read_b128 v[180:183], v4 offset:13312
v_mfma_f32_16x16x32_bf16 v[48:51], v[152:155], a[152:155], v[48:51]
buffer_load_dwordx4 v252, s[4:7], s57 offen offset:2048 lds
v_mfma_f32_16x16x32_bf16 v[52:55], v[152:155], a[184:187], v[52:55]
ds_read_b128 v[184:187], v4 offset:14336
v_mfma_f32_16x16x32_bf16 v[48:51], v[156:159], a[156:159], v[48:51]
v_exp_f32 v123, v35
v_mfma_f32_16x16x32_bf16 v[52:55], v[156:159], a[188:191], v[52:55]
ds_read_b128 v[188:191], v4 offset:15360
s_waitcnt lgkmcnt(4)
v_mfma_f32_16x16x32_bf16 v[56:59], v[160:163], a[128:131], v[208:211]
buffer_load_dwordx4 v252, s[4:7], s57 offen offset:3072 lds
v_mfma_f32_16x16x32_bf16 v[60:63], v[160:163], a[160:163], v[212:215]
ds_read_b128 v[128:131], v4 offset:16384
s_add_u32 m0, m0, 4096
v_mfma_f32_16x16x32_bf16 v[56:59], v[164:167], a[132:135], v[56:59]
v_exp_f32 v124, v36
v_mfma_f32_16x16x32_bf16 v[60:63], v[164:167], a[164:167], v[60:63]
ds_read_b128 v[132:135], v4 offset:17408
v_add_f32 v198, v120, v121
v_mfma_f32_16x16x32_bf16 v[56:59], v[168:171], a[136:139], v[56:59]
buffer_load_dwordx4 v253, s[4:7], s57 offen lds
v_mfma_f32_16x16x32_bf16 v[60:63], v[168:171], a[168:171], v[60:63]
ds_read_b128 v[136:139], v4 offset:18432
v_cvt_pk_bf16_f32 v88, v120, v121
v_mfma_f32_16x16x32_bf16 v[56:59], v[172:175], a[140:143], v[56:59]
v_exp_f32 v125, v37
v_mfma_f32_16x16x32_bf16 v[60:63], v[172:175], a[172:175], v[60:63]
ds_read_b128 v[140:143], v4 offset:19456
s_waitcnt lgkmcnt(4)
v_mfma_f32_16x16x32_bf16 v[56:59], v[176:179], a[144:147], v[56:59]
v_exp_f32 v126, v38
v_mfma_f32_16x16x32_bf16 v[60:63], v[176:179], a[176:179], v[60:63]
ds_read_b128 v[144:147], v4 offset:20480
v_add_f32 v198, v198, v122
v_mfma_f32_16x16x32_bf16 v[56:59], v[180:183], a[148:151], v[56:59]
buffer_load_dwordx4 v253, s[4:7], s57 offen offset:1024 lds
v_mfma_f32_16x16x32_bf16 v[60:63], v[180:183], a[180:183], v[60:63]
ds_read_b128 v[148:151], v4 offset:21504
v_add_f32 v198, v198, v123
v_mfma_f32_16x16x32_bf16 v[56:59], v[184:187], a[152:155], v[56:59]
v_exp_f32 v127, v39
v_mfma_f32_16x16x32_bf16 v[60:63], v[184:187], a[184:187], v[60:63]
ds_read_b128 v[152:155], v4 offset:22528
v_cvt_pk_bf16_f32 v89, v122, v123
v_mfma_f32_16x16x32_bf16 v[56:59], v[188:191], a[156:159], v[56:59]
buffer_load_dwordx4 v253, s[4:7], s57 offen offset:2048 lds
v_mfma_f32_16x16x32_bf16 v[60:63], v[188:191], a[188:191], v[60:63]
ds_read_b128 v[156:159], v4 offset:23552
s_waitcnt lgkmcnt(4)
v_mfma_f32_16x16x32_bf16 v[64:67], v[128:131], a[128:131], v[208:211]
v_exp_f32 v120, v40
v_mfma_f32_16x16x32_bf16 v[68:71], v[128:131], a[160:163], v[212:215]
ds_read_b128 v[160:163], v4 offset:24576
v_add_f32 v199, v124, v125
v_mfma_f32_16x16x32_bf16 v[64:67], v[132:135], a[132:135], v[64:67]
buffer_load_dwordx4 v253, s[4:7], s57 offen offset:3072 lds
v_mfma_f32_16x16x32_bf16 v[68:71], v[132:135], a[164:167], v[68:71]
ds_read_b128 v[164:167], v4 offset:25600
s_add_u32 s59, s59, 1
v_mfma_f32_16x16x32_bf16 v[64:67], v[136:139], a[136:139], v[64:67]
v_exp_f32 v121, v41
v_mfma_f32_16x16x32_bf16 v[68:71], v[136:139], a[168:171], v[68:71]
ds_read_b128 v[168:171], v4 offset:26624
s_add_u32 s57, s57, 32768
v_mfma_f32_16x16x32_bf16 v[64:67], v[140:143], a[140:143], v[64:67]
s_cmp_eq_u32 s59, s52
s_cselect_b32 s57, s58, s57
v_mfma_f32_16x16x32_bf16 v[68:71], v[140:143], a[172:175], v[68:71]
ds_read_b128 v[172:175], v4 offset:27648
s_waitcnt lgkmcnt(4)
v_mfma_f32_16x16x32_bf16 v[64:67], v[144:147], a[144:147], v[64:67]
v_exp_f32 v122, v42
v_mfma_f32_16x16x32_bf16 v[68:71], v[144:147], a[176:179], v[68:71]
ds_read_b128 v[176:179], v4 offset:28672
v_cvt_pk_bf16_f32 v92, v124, v125
v_mfma_f32_16x16x32_bf16 v[64:67], v[148:151], a[148:151], v[64:67]
s_cmp_ge_u32 s59, s53
s_cselect_b32 s57, 1073741824, s57
v_mfma_f32_16x16x32_bf16 v[68:71], v[148:151], a[180:183], v[68:71]
ds_read_b128 v[180:183], v4 offset:29696
v_add_f32 v199, v199, v126
v_mfma_f32_16x16x32_bf16 v[64:67], v[152:155], a[152:155], v[64:67]
v_exp_f32 v123, v43
v_mfma_f32_16x16x32_bf16 v[68:71], v[152:155], a[184:187], v[68:71]
ds_read_b128 v[184:187], v4 offset:30720
v_add_f32 v199, v199, v127
v_mfma_f32_16x16x32_bf16 v[64:67], v[156:159], a[156:159], v[64:67]
v_cvt_pk_bf16_f32 v93, v126, v127
v_add_f32 v198, v198, v120
v_mfma_f32_16x16x32_bf16 v[68:71], v[156:159], a[188:191], v[68:71]
ds_read_b128 v[188:191], v4 offset:31744
s_waitcnt lgkmcnt(4)
v_mfma_f32_16x16x32_bf16 v[72:75], v[160:163], a[128:131], v[208:211]
v_exp_f32 v124, v44
v_mfma_f32_16x16x32_bf16 v[76:79], v[160:163], a[160:163], v[212:215]
s_cmp_lg_u32 s67, 0
s_cbranch_scc1 F_W49_A0
s_waitcnt vmcnt(16)
F_WD_A0:
s_barrier
ds_read_b128 v[128:131], v5 offset:0
v_mfma_f32_16x16x32_bf16 v[72:75], v[164:167], a[132:135], v[72:75]
v_exp_f32 v125, v45
v_mfma_f32_16x16x32_bf16 v[76:79], v[164:167], a[164:167], v[76:79]
ds_read_b128 v[132:135], v5 offset:1024
v_add_f32 v198, v198, v121
v_mfma_f32_16x16x32_bf16 v[72:75], v[168:171], a[136:139], v[72:75]
v_exp_f32 v126, v46
v_mfma_f32_16x16x32_bf16 v[76:79], v[168:171], a[168:171], v[76:79]
ds_read_b128 v[136:139], v5 offset:2048
v_cvt_pk_bf16_f32 v90, v120, v121
v_mfma_f32_16x16x32_bf16 v[72:75], v[172:175], a[140:143], v[72:75]
v_exp_f32 v127, v47
v_mfma_f32_16x16x32_bf16 v[76:79], v[172:175], a[172:175], v[76:79]
ds_read_b128 v[140:143], v5 offset:3072
s_waitcnt lgkmcnt(4)
v_mfma_f32_16x16x32_bf16 v[72:75], v[176:179], a[144:147], v[72:75]
v_add_f32 v198, v198, v122
v_add_f32 v198, v198, v123
v_mfma_f32_16x16x32_bf16 v[76:79], v[176:179], a[176:179], v[76:79]
ds_read_b128 v[144:147], v5 offset:4096
v_cvt_pk_bf16_f32 v91, v122, v123
v_mfma_f32_16x16x32_bf16 v[72:75], v[180:183], a[148:151], v[72:75]
v_add_f32 v199, v199, v124
v_add_f32 v199, v199, v125
v_mfma_f32_16x16x32_bf16 v[76:79], v[180:183], a[180:183], v[76:79]
ds_read_b128 v[148:151], v5 offset:5120
v_cvt_pk_bf16_f32 v94, v124, v125
v_mfma_f32_16x16x32_bf16 v[72:75], v[184:187], a[152:155], v[72:75]
v_add_f32 v199, v199, v126
v_add_f32 v199, v199, v127
v_mfma_f32_16x16x32_bf16 v[76:79], v[184:187], a[184:187], v[76:79]
ds_read_b128 v[152:155], v5 offset:6144
v_cvt_pk_bf16_f32 v95, v126, v127
v_mfma_f32_16x16x32_bf16 v[72:75], v[188:191], a[156:159], v[72:75]
v_mfma_f32_16x16x32_bf16 v[76:79], v[188:191], a[188:191], v[76:79]
ds_read_b128 v[156:159], v5 offset:7168
v_add_f32 v196, v196, v198
v_add_f32 v197, v197, v199
v_add_f32 v13, v196, v197
v_cmp_nge_f32 vcc, s68, v13
s_cbranch_vccnz F_RARE_0
F_RARE_RET_0:
v_add_f32 v194, v194, v196
v_add_f32 v195, v195, v197
s_bitcmp1_b32 s77, s63
s_cbranch_scc1 F_EVA_0
F_EVA_RET_0:
s_waitcnt lgkmcnt(4)
v_mfma_f32_16x16x32_bf16 a[0:3], v[128:131], v[80:83], a[0:3]
v_exp_f32 v112, v48
v_mfma_f32_16x16x32_bf16 a[4:7], v[128:131], v[84:87], a[4:7]
ds_read_b128 v[160:163], v5 offset:8192
s_add_u32 s23, s61, 32768
v_mfma_f32_16x16x32_bf16 a[0:3], v[132:135], v[88:91], a[0:3]
s_sub_u32 s75, s23, 163840
s_cselect_b32 s75, s23, s75
v_mfma_f32_16x16x32_bf16 a[4:7], v[132:135], v[92:95], a[4:7]
ds_read_b128 v[164:167], v5 offset:9216
v_add_u32 v4, s75, v3
v_mfma_f32_16x16x32_bf16 a[8:11], v[136:139], v[80:83], a[8:11]
v_exp_f32 v113, v49
v_mfma_f32_16x16x32_bf16 a[12:15], v[136:139], v[84:87], a[12:15]
ds_read_b128 v[168:171], v5 offset:10240
s_add_u32 m0, s76, s62
v_mfma_f32_16x16x32_bf16 a[8:11], v[140:143], v[88:91], a[8:11]
buffer_load_dwordx4 v252, s[4:7], s54 offen lds
v_mfma_f32_16x16x32_bf16 a[12:15], v[140:143], v[92:95], a[12:15]
ds_read_b128 v[172:175], v5 offset:11264
s_waitcnt lgkmcnt(4)
v_mfma_f32_16x16x32_bf16 a[16:19], v[144:147], v[80:83], a[16:19]
buffer_load_dwordx4 v252, s[4:7], s54 offen offset:1024 lds
v_mfma_f32_16x16x32_bf16 a[20:23], v[144:147], v[84:87], a[20:23]
ds_read_b128 v[176:179], v5 offset:12288
v_mfma_f32_16x16x32_bf16 a[16:19], v[148:151], v[88:91], a[16:19]
v_exp_f32 v114, v50
v_mfma_f32_16x16x32_bf16 a[20:23], v[148:151], v[92:95], a[20:23]
ds_read_b128 v[180:183], v5 offset:13312
v_mfma_f32_16x16x32_bf16 a[24:27], v[152:155], v[80:83], a[24:27]
buffer_load_dwordx4 v252, s[4:7], s54 offen offset:2048 lds
v_mfma_f32_16x16x32_bf16 a[28:31], v[152:155], v[84:87], a[28:31]
ds_read_b128 v[184:187], v5 offset:14336
v_mfma_f32_16x16x32_bf16 a[24:27], v[156:159], v[88:91], a[24:27]
v_exp_f32 v115, v51
v_mfma_f32_16x16x32_bf16 a[28:31], v[156:159], v[92:95], a[28:31]
ds_read_b128 v[188:191], v5 offset:15360
s_waitcnt lgkmcnt(4)
v_mfma_f32_16x16x32_bf16 a[32:35], v[160:163], v[80:83], a[32:35]
buffer_load_dwordx4 v252, s[4:7], s54 offen offset:3072 lds
v_mfma_f32_16x16x32_bf16 a[36:39], v[160:163], v[84:87], a[36:39]
ds_read_b128 v[128:131], v5 offset:16384
s_add_u32 m0, m0, 4096
v_mfma_f32_16x16x32_bf16 a[32:35], v[164:167], v[88:91], a[32:35]
v_exp_f32 v116, v52
v_mfma_f32_16x16x32_bf16 a[36:39], v[164:167], v[92:95], a[36:39]
ds_read_b128 v[132:135], v5 offset:17408
v_add_f32 v196, v112, v113
v_mfma_f32_16x16x32_bf16 a[40:43], v[168:171], v[80:83], a[40:43]
buffer_load_dwordx4 v253, s[4:7], s54 offen lds
v_mfma_f32_16x16x32_bf16 a[44:47], v[168:171], v[84:87], a[44:47]
ds_read_b128 v[136:139], v5 offset:18432
v_cvt_pk_bf16_f32 v96, v112, v113
v_mfma_f32_16x16x32_bf16 a[40:43], v[172:175], v[88:91], a[40:43]
v_exp_f32 v117, v53
v_mfma_f32_16x16x32_bf16 a[44:47], v[172:175], v[92:95], a[44:47]
ds_read_b128 v[140:143], v5 offset:19456
s_waitcnt lgkmcnt(4)
v_mfma_f32_16x16x32_bf16 a[48:51], v[176:179], v[80:83], a[48:51]
v_exp_f32 v118, v54
v_mfma_f32_16x16x32_bf16 a[52:55], v[176:179], v[84:87], a[52:55]
ds_read_b128 v[144:147], v5 offset:20480
v_add_f32 v196, v196, v114
v_mfma_f32_16x16x32_bf16 a[48:51], v[180:183], v[88:91], a[48:51]
buffer_load_dwordx4 v253, s[4:7], s54 offen offset:1024 lds
v_mfma_f32_16x16x32_bf16 a[52:55], v[180:183], v[92:95], a[52:55]
ds_read_b128 v[148:151], v5 offset:21504
v_add_f32 v196, v196, v115
v_mfma_f32_16x16x32_bf16 a[56:59], v[184:187], v[80:83], a[56:59]
v_exp_f32 v119, v55
v_mfma_f32_16x16x32_bf16 a[60:63], v[184:187], v[84:87], a[60:63]
ds_read_b128 v[152:155], v5 offset:22528
v_cvt_pk_bf16_f32 v97, v114, v115
v_mfma_f32_16x16x32_bf16 a[56:59], v[188:191], v[88:91], a[56:59]
buffer_load_dwordx4 v253, s[4:7], s54 offen offset:2048 lds
v_mfma_f32_16x16x32_bf16 a[60:63], v[188:191], v[92:95], a[60:63]
ds_read_b128 v[156:159], v5 offset:23552
s_waitcnt lgkmcnt(4)
v_mfma_f32_16x16x32_bf16 a[64:67], v[128:131], v[80:83], a[64:67]
v_exp_f32 v112, v56
v_mfma_f32_16x16x32_bf16 a[68:71], v[128:131], v[84:87], a[68:71]
ds_read_b128 v[160:163], v5 offset:24576
v_add_f32 v197, v116, v117
v_mfma_f32_16x16x32_bf16 a[64:67], v[132:135], v[88:91], a[64:67]
buffer_load_dwordx4 v253, s[4:7], s54 offen offset:3072 lds
v_mfma_f32_16x16x32_bf16 a[68:71], v[132:135], v[92:95], a[68:71]
ds_read_b128 v[164:167], v5 offset:25600
s_add_u32 s56, s56, 1
v_mfma_f32_16x16x32_bf16 a[72:75], v[136:139], v[80:83], a[72:75]
v_exp_f32 v113, v57
v_mfma_f32_16x16x32_bf16 a[76:79], v[136:139], v[84:87], a[76:79]
ds_read_b128 v[168:171], v5 offset:26624
s_add_u32 s54, s54, 32768
v_mfma_f32_16x16x32_bf16 a[72:75], v[140:143], v[88:91], a[72:75]
s_cmp_eq_u32 s56, s52
s_cselect_b32 s54, s55, s54
v_mfma_f32_16x16x32_bf16 a[76:79], v[140:143], v[92:95], a[76:79]
ds_read_b128 v[172:175], v5 offset:27648
s_waitcnt lgkmcnt(4)
v_mfma_f32_16x16x32_bf16 a[80:83], v[144:147], v[80:83], a[80:83]
v_exp_f32 v114, v58
v_mfma_f32_16x16x32_bf16 a[84:87], v[144:147], v[84:87], a[84:87]
ds_read_b128 v[176:179], v5 offset:28672
v_cvt_pk_bf16_f32 v100, v116, v117
v_mfma_f32_16x16x32_bf16 a[80:83], v[148:151], v[88:91], a[80:83]
s_cmp_eq_u32 s56, s53
s_cselect_b32 s54, s78, s54
v_mfma_f32_16x16x32_bf16 a[84:87], v[148:151], v[92:95], a[84:87]
ds_read_b128 v[180:183], v5 offset:29696
v_add_f32 v197, v197, v118
v_mfma_f32_16x16x32_bf16 a[88:91], v[152:155], v[80:83], a[88:91]
v_exp_f32 v115, v59
v_mfma_f32_16x16x32_bf16 a[92:95], v[152:155], v[84:87], a[92:95]
ds_read_b128 v[184:187], v5 offset:30720
v_add_f32 v197, v197, v119
v_mfma_f32_16x16x32_bf16 a[88:91], v[156:159], v[88:91], a[88:91]
v_cvt_pk_bf16_f32 v101, v118, v119
v_add_f32 v196, v196, v112
v_mfma_f32_16x16x32_bf16 a[92:95], v[156:159], v[92:95], a[92:95]
ds_read_b128 v[188:191], v5 offset:31744
s_waitcnt lgkmcnt(4)
v_mfma_f32_16x16x32_bf16 a[96:99], v[160:163], v[80:83], a[96:99]
v_exp_f32 v116, v60
v_mfma_f32_16x16x32_bf16 a[100:103], v[160:163], v[84:87], a[100:103]
s_waitcnt vmcnt(16)
s_barrier
ds_read_b128 v[128:131], v4 offset:0
v_mfma_f32_16x16x32_bf16 a[96:99], v[164:167], v[88:91], a[96:99]
v_exp_f32 v117, v61
v_mfma_f32_16x16x32_bf16 a[100:103], v[164:167], v[92:95], a[100:103]
ds_read_b128 v[132:135], v4 offset:1024
v_add_f32 v196, v196, v113
v_mfma_f32_16x16x32_bf16 a[104:107], v[168:171], v[80:83], a[104:107]
v_exp_f32 v118, v62
v_mfma_f32_16x16x32_bf16 a[108:111], v[168:171], v[84:87], a[108:111]
ds_read_b128 v[136:139], v4 offset:2048
v_cvt_pk_bf16_f32 v98, v112, v113
v_mfma_f32_16x16x32_bf16 a[104:107], v[172:175], v[88:91], a[104:107]
v_exp_f32 v119, v63
v_mfma_f32_16x16x32_bf16 a[108:111], v[172:175], v[92:95], a[108:111]
ds_read_b128 v[140:143], v4 offset:3072
s_waitcnt lgkmcnt(4)
v_mfma_f32_16x16x32_bf16 a[112:115], v[176:179], v[80:83], a[112:115]
v_add_f32 v196, v196, v114
v_add_f32 v196, v196, v115
v_mfma_f32_16x16x32_bf16 a[116:119], v[176:179], v[84:87], a[116:119]
ds_read_b128 v[144:147], v4 offset:4096
v_cvt_pk_bf16_f32 v99, v114, v115
v_mfma_f32_16x16x32_bf16 a[112:115], v[180:183], v[88:91], a[112:115]
v_add_f32 v197, v197, v116
v_add_f32 v197, v197, v117
v_mfma_f32_16x16x32_bf16 a[116:119], v[180:183], v[92:95], a[116:119]
ds_read_b128 v[148:151], v4 offset:5120
v_cvt_pk_bf16_f32 v102, v116, v117
v_mfma_f32_16x16x32_bf16 a[120:123], v[184:187], v[80:83], a[120:123]
v_add_f32 v197, v197, v118
v_add_f32 v197, v197, v119
v_mfma_f32_16x16x32_bf16 a[124:127], v[184:187], v[84:87], a[124:127]
ds_read_b128 v[152:155], v4 offset:6144
v_cvt_pk_bf16_f32 v103, v118, v119
v_mfma_f32_16x16x32_bf16 a[120:123], v[188:191], v[88:91], a[120:123]
v_mfma_f32_16x16x32_bf16 a[124:127], v[188:191], v[92:95], a[124:127]
ds_read_b128 v[156:159], v4 offset:7168
F_HALF_END_0:
s_bitcmp1_b32 s80, s63
s_cbranch_scc1 F_EVB_0
F_EVB_RET_0:
s_add_u32 s63, s63, 1
s_waitcnt lgkmcnt(4)
v_mfma_f32_16x16x32_bf16 v[16:19], v[128:131], a[128:131], v[208:211]
v_exp_f32 v120, v64
v_mfma_f32_16x16x32_bf16 v[20:23], v[128:131], a[160:163], v[212:215]
ds_read_b128 v[160:163], v4 offset:8192
s_add_u32 s23, s75, 32768
v_mfma_f32_16x16x32_bf16 v[16:19], v[132:135], a[132:135], v[16:19]
s_sub_u32 s76, s23, 163840
s_cselect_b32 s76, s23, s76
v_mfma_f32_16x16x32_bf16 v[20:23], v[132:135], a[164:167], v[20:23]
ds_read_b128 v[164:167], v4 offset:9216
v_add_u32 v5, s76, v3
v_mfma_f32_16x16x32_bf16 v[16:19], v[136:139], a[136:139], v[16:19]
v_exp_f32 v121, v65
v_mfma_f32_16x16x32_bf16 v[20:23], v[136:139], a[168:171], v[20:23]
ds_read_b128 v[168:171], v4 offset:10240
s_add_u32 m0, s60, s62
v_mfma_f32_16x16x32_bf16 v[16:19], v[140:143], a[140:143], v[16:19]
buffer_load_dwordx4 v252, s[4:7], s57 offen lds
v_mfma_f32_16x16x32_bf16 v[20:23], v[140:143], a[172:175], v[20:23]
ds_read_b128 v[172:175], v4 offset:11264
s_waitcnt lgkmcnt(4)
v_mfma_f32_16x16x32_bf16 v[16:19], v[144:147], a[144:147], v[16:19]
buffer_load_dwordx4 v252, s[4:7], s57 offen offset:1024 lds
v_mfma_f32_16x16x32_bf16 v[20:23], v[144:147], a[176:179], v[20:23]
ds_read_b128 v[176:179], v4 offset:12288
v_mfma_f32_16x16x32_bf16 v[16:19], v[148:151], a[148:151], v[16:19]
v_exp_f32 v122, v66
v_mfma_f32_16x16x32_bf16 v[20:23], v[148:151], a[180:183], v[20:23]
ds_read_b128 v[180:183], v4 offset:13312
v_mfma_f32_16x16x32_bf16 v[16:19], v[152:155], a[152:155], v[16:19]
buffer_load_dwordx4 v252, s[4:7], s57 offen offset:2048 lds
v_mfma_f32_16x16x32_bf16 v[20:23], v[152:155], a[184:187], v[20:23]
ds_read_b128 v[184:187], v4 offset:14336
v_mfma_f32_16x16x32_bf16 v[16:19], v[156:159], a[156:159], v[16:19]
v_exp_f32 v123, v67
v_mfma_f32_16x16x32_bf16 v[20:23], v[156:159], a[188:191], v[20:23]
ds_read_b128 v[188:191], v4 offset:15360
s_waitcnt lgkmcnt(4)
v_mfma_f32_16x16x32_bf16 v[24:27], v[160:163], a[128:131], v[208:211]
buffer_load_dwordx4 v252, s[4:7], s57 offen offset:3072 lds
v_mfma_f32_16x16x32_bf16 v[28:31], v[160:163], a[160:163], v[212:215]
ds_read_b128 v[128:131], v4 offset:16384
s_add_u32 m0, m0, 4096
v_mfma_f32_16x16x32_bf16 v[24:27], v[164:167], a[132:135], v[24:27]
v_exp_f32 v124, v68
v_mfma_f32_16x16x32_bf16 v[28:31], v[164:167], a[164:167], v[28:31]
ds_read_b128 v[132:135], v4 offset:17408
v_add_f32 v198, v120, v121
v_mfma_f32_16x16x32_bf16 v[24:27], v[168:171], a[136:139], v[24:27]
buffer_load_dwordx4 v253, s[4:7], s57 offen lds
v_mfma_f32_16x16x32_bf16 v[28:31], v[168:171], a[168:171], v[28:31]
ds_read_b128 v[136:139], v4 offset:18432
v_cvt_pk_bf16_f32 v104, v120, v121
v_mfma_f32_16x16x32_bf16 v[24:27], v[172:175], a[140:143], v[24:27]
v_exp_f32 v125, v69
v_mfma_f32_16x16x32_bf16 v[28:31], v[172:175], a[172:175], v[28:31]
ds_read_b128 v[140:143], v4 offset:19456
s_waitcnt lgkmcnt(4)
v_mfma_f32_16x16x32_bf16 v[24:27], v[176:179], a[144:147], v[24:27]
v_exp_f32 v126, v70
v_mfma_f32_16x16x32_bf16 v[28:31], v[176:179], a[176:179], v[28:31]
ds_read_b128 v[144:147], v4 offset:20480
v_add_f32 v198, v198, v122
v_mfma_f32_16x16x32_bf16 v[24:27], v[180:183], a[148:151], v[24:27]
buffer_load_dwordx4 v253, s[4:7], s57 offen offset:1024 lds
v_mfma_f32_16x16x32_bf16 v[28:31], v[180:183], a[180:183], v[28:31]
ds_read_b128 v[148:151], v4 offset:21504
v_add_f32 v198, v198, v123
v_mfma_f32_16x16x32_bf16 v[24:27], v[184:187], a[152:155], v[24:27]
v_exp_f32 v127, v71
v_mfma_f32_16x16x32_bf16 v[28:31], v[184:187], a[184:187], v[28:31]
ds_read_b128 v[152:155], v4 offset:22528
v_cvt_pk_bf16_f32 v105, v122, v123
v_mfma_f32_16x16x32_bf16 v[24:27], v[188:191], a[156:159], v[24:27]
buffer_load_dwordx4 v253, s[4:7], s57 offen offset:2048 lds
v_mfma_f32_16x16x32_bf16 v[28:31], v[188:191], a[188:191], v[28:31]
ds_read_b128 v[156:159], v4 offset:23552
s_waitcnt lgkmcnt(4)
v_mfma_f32_16x16x32_bf16 v[32:35], v[128:131], a[128:131], v[208:211]
v_exp_f32 v120, v72
v_mfma_f32_16x16x32_bf16 v[36:39], v[128:131], a[160:163], v[212:215]
ds_read_b128 v[160:163], v4 offset:24576
v_add_f32 v199, v124, v125
v_mfma_f32_16x16x32_bf16 v[32:35], v[132:135], a[132:135], v[32:35]
buffer_load_dwordx4 v253, s[4:7], s57 offen offset:3072 lds
v_mfma_f32_16x16x32_bf16 v[36:39], v[132:135], a[164:167], v[36:39]
ds_read_b128 v[164:167], v4 offset:25600
s_add_u32 s59, s59, 1
v_mfma_f32_16x16x32_bf16 v[32:35], v[136:139], a[136:139], v[32:35]
v_exp_f32 v121, v73
v_mfma_f32_16x16x32_bf16 v[36:39], v[136:139], a[168:171], v[36:39]
ds_read_b128 v[168:171], v4 offset:26624
s_add_u32 s57, s57, 32768
v_mfma_f32_16x16x32_bf16 v[32:35], v[140:143], a[140:143], v[32:35]
s_cmp_eq_u32 s59, s52
s_cselect_b32 s57, s58, s57
v_mfma_f32_16x16x32_bf16 v[36:39], v[140:143], a[172:175], v[36:39]
ds_read_b128 v[172:175], v4 offset:27648
s_waitcnt lgkmcnt(4)
v_mfma_f32_16x16x32_bf16 v[32:35], v[144:147], a[144:147], v[32:35]
v_exp_f32 v122, v74
v_mfma_f32_16x16x32_bf16 v[36:39], v[144:147], a[176:179], v[36:39]
ds_read_b128 v[176:179], v4 offset:28672
v_cvt_pk_bf16_f32 v108, v124, v125
v_mfma_f32_16x16x32_bf16 v[32:35], v[148:151], a[148:151], v[32:35]
s_cmp_ge_u32 s59, s53
s_cselect_b32 s57, 1073741824, s57
v_mfma_f32_16x16x32_bf16 v[36:39], v[148:151], a[180:183], v[36:39]
ds_read_b128 v[180:183], v4 offset:29696
v_add_f32 v199, v199, v126
v_mfma_f32_16x16x32_bf16 v[32:35], v[152:155], a[152:155], v[32:35]
v_exp_f32 v123, v75
v_mfma_f32_16x16x32_bf16 v[36:39], v[152:155], a[184:187], v[36:39]
ds_read_b128 v[184:187], v4 offset:30720
v_add_f32 v199, v199, v127
v_mfma_f32_16x16x32_bf16 v[32:35], v[156:159], a[156:159], v[32:35]
v_cvt_pk_bf16_f32 v109, v126, v127
v_add_f32 v198, v198, v120
v_mfma_f32_16x16x32_bf16 v[36:39], v[156:159], a[188:191], v[36:39]
ds_read_b128 v[188:191], v4 offset:31744
s_waitcnt lgkmcnt(4)
v_mfma_f32_16x16x32_bf16 v[40:43], v[160:163], a[128:131], v[208:211]
v_exp_f32 v124, v76
v_mfma_f32_16x16x32_bf16 v[44:47], v[160:163], a[160:163], v[212:215]
s_waitcnt vmcnt(16)
s_barrier
ds_read_b128 v[128:131], v5 offset:0
v_mfma_f32_16x16x32_bf16 v[40:43], v[164:167], a[132:135], v[40:43]
v_exp_f32 v125, v77
v_mfma_f32_16x16x32_bf16 v[44:47], v[164:167], a[164:167], v[44:47]
ds_read_b128 v[132:135], v5 offset:1024
v_add_f32 v198, v198, v121
v_mfma_f32_16x16x32_bf16 v[40:43], v[168:171], a[136:139], v[40:43]
v_exp_f32 v126, v78
v_mfma_f32_16x16x32_bf16 v[44:47], v[168:171], a[168:171], v[44:47]
ds_read_b128 v[136:139], v5 offset:2048
v_cvt_pk_bf16_f32 v106, v120, v121
v_mfma_f32_16x16x32_bf16 v[40:43], v[172:175], a[140:143], v[40:43]
v_exp_f32 v127, v79
v_mfma_f32_16x16x32_bf16 v[44:47], v[172:175], a[172:175], v[44:47]
ds_read_b128 v[140:143], v5 offset:3072
s_waitcnt lgkmcnt(4)
v_mfma_f32_16x16x32_bf16 v[40:43], v[176:179], a[144:147], v[40:43]
v_add_f32 v198, v198, v122
v_add_f32 v198, v198, v123
v_mfma_f32_16x16x32_bf16 v[44:47], v[176:179], a[176:179], v[44:47]
ds_read_b128 v[144:147], v5 offset:4096
v_cvt_pk_bf16_f32 v107, v122, v123
v_mfma_f32_16x16x32_bf16 v[40:43], v[180:183], a[148:151], v[40:43]
v_add_f32 v199, v199, v124
v_add_f32 v199, v199, v125
v_mfma_f32_16x16x32_bf16 v[44:47], v[180:183], a[180:183], v[44:47]
ds_read_b128 v[148:151], v5 offset:5120
v_cvt_pk_bf16_f32 v110, v124, v125
v_mfma_f32_16x16x32_bf16 v[40:43], v[184:187], a[152:155], v[40:43]
v_add_f32 v199, v199, v126
v_add_f32 v199, v199, v127
v_mfma_f32_16x16x32_bf16 v[44:47], v[184:187], a[184:187], v[44:47]
ds_read_b128 v[152:155], v5 offset:6144
v_cvt_pk_bf16_f32 v111, v126, v127
v_mfma_f32_16x16x32_bf16 v[40:43], v[188:191], a[156:159], v[40:43]
v_mfma_f32_16x16x32_bf16 v[44:47], v[188:191], a[188:191], v[44:47]
ds_read_b128 v[156:159], v5 offset:7168
v_add_f32 v196, v196, v198
v_add_f32 v197, v197, v199
v_add_f32 v13, v196, v197
v_cmp_nge_f32 vcc, s68, v13
s_cbranch_vccnz F_RARE_1
F_RARE_RET_1:
v_add_f32 v194, v194, v196
v_add_f32 v195, v195, v197
s_bitcmp1_b32 s77, s63
s_cbranch_scc1 F_EVA_1
F_EVA_RET_1:
s_waitcnt lgkmcnt(4)
v_mfma_f32_16x16x32_bf16 a[0:3], v[128:131], v[96:99], a[0:3]
v_exp_f32 v112, v16
v_mfma_f32_16x16x32_bf16 a[4:7], v[128:131], v[100:103], a[4:7]
ds_read_b128 v[160:163], v5 offset:8192
s_add_u32 s23, s76, 32768
v_mfma_f32_16x16x32_bf16 a[0:3], v[132:135], v[104:107], a[0:3]
s_sub_u32 s60, s23, 163840
s_cselect_b32 s60, s23, s60
v_mfma_f32_16x16x32_bf16 a[4:7], v[132:135], v[108:111], a[4:7]
ds_read_b128 v[164:167], v5 offset:9216
v_add_u32 v4, s60, v3
v_mfma_f32_16x16x32_bf16 a[8:11], v[136:139], v[96:99], a[8:11]
v_exp_f32 v113, v17
v_mfma_f32_16x16x32_bf16 a[12:15], v[136:139], v[100:103], a[12:15]
ds_read_b128 v[168:171], v5 offset:10240
s_add_u32 m0, s61, s62
v_mfma_f32_16x16x32_bf16 a[8:11], v[140:143], v[104:107], a[8:11]
buffer_load_dwordx4 v252, s[4:7], s54 offen lds
v_mfma_f32_16x16x32_bf16 a[12:15], v[140:143], v[108:111], a[12:15]
ds_read_b128 v[172:175], v5 offset:11264
s_waitcnt lgkmcnt(4)
v_mfma_f32_16x16x32_bf16 a[16:19], v[144:147], v[96:99], a[16:19]
buffer_load_dwordx4 v252, s[4:7], s54 offen offset:1024 lds
v_mfma_f32_16x16x32_bf16 a[20:23], v[144:147], v[100:103], a[20:23]
ds_read_b128 v[176:179], v5 offset:12288
v_mfma_f32_16x16x32_bf16 a[16:19], v[148:151], v[104:107], a[16:19]
v_exp_f32 v114, v18
v_mfma_f32_16x16x32_bf16 a[20:23], v[148:151], v[108:111], a[20:23]
ds_read_b128 v[180:183], v5 offset:13312
v_mfma_f32_16x16x32_bf16 a[24:27], v[152:155], v[96:99], a[24:27]
buffer_load_dwordx4 v252, s[4:7], s54 offen offset:2048 lds
v_mfma_f32_16x16x32_bf16 a[28:31], v[152:155], v[100:103], a[28:31]
ds_read_b128 v[184:187], v5 offset:14336
v_mfma_f32_16x16x32_bf16 a[24:27], v[156:159], v[104:107], a[24:27]
v_exp_f32 v115, v19
v_mfma_f32_16x16x32_bf16 a[28:31], v[156:159], v[108:111], a[28:31]
ds_read_b128 v[188:191], v5 offset:15360
s_waitcnt lgkmcnt(4)
v_mfma_f32_16x16x32_bf16 a[32:35], v[160:163], v[96:99], a[32:35]
buffer_load_dwordx4 v252, s[4:7], s54 offen offset:3072 lds
v_mfma_f32_16x16x32_bf16 a[36:39], v[160:163], v[100:103], a[36:39]
ds_read_b128 v[128:131], v5 offset:16384
s_add_u32 m0, m0, 4096
v_mfma_f32_16x16x32_bf16 a[32:35], v[164:167], v[104:107], a[32:35]
v_exp_f32 v116, v20
v_mfma_f32_16x16x32_bf16 a[36:39], v[164:167], v[108:111], a[36:39]
ds_read_b128 v[132:135], v5 offset:17408
v_add_f32 v196, v112, v113
v_mfma_f32_16x16x32_bf16 a[40:43], v[168:171], v[96:99], a[40:43]
buffer_load_dwordx4 v253, s[4:7], s54 offen lds
v_mfma_f32_16x16x32_bf16 a[44:47], v[168:171], v[100:103], a[44:47]
ds_read_b128 v[136:139], v5 offset:18432
v_cvt_pk_bf16_f32 v80, v112, v113
v_mfma_f32_16x16x32_bf16 a[40:43], v[172:175], v[104:107], a[40:43]
v_exp_f32 v117, v21
v_mfma_f32_16x16x32_bf16 a[44:47], v[172:175], v[108:111], a[44:47]
ds_read_b128 v[140:143], v5 offset:19456
s_waitcnt lgkmcnt(4)
v_mfma_f32_16x16x32_bf16 a[48:51], v[176:179], v[96:99], a[48:51]
v_exp_f32 v118, v22
v_mfma_f32_16x16x32_bf16 a[52:55], v[176:179], v[100:103], a[52:55]
ds_read_b128 v[144:147], v5 offset:20480
v_add_f32 v196, v196, v114
v_mfma_f32_16x16x32_bf16 a[48:51], v[180:183], v[104:107], a[48:51]
buffer_load_dwordx4 v253, s[4:7], s54 offen offset:1024 lds
v_mfma_f32_16x16x32_bf16 a[52:55], v[180:183], v[108:111], a[52:55]
ds_read_b128 v[148:151], v5 offset:21504
v_add_f32 v196, v196, v115
v_mfma_f32_16x16x32_bf16 a[56:59], v[184:187], v[96:99], a[56:59]
v_exp_f32 v119, v23
v_mfma_f32_16x16x32_bf16 a[60:63], v[184:187], v[100:103], a[60:63]
ds_read_b128 v[152:155], v5 offset:22528
v_cvt_pk_bf16_f32 v81, v114, v115
v_mfma_f32_16x16x32_bf16 a[56:59], v[188:191], v[104:107], a[56:59]
buffer_load_dwordx4 v253, s[4:7], s54 offen offset:2048 lds
v_mfma_f32_16x16x32_bf16 a[60:63], v[188:191], v[108:111], a[60:63]
ds_read_b128 v[156:159], v5 offset:23552
s_waitcnt lgkmcnt(4)
v_mfma_f32_16x16x32_bf16 a[64:67], v[128:131], v[96:99], a[64:67]
v_exp_f32 v112, v24
v_mfma_f32_16x16x32_bf16 a[68:71], v[128:131], v[100:103], a[68:71]
ds_read_b128 v[160:163], v5 offset:24576
v_add_f32 v197, v116, v117
v_mfma_f32_16x16x32_bf16 a[64:67], v[132:135], v[104:107], a[64:67]
buffer_load_dwordx4 v253, s[4:7], s54 offen offset:3072 lds
v_mfma_f32_16x16x32_bf16 a[68:71], v[132:135], v[108:111], a[68:71]
ds_read_b128 v[164:167], v5 offset:25600
s_add_u32 s56, s56, 1
v_mfma_f32_16x16x32_bf16 a[72:75], v[136:139], v[96:99], a[72:75]
v_exp_f32 v113, v25
v_mfma_f32_16x16x32_bf16 a[76:79], v[136:139], v[100:103], a[76:79]
ds_read_b128 v[168:171], v5 offset:26624
s_add_u32 s54, s54, 32768
v_mfma_f32_16x16x32_bf16 a[72:75], v[140:143], v[104:107], a[72:75]
s_cmp_eq_u32 s56, s52
s_cselect_b32 s54, s55, s54
v_mfma_f32_16x16x32_bf16 a[76:79], v[140:143], v[108:111], a[76:79]
ds_read_b128 v[172:175], v5 offset:27648
s_waitcnt lgkmcnt(4)
v_mfma_f32_16x16x32_bf16 a[80:83], v[144:147], v[96:99], a[80:83]
v_exp_f32 v114, v26
v_mfma_f32_16x16x32_bf16 a[84:87], v[144:147], v[100:103], a[84:87]
ds_read_b128 v[176:179], v5 offset:28672
v_cvt_pk_bf16_f32 v84, v116, v117
v_mfma_f32_16x16x32_bf16 a[80:83], v[148:151], v[104:107], a[80:83]
s_cmp_eq_u32 s56, s53
s_cselect_b32 s54, s78, s54
v_mfma_f32_16x16x32_bf16 a[84:87], v[148:151], v[108:111], a[84:87]
ds_read_b128 v[180:183], v5 offset:29696
v_add_f32 v197, v197, v118
v_mfma_f32_16x16x32_bf16 a[88:91], v[152:155], v[96:99], a[88:91]
v_exp_f32 v115, v27
v_mfma_f32_16x16x32_bf16 a[92:95], v[152:155], v[100:103], a[92:95]
ds_read_b128 v[184:187], v5 offset:30720
v_add_f32 v197, v197, v119
v_mfma_f32_16x16x32_bf16 a[88:91], v[156:159], v[104:107], a[88:91]
v_cvt_pk_bf16_f32 v85, v118, v119
v_add_f32 v196, v196, v112
v_mfma_f32_16x16x32_bf16 a[92:95], v[156:159], v[108:111], a[92:95]
ds_read_b128 v[188:191], v5 offset:31744
s_waitcnt lgkmcnt(4)
v_mfma_f32_16x16x32_bf16 a[96:99], v[160:163], v[96:99], a[96:99]
v_exp_f32 v116, v28
v_mfma_f32_16x16x32_bf16 a[100:103], v[160:163], v[100:103], a[100:103]
s_waitcnt vmcnt(16)
s_barrier
ds_read_b128 v[128:131], v4 offset:0
v_mfma_f32_16x16x32_bf16 a[96:99], v[164:167], v[104:107], a[96:99]
v_exp_f32 v117, v29
v_mfma_f32_16x16x32_bf16 a[100:103], v[164:167], v[108:111], a[100:103]
ds_read_b128 v[132:135], v4 offset:1024
v_add_f32 v196, v196, v113
v_mfma_f32_16x16x32_bf16 a[104:107], v[168:171], v[96:99], a[104:107]
v_exp_f32 v118, v30
v_mfma_f32_16x16x32_bf16 a[108:111], v[168:171], v[100:103], a[108:111]
ds_read_b128 v[136:139], v4 offset:2048
v_cvt_pk_bf16_f32 v82, v112, v113
v_mfma_f32_16x16x32_bf16 a[104:107], v[172:175], v[104:107], a[104:107]
v_exp_f32 v119, v31
v_mfma_f32_16x16x32_bf16 a[108:111], v[172:175], v[108:111], a[108:111]
ds_read_b128 v[140:143], v4 offset:3072
s_waitcnt lgkmcnt(4)
v_mfma_f32_16x16x32_bf16 a[112:115], v[176:179], v[96:99], a[112:115]
v_add_f32 v196, v196, v114
v_add_f32 v196, v196, v115
v_mfma_f32_16x16x32_bf16 a[116:119], v[176:179], v[100:103], a[116:119]
ds_read_b128 v[144:147], v4 offset:4096
v_cvt_pk_bf16_f32 v83, v114, v115
v_mfma_f32_16x16x32_bf16 a[112:115], v[180:183], v[104:107], a[112:115]
v_add_f32 v197, v197, v116
v_add_f32 v197, v197, v117
v_mfma_f32_16x16x32_bf16 a[116:119], v[180:183], v[108:111], a[116:119]
ds_read_b128 v[148:151], v4 offset:5120
v_cvt_pk_bf16_f32 v86, v116, v117
v_mfma_f32_16x16x32_bf16 a[120:123], v[184:187], v[96:99], a[120:123]
v_add_f32 v197, v197, v118
v_add_f32 v197, v197, v119
v_mfma_f32_16x16x32_bf16 a[124:127], v[184:187], v[100:103], a[124:127]
ds_read_b128 v[152:155], v4 offset:6144
v_cvt_pk_bf16_f32 v87, v118, v119
v_mfma_f32_16x16x32_bf16 a[120:123], v[188:191], v[104:107], a[120:123]
v_mfma_f32_16x16x32_bf16 a[124:127], v[188:191], v[108:111], a[124:127]
ds_read_b128 v[156:159], v4 offset:7168
F_HALF_END_1:
s_bitcmp1_b32 s80, s63
s_cbranch_scc1 F_EVB_1
F_EVB_RET_1:
s_add_u32 s63, s63, 1
s_cmp_lt_u32 s63, 17
s_cbranch_scc1 F_LOOP
F_TAILC:
s_waitcnt vmcnt(0) lgkmcnt(0)
s_barrier
s_cmp_eq_u32 s52, 15
s_cbranch_scc1 F_PUB_2
F_PUB_RET_2:
v_add_u32 v4, 131072, v3
ds_read_b128 v[128:131], v4 offset:0
ds_read_b128 v[132:135], v4 offset:1024
ds_read_b128 v[136:139], v4 offset:2048
ds_read_b128 v[140:143], v4 offset:3072
ds_read_b128 v[144:147], v4 offset:4096
ds_read_b128 v[148:151], v4 offset:5120
ds_read_b128 v[152:155], v4 offset:6144
ds_read_b128 v[156:159], v4 offset:7168
s_cmp_lg_u32 s17, 0
s_cbranch_scc1 F_NOPRE
s_cmp_eq_u32 s19, 0
s_cbranch_scc1 F_NOPRE
s_cmp_lg_u32 s74, 0
s_cbranch_scc1 F_PRE2
v_cmp_ne_u32 vcc, 1, v248
s_cbranch_vccnz F_NOPRE
s_add_u32 m0, s62, 98304
s_add_u32 s22, s65, 0
buffer_load_dwordx4 v252, s[4:7], s22 offen lds
buffer_load_dwordx4 v252, s[4:7], s22 offen offset:1024 lds
buffer_load_dwordx4 v252, s[4:7], s22 offen offset:2048 lds
buffer_load_dwordx4 v252, s[4:7], s22 offen offset:3072 lds
s_add_u32 m0, m0, 4096
s_nop 0
buffer_load_dwordx4 v253, s[4:7], s22 offen lds
buffer_load_dwordx4 v253, s[4:7], s22 offen offset:1024 lds
buffer_load_dwordx4 v253, s[4:7], s22 offen offset:2048 lds
buffer_load_dwordx4 v253, s[4:7], s22 offen offset:3072 lds
s_add_u32 m0, s62, 0
s_add_u32 s22, s65, 32768
buffer_load_dwordx4 v252, s[4:7], s22 offen lds
buffer_load_dwordx4 v252, s[4:7], s22 offen offset:1024 lds
buffer_load_dwordx4 v252, s[4:7], s22 offen offset:2048 lds
buffer_load_dwordx4 v252, s[4:7], s22 offen offset:3072 lds
s_add_u32 m0, m0, 4096
s_nop 0
buffer_load_dwordx4 v253, s[4:7], s22 offen lds
buffer_load_dwordx4 v253, s[4:7], s22 offen offset:1024 lds
buffer_load_dwordx4 v253, s[4:7], s22 offen offset:2048 lds
buffer_load_dwordx4 v253, s[4:7], s22 offen offset:3072 lds
F_PRE2:
s_lshl_b32 s23, s12, 10
s_add_u32 s23, s23, s65
s_add_u32 s23, s23, 131072
buffer_load_dwordx4 v[220:223], v3, s[4:7], s23 offen
s_add_u32 m0, s62, 32768
s_add_u32 s22, s65, 65536
buffer_load_dwordx4 v252, s[4:7], s22 offen lds
buffer_load_dwordx4 v252, s[4:7], s22 offen offset:1024 lds
buffer_load_dwordx4 v252, s[4:7], s22 offen offset:2048 lds
buffer_load_dwordx4 v252, s[4:7], s22 offen offset:3072 lds
s_add_u32 m0, m0, 4096
s_nop 0
buffer_load_dwordx4 v253, s[4:7], s22 offen lds
buffer_load_dwordx4 v253, s[4:7], s22 offen offset:1024 lds
buffer_load_dwordx4 v253, s[4:7], s22 offen offset:2048 lds
buffer_load_dwordx4 v253, s[4:7], s22 offen offset:3072 lds
s_add_u32 m0, s62, 65536
s_add_u32 s22, s65, 98304
buffer_load_dwordx4 v252, s[4:7], s22 offen lds
buffer_load_dwordx4 v252, s[4:7], s22 offen offset:1024 lds
buffer_load_dwordx4 v252, s[4:7], s22 offen offset:2048 lds
buffer_load_dwordx4 v252, s[4:7], s22 offen offset:3072 lds
s_add_u32 m0, m0, 4096
s_nop 0
buffer_load_dwordx4 v253, s[4:7], s22 offen lds
buffer_load_dwordx4 v253, s[4:7], s22 offen offset:1024 lds
buffer_load_dwordx4 v253, s[4:7], s22 offen offset:2048 lds
buffer_load_dwordx4 v253, s[4:7], s22 offen offset:3072 lds
s_mov_b32 s74, 2
F_NOPRE:
v_exp_f32 v120, v32
v_exp_f32 v121, v33
v_exp_f32 v122, v34
v_exp_f32 v123, v35
v_add_f32 v198, v120, v121
v_cvt_pk_bf16_f32 v88, v120, v121
v_add_f32 v198, v198, v122
v_add_f32 v198, v198, v123
v_cvt_pk_bf16_f32 v89, v122, v123
v_exp_f32 v124, v36
v_exp_f32 v125, v37
v_exp_f32 v126, v38
v_exp_f32 v127, v39
v_add_f32 v199, v124, v125
v_cvt_pk_bf16_f32 v92, v124, v125
v_add_f32 v199, v199, v126
v_add_f32 v199, v199, v127
v_cvt_pk_bf16_f32 v93, v126, v127
v_exp_f32 v120, v40
v_exp_f32 v121, v41
v_exp_f32 v122, v42
v_exp_f32 v123, v43
v_add_f32 v198, v198, v120
v_add_f32 v198, v198, v121
v_cvt_pk_bf16_f32 v90, v120, v121
v_add_f32 v198, v198, v122
v_add_f32 v198, v198, v123
v_cvt_pk_bf16_f32 v91, v122, v123
v_exp_f32 v124, v44
v_exp_f32 v125, v45
v_exp_f32 v126, v46
v_exp_f32 v127, v47
v_add_f32 v199, v199, v124
v_add_f32 v199, v199, v125
v_cvt_pk_bf16_f32 v94, v124, v125
v_add_f32 v199, v199, v126
v_add_f32 v199, v199, v127
v_cvt_pk_bf16_f32 v95, v126, v127
v_add_f32 v196, v196, v198
v_add_f32 v197, v197, v199
v_add_f32 v13, v196, v197
v_cmp_nge_f32 vcc, s68, v13
s_cbranch_vccnz F_RARE_2
F_RARE_RET_2:
v_add_f32 v194, v194, v196
v_add_f32 v195, v195, v197
s_cmp_lg_u32 s17, 0
s_cbranch_scc1 F_EPI_B
s_waitcnt lgkmcnt(4)
v_mfma_f32_16x16x32_bf16 a[0:3], v[128:131], v[80:83], a[0:3]
ds_read_b128 v[160:163], v4 offset:8192
v_mfma_f32_16x16x32_bf16 a[4:7], v[128:131], v[84:87], a[4:7]
v_mfma_f32_16x16x32_bf16 a[0:3], v[132:135], v[88:91], a[0:3]
ds_read_b128 v[164:167], v4 offset:9216
v_mfma_f32_16x16x32_bf16 a[4:7], v[132:135], v[92:95], a[4:7]
v_mfma_f32_16x16x32_bf16 a[8:11], v[136:139], v[80:83], a[8:11]
ds_read_b128 v[168:171], v4 offset:10240
v_mfma_f32_16x16x32_bf16 a[12:15], v[136:139], v[84:87], a[12:15]
v_mfma_f32_16x16x32_bf16 a[8:11], v[140:143], v[88:91], a[8:11]
ds_read_b128 v[172:175], v4 offset:11264
v_mfma_f32_16x16x32_bf16 a[12:15], v[140:143], v[92:95], a[12:15]
s_waitcnt lgkmcnt(4)
v_mfma_f32_16x16x32_bf16 a[16:19], v[144:147], v[80:83], a[16:19]
ds_read_b128 v[176:179], v4 offset:12288
v_mfma_f32_16x16x32_bf16 a[20:23], v[144:147], v[84:87], a[20:23]
v_mfma_f32_16x16x32_bf16 a[16:19], v[148:151], v[88:91], a[16:19]
ds_read_b128 v[180:183], v4 offset:13312
v_mfma_f32_16x16x32_bf16 a[20:23], v[148:151], v[92:95], a[20:23]
v_mfma_f32_16x16x32_bf16 a[24:27], v[152:155], v[80:83], a[24:27]
ds_read_b128 v[184:187], v4 offset:14336
v_mfma_f32_16x16x32_bf16 a[28:31], v[152:155], v[84:87], a[28:31]
v_mfma_f32_16x16x32_bf16 a[24:27], v[156:159], v[88:91], a[24:27]
ds_read_b128 v[188:191], v4 offset:15360
v_mfma_f32_16x16x32_bf16 a[28:31], v[156:159], v[92:95], a[28:31]
s_waitcnt lgkmcnt(4)
v_mfma_f32_16x16x32_bf16 a[32:35], v[160:163], v[80:83], a[32:35]
ds_read_b128 v[128:131], v4 offset:16384
v_mfma_f32_16x16x32_bf16 a[36:39], v[160:163], v[84:87], a[36:39]
v_mfma_f32_16x16x32_bf16 a[32:35], v[164:167], v[88:91], a[32:35]
ds_read_b128 v[132:135], v4 offset:17408
v_mfma_f32_16x16x32_bf16 a[36:39], v[164:167], v[92:95], a[36:39]
v_mfma_f32_16x16x32_bf16 a[40:43], v[168:171], v[80:83], a[40:43]
ds_read_b128 v[136:139], v4 offset:18432
v_mfma_f32_16x16x32_bf16 a[44:47], v[168:171], v[84:87], a[44:47]
v_mfma_f32_16x16x32_bf16 a[40:43], v[172:175], v[88:91], a[40:43]
ds_read_b128 v[140:143], v4 offset:19456
v_mfma_f32_16x16x32_bf16 a[44:47], v[172:175], v[92:95], a[44:47]
s_waitcnt lgkmcnt(4)
v_mfma_f32_16x16x32_bf16 a[48:51], v[176:179], v[80:83], a[48:51]
ds_read_b128 v[144:147], v4 offset:20480
v_mfma_f32_16x16x32_bf16 a[52:55], v[176:179], v[84:87], a[52:55]
v_mfma_f32_16x16x32_bf16 a[48:51], v[180:183], v[88:91], a[48:51]
ds_read_b128 v[148:151], v4 offset:21504
v_mfma_f32_16x16x32_bf16 a[52:55], v[180:183], v[92:95], a[52:55]
v_mfma_f32_16x16x32_bf16 a[56:59], v[184:187], v[80:83], a[56:59]
ds_read_b128 v[152:155], v4 offset:22528
v_mfma_f32_16x16x32_bf16 a[60:63], v[184:187], v[84:87], a[60:63]
v_mfma_f32_16x16x32_bf16 a[56:59], v[188:191], v[88:91], a[56:59]
ds_read_b128 v[156:159], v4 offset:23552
v_mfma_f32_16x16x32_bf16 a[60:63], v[188:191], v[92:95], a[60:63]
s_waitcnt lgkmcnt(4)
v_mfma_f32_16x16x32_bf16 a[64:67], v[128:131], v[80:83], a[64:67]
ds_read_b128 v[160:163], v4 offset:24576
v_mfma_f32_16x16x32_bf16 a[68:71], v[128:131], v[84:87], a[68:71]
v_mfma_f32_16x16x32_bf16 a[64:67], v[132:135], v[88:91], a[64:67]
ds_read_b128 v[164:167], v4 offset:25600
v_mfma_f32_16x16x32_bf16 a[68:71], v[132:135], v[92:95], a[68:71]
v_mfma_f32_16x16x32_bf16 a[72:75], v[136:139], v[80:83], a[72:75]
ds_read_b128 v[168:171], v4 offset:26624
v_mfma_f32_16x16x32_bf16 a[76:79], v[136:139], v[84:87], a[76:79]
v_mfma_f32_16x16x32_bf16 a[72:75], v[140:143], v[88:91], a[72:75]
ds_read_b128 v[172:175], v4 offset:27648
v_mfma_f32_16x16x32_bf16 a[76:79], v[140:143], v[92:95], a[76:79]
s_waitcnt lgkmcnt(4)
v_mfma_f32_16x16x32_bf16 a[80:83], v[144:147], v[80:83], a[80:83]
ds_read_b128 v[176:179], v4 offset:28672
v_mfma_f32_16x16x32_bf16 a[84:87], v[144:147], v[84:87], a[84:87]
v_mfma_f32_16x16x32_bf16 a[80:83], v[148:151], v[88:91], a[80:83]
ds_read_b128 v[180:183], v4 offset:29696
v_mfma_f32_16x16x32_bf16 a[84:87], v[148:151], v[92:95], a[84:87]
v_mfma_f32_16x16x32_bf16 a[88:91], v[152:155], v[80:83], a[88:91]
ds_read_b128 v[184:187], v4 offset:30720
v_mfma_f32_16x16x32_bf16 a[92:95], v[152:155], v[84:87], a[92:95]
v_mfma_f32_16x16x32_bf16 a[88:91], v[156:159], v[88:91], a[88:91]
ds_read_b128 v[188:191], v4 offset:31744
v_mfma_f32_16x16x32_bf16 a[92:95], v[156:159], v[92:95], a[92:95]
s_waitcnt lgkmcnt(4)
v_mfma_f32_16x16x32_bf16 a[96:99], v[160:163], v[80:83], a[96:99]
v_mfma_f32_16x16x32_bf16 a[100:103], v[160:163], v[84:87], a[100:103]
v_mfma_f32_16x16x32_bf16 a[96:99], v[164:167], v[88:91], a[96:99]
v_mfma_f32_16x16x32_bf16 a[100:103], v[164:167], v[92:95], a[100:103]
v_mfma_f32_16x16x32_bf16 a[104:107], v[168:171], v[80:83], a[104:107]
v_mfma_f32_16x16x32_bf16 a[108:111], v[168:171], v[84:87], a[108:111]
v_mfma_f32_16x16x32_bf16 a[104:107], v[172:175], v[88:91], a[104:107]
v_mfma_f32_16x16x32_bf16 a[108:111], v[172:175], v[92:95], a[108:111]
s_waitcnt lgkmcnt(0)
v_mfma_f32_16x16x32_bf16 a[112:115], v[176:179], v[80:83], a[112:115]
v_mfma_f32_16x16x32_bf16 a[116:119], v[176:179], v[84:87], a[116:119]
v_mfma_f32_16x16x32_bf16 a[112:115], v[180:183], v[88:91], a[112:115]
v_mfma_f32_16x16x32_bf16 a[116:119], v[180:183], v[92:95], a[116:119]
v_mfma_f32_16x16x32_bf16 a[120:123], v[184:187], v[80:83], a[120:123]
v_mfma_f32_16x16x32_bf16 a[124:127], v[184:187], v[84:87], a[124:127]
v_mfma_f32_16x16x32_bf16 a[120:123], v[188:191], v[88:91], a[120:123]
v_mfma_f32_16x16x32_bf16 a[124:127], v[188:191], v[92:95], a[124:127]
s_nop 7
s_cmp_eq_u32 s74, 2
s_cbranch_scc1 F_GOT
F_POLL:
buffer_load_dword v248, v249, s[4:7], s73 offen sc1
s_waitcnt vmcnt(0)
v_cmp_ne_u32 vcc, 1, v248
s_cbranch_vccz F_POLL_DONE
s_sleep 2
s_branch F_POLL
F_POLL_DONE:
s_cmp_lg_u32 s19, 0
s_cbranch_scc1 F_POLL_F
buffer_inv sc1
s_waitcnt vmcnt(0)
F_POLL_F:
s_add_u32 m0, s62, 98304
s_add_u32 s22, s65, 0
buffer_load_dwordx4 v252, s[4:7], s22 offen lds
buffer_load_dwordx4 v252, s[4:7], s22 offen offset:1024 lds
buffer_load_dwordx4 v252, s[4:7], s22 offen offset:2048 lds
buffer_load_dwordx4 v252, s[4:7], s22 offen offset:3072 lds
s_add_u32 m0, m0, 4096
s_nop 0
buffer_load_dwordx4 v253, s[4:7], s22 offen lds
buffer_load_dwordx4 v253, s[4:7], s22 offen offset:1024 lds
buffer_load_dwordx4 v253, s[4:7], s22 offen offset:2048 lds
buffer_load_dwordx4 v253, s[4:7], s22 offen offset:3072 lds
s_add_u32 m0, s62, 0
s_add_u32 s22, s65, 32768
buffer_load_dwordx4 v252, s[4:7], s22 offen lds
buffer_load_dwordx4 v252, s[4:7], s22 offen offset:1024 lds
buffer_load_dwordx4 v252, s[4:7], s22 offen offset:2048 lds
buffer_load_dwordx4 v252, s[4:7], s22 offen offset:3072 lds
s_add_u32 m0, m0, 4096
s_nop 0
buffer_load_dwordx4 v253, s[4:7], s22 offen lds
buffer_load_dwordx4 v253, s[4:7], s22 offen offset:1024 lds
buffer_load_dwordx4 v253, s[4:7], s22 offen offset:2048 lds
buffer_load_dwordx4 v253, s[4:7], s22 offen offset:3072 lds
s_lshl_b32 s23, s12, 10
s_add_u32 s23, s23, s65
s_add_u32 s23, s23, 131072
buffer_load_dwordx4 v[220:223], v3, s[4:7], s23 offen
s_add_u32 m0, s62, 32768
s_add_u32 s22, s65, 65536
buffer_load_dwordx4 v252, s[4:7], s22 offen lds
buffer_load_dwordx4 v252, s[4:7], s22 offen offset:1024 lds
buffer_load_dwordx4 v252, s[4:7], s22 offen offset:2048 lds
buffer_load_dwordx4 v252, s[4:7], s22 offen offset:3072 lds
s_add_u32 m0, m0, 4096
s_nop 0
buffer_load_dwordx4 v253, s[4:7], s22 offen lds
buffer_load_dwordx4 v253, s[4:7], s22 offen offset:1024 lds
buffer_load_dwordx4 v253, s[4:7], s22 offen offset:2048 lds
buffer_load_dwordx4 v253, s[4:7], s22 offen offset:3072 lds
s_add_u32 m0, s62, 65536
s_add_u32 s22, s65, 98304
buffer_load_dwordx4 v252, s[4:7], s22 offen lds
buffer_load_dwordx4 v252, s[4:7], s22 offen offset:1024 lds
buffer_load_dwordx4 v252, s[4:7], s22 offen offset:2048 lds
buffer_load_dwordx4 v252, s[4:7], s22 offen offset:3072 lds
s_add_u32 m0, m0, 4096
s_nop 0
buffer_load_dwordx4 v253, s[4:7], s22 offen lds
buffer_load_dwordx4 v253, s[4:7], s22 offen offset:1024 lds
buffer_load_dwordx4 v253, s[4:7], s22 offen offset:2048 lds
buffer_load_dwordx4 v253, s[4:7], s22 offen offset:3072 lds
F_GOT:
s_waitcnt vmcnt(16)
v_add_u32 v6, 65536, v252
ds_read_b128 v[128:131], v6 offset:32768
ds_read_b128 v[132:135], v6 offset:34816
ds_read_b128 v[136:139], v6 offset:33792
ds_read_b128 v[140:143], v6 offset:35840
ds_read_b128 v[144:147], v6 offset:36864
ds_read_b128 v[148:151], v6 offset:38912
v_max_f32 v7, v192, v220
v_sub_f32 v216, v192, v7
v_sub_f32 v218, v220, v7
v_exp_f32 v216, v216
v_exp_f32 v218, v218
s_nop 0
v_mul_f32 v7, v216, v194
v_fmac_f32 v7, v218, v222
v_mov_b32 v15, v7
s_nop 1
v_permlane32_swap_b32 v15, v7
s_nop 1
v_add_f32 v7, v7, v15
v_mov_b32 v15, v7
s_nop 1
v_permlane16_swap_b32 v15, v7
s_nop 1
v_add_f32 v7, v7, v15
v_rcp_f32 v7, v7
s_nop 0
v_mul_f32 v216, v216, v7
v_mul_f32 v218, v218, v7
v_max_f32 v7, v193, v221
v_sub_f32 v217, v193, v7
v_sub_f32 v219, v221, v7
v_exp_f32 v217, v217
v_exp_f32 v219, v219
s_nop 0
v_mul_f32 v7, v217, v195
v_fmac_f32 v7, v219, v223
v_mov_b32 v15, v7
s_nop 1
v_permlane32_swap_b32 v15, v7
s_nop 1
v_add_f32 v7, v7, v15
v_mov_b32 v15, v7
s_nop 1
v_permlane16_swap_b32 v15, v7
s_nop 1
v_add_f32 v7, v7, v15
v_rcp_f32 v7, v7
s_nop 0
v_mul_f32 v217, v217, v7
v_mul_f32 v219, v219, v7
ds_read_b128 v[152:155], v6 offset:37888
ds_read_b128 v[156:159], v6 offset:39936
v_accvgpr_read_b32 v112, a0
v_accvgpr_read_b32 v113, a1
v_accvgpr_read_b32 v114, a2
v_accvgpr_read_b32 v115, a3
v_accvgpr_read_b32 v116, a8
v_accvgpr_read_b32 v117, a9
v_accvgpr_read_b32 v118, a10
v_accvgpr_read_b32 v119, a11
v_mul_f32 v112, v216, v112
v_mul_f32 v113, v216, v113
v_mul_f32 v114, v216, v114
v_mul_f32 v115, v216, v115
v_mul_f32 v116, v216, v116
v_mul_f32 v117, v216, v117
v_mul_f32 v118, v216, v118
v_mul_f32 v119, v216, v119
s_waitcnt lgkmcnt(6)
v_fmac_f32 v112, v218, v128
v_fmac_f32 v113, v218, v129
v_fmac_f32 v114, v218, v130
v_fmac_f32 v115, v218, v131
v_fmac_f32 v116, v218, v132
v_fmac_f32 v117, v218, v133
v_fmac_f32 v118, v218, v134
v_fmac_f32 v119, v218, v135
v_cvt_pk_bf16_f32 v16, v112, v113
v_cvt_pk_bf16_f32 v17, v114, v115
v_cvt_pk_bf16_f32 v18, v116, v117
v_cvt_pk_bf16_f32 v19, v118, v119
ds_read_b128 v[128:131], v252 offset:0
ds_read_b128 v[132:135], v252 offset:2048
v_accvgpr_read_b32 v120, a4
v_accvgpr_read_b32 v121, a5
v_accvgpr_read_b32 v122, a6
v_accvgpr_read_b32 v123, a7
v_accvgpr_read_b32 v124, a12
v_accvgpr_read_b32 v125, a13
v_accvgpr_read_b32 v126, a14
v_accvgpr_read_b32 v127, a15
v_mul_f32 v120, v217, v120
v_mul_f32 v121, v217, v121
v_mul_f32 v122, v217, v122
v_mul_f32 v123, v217, v123
v_mul_f32 v124, v217, v124
v_mul_f32 v125, v217, v125
v_mul_f32 v126, v217, v126
v_mul_f32 v127, v217, v127
s_waitcnt lgkmcnt(6)
v_fmac_f32 v120, v219, v136
v_fmac_f32 v121, v219, v137
v_fmac_f32 v122, v219, v138
v_fmac_f32 v123, v219, v139
v_fmac_f32 v124, v219, v140
v_fmac_f32 v125, v219, v141
v_fmac_f32 v126, v219, v142
v_fmac_f32 v127, v219, v143
v_cvt_pk_bf16_f32 v20, v120, v121
v_cvt_pk_bf16_f32 v21, v122, v123
v_cvt_pk_bf16_f32 v22, v124, v125
v_cvt_pk_bf16_f32 v23, v126, v127
ds_read_b128 v[136:139], v252 offset:1024
ds_read_b128 v[140:143], v252 offset:3072
v_accvgpr_read_b32 v112, a16
v_accvgpr_read_b32 v113, a17
v_accvgpr_read_b32 v114, a18
v_accvgpr_read_b32 v115, a19
v_accvgpr_read_b32 v116, a24
v_accvgpr_read_b32 v117, a25
v_accvgpr_read_b32 v118, a26
v_accvgpr_read_b32 v119, a27
v_mul_f32 v112, v216, v112
v_mul_f32 v113, v216, v113
v_mul_f32 v114, v216, v114
v_mul_f32 v115, v216, v115
v_mul_f32 v116, v216, v116
v_mul_f32 v117, v216, v117
v_mul_f32 v118, v216, v118
v_mul_f32 v119, v216, v119
s_waitcnt lgkmcnt(6)
v_fmac_f32 v112, v218, v144
v_fmac_f32 v113, v218, v145
v_fmac_f32 v114, v218, v146
v_fmac_f32 v115, v218, v147
v_fmac_f32 v116, v218, v148
v_fmac_f32 v117, v218, v149
v_fmac_f32 v118, v218, v150
v_fmac_f32 v119, v218, v151
v_cvt_pk_bf16_f32 v24, v112, v113
v_cvt_pk_bf16_f32 v25, v114, v115
v_cvt_pk_bf16_f32 v26, v116, v117
v_cvt_pk_bf16_f32 v27, v118, v119
ds_read_b128 v[144:147], v252 offset:4096
ds_read_b128 v[148:151], v252 offset:6144
v_accvgpr_read_b32 v120, a20
v_accvgpr_read_b32 v121, a21
v_accvgpr_read_b32 v122, a22
v_accvgpr_read_b32 v123, a23
v_accvgpr_read_b32 v124, a28
v_accvgpr_read_b32 v125, a29
v_accvgpr_read_b32 v126, a30
v_accvgpr_read_b32 v127, a31
v_mul_f32 v120, v217, v120
v_mul_f32 v121, v217, v121
v_mul_f32 v122, v217, v122
v_mul_f32 v123, v217, v123
v_mul_f32 v124, v217, v124
v_mul_f32 v125, v217, v125
v_mul_f32 v126, v217, v126
v_mul_f32 v127, v217, v127
s_waitcnt lgkmcnt(6)
s_add_u32 m0, s62, 98304
s_add_u32 s22, s36, 0
buffer_load_dwordx4 v240, s[28:31], s22 offen lds
buffer_load_dwordx4 v241, s[28:31], s22 offen offset:1024 lds
buffer_load_dwordx4 v242, s[28:31], s22 offen offset:2048 lds
buffer_load_dwordx4 v243, s[28:31], s22 offen offset:3072 lds
s_add_u32 m0, m0, 4096
s_add_u32 s22, s22, 28672
buffer_load_dwordx4 v240, s[28:31], s22 offen lds
buffer_load_dwordx4 v241, s[28:31], s22 offen offset:1024 lds
buffer_load_dwordx4 v242, s[28:31], s22 offen offset:2048 lds
buffer_load_dwordx4 v243, s[28:31], s22 offen offset:3072 lds
v_fmac_f32 v120, v219, v152
v_fmac_f32 v121, v219, v153
v_fmac_f32 v122, v219, v154
v_fmac_f32 v123, v219, v155
v_fmac_f32 v124, v219, v156
v_fmac_f32 v125, v219, v157
v_fmac_f32 v126, v219, v158
v_fmac_f32 v127, v219, v159
v_cvt_pk_bf16_f32 v28, v120, v121
v_cvt_pk_bf16_f32 v29, v122, v123
v_cvt_pk_bf16_f32 v30, v124, v125
v_cvt_pk_bf16_f32 v31, v126, v127
ds_read_b128 v[152:155], v252 offset:5120
ds_read_b128 v[156:159], v252 offset:7168
v_accvgpr_read_b32 v112, a32
v_accvgpr_read_b32 v113, a33
v_accvgpr_read_b32 v114, a34
v_accvgpr_read_b32 v115, a35
v_accvgpr_read_b32 v116, a40
v_accvgpr_read_b32 v117, a41
v_accvgpr_read_b32 v118, a42
v_accvgpr_read_b32 v119, a43
v_mul_f32 v112, v216, v112
v_mul_f32 v113, v216, v113
v_mul_f32 v114, v216, v114
v_mul_f32 v115, v216, v115
v_mul_f32 v116, v216, v116
v_mul_f32 v117, v216, v117
v_mul_f32 v118, v216, v118
v_mul_f32 v119, v216, v119
s_waitcnt lgkmcnt(6)
v_fmac_f32 v112, v218, v128
v_fmac_f32 v113, v218, v129
v_fmac_f32 v114, v218, v130
v_fmac_f32 v115, v218, v131
v_fmac_f32 v116, v218, v132
v_fmac_f32 v117, v218, v133
v_fmac_f32 v118, v218, v134
v_fmac_f32 v119, v218, v135
v_cvt_pk_bf16_f32 v32, v112, v113
v_cvt_pk_bf16_f32 v33, v114, v115
v_cvt_pk_bf16_f32 v34, v116, v117
v_cvt_pk_bf16_f32 v35, v118, v119
s_waitcnt vmcnt(16)
ds_read_b128 v[128:131], v252 offset:32768
ds_read_b128 v[132:135], v252 offset:34816
v_accvgpr_read_b32 v120, a36
v_accvgpr_read_b32 v121, a37
v_accvgpr_read_b32 v122, a38
v_accvgpr_read_b32 v123, a39
v_accvgpr_read_b32 v124, a44
v_accvgpr_read_b32 v125, a45
v_accvgpr_read_b32 v126, a46
v_accvgpr_read_b32 v127, a47
v_mul_f32 v120, v217, v120
v_mul_f32 v121, v217, v121
v_mul_f32 v122, v217, v122
v_mul_f32 v123, v217, v123
v_mul_f32 v124, v217, v124
v_mul_f32 v125, v217, v125
v_mul_f32 v126, v217, v126
v_mul_f32 v127, v217, v127
s_waitcnt lgkmcnt(6)
v_fmac_f32 v120, v219, v136
v_fmac_f32 v121, v219, v137
v_fmac_f32 v122, v219, v138
v_fmac_f32 v123, v219, v139
v_fmac_f32 v124, v219, v140
v_fmac_f32 v125, v219, v141
v_fmac_f32 v126, v219, v142
v_fmac_f32 v127, v219, v143
v_cvt_pk_bf16_f32 v36, v120, v121
v_cvt_pk_bf16_f32 v37, v122, v123
v_cvt_pk_bf16_f32 v38, v124, v125
v_cvt_pk_bf16_f32 v39, v126, v127
ds_read_b128 v[136:139], v252 offset:33792
ds_read_b128 v[140:143], v252 offset:35840
v_accvgpr_read_b32 v112, a48
v_accvgpr_read_b32 v113, a49
v_accvgpr_read_b32 v114, a50
v_accvgpr_read_b32 v115, a51
v_accvgpr_read_b32 v116, a56
v_accvgpr_read_b32 v117, a57
v_accvgpr_read_b32 v118, a58
v_accvgpr_read_b32 v119, a59
v_mul_f32 v112, v216, v112
v_mul_f32 v113, v216, v113
v_mul_f32 v114, v216, v114
v_mul_f32 v115, v216, v115
v_mul_f32 v116, v216, v116
v_mul_f32 v117, v216, v117
v_mul_f32 v118, v216, v118
v_mul_f32 v119, v216, v119
s_waitcnt lgkmcnt(6)
v_fmac_f32 v112, v218, v144
v_fmac_f32 v113, v218, v145
v_fmac_f32 v114, v218, v146
v_fmac_f32 v115, v218, v147
v_fmac_f32 v116, v218, v148
v_fmac_f32 v117, v218, v149
v_fmac_f32 v118, v218, v150
v_fmac_f32 v119, v218, v151
v_cvt_pk_bf16_f32 v40, v112, v113
v_cvt_pk_bf16_f32 v41, v114, v115
v_cvt_pk_bf16_f32 v42, v116, v117
v_cvt_pk_bf16_f32 v43, v118, v119
ds_read_b128 v[144:147], v252 offset:36864
ds_read_b128 v[148:151], v252 offset:38912
v_accvgpr_read_b32 v120, a52
v_accvgpr_read_b32 v121, a53
v_accvgpr_read_b32 v122, a54
v_accvgpr_read_b32 v123, a55
v_accvgpr_read_b32 v124, a60
v_accvgpr_read_b32 v125, a61
v_accvgpr_read_b32 v126, a62
v_accvgpr_read_b32 v127, a63
v_mul_f32 v120, v217, v120
v_mul_f32 v121, v217, v121
v_mul_f32 v122, v217, v122
v_mul_f32 v123, v217, v123
v_mul_f32 v124, v217, v124
v_mul_f32 v125, v217, v125
v_mul_f32 v126, v217, v126
v_mul_f32 v127, v217, v127
s_waitcnt lgkmcnt(6)
s_add_u32 m0, s62, 0
s_add_u32 s22, s36, 128
buffer_load_dwordx4 v240, s[28:31], s22 offen lds
buffer_load_dwordx4 v241, s[28:31], s22 offen offset:1024 lds
buffer_load_dwordx4 v242, s[28:31], s22 offen offset:2048 lds
buffer_load_dwordx4 v243, s[28:31], s22 offen offset:3072 lds
s_add_u32 m0, m0, 4096
s_add_u32 s22, s22, 28672
buffer_load_dwordx4 v240, s[28:31], s22 offen lds
buffer_load_dwordx4 v241, s[28:31], s22 offen offset:1024 lds
buffer_load_dwordx4 v242, s[28:31], s22 offen offset:2048 lds
buffer_load_dwordx4 v243, s[28:31], s22 offen offset:3072 lds
v_fmac_f32 v120, v219, v152
v_fmac_f32 v121, v219, v153
v_fmac_f32 v122, v219, v154
v_fmac_f32 v123, v219, v155
v_fmac_f32 v124, v219, v156
v_fmac_f32 v125, v219, v157
v_fmac_f32 v126, v219, v158
v_fmac_f32 v127, v219, v159
v_cvt_pk_bf16_f32 v44, v120, v121
v_cvt_pk_bf16_f32 v45, v122, v123
v_cvt_pk_bf16_f32 v46, v124, v125
v_cvt_pk_bf16_f32 v47, v126, v127
ds_read_b128 v[152:155], v252 offset:37888
ds_read_b128 v[156:159], v252 offset:39936
v_accvgpr_read_b32 v112, a64
v_accvgpr_read_b32 v113, a65
v_accvgpr_read_b32 v114, a66
v_accvgpr_read_b32 v115, a67
v_accvgpr_read_b32 v116, a72
v_accvgpr_read_b32 v117, a73
v_accvgpr_read_b32 v118, a74
v_accvgpr_read_b32 v119, a75
v_mul_f32 v112, v216, v112
v_mul_f32 v113, v216, v113
v_mul_f32 v114, v216, v114
v_mul_f32 v115, v216, v115
v_mul_f32 v116, v216, v116
v_mul_f32 v117, v216, v117
v_mul_f32 v118, v216, v118
v_mul_f32 v119, v216, v119
s_waitcnt lgkmcnt(6)
v_fmac_f32 v112, v218, v128
v_fmac_f32 v113, v218, v129
v_fmac_f32 v114, v218, v130
v_fmac_f32 v115, v218, v131
v_fmac_f32 v116, v218, v132
v_fmac_f32 v117, v218, v133
v_fmac_f32 v118, v218, v134
v_fmac_f32 v119, v218, v135
v_cvt_pk_bf16_f32 v48, v112, v113
v_cvt_pk_bf16_f32 v49, v114, v115
v_cvt_pk_bf16_f32 v50, v116, v117
v_cvt_pk_bf16_f32 v51, v118, v119
s_waitcnt vmcnt(16)
ds_read_b128 v[128:131], v6 offset:0
ds_read_b128 v[132:135], v6 offset:2048
v_accvgpr_read_b32 v120, a68
v_accvgpr_read_b32 v121, a69
v_accvgpr_read_b32 v122, a70
v_accvgpr_read_b32 v123, a71
v_accvgpr_read_b32 v124, a76
v_accvgpr_read_b32 v125, a77
v_accvgpr_read_b32 v126, a78
v_accvgpr_read_b32 v127, a79
v_mul_f32 v120, v217, v120
v_mul_f32 v121, v217, v121
v_mul_f32 v122, v217, v122
v_mul_f32 v123, v217, v123
v_mul_f32 v124, v217, v124
v_mul_f32 v125, v217, v125
v_mul_f32 v126, v217, v126
v_mul_f32 v127, v217, v127
s_waitcnt lgkmcnt(6)
v_fmac_f32 v120, v219, v136
v_fmac_f32 v121, v219, v137
v_fmac_f32 v122, v219, v138
v_fmac_f32 v123, v219, v139
v_fmac_f32 v124, v219, v140
v_fmac_f32 v125, v219, v141
v_fmac_f32 v126, v219, v142
v_fmac_f32 v127, v219, v143
v_cvt_pk_bf16_f32 v52, v120, v121
v_cvt_pk_bf16_f32 v53, v122, v123
v_cvt_pk_bf16_f32 v54, v124, v125
v_cvt_pk_bf16_f32 v55, v126, v127
ds_read_b128 v[136:139], v6 offset:1024
ds_read_b128 v[140:143], v6 offset:3072
v_accvgpr_read_b32 v112, a80
v_accvgpr_read_b32 v113, a81
v_accvgpr_read_b32 v114, a82
v_accvgpr_read_b32 v115, a83
v_accvgpr_read_b32 v116, a88
v_accvgpr_read_b32 v117, a89
v_accvgpr_read_b32 v118, a90
v_accvgpr_read_b32 v119, a91
v_mul_f32 v112, v216, v112
v_mul_f32 v113, v216, v113
v_mul_f32 v114, v216, v114
v_mul_f32 v115, v216, v115
v_mul_f32 v116, v216, v116
v_mul_f32 v117, v216, v117
v_mul_f32 v118, v216, v118
v_mul_f32 v119, v216, v119
s_waitcnt lgkmcnt(6)
v_fmac_f32 v112, v218, v144
v_fmac_f32 v113, v218, v145
v_fmac_f32 v114, v218, v146
v_fmac_f32 v115, v218, v147
v_fmac_f32 v116, v218, v148
v_fmac_f32 v117, v218, v149
v_fmac_f32 v118, v218, v150
v_fmac_f32 v119, v218, v151
v_cvt_pk_bf16_f32 v56, v112, v113
v_cvt_pk_bf16_f32 v57, v114, v115
v_cvt_pk_bf16_f32 v58, v116, v117
v_cvt_pk_bf16_f32 v59, v118, v119
ds_read_b128 v[144:147], v6 offset:4096
ds_read_b128 v[148:151], v6 offset:6144
v_accvgpr_read_b32 v120, a84
v_accvgpr_read_b32 v121, a85
v_accvgpr_read_b32 v122, a86
v_accvgpr_read_b32 v123, a87
v_accvgpr_read_b32 v124, a92
v_accvgpr_read_b32 v125, a93
v_accvgpr_read_b32 v126, a94
v_accvgpr_read_b32 v127, a95
v_mul_f32 v120, v217, v120
v_mul_f32 v121, v217, v121
v_mul_f32 v122, v217, v122
v_mul_f32 v123, v217, v123
v_mul_f32 v124, v217, v124
v_mul_f32 v125, v217, v125
v_mul_f32 v126, v217, v126
v_mul_f32 v127, v217, v127
s_waitcnt lgkmcnt(6)
s_add_u32 m0, s62, 32768
s_add_u32 s22, s36, 256
buffer_load_dwordx4 v240, s[28:31], s22 offen lds
buffer_load_dwordx4 v241, s[28:31], s22 offen offset:1024 lds
buffer_load_dwordx4 v242, s[28:31], s22 offen offset:2048 lds
buffer_load_dwordx4 v243, s[28:31], s22 offen offset:3072 lds
s_add_u32 m0, m0, 4096
s_add_u32 s22, s22, 28672
buffer_load_dwordx4 v240, s[28:31], s22 offen lds
buffer_load_dwordx4 v241, s[28:31], s22 offen offset:1024 lds
buffer_load_dwordx4 v242, s[28:31], s22 offen offset:2048 lds
buffer_load_dwordx4 v243, s[28:31], s22 offen offset:3072 lds
v_fmac_f32 v120, v219, v152
v_fmac_f32 v121, v219, v153
v_fmac_f32 v122, v219, v154
v_fmac_f32 v123, v219, v155
v_fmac_f32 v124, v219, v156
v_fmac_f32 v125, v219, v157
v_fmac_f32 v126, v219, v158
v_fmac_f32 v127, v219, v159
v_cvt_pk_bf16_f32 v60, v120, v121
v_cvt_pk_bf16_f32 v61, v122, v123
v_cvt_pk_bf16_f32 v62, v124, v125
v_cvt_pk_bf16_f32 v63, v126, v127
ds_read_b128 v[152:155], v6 offset:5120
ds_read_b128 v[156:159], v6 offset:7168
v_accvgpr_read_b32 v112, a96
v_accvgpr_read_b32 v113, a97
v_accvgpr_read_b32 v114, a98
v_accvgpr_read_b32 v115, a99
v_accvgpr_read_b32 v116, a104
v_accvgpr_read_b32 v117, a105
v_accvgpr_read_b32 v118, a106
v_accvgpr_read_b32 v119, a107
v_mul_f32 v112, v216, v112
v_mul_f32 v113, v216, v113
v_mul_f32 v114, v216, v114
v_mul_f32 v115, v216, v115
v_mul_f32 v116, v216, v116
v_mul_f32 v117, v216, v117
v_mul_f32 v118, v216, v118
v_mul_f32 v119, v216, v119
s_waitcnt lgkmcnt(6)
v_fmac_f32 v112, v218, v128
v_fmac_f32 v113, v218, v129
v_fmac_f32 v114, v218, v130
v_fmac_f32 v115, v218, v131
v_fmac_f32 v116, v218, v132
v_fmac_f32 v117, v218, v133
v_fmac_f32 v118, v218, v134
v_fmac_f32 v119, v218, v135
v_cvt_pk_bf16_f32 v64, v112, v113
v_cvt_pk_bf16_f32 v65, v114, v115
v_cvt_pk_bf16_f32 v66, v116, v117
v_cvt_pk_bf16_f32 v67, v118, v119
v_accvgpr_read_b32 v120, a100
v_accvgpr_read_b32 v121, a101
v_accvgpr_read_b32 v122, a102
v_accvgpr_read_b32 v123, a103
v_accvgpr_read_b32 v124, a108
v_accvgpr_read_b32 v125, a109
v_accvgpr_read_b32 v126, a110
v_accvgpr_read_b32 v127, a111
v_mul_f32 v120, v217, v120
v_mul_f32 v121, v217, v121
v_mul_f32 v122, v217, v122
v_mul_f32 v123, v217, v123
v_mul_f32 v124, v217, v124
v_mul_f32 v125, v217, v125
v_mul_f32 v126, v217, v126
v_mul_f32 v127, v217, v127
s_waitcnt lgkmcnt(4)
v_fmac_f32 v120, v219, v136
v_fmac_f32 v121, v219, v137
v_fmac_f32 v122, v219, v138
v_fmac_f32 v123, v219, v139
v_fmac_f32 v124, v219, v140
v_fmac_f32 v125, v219, v141
v_fmac_f32 v126, v219, v142
v_fmac_f32 v127, v219, v143
v_cvt_pk_bf16_f32 v68, v120, v121
v_cvt_pk_bf16_f32 v69, v122, v123
v_cvt_pk_bf16_f32 v70, v124, v125
v_cvt_pk_bf16_f32 v71, v126, v127
v_accvgpr_read_b32 v112, a112
v_accvgpr_read_b32 v113, a113
v_accvgpr_read_b32 v114, a114
v_accvgpr_read_b32 v115, a115
v_accvgpr_read_b32 v116, a120
v_accvgpr_read_b32 v117, a121
v_accvgpr_read_b32 v118, a122
v_accvgpr_read_b32 v119, a123
v_mul_f32 v112, v216, v112
v_mul_f32 v113, v216, v113
v_mul_f32 v114, v216, v114
v_mul_f32 v115, v216, v115
v_mul_f32 v116, v216, v116
v_mul_f32 v117, v216, v117
v_mul_f32 v118, v216, v118
v_mul_f32 v119, v216, v119
s_waitcnt lgkmcnt(2)
v_fmac_f32 v112, v218, v144
v_fmac_f32 v113, v218, v145
v_fmac_f32 v114, v218, v146
v_fmac_f32 v115, v218, v147
v_fmac_f32 v116, v218, v148
v_fmac_f32 v117, v218, v149
v_fmac_f32 v118, v218, v150
v_fmac_f32 v119, v218, v151
v_cvt_pk_bf16_f32 v72, v112, v113
v_cvt_pk_bf16_f32 v73, v114, v115
v_cvt_pk_bf16_f32 v74, v116, v117
v_cvt_pk_bf16_f32 v75, v118, v119
v_accvgpr_read_b32 v120, a116
v_accvgpr_read_b32 v121, a117
v_accvgpr_read_b32 v122, a118
v_accvgpr_read_b32 v123, a119
v_accvgpr_read_b32 v124, a124
v_accvgpr_read_b32 v125, a125
v_accvgpr_read_b32 v126, a126
v_accvgpr_read_b32 v127, a127
v_mul_f32 v120, v217, v120
v_mul_f32 v121, v217, v121
v_mul_f32 v122, v217, v122
v_mul_f32 v123, v217, v123
v_mul_f32 v124, v217, v124
v_mul_f32 v125, v217, v125
v_mul_f32 v126, v217, v126
v_mul_f32 v127, v217, v127
s_waitcnt lgkmcnt(0)
s_add_u32 m0, s62, 65536
s_add_u32 s22, s36, 384
buffer_load_dwordx4 v240, s[28:31], s22 offen lds
buffer_load_dwordx4 v241, s[28:31], s22 offen offset:1024 lds
buffer_load_dwordx4 v242, s[28:31], s22 offen offset:2048 lds
buffer_load_dwordx4 v243, s[28:31], s22 offen offset:3072 lds
s_add_u32 m0, m0, 4096
s_add_u32 s22, s22, 28672
buffer_load_dwordx4 v240, s[28:31], s22 offen lds
buffer_load_dwordx4 v241, s[28:31], s22 offen offset:1024 lds
buffer_load_dwordx4 v242, s[28:31], s22 offen offset:2048 lds
buffer_load_dwordx4 v243, s[28:31], s22 offen offset:3072 lds
v_fmac_f32 v120, v219, v152
v_fmac_f32 v121, v219, v153
v_fmac_f32 v122, v219, v154
v_fmac_f32 v123, v219, v155
v_fmac_f32 v124, v219, v156
v_fmac_f32 v125, v219, v157
v_fmac_f32 v126, v219, v158
v_fmac_f32 v127, v219, v159
v_cvt_pk_bf16_f32 v76, v120, v121
v_cvt_pk_bf16_f32 v77, v122, v123
v_cvt_pk_bf16_f32 v78, v124, v125
v_cvt_pk_bf16_f32 v79, v126, v127
s_branch F_OUTPROJ
F_EPI_B:
v_mov_b32 v216, v194
v_mov_b32 v15, v216
s_nop 1
v_permlane32_swap_b32 v15, v216
s_nop 1
v_add_f32 v216, v216, v15
v_mov_b32 v15, v216
s_nop 1
v_permlane16_swap_b32 v15, v216
s_nop 1
v_add_f32 v216, v216, v15
v_rcp_f32 v216, v216
v_mov_b32 v217, v195
v_mov_b32 v15, v217
s_nop 1
v_permlane32_swap_b32 v15, v217
s_nop 1
v_add_f32 v217, v217, v15
v_mov_b32 v15, v217
s_nop 1
v_permlane16_swap_b32 v15, v217
s_nop 1
v_add_f32 v217, v217, v15
v_rcp_f32 v217, v217
s_waitcnt lgkmcnt(4)
v_mfma_f32_16x16x32_bf16 a[0:3], v[128:131], v[80:83], a[0:3]
ds_read_b128 v[160:163], v4 offset:8192
v_mfma_f32_16x16x32_bf16 a[4:7], v[128:131], v[84:87], a[4:7]
s_add_u32 m0, s62, 98304
s_add_u32 s22, s36, 0
v_mfma_f32_16x16x32_bf16 a[0:3], v[132:135], v[88:91], a[0:3]
ds_read_b128 v[164:167], v4 offset:9216
v_mfma_f32_16x16x32_bf16 a[4:7], v[132:135], v[92:95], a[4:7]
buffer_load_dwordx4 v240, s[28:31], s22 offen lds
buffer_load_dwordx4 v241, s[28:31], s22 offen offset:1024 lds
v_mfma_f32_16x16x32_bf16 a[8:11], v[136:139], v[80:83], a[8:11]
ds_read_b128 v[168:171], v4 offset:10240
v_mfma_f32_16x16x32_bf16 a[12:15], v[136:139], v[84:87], a[12:15]
buffer_load_dwordx4 v242, s[28:31], s22 offen offset:2048 lds
buffer_load_dwordx4 v243, s[28:31], s22 offen offset:3072 lds
v_mfma_f32_16x16x32_bf16 a[8:11], v[140:143], v[88:91], a[8:11]
ds_read_b128 v[172:175], v4 offset:11264
v_mfma_f32_16x16x32_bf16 a[12:15], v[140:143], v[92:95], a[12:15]
s_add_u32 m0, m0, 4096
s_add_u32 s22, s22, 28672
s_waitcnt lgkmcnt(4)
v_mfma_f32_16x16x32_bf16 a[16:19], v[144:147], v[80:83], a[16:19]
ds_read_b128 v[176:179], v4 offset:12288
v_mfma_f32_16x16x32_bf16 a[20:23], v[144:147], v[84:87], a[20:23]
buffer_load_dwordx4 v240, s[28:31], s22 offen lds
buffer_load_dwordx4 v241, s[28:31], s22 offen offset:1024 lds
v_mfma_f32_16x16x32_bf16 a[16:19], v[148:151], v[88:91], a[16:19]
ds_read_b128 v[180:183], v4 offset:13312
v_mfma_f32_16x16x32_bf16 a[20:23], v[148:151], v[92:95], a[20:23]
buffer_load_dwordx4 v242, s[28:31], s22 offen offset:2048 lds
buffer_load_dwordx4 v243, s[28:31], s22 offen offset:3072 lds
v_mfma_f32_16x16x32_bf16 a[24:27], v[152:155], v[80:83], a[24:27]
ds_read_b128 v[184:187], v4 offset:14336
v_mfma_f32_16x16x32_bf16 a[28:31], v[152:155], v[84:87], a[28:31]
s_add_u32 m0, s62, 0
s_add_u32 s22, s36, 128
v_mfma_f32_16x16x32_bf16 a[24:27], v[156:159], v[88:91], a[24:27]
ds_read_b128 v[188:191], v4 offset:15360
v_mfma_f32_16x16x32_bf16 a[28:31], v[156:159], v[92:95], a[28:31]
buffer_load_dwordx4 v240, s[28:31], s22 offen lds
buffer_load_dwordx4 v241, s[28:31], s22 offen offset:1024 lds
v_accvgpr_read_b32 v112, a0
v_accvgpr_read_b32 v113, a1
v_accvgpr_read_b32 v114, a2
v_accvgpr_read_b32 v115, a3
v_accvgpr_read_b32 v116, a8
v_accvgpr_read_b32 v117, a9
v_accvgpr_read_b32 v118, a10
v_accvgpr_read_b32 v119, a11
v_mul_f32 v112, v216, v112
v_mul_f32 v113, v216, v113
s_waitcnt lgkmcnt(4)
v_mfma_f32_16x16x32_bf16 a[32:35], v[160:163], v[80:83], a[32:35]
ds_read_b128 v[128:131], v4 offset:16384
v_mfma_f32_16x16x32_bf16 a[36:39], v[160:163], v[84:87], a[36:39]
buffer_load_dwordx4 v242, s[28:31], s22 offen offset:2048 lds
buffer_load_dwordx4 v243, s[28:31], s22 offen offset:3072 lds
v_mul_f32 v114, v216, v114
v_mul_f32 v115, v216, v115
v_mul_f32 v116, v216, v116
v_mul_f32 v117, v216, v117
v_mul_f32 v118, v216, v118
v_mul_f32 v119, v216, v119
v_cvt_pk_bf16_f32 v16, v112, v113
v_cvt_pk_bf16_f32 v17, v114, v115
v_cvt_pk_bf16_f32 v18, v116, v117
v_cvt_pk_bf16_f32 v19, v118, v119
v_mfma_f32_16x16x32_bf16 a[32:35], v[164:167], v[88:91], a[32:35]
ds_read_b128 v[132:135], v4 offset:17408
v_mfma_f32_16x16x32_bf16 a[36:39], v[164:167], v[92:95], a[36:39]
s_add_u32 m0, m0, 4096
s_add_u32 s22, s22, 28672
v_accvgpr_read_b32 v120, a4
v_accvgpr_read_b32 v121, a5
v_accvgpr_read_b32 v122, a6
v_accvgpr_read_b32 v123, a7
v_accvgpr_read_b32 v124, a12
v_accvgpr_read_b32 v125, a13
v_accvgpr_read_b32 v126, a14
v_accvgpr_read_b32 v127, a15
v_mul_f32 v120, v217, v120
v_mul_f32 v121, v217, v121
v_mfma_f32_16x16x32_bf16 a[40:43], v[168:171], v[80:83], a[40:43]
ds_read_b128 v[136:139], v4 offset:18432
v_mfma_f32_16x16x32_bf16 a[44:47], v[168:171], v[84:87], a[44:47]
buffer_load_dwordx4 v240, s[28:31], s22 offen lds
buffer_load_dwordx4 v241, s[28:31], s22 offen offset:1024 lds
v_mul_f32 v122, v217, v122
v_mul_f32 v123, v217, v123
v_mul_f32 v124, v217, v124
v_mul_f32 v125, v217, v125
v_mul_f32 v126, v217, v126
v_mul_f32 v127, v217, v127
v_cvt_pk_bf16_f32 v20, v120, v121
v_cvt_pk_bf16_f32 v21, v122, v123
v_cvt_pk_bf16_f32 v22, v124, v125
v_cvt_pk_bf16_f32 v23, v126, v127
v_mfma_f32_16x16x32_bf16 a[40:43], v[172:175], v[88:91], a[40:43]
ds_read_b128 v[140:143], v4 offset:19456
v_mfma_f32_16x16x32_bf16 a[44:47], v[172:175], v[92:95], a[44:47]
buffer_load_dwordx4 v242, s[28:31], s22 offen offset:2048 lds
buffer_load_dwordx4 v243, s[28:31], s22 offen offset:3072 lds
v_accvgpr_read_b32 v112, a16
v_accvgpr_read_b32 v113, a17
v_accvgpr_read_b32 v114, a18
v_accvgpr_read_b32 v115, a19
v_accvgpr_read_b32 v116, a24
v_accvgpr_read_b32 v117, a25
v_accvgpr_read_b32 v118, a26
v_accvgpr_read_b32 v119, a27
v_mul_f32 v112, v216, v112
v_mul_f32 v113, v216, v113
s_waitcnt lgkmcnt(4)
v_mfma_f32_16x16x32_bf16 a[48:51], v[176:179], v[80:83], a[48:51]
ds_read_b128 v[144:147], v4 offset:20480
v_mfma_f32_16x16x32_bf16 a[52:55], v[176:179], v[84:87], a[52:55]
v_mul_f32 v114, v216, v114
v_mul_f32 v115, v216, v115
v_mul_f32 v116, v216, v116
v_mul_f32 v117, v216, v117
v_mul_f32 v118, v216, v118
v_mul_f32 v119, v216, v119
v_cvt_pk_bf16_f32 v24, v112, v113
v_cvt_pk_bf16_f32 v25, v114, v115
v_cvt_pk_bf16_f32 v26, v116, v117
v_cvt_pk_bf16_f32 v27, v118, v119
v_mfma_f32_16x16x32_bf16 a[48:51], v[180:183], v[88:91], a[48:51]
ds_read_b128 v[148:151], v4 offset:21504
v_mfma_f32_16x16x32_bf16 a[52:55], v[180:183], v[92:95], a[52:55]
v_accvgpr_read_b32 v120, a20
v_accvgpr_read_b32 v121, a21
v_accvgpr_read_b32 v122, a22
v_accvgpr_read_b32 v123, a23
v_accvgpr_read_b32 v124, a28
v_accvgpr_read_b32 v125, a29
v_accvgpr_read_b32 v126, a30
v_accvgpr_read_b32 v127, a31
v_mul_f32 v120, v217, v120
v_mul_f32 v121, v217, v121
v_mfma_f32_16x16x32_bf16 a[56:59], v[184:187], v[80:83], a[56:59]
ds_read_b128 v[152:155], v4 offset:22528
v_mfma_f32_16x16x32_bf16 a[60:63], v[184:187], v[84:87], a[60:63]
v_mul_f32 v122, v217, v122
v_mul_f32 v123, v217, v123
v_mul_f32 v124, v217, v124
v_mul_f32 v125, v217, v125
v_mul_f32 v126, v217, v126
v_mul_f32 v127, v217, v127
v_cvt_pk_bf16_f32 v28, v120, v121
v_cvt_pk_bf16_f32 v29, v122, v123
v_cvt_pk_bf16_f32 v30, v124, v125
v_cvt_pk_bf16_f32 v31, v126, v127
v_mfma_f32_16x16x32_bf16 a[56:59], v[188:191], v[88:91], a[56:59]
ds_read_b128 v[156:159], v4 offset:23552
v_mfma_f32_16x16x32_bf16 a[60:63], v[188:191], v[92:95], a[60:63]
v_accvgpr_read_b32 v112, a32
v_accvgpr_read_b32 v113, a33
v_accvgpr_read_b32 v114, a34
v_accvgpr_read_b32 v115, a35
v_accvgpr_read_b32 v116, a40
v_accvgpr_read_b32 v117, a41
v_accvgpr_read_b32 v118, a42
v_accvgpr_read_b32 v119, a43
v_mul_f32 v112, v216, v112
v_mul_f32 v113, v216, v113
s_waitcnt lgkmcnt(4)
v_mfma_f32_16x16x32_bf16 a[64:67], v[128:131], v[80:83], a[64:67]
ds_read_b128 v[160:163], v4 offset:24576
v_mfma_f32_16x16x32_bf16 a[68:71], v[128:131], v[84:87], a[68:71]
v_mul_f32 v114, v216, v114
v_mul_f32 v115, v216, v115
v_mul_f32 v116, v216, v116
v_mul_f32 v117, v216, v117
v_mul_f32 v118, v216, v118
v_mul_f32 v119, v216, v119
v_cvt_pk_bf16_f32 v32, v112, v113
v_cvt_pk_bf16_f32 v33, v114, v115
v_cvt_pk_bf16_f32 v34, v116, v117
v_cvt_pk_bf16_f32 v35, v118, v119
v_mfma_f32_16x16x32_bf16 a[64:67], v[132:135], v[88:91], a[64:67]
ds_read_b128 v[164:167], v4 offset:25600
v_mfma_f32_16x16x32_bf16 a[68:71], v[132:135], v[92:95], a[68:71]
v_accvgpr_read_b32 v120, a36
v_accvgpr_read_b32 v121, a37
v_accvgpr_read_b32 v122, a38
v_accvgpr_read_b32 v123, a39
v_accvgpr_read_b32 v124, a44
v_accvgpr_read_b32 v125, a45
v_accvgpr_read_b32 v126, a46
v_accvgpr_read_b32 v127, a47
v_mul_f32 v120, v217, v120
v_mul_f32 v121, v217, v121
v_mfma_f32_16x16x32_bf16 a[72:75], v[136:139], v[80:83], a[72:75]
ds_read_b128 v[168:171], v4 offset:26624
v_mfma_f32_16x16x32_bf16 a[76:79], v[136:139], v[84:87], a[76:79]
v_mul_f32 v122, v217, v122
v_mul_f32 v123, v217, v123
v_mul_f32 v124, v217, v124
v_mul_f32 v125, v217, v125
v_mul_f32 v126, v217, v126
v_mul_f32 v127, v217, v127
v_cvt_pk_bf16_f32 v36, v120, v121
v_cvt_pk_bf16_f32 v37, v122, v123
v_cvt_pk_bf16_f32 v38, v124, v125
v_cvt_pk_bf16_f32 v39, v126, v127
v_mfma_f32_16x16x32_bf16 a[72:75], v[140:143], v[88:91], a[72:75]
ds_read_b128 v[172:175], v4 offset:27648
v_mfma_f32_16x16x32_bf16 a[76:79], v[140:143], v[92:95], a[76:79]
s_add_u32 m0, s62, 32768
s_add_u32 s22, s36, 256
buffer_load_dwordx4 v240, s[28:31], s22 offen lds
buffer_load_dwordx4 v241, s[28:31], s22 offen offset:1024 lds
buffer_load_dwordx4 v242, s[28:31], s22 offen offset:2048 lds
buffer_load_dwordx4 v243, s[28:31], s22 offen offset:3072 lds
s_add_u32 m0, m0, 4096
s_add_u32 s22, s22, 28672
buffer_load_dwordx4 v240, s[28:31], s22 offen lds
buffer_load_dwordx4 v241, s[28:31], s22 offen offset:1024 lds
s_waitcnt lgkmcnt(4)
v_mfma_f32_16x16x32_bf16 a[80:83], v[144:147], v[80:83], a[80:83]
ds_read_b128 v[176:179], v4 offset:28672
v_mfma_f32_16x16x32_bf16 a[84:87], v[144:147], v[84:87], a[84:87]
buffer_load_dwordx4 v242, s[28:31], s22 offen offset:2048 lds
buffer_load_dwordx4 v243, s[28:31], s22 offen offset:3072 lds
v_accvgpr_read_b32 v112, a48
v_accvgpr_read_b32 v113, a49
v_accvgpr_read_b32 v114, a50
v_accvgpr_read_b32 v115, a51
v_accvgpr_read_b32 v116, a56
v_accvgpr_read_b32 v117, a57
v_accvgpr_read_b32 v118, a58
v_accvgpr_read_b32 v119, a59
v_mfma_f32_16x16x32_bf16 a[80:83], v[148:151], v[88:91], a[80:83]
ds_read_b128 v[180:183], v4 offset:29696
v_mfma_f32_16x16x32_bf16 a[84:87], v[148:151], v[92:95], a[84:87]
v_mul_f32 v112, v216, v112
v_mul_f32 v113, v216, v113
v_mul_f32 v114, v216, v114
v_mul_f32 v115, v216, v115
v_mul_f32 v116, v216, v116
v_mul_f32 v117, v216, v117
v_mul_f32 v118, v216, v118
v_mul_f32 v119, v216, v119
v_cvt_pk_bf16_f32 v40, v112, v113
v_cvt_pk_bf16_f32 v41, v114, v115
v_mfma_f32_16x16x32_bf16 a[88:91], v[152:155], v[80:83], a[88:91]
ds_read_b128 v[184:187], v4 offset:30720
v_mfma_f32_16x16x32_bf16 a[92:95], v[152:155], v[84:87], a[92:95]
v_cvt_pk_bf16_f32 v42, v116, v117
v_cvt_pk_bf16_f32 v43, v118, v119
v_accvgpr_read_b32 v120, a52
v_accvgpr_read_b32 v121, a53
v_accvgpr_read_b32 v122, a54
v_accvgpr_read_b32 v123, a55
v_accvgpr_read_b32 v124, a60
v_accvgpr_read_b32 v125, a61
v_accvgpr_read_b32 v126, a62
v_accvgpr_read_b32 v127, a63
v_mfma_f32_16x16x32_bf16 a[88:91], v[156:159], v[88:91], a[88:91]
ds_read_b128 v[188:191], v4 offset:31744
v_mfma_f32_16x16x32_bf16 a[92:95], v[156:159], v[92:95], a[92:95]
v_mul_f32 v120, v217, v120
v_mul_f32 v121, v217, v121
v_mul_f32 v122, v217, v122
v_mul_f32 v123, v217, v123
v_mul_f32 v124, v217, v124
v_mul_f32 v125, v217, v125
v_mul_f32 v126, v217, v126
v_mul_f32 v127, v217, v127
v_cvt_pk_bf16_f32 v44, v120, v121
v_cvt_pk_bf16_f32 v45, v122, v123
s_waitcnt lgkmcnt(4)
v_mfma_f32_16x16x32_bf16 a[96:99], v[160:163], v[80:83], a[96:99]
v_mfma_f32_16x16x32_bf16 a[100:103], v[160:163], v[84:87], a[100:103]
v_cvt_pk_bf16_f32 v46, v124, v125
v_cvt_pk_bf16_f32 v47, v126, v127
v_accvgpr_read_b32 v112, a64
v_accvgpr_read_b32 v113, a65
v_accvgpr_read_b32 v114, a66
v_accvgpr_read_b32 v115, a67
v_accvgpr_read_b32 v116, a72
v_accvgpr_read_b32 v117, a73
v_accvgpr_read_b32 v118, a74
v_accvgpr_read_b32 v119, a75
v_mfma_f32_16x16x32_bf16 a[96:99], v[164:167], v[88:91], a[96:99]
v_mfma_f32_16x16x32_bf16 a[100:103], v[164:167], v[92:95], a[100:103]
v_mul_f32 v112, v216, v112
v_mul_f32 v113, v216, v113
v_mul_f32 v114, v216, v114
v_mul_f32 v115, v216, v115
v_mul_f32 v116, v216, v116
v_mul_f32 v117, v216, v117
v_mul_f32 v118, v216, v118
v_mul_f32 v119, v216, v119
v_cvt_pk_bf16_f32 v48, v112, v113
v_cvt_pk_bf16_f32 v49, v114, v115
v_mfma_f32_16x16x32_bf16 a[104:107], v[168:171], v[80:83], a[104:107]
v_mfma_f32_16x16x32_bf16 a[108:111], v[168:171], v[84:87], a[108:111]
v_cvt_pk_bf16_f32 v50, v116, v117
v_cvt_pk_bf16_f32 v51, v118, v119
v_accvgpr_read_b32 v120, a68
v_accvgpr_read_b32 v121, a69
v_accvgpr_read_b32 v122, a70
v_accvgpr_read_b32 v123, a71
v_accvgpr_read_b32 v124, a76
v_accvgpr_read_b32 v125, a77
v_accvgpr_read_b32 v126, a78
v_accvgpr_read_b32 v127, a79
v_mfma_f32_16x16x32_bf16 a[104:107], v[172:175], v[88:91], a[104:107]
v_mfma_f32_16x16x32_bf16 a[108:111], v[172:175], v[92:95], a[108:111]
v_mul_f32 v120, v217, v120
v_mul_f32 v121, v217, v121
v_mul_f32 v122, v217, v122
v_mul_f32 v123, v217, v123
v_mul_f32 v124, v217, v124
v_mul_f32 v125, v217, v125
v_mul_f32 v126, v217, v126
v_mul_f32 v127, v217, v127
v_cvt_pk_bf16_f32 v52, v120, v121
v_cvt_pk_bf16_f32 v53, v122, v123
s_waitcnt lgkmcnt(0)
v_mfma_f32_16x16x32_bf16 a[112:115], v[176:179], v[80:83], a[112:115]
v_mfma_f32_16x16x32_bf16 a[116:119], v[176:179], v[84:87], a[116:119]
v_cvt_pk_bf16_f32 v54, v124, v125
v_cvt_pk_bf16_f32 v55, v126, v127
v_accvgpr_read_b32 v112, a80
v_accvgpr_read_b32 v113, a81
v_accvgpr_read_b32 v114, a82
v_accvgpr_read_b32 v115, a83
v_accvgpr_read_b32 v116, a88
v_accvgpr_read_b32 v117, a89
v_accvgpr_read_b32 v118, a90
v_accvgpr_read_b32 v119, a91
v_mfma_f32_16x16x32_bf16 a[112:115], v[180:183], v[88:91], a[112:115]
v_mfma_f32_16x16x32_bf16 a[116:119], v[180:183], v[92:95], a[116:119]
v_mul_f32 v112, v216, v112
v_mul_f32 v113, v216, v113
v_mul_f32 v114, v216, v114
v_mul_f32 v115, v216, v115
v_mul_f32 v116, v216, v116
v_mul_f32 v117, v216, v117
v_mul_f32 v118, v216, v118
v_mul_f32 v119, v216, v119
v_cvt_pk_bf16_f32 v56, v112, v113
v_cvt_pk_bf16_f32 v57, v114, v115
v_mfma_f32_16x16x32_bf16 a[120:123], v[184:187], v[80:83], a[120:123]
v_mfma_f32_16x16x32_bf16 a[124:127], v[184:187], v[84:87], a[124:127]
v_cvt_pk_bf16_f32 v58, v116, v117
v_cvt_pk_bf16_f32 v59, v118, v119
s_add_u32 m0, s62, 65536
s_add_u32 s22, s36, 384
buffer_load_dwordx4 v240, s[28:31], s22 offen lds
buffer_load_dwordx4 v241, s[28:31], s22 offen offset:1024 lds
buffer_load_dwordx4 v242, s[28:31], s22 offen offset:2048 lds
buffer_load_dwordx4 v243, s[28:31], s22 offen offset:3072 lds
s_add_u32 m0, m0, 4096
s_add_u32 s22, s22, 28672
v_mfma_f32_16x16x32_bf16 a[120:123], v[188:191], v[88:91], a[120:123]
v_mfma_f32_16x16x32_bf16 a[124:127], v[188:191], v[92:95], a[124:127]
buffer_load_dwordx4 v240, s[28:31], s22 offen lds
buffer_load_dwordx4 v241, s[28:31], s22 offen offset:1024 lds
buffer_load_dwordx4 v242, s[28:31], s22 offen offset:2048 lds
buffer_load_dwordx4 v243, s[28:31], s22 offen offset:3072 lds
v_accvgpr_read_b32 v120, a84
v_accvgpr_read_b32 v121, a85
v_accvgpr_read_b32 v122, a86
v_accvgpr_read_b32 v123, a87
v_accvgpr_read_b32 v124, a92
v_accvgpr_read_b32 v125, a93
s_nop 7
v_accvgpr_read_b32 v126, a94
v_accvgpr_read_b32 v127, a95
v_mul_f32 v120, v217, v120
v_mul_f32 v121, v217, v121
v_mul_f32 v122, v217, v122
v_mul_f32 v123, v217, v123
v_mul_f32 v124, v217, v124
v_mul_f32 v125, v217, v125
v_mul_f32 v126, v217, v126
v_mul_f32 v127, v217, v127
v_cvt_pk_bf16_f32 v60, v120, v121
v_cvt_pk_bf16_f32 v61, v122, v123
v_cvt_pk_bf16_f32 v62, v124, v125
v_cvt_pk_bf16_f32 v63, v126, v127
v_accvgpr_read_b32 v112, a96
v_accvgpr_read_b32 v113, a97
v_accvgpr_read_b32 v114, a98
v_accvgpr_read_b32 v115, a99
v_accvgpr_read_b32 v116, a104
v_accvgpr_read_b32 v117, a105
v_accvgpr_read_b32 v118, a106
v_accvgpr_read_b32 v119, a107
v_mul_f32 v112, v216, v112
v_mul_f32 v113, v216, v113
v_mul_f32 v114, v216, v114
v_mul_f32 v115, v216, v115
v_mul_f32 v116, v216, v116
v_mul_f32 v117, v216, v117
v_mul_f32 v118, v216, v118
v_mul_f32 v119, v216, v119
v_cvt_pk_bf16_f32 v64, v112, v113
v_cvt_pk_bf16_f32 v65, v114, v115
v_cvt_pk_bf16_f32 v66, v116, v117
v_cvt_pk_bf16_f32 v67, v118, v119
v_accvgpr_read_b32 v120, a100
v_accvgpr_read_b32 v121, a101
v_accvgpr_read_b32 v122, a102
v_accvgpr_read_b32 v123, a103
v_accvgpr_read_b32 v124, a108
v_accvgpr_read_b32 v125, a109
v_accvgpr_read_b32 v126, a110
v_accvgpr_read_b32 v127, a111
v_mul_f32 v120, v217, v120
v_mul_f32 v121, v217, v121
v_mul_f32 v122, v217, v122
v_mul_f32 v123, v217, v123
v_mul_f32 v124, v217, v124
v_mul_f32 v125, v217, v125
v_mul_f32 v126, v217, v126
v_mul_f32 v127, v217, v127
v_cvt_pk_bf16_f32 v68, v120, v121
v_cvt_pk_bf16_f32 v69, v122, v123
v_cvt_pk_bf16_f32 v70, v124, v125
v_cvt_pk_bf16_f32 v71, v126, v127
v_accvgpr_read_b32 v112, a112
v_accvgpr_read_b32 v113, a113
v_accvgpr_read_b32 v114, a114
v_accvgpr_read_b32 v115, a115
v_accvgpr_read_b32 v116, a120
v_accvgpr_read_b32 v117, a121
v_accvgpr_read_b32 v118, a122
v_accvgpr_read_b32 v119, a123
v_mul_f32 v112, v216, v112
v_mul_f32 v113, v216, v113
v_mul_f32 v114, v216, v114
v_mul_f32 v115, v216, v115
v_mul_f32 v116, v216, v116
v_mul_f32 v117, v216, v117
v_mul_f32 v118, v216, v118
v_mul_f32 v119, v216, v119
v_cvt_pk_bf16_f32 v72, v112, v113
v_cvt_pk_bf16_f32 v73, v114, v115
v_cvt_pk_bf16_f32 v74, v116, v117
v_cvt_pk_bf16_f32 v75, v118, v119
v_accvgpr_read_b32 v120, a116
v_accvgpr_read_b32 v121, a117
v_accvgpr_read_b32 v122, a118
v_accvgpr_read_b32 v123, a119
v_accvgpr_read_b32 v124, a124
v_accvgpr_read_b32 v125, a125
v_accvgpr_read_b32 v126, a126
v_accvgpr_read_b32 v127, a127
v_mul_f32 v120, v217, v120
v_mul_f32 v121, v217, v121
v_mul_f32 v122, v217, v122
v_mul_f32 v123, v217, v123
v_mul_f32 v124, v217, v124
v_mul_f32 v125, v217, v125
v_mul_f32 v126, v217, v126
v_mul_f32 v127, v217, v127
v_cvt_pk_bf16_f32 v76, v120, v121
v_cvt_pk_bf16_f32 v77, v122, v123
v_cvt_pk_bf16_f32 v78, v124, v125
v_cvt_pk_bf16_f32 v79, v126, v127
F_OUTPROJ:
v_and_b32 v5, 63, v0
v_lshrrev_b32 v9, 5, v5
v_lshlrev_b32 v9, 10, v9
v_bfe_u32 v10, v5, 2, 3
v_lshlrev_b32 v10, 5, v10
v_and_b32 v11, 3, v5
v_lshlrev_b32 v11, 3, v11
v_add3_u32 v6, v9, v10, v11
v_add_u32 v7, 65536, v6
v_add_u32 v8, 131072, v6
s_lshr_b32 s41, s2, 4
s_lshl_b32 s40, s41, 7
s_add_u32 s40, s40, 100667392
v_and_b32 v12, 15, v5
v_lshlrev_b32 v12, 2, v12
v_lshlrev_b32 v14, 2, v5
s_and_b32 s42, s2, 15
s_mul_i32 s42, s42, 7
s_add_u32 s42, s42, s12
s_mul_i32 s43, s41, 1835008
s_add_u32 s43, s43, 117440512
s_lshl_b32 s22, s42, 10
s_add_u32 s43, s43, s22
s_cmp_eq_u32 s12, 3
s_cselect_b32 s22, 1073741824, 4096
v_add_u32 v11, s22, v3
s_mov_b32 s44, 0
s_mov_b32 s45, 0
s_mov_b32 s50, 0
s_waitcnt vmcnt(24)
s_barrier
ds_read_b64_tr_b16 v[128:129], v7 offset:32768
ds_read_b64_tr_b16 v[130:131], v7 offset:34816
ds_read_b64_tr_b16 v[132:133], v7 offset:36864
ds_read_b64_tr_b16 v[134:135], v7 offset:38912
ds_read_b64_tr_b16 v[136:137], v7 offset:40960
ds_read_b64_tr_b16 v[138:139], v7 offset:43008
ds_read_b64_tr_b16 v[140:141], v7 offset:45056
ds_read_b64_tr_b16 v[142:143], v7 offset:47104
ds_read_b64_tr_b16 v[144:145], v7 offset:49152
ds_read_b64_tr_b16 v[146:147], v7 offset:51200
ds_read_b64_tr_b16 v[148:149], v7 offset:53248
ds_read_b64_tr_b16 v[150:151], v7 offset:55296
s_waitcnt lgkmcnt(8)
v_mfma_f32_16x16x32_bf16 v[80:83], v[128:131], v[16:19], 0
ds_read_b64_tr_b16 v[152:153], v7 offset:57344
v_mfma_f32_16x16x32_bf16 v[84:87], v[128:131], v[20:23], 0
ds_read_b64_tr_b16 v[154:155], v7 offset:59392
v_mfma_f32_16x16x32_bf16 v[80:83], v[132:135], v[24:27], v[80:83]
ds_read_b64_tr_b16 v[156:157], v7 offset:61440
v_mfma_f32_16x16x32_bf16 v[84:87], v[132:135], v[28:31], v[84:87]
ds_read_b64_tr_b16 v[158:159], v7 offset:63488
s_waitcnt lgkmcnt(8)
v_mfma_f32_16x16x32_bf16 v[80:83], v[136:139], v[32:35], v[80:83]
ds_read_b64_tr_b16 v[160:161], v7 offset:33024
s_add_u32 m0, s62, 131072
v_mfma_f32_16x16x32_bf16 v[84:87], v[136:139], v[36:39], v[84:87]
ds_read_b64_tr_b16 v[162:163], v7 offset:35072
s_add_u32 s22, s36, 512
v_mfma_f32_16x16x32_bf16 v[80:83], v[140:143], v[40:43], v[80:83]
ds_read_b64_tr_b16 v[164:165], v7 offset:37120
buffer_load_dwordx4 v240, s[28:31], s22 offen lds
v_mfma_f32_16x16x32_bf16 v[84:87], v[140:143], v[44:47], v[84:87]
ds_read_b64_tr_b16 v[166:167], v7 offset:39168
buffer_load_dwordx4 v241, s[28:31], s22 offen offset:1024 lds
s_waitcnt lgkmcnt(8)
v_mfma_f32_16x16x32_bf16 v[80:83], v[144:147], v[48:51], v[80:83]
ds_read_b64_tr_b16 v[168:169], v7 offset:41216
buffer_load_dwordx4 v242, s[28:31], s22 offen offset:2048 lds
v_mfma_f32_16x16x32_bf16 v[84:87], v[144:147], v[52:55], v[84:87]
ds_read_b64_tr_b16 v[170:171], v7 offset:43264
buffer_load_dwordx4 v243, s[28:31], s22 offen offset:3072 lds
v_mfma_f32_16x16x32_bf16 v[80:83], v[148:151], v[56:59], v[80:83]
ds_read_b64_tr_b16 v[172:173], v7 offset:45312
s_add_u32 m0, m0, 4096
v_mfma_f32_16x16x32_bf16 v[84:87], v[148:151], v[60:63], v[84:87]
ds_read_b64_tr_b16 v[174:175], v7 offset:47360
s_add_u32 s22, s22, 28672
s_waitcnt lgkmcnt(8)
v_mfma_f32_16x16x32_bf16 v[80:83], v[152:155], v[64:67], v[80:83]
ds_read_b64_tr_b16 v[176:177], v7 offset:49408
buffer_load_dwordx4 v240, s[28:31], s22 offen lds
v_mfma_f32_16x16x32_bf16 v[84:87], v[152:155], v[68:71], v[84:87]
ds_read_b64_tr_b16 v[178:179], v7 offset:51456
buffer_load_dwordx4 v241, s[28:31], s22 offen offset:1024 lds
v_mfma_f32_16x16x32_bf16 v[80:83], v[156:159], v[72:75], v[80:83]
ds_read_b64_tr_b16 v[180:181], v7 offset:53504
buffer_load_dwordx4 v242, s[28:31], s22 offen offset:2048 lds
v_mfma_f32_16x16x32_bf16 v[84:87], v[156:159], v[76:79], v[84:87]
ds_read_b64_tr_b16 v[182:183], v7 offset:55552
buffer_load_dwordx4 v243, s[28:31], s22 offen offset:3072 lds
s_waitcnt lgkmcnt(8)
v_mfma_f32_16x16x32_bf16 v[88:91], v[160:163], v[16:19], 0
ds_read_b64_tr_b16 v[184:185], v7 offset:57600
v_mfma_f32_16x16x32_bf16 v[92:95], v[160:163], v[20:23], 0
ds_read_b64_tr_b16 v[186:187], v7 offset:59648
v_mfma_f32_16x16x32_bf16 v[88:91], v[164:167], v[24:27], v[88:91]
ds_read_b64_tr_b16 v[188:189], v7 offset:61696
v_mfma_f32_16x16x32_bf16 v[92:95], v[164:167], v[28:31], v[92:95]
ds_read_b64_tr_b16 v[190:191], v7 offset:63744
s_waitcnt lgkmcnt(8)
v_mfma_f32_16x16x32_bf16 v[88:91], v[168:171], v[32:35], v[88:91]
ds_read_b64_tr_b16 v[128:129], v7 offset:33280
v_mfma_f32_16x16x32_bf16 v[92:95], v[168:171], v[36:39], v[92:95]
ds_read_b64_tr_b16 v[130:131], v7 offset:35328
v_mfma_f32_16x16x32_bf16 v[88:91], v[172:175], v[40:43], v[88:91]
ds_read_b64_tr_b16 v[132:133], v7 offset:37376
v_mfma_f32_16x16x32_bf16 v[92:95], v[172:175], v[44:47], v[92:95]
ds_read_b64_tr_b16 v[134:135], v7 offset:39424
s_waitcnt lgkmcnt(8)
v_mfma_f32_16x16x32_bf16 v[88:91], v[176:179], v[48:51], v[88:91]
ds_read_b64_tr_b16 v[136:137], v7 offset:41472
v_mfma_f32_16x16x32_bf16 v[92:95], v[176:179], v[52:55], v[92:95]
ds_read_b64_tr_b16 v[138:139], v7 offset:43520
v_mfma_f32_16x16x32_bf16 v[88:91], v[180:183], v[56:59], v[88:91]
ds_read_b64_tr_b16 v[140:141], v7 offset:45568
v_mfma_f32_16x16x32_bf16 v[92:95], v[180:183], v[60:63], v[92:95]
ds_read_b64_tr_b16 v[142:143], v7 offset:47616
s_waitcnt lgkmcnt(8)
v_mfma_f32_16x16x32_bf16 v[88:91], v[184:187], v[64:67], v[88:91]
ds_read_b64_tr_b16 v[144:145], v7 offset:49664
v_mfma_f32_16x16x32_bf16 v[92:95], v[184:187], v[68:71], v[92:95]
ds_read_b64_tr_b16 v[146:147], v7 offset:51712
v_mfma_f32_16x16x32_bf16 v[88:91], v[188:191], v[72:75], v[88:91]
ds_read_b64_tr_b16 v[148:149], v7 offset:53760
v_mfma_f32_16x16x32_bf16 v[92:95], v[188:191], v[76:79], v[92:95]
ds_read_b64_tr_b16 v[150:151], v7 offset:55808
s_waitcnt lgkmcnt(8)
v_mfma_f32_16x16x32_bf16 v[96:99], v[128:131], v[16:19], 0
ds_read_b64_tr_b16 v[152:153], v7 offset:57856
v_mfma_f32_16x16x32_bf16 v[100:103], v[128:131], v[20:23], 0
ds_read_b64_tr_b16 v[154:155], v7 offset:59904
v_mfma_f32_16x16x32_bf16 v[96:99], v[132:135], v[24:27], v[96:99]
ds_read_b64_tr_b16 v[156:157], v7 offset:61952
v_mfma_f32_16x16x32_bf16 v[100:103], v[132:135], v[28:31], v[100:103]
ds_read_b64_tr_b16 v[158:159], v7 offset:64000
s_waitcnt lgkmcnt(8)
v_mfma_f32_16x16x32_bf16 v[96:99], v[136:139], v[32:35], v[96:99]
ds_read_b64_tr_b16 v[160:161], v7 offset:33536
v_mfma_f32_16x16x32_bf16 v[100:103], v[136:139], v[36:39], v[100:103]
ds_read_b64_tr_b16 v[162:163], v7 offset:35584
v_mfma_f32_16x16x32_bf16 v[96:99], v[140:143], v[40:43], v[96:99]
ds_read_b64_tr_b16 v[164:165], v7 offset:37632
v_mfma_f32_16x16x32_bf16 v[100:103], v[140:143], v[44:47], v[100:103]
ds_read_b64_tr_b16 v[166:167], v7 offset:39680
s_waitcnt lgkmcnt(8)
v_mfma_f32_16x16x32_bf16 v[96:99], v[144:147], v[48:51], v[96:99]
ds_read_b64_tr_b16 v[168:169], v7 offset:41728
v_mfma_f32_16x16x32_bf16 v[100:103], v[144:147], v[52:55], v[100:103]
ds_read_b64_tr_b16 v[170:171], v7 offset:43776
v_mfma_f32_16x16x32_bf16 v[96:99], v[148:151], v[56:59], v[96:99]
ds_read_b64_tr_b16 v[172:173], v7 offset:45824
v_mfma_f32_16x16x32_bf16 v[100:103], v[148:151], v[60:63], v[100:103]
ds_read_b64_tr_b16 v[174:175], v7 offset:47872
s_waitcnt lgkmcnt(8)
v_mfma_f32_16x16x32_bf16 v[96:99], v[152:155], v[64:67], v[96:99]
ds_read_b64_tr_b16 v[176:177], v7 offset:49920
v_mfma_f32_16x16x32_bf16 v[100:103], v[152:155], v[68:71], v[100:103]
ds_read_b64_tr_b16 v[178:179], v7 offset:51968
v_mfma_f32_16x16x32_bf16 v[96:99], v[156:159], v[72:75], v[96:99]
ds_read_b64_tr_b16 v[180:181], v7 offset:54016
v_mfma_f32_16x16x32_bf16 v[100:103], v[156:159], v[76:79], v[100:103]
ds_read_b64_tr_b16 v[182:183], v7 offset:56064
s_waitcnt lgkmcnt(8)
v_mfma_f32_16x16x32_bf16 v[104:107], v[160:163], v[16:19], 0
ds_read_b64_tr_b16 v[184:185], v7 offset:58112
v_mfma_f32_16x16x32_bf16 v[108:111], v[160:163], v[20:23], 0
ds_read_b64_tr_b16 v[186:187], v7 offset:60160
v_mfma_f32_16x16x32_bf16 v[104:107], v[164:167], v[24:27], v[104:107]
ds_read_b64_tr_b16 v[188:189], v7 offset:62208
v_mfma_f32_16x16x32_bf16 v[108:111], v[164:167], v[28:31], v[108:111]
ds_read_b64_tr_b16 v[190:191], v7 offset:64256
s_waitcnt lgkmcnt(8)
v_mfma_f32_16x16x32_bf16 v[104:107], v[168:171], v[32:35], v[104:107]
s_waitcnt vmcnt(24)
s_barrier
ds_read_b64_tr_b16 v[128:129], v6 offset:0
v_mfma_f32_16x16x32_bf16 v[108:111], v[168:171], v[36:39], v[108:111]
ds_read_b64_tr_b16 v[130:131], v6 offset:2048
v_mfma_f32_16x16x32_bf16 v[104:107], v[172:175], v[40:43], v[104:107]
ds_read_b64_tr_b16 v[132:133], v6 offset:4096
v_mfma_f32_16x16x32_bf16 v[108:111], v[172:175], v[44:47], v[108:111]
ds_read_b64_tr_b16 v[134:135], v6 offset:6144
s_waitcnt lgkmcnt(8)
v_mfma_f32_16x16x32_bf16 v[104:107], v[176:179], v[48:51], v[104:107]
ds_read_b64_tr_b16 v[136:137], v6 offset:8192
v_mfma_f32_16x16x32_bf16 v[108:111], v[176:179], v[52:55], v[108:111]
ds_read_b64_tr_b16 v[138:139], v6 offset:10240
v_mfma_f32_16x16x32_bf16 v[104:107], v[180:183], v[56:59], v[104:107]
ds_read_b64_tr_b16 v[140:141], v6 offset:12288
v_mfma_f32_16x16x32_bf16 v[108:111], v[180:183], v[60:63], v[108:111]
ds_read_b64_tr_b16 v[142:143], v6 offset:14336
s_waitcnt lgkmcnt(8)
v_mfma_f32_16x16x32_bf16 v[104:107], v[184:187], v[64:67], v[104:107]
ds_read_b64_tr_b16 v[144:145], v6 offset:16384
v_mfma_f32_16x16x32_bf16 v[108:111], v[184:187], v[68:71], v[108:111]
ds_read_b64_tr_b16 v[146:147], v6 offset:18432
v_mfma_f32_16x16x32_bf16 v[104:107], v[188:191], v[72:75], v[104:107]
ds_read_b64_tr_b16 v[148:149], v6 offset:20480
v_mfma_f32_16x16x32_bf16 v[108:111], v[188:191], v[76:79], v[108:111]
ds_read_b64_tr_b16 v[150:151], v6 offset:22528
s_waitcnt lgkmcnt(8)
v_mfma_f32_16x16x32_bf16 v[192:195], v[128:131], v[16:19], 0
ds_read_b64_tr_b16 v[152:153], v6 offset:24576
v_mfma_f32_16x16x32_bf16 v[196:199], v[128:131], v[20:23], 0
ds_read_b64_tr_b16 v[154:155], v6 offset:26624
v_mfma_f32_16x16x32_bf16 v[192:195], v[132:135], v[24:27], v[192:195]
ds_read_b64_tr_b16 v[156:157], v6 offset:28672
v_mfma_f32_16x16x32_bf16 v[196:199], v[132:135], v[28:31], v[196:199]
ds_read_b64_tr_b16 v[158:159], v6 offset:30720
s_waitcnt lgkmcnt(8)
v_mfma_f32_16x16x32_bf16 v[192:195], v[136:139], v[32:35], v[192:195]
ds_read_b64_tr_b16 v[160:161], v6 offset:256
v_cvt_pk_bf16_f32 v224, v80, v81
v_mfma_f32_16x16x32_bf16 v[196:199], v[136:139], v[36:39], v[196:199]
ds_read_b64_tr_b16 v[162:163], v6 offset:2304
v_cvt_pk_bf16_f32 v225, v82, v83
v_mfma_f32_16x16x32_bf16 v[192:195], v[140:143], v[40:43], v[192:195]
ds_read_b64_tr_b16 v[164:165], v6 offset:4352
v_cvt_pk_bf16_f32 v226, v88, v89
v_mfma_f32_16x16x32_bf16 v[196:199], v[140:143], v[44:47], v[196:199]
ds_read_b64_tr_b16 v[166:167], v6 offset:6400
v_cvt_pk_bf16_f32 v227, v90, v91
s_waitcnt lgkmcnt(8)
v_mfma_f32_16x16x32_bf16 v[192:195], v[144:147], v[48:51], v[192:195]
ds_read_b64_tr_b16 v[168:169], v6 offset:8448
s_add_u32 s24, s37, 0
buffer_store_dwordx4 v[224:227], v3, s[4:7], s24 offen offset:0 sc1
v_mfma_f32_16x16x32_bf16 v[196:199], v[144:147], v[52:55], v[196:199]
ds_read_b64_tr_b16 v[170:171], v6 offset:10496
v_cvt_pk_bf16_f32 v228, v84, v85
v_mfma_f32_16x16x32_bf16 v[192:195], v[148:151], v[56:59], v[192:195]
ds_read_b64_tr_b16 v[172:173], v6 offset:12544
v_cvt_pk_bf16_f32 v229, v86, v87
v_mfma_f32_16x16x32_bf16 v[196:199], v[148:151], v[60:63], v[196:199]
ds_read_b64_tr_b16 v[174:175], v6 offset:14592
v_cvt_pk_bf16_f32 v230, v92, v93
s_waitcnt lgkmcnt(8)
v_mfma_f32_16x16x32_bf16 v[192:195], v[152:155], v[64:67], v[192:195]
ds_read_b64_tr_b16 v[176:177], v6 offset:16640
v_cvt_pk_bf16_f32 v231, v94, v95
v_mfma_f32_16x16x32_bf16 v[196:199], v[152:155], v[68:71], v[196:199]
ds_read_b64_tr_b16 v[178:179], v6 offset:18688
s_add_u32 s24, s37, 12288
buffer_store_dwordx4 v[228:231], v3, s[4:7], s24 offen offset:2048 sc1
v_mfma_f32_16x16x32_bf16 v[192:195], v[156:159], v[72:75], v[192:195]
ds_read_b64_tr_b16 v[180:181], v6 offset:20736
v_cvt_pk_bf16_f32 v232, v96, v97
v_mfma_f32_16x16x32_bf16 v[196:199], v[156:159], v[76:79], v[196:199]
ds_read_b64_tr_b16 v[182:183], v6 offset:22784
v_cvt_pk_bf16_f32 v233, v98, v99
s_waitcnt lgkmcnt(8)
v_mfma_f32_16x16x32_bf16 v[200:203], v[160:163], v[16:19], 0
ds_read_b64_tr_b16 v[184:185], v6 offset:24832
v_cvt_pk_bf16_f32 v234, v104, v105
v_mfma_f32_16x16x32_bf16 v[204:207], v[160:163], v[20:23], 0
ds_read_b64_tr_b16 v[186:187], v6 offset:26880
v_cvt_pk_bf16_f32 v235, v106, v107
v_mfma_f32_16x16x32_bf16 v[200:203], v[164:167], v[24:27], v[200:203]
ds_read_b64_tr_b16 v[188:189], v6 offset:28928
s_add_u32 s24, s37, 0
buffer_store_dwordx4 v[232:235], v3, s[4:7], s24 offen offset:1024 sc1
v_mfma_f32_16x16x32_bf16 v[204:207], v[164:167], v[28:31], v[204:207]
ds_read_b64_tr_b16 v[190:191], v6 offset:30976
v_cvt_pk_bf16_f32 v236, v100, v101
s_waitcnt lgkmcnt(8)
v_mfma_f32_16x16x32_bf16 v[200:203], v[168:171], v[32:35], v[200:203]
ds_read_b64_tr_b16 v[128:129], v6 offset:512
v_cvt_pk_bf16_f32 v237, v102, v103
v_mfma_f32_16x16x32_bf16 v[204:207], v[168:171], v[36:39], v[204:207]
ds_read_b64_tr_b16 v[130:131], v6 offset:2560
v_cvt_pk_bf16_f32 v238, v108, v109
v_mfma_f32_16x16x32_bf16 v[200:203], v[172:175], v[40:43], v[200:203]
ds_read_b64_tr_b16 v[132:133], v6 offset:4608
v_cvt_pk_bf16_f32 v239, v110, v111
v_mfma_f32_16x16x32_bf16 v[204:207], v[172:175], v[44:47], v[204:207]
ds_read_b64_tr_b16 v[134:135], v6 offset:6656
s_add_u32 s24, s37, 12288
buffer_store_dwordx4 v[236:239], v3, s[4:7], s24 offen offset:3072 sc1
s_waitcnt lgkmcnt(8)
v_mfma_f32_16x16x32_bf16 v[200:203], v[176:179], v[48:51], v[200:203]
ds_read_b64_tr_b16 v[136:137], v6 offset:8704
v_mfma_f32_16x16x32_bf16 v[204:207], v[176:179], v[52:55], v[204:207]
ds_read_b64_tr_b16 v[138:139], v6 offset:10752
v_mfma_f32_16x16x32_bf16 v[200:203], v[180:183], v[56:59], v[200:203]
ds_read_b64_tr_b16 v[140:141], v6 offset:12800
v_mfma_f32_16x16x32_bf16 v[204:207], v[180:183], v[60:63], v[204:207]
ds_read_b64_tr_b16 v[142:143], v6 offset:14848
s_waitcnt lgkmcnt(8)
v_mfma_f32_16x16x32_bf16 v[200:203], v[184:187], v[64:67], v[200:203]
ds_read_b64_tr_b16 v[144:145], v6 offset:16896
v_mfma_f32_16x16x32_bf16 v[204:207], v[184:187], v[68:71], v[204:207]
ds_read_b64_tr_b16 v[146:147], v6 offset:18944
v_mfma_f32_16x16x32_bf16 v[200:203], v[188:191], v[72:75], v[200:203]
ds_read_b64_tr_b16 v[148:149], v6 offset:20992
v_mfma_f32_16x16x32_bf16 v[204:207], v[188:191], v[76:79], v[204:207]
ds_read_b64_tr_b16 v[150:151], v6 offset:23040
s_waitcnt lgkmcnt(8)
v_mfma_f32_16x16x32_bf16 v[208:211], v[128:131], v[16:19], 0
ds_read_b64_tr_b16 v[152:153], v6 offset:25088
v_mfma_f32_16x16x32_bf16 v[212:215], v[128:131], v[20:23], 0
ds_read_b64_tr_b16 v[154:155], v6 offset:27136
v_mfma_f32_16x16x32_bf16 v[208:211], v[132:135], v[24:27], v[208:211]
ds_read_b64_tr_b16 v[156:157], v6 offset:29184
v_mfma_f32_16x16x32_bf16 v[212:215], v[132:135], v[28:31], v[212:215]
ds_read_b64_tr_b16 v[158:159], v6 offset:31232
s_waitcnt lgkmcnt(8)
v_mfma_f32_16x16x32_bf16 v[208:211], v[136:139], v[32:35], v[208:211]
ds_read_b64_tr_b16 v[160:161], v6 offset:768
v_mfma_f32_16x16x32_bf16 v[212:215], v[136:139], v[36:39], v[212:215]
ds_read_b64_tr_b16 v[162:163], v6 offset:2816
v_mfma_f32_16x16x32_bf16 v[208:211], v[140:143], v[40:43], v[208:211]
ds_read_b64_tr_b16 v[164:165], v6 offset:4864
v_mfma_f32_16x16x32_bf16 v[212:215], v[140:143], v[44:47], v[212:215]
ds_read_b64_tr_b16 v[166:167], v6 offset:6912
s_waitcnt lgkmcnt(8)
v_mfma_f32_16x16x32_bf16 v[208:211], v[144:147], v[48:51], v[208:211]
ds_read_b64_tr_b16 v[168:169], v6 offset:8960
v_mfma_f32_16x16x32_bf16 v[212:215], v[144:147], v[52:55], v[212:215]
ds_read_b64_tr_b16 v[170:171], v6 offset:11008
v_mfma_f32_16x16x32_bf16 v[208:211], v[148:151], v[56:59], v[208:211]
ds_read_b64_tr_b16 v[172:173], v6 offset:13056
v_mfma_f32_16x16x32_bf16 v[212:215], v[148:151], v[60:63], v[212:215]
ds_read_b64_tr_b16 v[174:175], v6 offset:15104
s_waitcnt lgkmcnt(8)
v_mfma_f32_16x16x32_bf16 v[208:211], v[152:155], v[64:67], v[208:211]
ds_read_b64_tr_b16 v[176:177], v6 offset:17152
v_mfma_f32_16x16x32_bf16 v[212:215], v[152:155], v[68:71], v[212:215]
ds_read_b64_tr_b16 v[178:179], v6 offset:19200
v_mfma_f32_16x16x32_bf16 v[208:211], v[156:159], v[72:75], v[208:211]
ds_read_b64_tr_b16 v[180:181], v6 offset:21248
v_mfma_f32_16x16x32_bf16 v[212:215], v[156:159], v[76:79], v[212:215]
ds_read_b64_tr_b16 v[182:183], v6 offset:23296
s_waitcnt lgkmcnt(8)
v_mfma_f32_16x16x32_bf16 v[216:219], v[160:163], v[16:19], 0
ds_read_b64_tr_b16 v[184:185], v6 offset:25344
v_mfma_f32_16x16x32_bf16 v[220:223], v[160:163], v[20:23], 0
ds_read_b64_tr_b16 v[186:187], v6 offset:27392
v_mfma_f32_16x16x32_bf16 v[216:219], v[164:167], v[24:27], v[216:219]
ds_read_b64_tr_b16 v[188:189], v6 offset:29440
v_mfma_f32_16x16x32_bf16 v[220:223], v[164:167], v[28:31], v[220:223]
ds_read_b64_tr_b16 v[190:191], v6 offset:31488
s_waitcnt lgkmcnt(8)
v_mfma_f32_16x16x32_bf16 v[216:219], v[168:171], v[32:35], v[216:219]
s_waitcnt vmcnt(20)
s_barrier
ds_read_b64_tr_b16 v[128:129], v6 offset:32768
v_mfma_f32_16x16x32_bf16 v[220:223], v[168:171], v[36:39], v[220:223]
ds_read_b64_tr_b16 v[130:131], v6 offset:34816
v_mfma_f32_16x16x32_bf16 v[216:219], v[172:175], v[40:43], v[216:219]
ds_read_b64_tr_b16 v[132:133], v6 offset:36864
v_mfma_f32_16x16x32_bf16 v[220:223], v[172:175], v[44:47], v[220:223]
ds_read_b64_tr_b16 v[134:135], v6 offset:38912
s_waitcnt lgkmcnt(8)
v_mfma_f32_16x16x32_bf16 v[216:219], v[176:179], v[48:51], v[216:219]
ds_read_b64_tr_b16 v[136:137], v6 offset:40960
v_mfma_f32_16x16x32_bf16 v[220:223], v[176:179], v[52:55], v[220:223]
ds_read_b64_tr_b16 v[138:139], v6 offset:43008
v_mfma_f32_16x16x32_bf16 v[216:219], v[180:183], v[56:59], v[216:219]
ds_read_b64_tr_b16 v[140:141], v6 offset:45056
v_mfma_f32_16x16x32_bf16 v[220:223], v[180:183], v[60:63], v[220:223]
ds_read_b64_tr_b16 v[142:143], v6 offset:47104
s_waitcnt lgkmcnt(8)
v_mfma_f32_16x16x32_bf16 v[216:219], v[184:187], v[64:67], v[216:219]
ds_read_b64_tr_b16 v[144:145], v6 offset:49152
v_mfma_f32_16x16x32_bf16 v[220:223], v[184:187], v[68:71], v[220:223]
ds_read_b64_tr_b16 v[146:147], v6 offset:51200
v_mfma_f32_16x16x32_bf16 v[216:219], v[188:191], v[72:75], v[216:219]
ds_read_b64_tr_b16 v[148:149], v6 offset:53248
v_mfma_f32_16x16x32_bf16 v[220:223], v[188:191], v[76:79], v[220:223]
ds_read_b64_tr_b16 v[150:151], v6 offset:55296
s_waitcnt lgkmcnt(8)
v_mfma_f32_16x16x32_bf16 v[80:83], v[128:131], v[16:19], 0
ds_read_b64_tr_b16 v[152:153], v6 offset:57344
v_mfma_f32_16x16x32_bf16 v[84:87], v[128:131], v[20:23], 0
ds_read_b64_tr_b16 v[154:155], v6 offset:59392
v_mfma_f32_16x16x32_bf16 v[80:83], v[132:135], v[24:27], v[80:83]
ds_read_b64_tr_b16 v[156:157], v6 offset:61440
v_mfma_f32_16x16x32_bf16 v[84:87], v[132:135], v[28:31], v[84:87]
ds_read_b64_tr_b16 v[158:159], v6 offset:63488
s_waitcnt lgkmcnt(8)
v_mfma_f32_16x16x32_bf16 v[80:83], v[136:139], v[32:35], v[80:83]
ds_read_b64_tr_b16 v[160:161], v6 offset:33024
v_cvt_pk_bf16_f32 v224, v192, v193
v_mfma_f32_16x16x32_bf16 v[84:87], v[136:139], v[36:39], v[84:87]
ds_read_b64_tr_b16 v[162:163], v6 offset:35072
v_cvt_pk_bf16_f32 v225, v194, v195
v_mfma_f32_16x16x32_bf16 v[80:83], v[140:143], v[40:43], v[80:83]
ds_read_b64_tr_b16 v[164:165], v6 offset:37120
v_cvt_pk_bf16_f32 v226, v200, v201
v_mfma_f32_16x16x32_bf16 v[84:87], v[140:143], v[44:47], v[84:87]
ds_read_b64_tr_b16 v[166:167], v6 offset:39168
v_cvt_pk_bf16_f32 v227, v202, v203
s_waitcnt lgkmcnt(8)
v_mfma_f32_16x16x32_bf16 v[80:83], v[144:147], v[48:51], v[80:83]
ds_read_b64_tr_b16 v[168:169], v6 offset:41216
s_add_u32 s24, s37, 0
buffer_store_dwordx4 v[224:227], v3, s[4:7], s24 offen offset:2048 sc1
v_mfma_f32_16x16x32_bf16 v[84:87], v[144:147], v[52:55], v[84:87]
ds_read_b64_tr_b16 v[170:171], v6 offset:43264
v_cvt_pk_bf16_f32 v228, v196, v197
v_mfma_f32_16x16x32_bf16 v[80:83], v[148:151], v[56:59], v[80:83]
ds_read_b64_tr_b16 v[172:173], v6 offset:45312
v_cvt_pk_bf16_f32 v229, v198, v199
v_mfma_f32_16x16x32_bf16 v[84:87], v[148:151], v[60:63], v[84:87]
ds_read_b64_tr_b16 v[174:175], v6 offset:47360
v_cvt_pk_bf16_f32 v230, v204, v205
s_waitcnt lgkmcnt(8)
v_mfma_f32_16x16x32_bf16 v[80:83], v[152:155], v[64:67], v[80:83]
ds_read_b64_tr_b16 v[176:177], v6 offset:49408
v_cvt_pk_bf16_f32 v231, v206, v207
v_mfma_f32_16x16x32_bf16 v[84:87], v[152:155], v[68:71], v[84:87]
ds_read_b64_tr_b16 v[178:179], v6 offset:51456
s_add_u32 s24, s37, 16384
buffer_store_dwordx4 v[228:231], v3, s[4:7], s24 offen offset:0 sc1
v_mfma_f32_16x16x32_bf16 v[80:83], v[156:159], v[72:75], v[80:83]
ds_read_b64_tr_b16 v[180:181], v6 offset:53504
v_cvt_pk_bf16_f32 v232, v208, v209
v_mfma_f32_16x16x32_bf16 v[84:87], v[156:159], v[76:79], v[84:87]
ds_read_b64_tr_b16 v[182:183], v6 offset:55552
v_cvt_pk_bf16_f32 v233, v210, v211
s_waitcnt lgkmcnt(8)
v_mfma_f32_16x16x32_bf16 v[88:91], v[160:163], v[16:19], 0
ds_read_b64_tr_b16 v[184:185], v6 offset:57600
v_cvt_pk_bf16_f32 v234, v216, v217
v_mfma_f32_16x16x32_bf16 v[92:95], v[160:163], v[20:23], 0
ds_read_b64_tr_b16 v[186:187], v6 offset:59648
v_cvt_pk_bf16_f32 v235, v218, v219
v_mfma_f32_16x16x32_bf16 v[88:91], v[164:167], v[24:27], v[88:91]
ds_read_b64_tr_b16 v[188:189], v6 offset:61696
s_add_u32 s24, s37, 0
buffer_store_dwordx4 v[232:235], v3, s[4:7], s24 offen offset:3072 sc1
v_mfma_f32_16x16x32_bf16 v[92:95], v[164:167], v[28:31], v[92:95]
ds_read_b64_tr_b16 v[190:191], v6 offset:63744
v_cvt_pk_bf16_f32 v236, v212, v213
s_waitcnt lgkmcnt(8)
v_mfma_f32_16x16x32_bf16 v[88:91], v[168:171], v[32:35], v[88:91]
ds_read_b64_tr_b16 v[128:129], v6 offset:33280
v_cvt_pk_bf16_f32 v237, v214, v215
v_mfma_f32_16x16x32_bf16 v[92:95], v[168:171], v[36:39], v[92:95]
ds_read_b64_tr_b16 v[130:131], v6 offset:35328
v_cvt_pk_bf16_f32 v238, v220, v221
v_mfma_f32_16x16x32_bf16 v[88:91], v[172:175], v[40:43], v[88:91]
ds_read_b64_tr_b16 v[132:133], v6 offset:37376
v_cvt_pk_bf16_f32 v239, v222, v223
v_mfma_f32_16x16x32_bf16 v[92:95], v[172:175], v[44:47], v[92:95]
ds_read_b64_tr_b16 v[134:135], v6 offset:39424
s_add_u32 s24, s37, 16384
buffer_store_dwordx4 v[236:239], v3, s[4:7], s24 offen offset:1024 sc1
s_waitcnt lgkmcnt(8)
v_mfma_f32_16x16x32_bf16 v[88:91], v[176:179], v[48:51], v[88:91]
ds_read_b64_tr_b16 v[136:137], v6 offset:41472
s_add_u32 m0, s62, 98304
v_mfma_f32_16x16x32_bf16 v[92:95], v[176:179], v[52:55], v[92:95]
ds_read_b64_tr_b16 v[138:139], v6 offset:43520
s_add_u32 s22, s36, 640
v_mfma_f32_16x16x32_bf16 v[88:91], v[180:183], v[56:59], v[88:91]
ds_read_b64_tr_b16 v[140:141], v6 offset:45568
buffer_load_dwordx4 v240, s[28:31], s22 offen lds
v_mfma_f32_16x16x32_bf16 v[92:95], v[180:183], v[60:63], v[92:95]
ds_read_b64_tr_b16 v[142:143], v6 offset:47616
buffer_load_dwordx4 v241, s[28:31], s22 offen offset:1024 lds
s_waitcnt lgkmcnt(8)
v_mfma_f32_16x16x32_bf16 v[88:91], v[184:187], v[64:67], v[88:91]
ds_read_b64_tr_b16 v[144:145], v6 offset:49664
buffer_load_dwordx4 v242, s[28:31], s22 offen offset:2048 lds
v_mfma_f32_16x16x32_bf16 v[92:95], v[184:187], v[68:71], v[92:95]
ds_read_b64_tr_b16 v[146:147], v6 offset:51712
buffer_load_dwordx4 v243, s[28:31], s22 offen offset:3072 lds
v_mfma_f32_16x16x32_bf16 v[88:91], v[188:191], v[72:75], v[88:91]
ds_read_b64_tr_b16 v[148:149], v6 offset:53760
s_add_u32 m0, m0, 4096
v_mfma_f32_16x16x32_bf16 v[92:95], v[188:191], v[76:79], v[92:95]
ds_read_b64_tr_b16 v[150:151], v6 offset:55808
s_add_u32 s22, s22, 28672
s_waitcnt lgkmcnt(8)
v_mfma_f32_16x16x32_bf16 v[96:99], v[128:131], v[16:19], 0
ds_read_b64_tr_b16 v[152:153], v6 offset:57856
buffer_load_dwordx4 v240, s[28:31], s22 offen lds
v_mfma_f32_16x16x32_bf16 v[100:103], v[128:131], v[20:23], 0
ds_read_b64_tr_b16 v[154:155], v6 offset:59904
buffer_load_dwordx4 v241, s[28:31], s22 offen offset:1024 lds
v_mfma_f32_16x16x32_bf16 v[96:99], v[132:135], v[24:27], v[96:99]
ds_read_b64_tr_b16 v[156:157], v6 offset:61952
buffer_load_dwordx4 v242, s[28:31], s22 offen offset:2048 lds
v_mfma_f32_16x16x32_bf16 v[100:103], v[132:135], v[28:31], v[100:103]
ds_read_b64_tr_b16 v[158:159], v6 offset:64000
buffer_load_dwordx4 v243, s[28:31], s22 offen offset:3072 lds
s_waitcnt lgkmcnt(8)
v_mfma_f32_16x16x32_bf16 v[96:99], v[136:139], v[32:35], v[96:99]
ds_read_b64_tr_b16 v[160:161], v6 offset:33536
v_mfma_f32_16x16x32_bf16 v[100:103], v[136:139], v[36:39], v[100:103]
ds_read_b64_tr_b16 v[162:163], v6 offset:35584
v_mfma_f32_16x16x32_bf16 v[96:99], v[140:143], v[40:43], v[96:99]
ds_read_b64_tr_b16 v[164:165], v6 offset:37632
v_mfma_f32_16x16x32_bf16 v[100:103], v[140:143], v[44:47], v[100:103]
ds_read_b64_tr_b16 v[166:167], v6 offset:39680
s_waitcnt lgkmcnt(8)
v_mfma_f32_16x16x32_bf16 v[96:99], v[144:147], v[48:51], v[96:99]
ds_read_b64_tr_b16 v[168:169], v6 offset:41728
v_mfma_f32_16x16x32_bf16 v[100:103], v[144:147], v[52:55], v[100:103]
ds_read_b64_tr_b16 v[170:171], v6 offset:43776
v_mfma_f32_16x16x32_bf16 v[96:99], v[148:151], v[56:59], v[96:99]
ds_read_b64_tr_b16 v[172:173], v6 offset:45824
v_mfma_f32_16x16x32_bf16 v[100:103], v[148:151], v[60:63], v[100:103]
ds_read_b64_tr_b16 v[174:175], v6 offset:47872
s_waitcnt lgkmcnt(8)
v_mfma_f32_16x16x32_bf16 v[96:99], v[152:155], v[64:67], v[96:99]
ds_read_b64_tr_b16 v[176:177], v6 offset:49920
v_mfma_f32_16x16x32_bf16 v[100:103], v[152:155], v[68:71], v[100:103]
ds_read_b64_tr_b16 v[178:179], v6 offset:51968
v_mfma_f32_16x16x32_bf16 v[96:99], v[156:159], v[72:75], v[96:99]
ds_read_b64_tr_b16 v[180:181], v6 offset:54016
v_mfma_f32_16x16x32_bf16 v[100:103], v[156:159], v[76:79], v[100:103]
ds_read_b64_tr_b16 v[182:183], v6 offset:56064
s_waitcnt lgkmcnt(8)
v_mfma_f32_16x16x32_bf16 v[104:107], v[160:163], v[16:19], 0
ds_read_b64_tr_b16 v[184:185], v6 offset:58112
v_mfma_f32_16x16x32_bf16 v[108:111], v[160:163], v[20:23], 0
ds_read_b64_tr_b16 v[186:187], v6 offset:60160
v_mfma_f32_16x16x32_bf16 v[104:107], v[164:167], v[24:27], v[104:107]
ds_read_b64_tr_b16 v[188:189], v6 offset:62208
v_mfma_f32_16x16x32_bf16 v[108:111], v[164:167], v[28:31], v[108:111]
ds_read_b64_tr_b16 v[190:191], v6 offset:64256
s_waitcnt lgkmcnt(8)
v_mfma_f32_16x16x32_bf16 v[104:107], v[168:171], v[32:35], v[104:107]
s_waitcnt vmcnt(24)
s_barrier
ds_read_b64_tr_b16 v[128:129], v7 offset:0
v_mfma_f32_16x16x32_bf16 v[108:111], v[168:171], v[36:39], v[108:111]
ds_read_b64_tr_b16 v[130:131], v7 offset:2048
v_mfma_f32_16x16x32_bf16 v[104:107], v[172:175], v[40:43], v[104:107]
ds_read_b64_tr_b16 v[132:133], v7 offset:4096
v_mfma_f32_16x16x32_bf16 v[108:111], v[172:175], v[44:47], v[108:111]
ds_read_b64_tr_b16 v[134:135], v7 offset:6144
s_waitcnt lgkmcnt(8)
v_mfma_f32_16x16x32_bf16 v[104:107], v[176:179], v[48:51], v[104:107]
ds_read_b64_tr_b16 v[136:137], v7 offset:8192
v_mfma_f32_16x16x32_bf16 v[108:111], v[176:179], v[52:55], v[108:111]
ds_read_b64_tr_b16 v[138:139], v7 offset:10240
v_mfma_f32_16x16x32_bf16 v[104:107], v[180:183], v[56:59], v[104:107]
ds_read_b64_tr_b16 v[140:141], v7 offset:12288
v_mfma_f32_16x16x32_bf16 v[108:111], v[180:183], v[60:63], v[108:111]
ds_read_b64_tr_b16 v[142:143], v7 offset:14336
s_waitcnt lgkmcnt(8)
v_mfma_f32_16x16x32_bf16 v[104:107], v[184:187], v[64:67], v[104:107]
ds_read_b64_tr_b16 v[144:145], v7 offset:16384
v_mfma_f32_16x16x32_bf16 v[108:111], v[184:187], v[68:71], v[108:111]
ds_read_b64_tr_b16 v[146:147], v7 offset:18432
v_mfma_f32_16x16x32_bf16 v[104:107], v[188:191], v[72:75], v[104:107]
ds_read_b64_tr_b16 v[148:149], v7 offset:20480
v_mfma_f32_16x16x32_bf16 v[108:111], v[188:191], v[76:79], v[108:111]
ds_read_b64_tr_b16 v[150:151], v7 offset:22528
s_waitcnt lgkmcnt(8)
v_mfma_f32_16x16x32_bf16 v[192:195], v[128:131], v[16:19], 0
ds_read_b64_tr_b16 v[152:153], v7 offset:24576
v_mfma_f32_16x16x32_bf16 v[196:199], v[128:131], v[20:23], 0
ds_read_b64_tr_b16 v[154:155], v7 offset:26624
v_mfma_f32_16x16x32_bf16 v[192:195], v[132:135], v[24:27], v[192:195]
ds_read_b64_tr_b16 v[156:157], v7 offset:28672
v_mfma_f32_16x16x32_bf16 v[196:199], v[132:135], v[28:31], v[196:199]
ds_read_b64_tr_b16 v[158:159], v7 offset:30720
s_waitcnt lgkmcnt(8)
v_mfma_f32_16x16x32_bf16 v[192:195], v[136:139], v[32:35], v[192:195]
ds_read_b64_tr_b16 v[160:161], v7 offset:256
buffer_load_dword v13, v12, s[4:7], s40 offen sc1
v_mfma_f32_16x16x32_bf16 v[196:199], v[136:139], v[36:39], v[196:199]
ds_read_b64_tr_b16 v[162:163], v7 offset:2304
v_cvt_pk_bf16_f32 v224, v80, v81
v_mfma_f32_16x16x32_bf16 v[192:195], v[140:143], v[40:43], v[192:195]
ds_read_b64_tr_b16 v[164:165], v7 offset:4352
v_cvt_pk_bf16_f32 v225, v82, v83
v_mfma_f32_16x16x32_bf16 v[196:199], v[140:143], v[44:47], v[196:199]
ds_read_b64_tr_b16 v[166:167], v7 offset:6400
v_cvt_pk_bf16_f32 v226, v88, v89
s_waitcnt lgkmcnt(8)
v_mfma_f32_16x16x32_bf16 v[192:195], v[144:147], v[48:51], v[192:195]
ds_read_b64_tr_b16 v[168:169], v7 offset:8448
v_cvt_pk_bf16_f32 v227, v90, v91
v_mfma_f32_16x16x32_bf16 v[196:199], v[144:147], v[52:55], v[196:199]
ds_read_b64_tr_b16 v[170:171], v7 offset:10496
s_add_u32 s24, s37, 4096
buffer_store_dwordx4 v[224:227], v3, s[4:7], s24 offen offset:0 sc1
v_mfma_f32_16x16x32_bf16 v[192:195], v[148:151], v[56:59], v[192:195]
ds_read_b64_tr_b16 v[172:173], v7 offset:12544
v_cvt_pk_bf16_f32 v228, v84, v85
v_mfma_f32_16x16x32_bf16 v[196:199], v[148:151], v[60:63], v[196:199]
ds_read_b64_tr_b16 v[174:175], v7 offset:14592
v_cvt_pk_bf16_f32 v229, v86, v87
s_waitcnt lgkmcnt(8)
v_mfma_f32_16x16x32_bf16 v[192:195], v[152:155], v[64:67], v[192:195]
ds_read_b64_tr_b16 v[176:177], v7 offset:16640
v_cvt_pk_bf16_f32 v230, v92, v93
v_mfma_f32_16x16x32_bf16 v[196:199], v[152:155], v[68:71], v[196:199]
ds_read_b64_tr_b16 v[178:179], v7 offset:18688
v_cvt_pk_bf16_f32 v231, v94, v95
v_mfma_f32_16x16x32_bf16 v[192:195], v[156:159], v[72:75], v[192:195]
ds_read_b64_tr_b16 v[180:181], v7 offset:20736
s_add_u32 s24, s37, 16384
buffer_store_dwordx4 v[228:231], v3, s[4:7], s24 offen offset:2048 sc1
v_mfma_f32_16x16x32_bf16 v[196:199], v[156:159], v[76:79], v[196:199]
ds_read_b64_tr_b16 v[182:183], v7 offset:22784
v_cvt_pk_bf16_f32 v232, v96, v97
s_waitcnt lgkmcnt(8)
v_mfma_f32_16x16x32_bf16 v[200:203], v[160:163], v[16:19], 0
ds_read_b64_tr_b16 v[184:185], v7 offset:24832
v_cvt_pk_bf16_f32 v233, v98, v99
v_mfma_f32_16x16x32_bf16 v[204:207], v[160:163], v[20:23], 0
ds_read_b64_tr_b16 v[186:187], v7 offset:26880
v_cvt_pk_bf16_f32 v234, v104, v105
v_mfma_f32_16x16x32_bf16 v[200:203], v[164:167], v[24:27], v[200:203]
ds_read_b64_tr_b16 v[188:189], v7 offset:28928
v_cvt_pk_bf16_f32 v235, v106, v107
v_mfma_f32_16x16x32_bf16 v[204:207], v[164:167], v[28:31], v[204:207]
ds_read_b64_tr_b16 v[190:191], v7 offset:30976
s_add_u32 s24, s37, 4096
buffer_store_dwordx4 v[232:235], v3, s[4:7], s24 offen offset:1024 sc1
s_waitcnt lgkmcnt(8)
v_mfma_f32_16x16x32_bf16 v[200:203], v[168:171], v[32:35], v[200:203]
ds_read_b64_tr_b16 v[128:129], v7 offset:512
v_cvt_pk_bf16_f32 v236, v100, v101
v_mfma_f32_16x16x32_bf16 v[204:207], v[168:171], v[36:39], v[204:207]
ds_read_b64_tr_b16 v[130:131], v7 offset:2560
v_cvt_pk_bf16_f32 v237, v102, v103
v_mfma_f32_16x16x32_bf16 v[200:203], v[172:175], v[40:43], v[200:203]
ds_read_b64_tr_b16 v[132:133], v7 offset:4608
v_cvt_pk_bf16_f32 v238, v108, v109
v_mfma_f32_16x16x32_bf16 v[204:207], v[172:175], v[44:47], v[204:207]
ds_read_b64_tr_b16 v[134:135], v7 offset:6656
v_cvt_pk_bf16_f32 v239, v110, v111
s_waitcnt lgkmcnt(8)
v_mfma_f32_16x16x32_bf16 v[200:203], v[176:179], v[48:51], v[200:203]
ds_read_b64_tr_b16 v[136:137], v7 offset:8704
s_add_u32 s24, s37, 16384
buffer_store_dwordx4 v[236:239], v3, s[4:7], s24 offen offset:3072 sc1
v_mfma_f32_16x16x32_bf16 v[204:207], v[176:179], v[52:55], v[204:207]
ds_read_b64_tr_b16 v[138:139], v7 offset:10752
s_add_u32 m0, s62, 0
v_mfma_f32_16x16x32_bf16 v[200:203], v[180:183], v[56:59], v[200:203]
ds_read_b64_tr_b16 v[140:141], v7 offset:12800
s_add_u32 s22, s36, 768
v_mfma_f32_16x16x32_bf16 v[204:207], v[180:183], v[60:63], v[204:207]
ds_read_b64_tr_b16 v[142:143], v7 offset:14848
buffer_load_dwordx4 v240, s[28:31], s22 offen lds
s_waitcnt lgkmcnt(8)
v_mfma_f32_16x16x32_bf16 v[200:203], v[184:187], v[64:67], v[200:203]
ds_read_b64_tr_b16 v[144:145], v7 offset:16896
buffer_load_dwordx4 v241, s[28:31], s22 offen offset:1024 lds
v_mfma_f32_16x16x32_bf16 v[204:207], v[184:187], v[68:71], v[204:207]
ds_read_b64_tr_b16 v[146:147], v7 offset:18944
buffer_load_dwordx4 v242, s[28:31], s22 offen offset:2048 lds
v_mfma_f32_16x16x32_bf16 v[200:203], v[188:191], v[72:75], v[200:203]
ds_read_b64_tr_b16 v[148:149], v7 offset:20992
buffer_load_dwordx4 v243, s[28:31], s22 offen offset:3072 lds
v_mfma_f32_16x16x32_bf16 v[204:207], v[188:191], v[76:79], v[204:207]
ds_read_b64_tr_b16 v[150:151], v7 offset:23040
s_add_u32 m0, m0, 4096
s_waitcnt lgkmcnt(8)
v_mfma_f32_16x16x32_bf16 v[208:211], v[128:131], v[16:19], 0
ds_read_b64_tr_b16 v[152:153], v7 offset:25088
s_add_u32 s22, s22, 28672
v_mfma_f32_16x16x32_bf16 v[212:215], v[128:131], v[20:23], 0
ds_read_b64_tr_b16 v[154:155], v7 offset:27136
buffer_load_dwordx4 v240, s[28:31], s22 offen lds
v_mfma_f32_16x16x32_bf16 v[208:211], v[132:135], v[24:27], v[208:211]
ds_read_b64_tr_b16 v[156:157], v7 offset:29184
buffer_load_dwordx4 v241, s[28:31], s22 offen offset:1024 lds
v_mfma_f32_16x16x32_bf16 v[212:215], v[132:135], v[28:31], v[212:215]
ds_read_b64_tr_b16 v[158:159], v7 offset:31232
buffer_load_dwordx4 v242, s[28:31], s22 offen offset:2048 lds
s_waitcnt lgkmcnt(8)
v_mfma_f32_16x16x32_bf16 v[208:211], v[136:139], v[32:35], v[208:211]
ds_read_b64_tr_b16 v[160:161], v7 offset:768
buffer_load_dwordx4 v243, s[28:31], s22 offen offset:3072 lds
v_mfma_f32_16x16x32_bf16 v[212:215], v[136:139], v[36:39], v[212:215]
ds_read_b64_tr_b16 v[162:163], v7 offset:2816
v_mfma_f32_16x16x32_bf16 v[208:211], v[140:143], v[40:43], v[208:211]
ds_read_b64_tr_b16 v[164:165], v7 offset:4864
v_mfma_f32_16x16x32_bf16 v[212:215], v[140:143], v[44:47], v[212:215]
ds_read_b64_tr_b16 v[166:167], v7 offset:6912
s_waitcnt lgkmcnt(8)
v_mfma_f32_16x16x32_bf16 v[208:211], v[144:147], v[48:51], v[208:211]
ds_read_b64_tr_b16 v[168:169], v7 offset:8960
v_mfma_f32_16x16x32_bf16 v[212:215], v[144:147], v[52:55], v[212:215]
ds_read_b64_tr_b16 v[170:171], v7 offset:11008
v_mfma_f32_16x16x32_bf16 v[208:211], v[148:151], v[56:59], v[208:211]
ds_read_b64_tr_b16 v[172:173], v7 offset:13056
v_mfma_f32_16x16x32_bf16 v[212:215], v[148:151], v[60:63], v[212:215]
ds_read_b64_tr_b16 v[174:175], v7 offset:15104
s_waitcnt lgkmcnt(8)
v_mfma_f32_16x16x32_bf16 v[208:211], v[152:155], v[64:67], v[208:211]
ds_read_b64_tr_b16 v[176:177], v7 offset:17152
v_mfma_f32_16x16x32_bf16 v[212:215], v[152:155], v[68:71], v[212:215]
ds_read_b64_tr_b16 v[178:179], v7 offset:19200
v_mfma_f32_16x16x32_bf16 v[208:211], v[156:159], v[72:75], v[208:211]
ds_read_b64_tr_b16 v[180:181], v7 offset:21248
v_mfma_f32_16x16x32_bf16 v[212:215], v[156:159], v[76:79], v[212:215]
ds_read_b64_tr_b16 v[182:183], v7 offset:23296
s_waitcnt lgkmcnt(8)
v_mfma_f32_16x16x32_bf16 v[216:219], v[160:163], v[16:19], 0
ds_read_b64_tr_b16 v[184:185], v7 offset:25344
v_mfma_f32_16x16x32_bf16 v[220:223], v[160:163], v[20:23], 0
ds_read_b64_tr_b16 v[186:187], v7 offset:27392
v_mfma_f32_16x16x32_bf16 v[216:219], v[164:167], v[24:27], v[216:219]
ds_read_b64_tr_b16 v[188:189], v7 offset:29440
v_mfma_f32_16x16x32_bf16 v[220:223], v[164:167], v[28:31], v[220:223]
ds_read_b64_tr_b16 v[190:191], v7 offset:31488
s_waitcnt lgkmcnt(8)
v_mfma_f32_16x16x32_bf16 v[216:219], v[168:171], v[32:35], v[216:219]
s_waitcnt vmcnt(29)
s_barrier
ds_read_b64_tr_b16 v[128:129], v8 offset:0
v_mfma_f32_16x16x32_bf16 v[220:223], v[168:171], v[36:39], v[220:223]
ds_read_b64_tr_b16 v[130:131], v8 offset:2048
v_mfma_f32_16x16x32_bf16 v[216:219], v[172:175], v[40:43], v[216:219]
ds_read_b64_tr_b16 v[132:133], v8 offset:4096
v_mfma_f32_16x16x32_bf16 v[220:223], v[172:175], v[44:47], v[220:223]
ds_read_b64_tr_b16 v[134:135], v8 offset:6144
s_waitcnt lgkmcnt(8)
v_mfma_f32_16x16x32_bf16 v[216:219], v[176:179], v[48:51], v[216:219]
ds_read_b64_tr_b16 v[136:137], v8 offset:8192
v_mfma_f32_16x16x32_bf16 v[220:223], v[176:179], v[52:55], v[220:223]
ds_read_b64_tr_b16 v[138:139], v8 offset:10240
v_mfma_f32_16x16x32_bf16 v[216:219], v[180:183], v[56:59], v[216:219]
ds_read_b64_tr_b16 v[140:141], v8 offset:12288
v_mfma_f32_16x16x32_bf16 v[220:223], v[180:183], v[60:63], v[220:223]
ds_read_b64_tr_b16 v[142:143], v8 offset:14336
s_waitcnt lgkmcnt(8)
v_mfma_f32_16x16x32_bf16 v[216:219], v[184:187], v[64:67], v[216:219]
ds_read_b64_tr_b16 v[144:145], v8 offset:16384
v_mfma_f32_16x16x32_bf16 v[220:223], v[184:187], v[68:71], v[220:223]
ds_read_b64_tr_b16 v[146:147], v8 offset:18432
v_mfma_f32_16x16x32_bf16 v[216:219], v[188:191], v[72:75], v[216:219]
ds_read_b64_tr_b16 v[148:149], v8 offset:20480
v_mfma_f32_16x16x32_bf16 v[220:223], v[188:191], v[76:79], v[220:223]
ds_read_b64_tr_b16 v[150:151], v8 offset:22528
s_waitcnt vmcnt(12)
v_cmp_eq_u32 vcc, 1, v13
s_nop 3
s_lshr_b32 s50, vcc_lo, 1
s_and_b32 s50, s50, vcc_lo
s_and_b32 s50, s50, 0x5555
s_and_b32 s25, s50, 21
s_or_b32 s44, s44, s25
s_waitcnt lgkmcnt(8)
v_mfma_f32_16x16x32_bf16 v[80:83], v[128:131], v[16:19], 0
ds_read_b64_tr_b16 v[152:153], v8 offset:24576
v_mfma_f32_16x16x32_bf16 v[84:87], v[128:131], v[20:23], 0
ds_read_b64_tr_b16 v[154:155], v8 offset:26624
v_mfma_f32_16x16x32_bf16 v[80:83], v[132:135], v[24:27], v[80:83]
ds_read_b64_tr_b16 v[156:157], v8 offset:28672
v_mfma_f32_16x16x32_bf16 v[84:87], v[132:135], v[28:31], v[84:87]
ds_read_b64_tr_b16 v[158:159], v8 offset:30720
s_waitcnt lgkmcnt(8)
v_mfma_f32_16x16x32_bf16 v[80:83], v[136:139], v[32:35], v[80:83]
ds_read_b64_tr_b16 v[160:161], v8 offset:256
buffer_load_dword v13, v12, s[4:7], s40 offen sc1
v_mfma_f32_16x16x32_bf16 v[84:87], v[136:139], v[36:39], v[84:87]
ds_read_b64_tr_b16 v[162:163], v8 offset:2304
s_add_u32 s51, s43, 0
s_bitcmp1_b32 s50, 0
s_cselect_b32 s51, s51, 1073741824
v_mfma_f32_16x16x32_bf16 v[80:83], v[140:143], v[40:43], v[80:83]
ds_read_b64_tr_b16 v[164:165], v8 offset:4352
buffer_load_dwordx4 a[0:3], v3, s[4:7], s51 offen sc1
v_mfma_f32_16x16x32_bf16 v[84:87], v[140:143], v[44:47], v[84:87]
ds_read_b64_tr_b16 v[166:167], v8 offset:6400
buffer_load_dwordx4 a[8:11], v11, s[4:7], s51 offen sc1
s_waitcnt lgkmcnt(8)
v_mfma_f32_16x16x32_bf16 v[80:83], v[144:147], v[48:51], v[80:83]
ds_read_b64_tr_b16 v[168:169], v8 offset:8448
s_add_u32 s51, s51, 114688
v_mfma_f32_16x16x32_bf16 v[84:87], v[144:147], v[52:55], v[84:87]
ds_read_b64_tr_b16 v[170:171], v8 offset:10496
buffer_load_dwordx4 a[4:7], v3, s[4:7], s51 offen sc1
v_mfma_f32_16x16x32_bf16 v[80:83], v[148:151], v[56:59], v[80:83]
ds_read_b64_tr_b16 v[172:173], v8 offset:12544
buffer_load_dwordx4 a[12:15], v11, s[4:7], s51 offen sc1
v_mfma_f32_16x16x32_bf16 v[84:87], v[148:151], v[60:63], v[84:87]
ds_read_b64_tr_b16 v[174:175], v8 offset:14592
s_add_u32 s51, s43, 229376
s_bitcmp1_b32 s50, 2
s_cselect_b32 s51, s51, 1073741824
s_waitcnt lgkmcnt(8)
v_mfma_f32_16x16x32_bf16 v[80:83], v[152:155], v[64:67], v[80:83]
ds_read_b64_tr_b16 v[176:177], v8 offset:16640
buffer_load_dwordx4 a[16:19], v3, s[4:7], s51 offen sc1
v_mfma_f32_16x16x32_bf16 v[84:87], v[152:155], v[68:71], v[84:87]
ds_read_b64_tr_b16 v[178:179], v8 offset:18688
buffer_load_dwordx4 a[24:27], v11, s[4:7], s51 offen sc1
v_mfma_f32_16x16x32_bf16 v[80:83], v[156:159], v[72:75], v[80:83]
ds_read_b64_tr_b16 v[180:181], v8 offset:20736
v_cvt_pk_bf16_f32 v224, v192, v193
v_mfma_f32_16x16x32_bf16 v[84:87], v[156:159], v[76:79], v[84:87]
ds_read_b64_tr_b16 v[182:183], v8 offset:22784
v_cvt_pk_bf16_f32 v225, v194, v195
s_waitcnt lgkmcnt(8)
v_mfma_f32_16x16x32_bf16 v[88:91], v[160:163], v[16:19], 0
ds_read_b64_tr_b16 v[184:185], v8 offset:24832
v_cvt_pk_bf16_f32 v226, v200, v201
v_mfma_f32_16x16x32_bf16 v[92:95], v[160:163], v[20:23], 0
ds_read_b64_tr_b16 v[186:187], v8 offset:26880
v_cvt_pk_bf16_f32 v227, v202, v203
v_mfma_f32_16x16x32_bf16 v[88:91], v[164:167], v[24:27], v[88:91]
ds_read_b64_tr_b16 v[188:189], v8 offset:28928
s_add_u32 s24, s37, 4096
buffer_store_dwordx4 v[224:227], v3, s[4:7], s24 offen offset:2048 sc1
v_mfma_f32_16x16x32_bf16 v[92:95], v[164:167], v[28:31], v[92:95]
ds_read_b64_tr_b16 v[190:191], v8 offset:30976
v_cvt_pk_bf16_f32 v228, v196, v197
s_waitcnt lgkmcnt(8)
v_mfma_f32_16x16x32_bf16 v[88:91], v[168:171], v[32:35], v[88:91]
ds_read_b64_tr_b16 v[128:129], v8 offset:512
v_cvt_pk_bf16_f32 v229, v198, v199
v_mfma_f32_16x16x32_bf16 v[92:95], v[168:171], v[36:39], v[92:95]
ds_read_b64_tr_b16 v[130:131], v8 offset:2560
v_cvt_pk_bf16_f32 v230, v204, v205
v_mfma_f32_16x16x32_bf16 v[88:91], v[172:175], v[40:43], v[88:91]
ds_read_b64_tr_b16 v[132:133], v8 offset:4608
v_cvt_pk_bf16_f32 v231, v206, v207
v_mfma_f32_16x16x32_bf16 v[92:95], v[172:175], v[44:47], v[92:95]
ds_read_b64_tr_b16 v[134:135], v8 offset:6656
s_add_u32 s24, s37, 20480
buffer_store_dwordx4 v[228:231], v3, s[4:7], s24 offen offset:0 sc1
s_waitcnt lgkmcnt(8)
v_mfma_f32_16x16x32_bf16 v[88:91], v[176:179], v[48:51], v[88:91]
ds_read_b64_tr_b16 v[136:137], v8 offset:8704
v_cvt_pk_bf16_f32 v232, v208, v209
v_mfma_f32_16x16x32_bf16 v[92:95], v[176:179], v[52:55], v[92:95]
ds_read_b64_tr_b16 v[138:139], v8 offset:10752
v_cvt_pk_bf16_f32 v233, v210, v211
v_mfma_f32_16x16x32_bf16 v[88:91], v[180:183], v[56:59], v[88:91]
ds_read_b64_tr_b16 v[140:141], v8 offset:12800
v_cvt_pk_bf16_f32 v234, v216, v217
v_mfma_f32_16x16x32_bf16 v[92:95], v[180:183], v[60:63], v[92:95]
ds_read_b64_tr_b16 v[142:143], v8 offset:14848
v_cvt_pk_bf16_f32 v235, v218, v219
s_waitcnt lgkmcnt(8)
v_mfma_f32_16x16x32_bf16 v[88:91], v[184:187], v[64:67], v[88:91]
ds_read_b64_tr_b16 v[144:145], v8 offset:16896
s_add_u32 s24, s37, 4096
buffer_store_dwordx4 v[232:235], v3, s[4:7], s24 offen offset:3072 sc1
v_mfma_f32_16x16x32_bf16 v[92:95], v[184:187], v[68:71], v[92:95]
ds_read_b64_tr_b16 v[146:147], v8 offset:18944
v_cvt_pk_bf16_f32 v236, v212, v213
v_mfma_f32_16x16x32_bf16 v[88:91], v[188:191], v[72:75], v[88:91]
ds_read_b64_tr_b16 v[148:149], v8 offset:20992
v_cvt_pk_bf16_f32 v237, v214, v215
v_mfma_f32_16x16x32_bf16 v[92:95], v[188:191], v[76:79], v[92:95]
ds_read_b64_tr_b16 v[150:151], v8 offset:23040
v_cvt_pk_bf16_f32 v238, v220, v221
s_waitcnt lgkmcnt(8)
v_mfma_f32_16x16x32_bf16 v[96:99], v[128:131], v[16:19], 0
ds_read_b64_tr_b16 v[152:153], v8 offset:25088
v_cvt_pk_bf16_f32 v239, v222, v223
v_mfma_f32_16x16x32_bf16 v[100:103], v[128:131], v[20:23], 0
ds_read_b64_tr_b16 v[154:155], v8 offset:27136
s_add_u32 s24, s37, 20480
buffer_store_dwordx4 v[236:239], v3, s[4:7], s24 offen offset:1024 sc1
v_mfma_f32_16x16x32_bf16 v[96:99], v[132:135], v[24:27], v[96:99]
ds_read_b64_tr_b16 v[156:157], v8 offset:29184
s_add_u32 s51, s51, 114688
v_mfma_f32_16x16x32_bf16 v[100:103], v[132:135], v[28:31], v[100:103]
ds_read_b64_tr_b16 v[158:159], v8 offset:31232
buffer_load_dwordx4 a[20:23], v3, s[4:7], s51 offen sc1
s_waitcnt lgkmcnt(8)
v_mfma_f32_16x16x32_bf16 v[96:99], v[136:139], v[32:35], v[96:99]
ds_read_b64_tr_b16 v[160:161], v8 offset:768
buffer_load_dwordx4 a[28:31], v11, s[4:7], s51 offen sc1
v_mfma_f32_16x16x32_bf16 v[100:103], v[136:139], v[36:39], v[100:103]
ds_read_b64_tr_b16 v[162:163], v8 offset:2816
s_add_u32 s51, s43, 458752
s_bitcmp1_b32 s50, 4
s_cselect_b32 s51, s51, 1073741824
v_mfma_f32_16x16x32_bf16 v[96:99], v[140:143], v[40:43], v[96:99]
ds_read_b64_tr_b16 v[164:165], v8 offset:4864
buffer_load_dwordx4 a[32:35], v3, s[4:7], s51 offen sc1
v_mfma_f32_16x16x32_bf16 v[100:103], v[140:143], v[44:47], v[100:103]
ds_read_b64_tr_b16 v[166:167], v8 offset:6912
buffer_load_dwordx4 a[40:43], v11, s[4:7], s51 offen sc1
s_waitcnt lgkmcnt(8)
v_mfma_f32_16x16x32_bf16 v[96:99], v[144:147], v[48:51], v[96:99]
ds_read_b64_tr_b16 v[168:169], v8 offset:8960
s_add_u32 s51, s51, 114688
v_mfma_f32_16x16x32_bf16 v[100:103], v[144:147], v[52:55], v[100:103]
ds_read_b64_tr_b16 v[170:171], v8 offset:11008
buffer_load_dwordx4 a[36:39], v3, s[4:7], s51 offen sc1
v_mfma_f32_16x16x32_bf16 v[96:99], v[148:151], v[56:59], v[96:99]
ds_read_b64_tr_b16 v[172:173], v8 offset:13056
buffer_load_dwordx4 a[44:47], v11, s[4:7], s51 offen sc1
v_mfma_f32_16x16x32_bf16 v[100:103], v[148:151], v[60:63], v[100:103]
ds_read_b64_tr_b16 v[174:175], v8 offset:15104
s_waitcnt lgkmcnt(8)
v_mfma_f32_16x16x32_bf16 v[96:99], v[152:155], v[64:67], v[96:99]
ds_read_b64_tr_b16 v[176:177], v8 offset:17152
v_mfma_f32_16x16x32_bf16 v[100:103], v[152:155], v[68:71], v[100:103]
ds_read_b64_tr_b16 v[178:179], v8 offset:19200
v_mfma_f32_16x16x32_bf16 v[96:99], v[156:159], v[72:75], v[96:99]
ds_read_b64_tr_b16 v[180:181], v8 offset:21248
v_mfma_f32_16x16x32_bf16 v[100:103], v[156:159], v[76:79], v[100:103]
ds_read_b64_tr_b16 v[182:183], v8 offset:23296
s_waitcnt lgkmcnt(8)
v_mfma_f32_16x16x32_bf16 v[104:107], v[160:163], v[16:19], 0
ds_read_b64_tr_b16 v[184:185], v8 offset:25344
v_mfma_f32_16x16x32_bf16 v[108:111], v[160:163], v[20:23], 0
ds_read_b64_tr_b16 v[186:187], v8 offset:27392
v_mfma_f32_16x16x32_bf16 v[104:107], v[164:167], v[24:27], v[104:107]
ds_read_b64_tr_b16 v[188:189], v8 offset:29440
v_mfma_f32_16x16x32_bf16 v[108:111], v[164:167], v[28:31], v[108:111]
ds_read_b64_tr_b16 v[190:191], v8 offset:31488
s_waitcnt lgkmcnt(8)
v_mfma_f32_16x16x32_bf16 v[104:107], v[168:171], v[32:35], v[104:107]
s_waitcnt vmcnt(30)
s_barrier
ds_read_b64_tr_b16 v[128:129], v7 offset:32768
v_mfma_f32_16x16x32_bf16 v[108:111], v[168:171], v[36:39], v[108:111]
ds_read_b64_tr_b16 v[130:131], v7 offset:34816
v_mfma_f32_16x16x32_bf16 v[104:107], v[172:175], v[40:43], v[104:107]
ds_read_b64_tr_b16 v[132:133], v7 offset:36864
v_mfma_f32_16x16x32_bf16 v[108:111], v[172:175], v[44:47], v[108:111]
ds_read_b64_tr_b16 v[134:135], v7 offset:38912
s_waitcnt lgkmcnt(8)
v_mfma_f32_16x16x32_bf16 v[104:107], v[176:179], v[48:51], v[104:107]
ds_read_b64_tr_b16 v[136:137], v7 offset:40960
v_mfma_f32_16x16x32_bf16 v[108:111], v[176:179], v[52:55], v[108:111]
ds_read_b64_tr_b16 v[138:139], v7 offset:43008
v_mfma_f32_16x16x32_bf16 v[104:107], v[180:183], v[56:59], v[104:107]
ds_read_b64_tr_b16 v[140:141], v7 offset:45056
v_mfma_f32_16x16x32_bf16 v[108:111], v[180:183], v[60:63], v[108:111]
ds_read_b64_tr_b16 v[142:143], v7 offset:47104
s_waitcnt lgkmcnt(8)
v_mfma_f32_16x16x32_bf16 v[104:107], v[184:187], v[64:67], v[104:107]
ds_read_b64_tr_b16 v[144:145], v7 offset:49152
v_mfma_f32_16x16x32_bf16 v[108:111], v[184:187], v[68:71], v[108:111]
ds_read_b64_tr_b16 v[146:147], v7 offset:51200
v_mfma_f32_16x16x32_bf16 v[104:107], v[188:191], v[72:75], v[104:107]
ds_read_b64_tr_b16 v[148:149], v7 offset:53248
v_mfma_f32_16x16x32_bf16 v[108:111], v[188:191], v[76:79], v[108:111]
ds_read_b64_tr_b16 v[150:151], v7 offset:55296
s_waitcnt vmcnt(16)
v_cmp_eq_u32 vcc, 1, v13
s_nop 3
s_lshr_b32 s50, vcc_lo, 1
s_and_b32 s50, s50, vcc_lo
s_and_b32 s50, s50, 0x5555
s_and_b32 s25, s50, 1344
s_or_b32 s44, s44, s25
s_waitcnt lgkmcnt(8)
v_mfma_f32_16x16x32_bf16 v[192:195], v[128:131], v[16:19], 0
ds_read_b64_tr_b16 v[152:153], v7 offset:57344
v_mfma_f32_16x16x32_bf16 v[196:199], v[128:131], v[20:23], 0
ds_read_b64_tr_b16 v[154:155], v7 offset:59392
v_mfma_f32_16x16x32_bf16 v[192:195], v[132:135], v[24:27], v[192:195]
ds_read_b64_tr_b16 v[156:157], v7 offset:61440
v_mfma_f32_16x16x32_bf16 v[196:199], v[132:135], v[28:31], v[196:199]
ds_read_b64_tr_b16 v[158:159], v7 offset:63488
s_waitcnt lgkmcnt(8)
v_mfma_f32_16x16x32_bf16 v[192:195], v[136:139], v[32:35], v[192:195]
ds_read_b64_tr_b16 v[160:161], v7 offset:33024
buffer_load_dword v13, v12, s[4:7], s40 offen sc1
v_mfma_f32_16x16x32_bf16 v[196:199], v[136:139], v[36:39], v[196:199]
ds_read_b64_tr_b16 v[162:163], v7 offset:35072
s_add_u32 s51, s43, 688128
s_bitcmp1_b32 s50, 6
s_cselect_b32 s51, s51, 1073741824
v_mfma_f32_16x16x32_bf16 v[192:195], v[140:143], v[40:43], v[192:195]
ds_read_b64_tr_b16 v[164:165], v7 offset:37120
buffer_load_dwordx4 a[48:51], v3, s[4:7], s51 offen sc1
v_mfma_f32_16x16x32_bf16 v[196:199], v[140:143], v[44:47], v[196:199]
ds_read_b64_tr_b16 v[166:167], v7 offset:39168
buffer_load_dwordx4 a[56:59], v11, s[4:7], s51 offen sc1
s_waitcnt lgkmcnt(8)
v_mfma_f32_16x16x32_bf16 v[192:195], v[144:147], v[48:51], v[192:195]
ds_read_b64_tr_b16 v[168:169], v7 offset:41216
s_add_u32 s51, s51, 114688
v_mfma_f32_16x16x32_bf16 v[196:199], v[144:147], v[52:55], v[196:199]
ds_read_b64_tr_b16 v[170:171], v7 offset:43264
buffer_load_dwordx4 a[52:55], v3, s[4:7], s51 offen sc1
v_mfma_f32_16x16x32_bf16 v[192:195], v[148:151], v[56:59], v[192:195]
ds_read_b64_tr_b16 v[172:173], v7 offset:45312
buffer_load_dwordx4 a[60:63], v11, s[4:7], s51 offen sc1
v_mfma_f32_16x16x32_bf16 v[196:199], v[148:151], v[60:63], v[196:199]
ds_read_b64_tr_b16 v[174:175], v7 offset:47360
s_add_u32 s51, s43, 917504
s_bitcmp1_b32 s50, 8
s_cselect_b32 s51, s51, 1073741824
s_waitcnt lgkmcnt(8)
v_mfma_f32_16x16x32_bf16 v[192:195], v[152:155], v[64:67], v[192:195]
ds_read_b64_tr_b16 v[176:177], v7 offset:49408
buffer_load_dwordx4 a[64:67], v3, s[4:7], s51 offen sc1
v_mfma_f32_16x16x32_bf16 v[196:199], v[152:155], v[68:71], v[196:199]
ds_read_b64_tr_b16 v[178:179], v7 offset:51456
buffer_load_dwordx4 a[72:75], v11, s[4:7], s51 offen sc1
v_mfma_f32_16x16x32_bf16 v[192:195], v[156:159], v[72:75], v[192:195]
ds_read_b64_tr_b16 v[180:181], v7 offset:53504
v_cvt_pk_bf16_f32 v224, v80, v81
v_mfma_f32_16x16x32_bf16 v[196:199], v[156:159], v[76:79], v[196:199]
ds_read_b64_tr_b16 v[182:183], v7 offset:55552
v_cvt_pk_bf16_f32 v225, v82, v83
s_waitcnt lgkmcnt(8)
v_mfma_f32_16x16x32_bf16 v[200:203], v[160:163], v[16:19], 0
ds_read_b64_tr_b16 v[184:185], v7 offset:57600
v_cvt_pk_bf16_f32 v226, v88, v89
v_mfma_f32_16x16x32_bf16 v[204:207], v[160:163], v[20:23], 0
ds_read_b64_tr_b16 v[186:187], v7 offset:59648
v_cvt_pk_bf16_f32 v227, v90, v91
v_mfma_f32_16x16x32_bf16 v[200:203], v[164:167], v[24:27], v[200:203]
ds_read_b64_tr_b16 v[188:189], v7 offset:61696
s_add_u32 s24, s37, 8192
buffer_store_dwordx4 v[224:227], v3, s[4:7], s24 offen offset:0 sc1
v_mfma_f32_16x16x32_bf16 v[204:207], v[164:167], v[28:31], v[204:207]
ds_read_b64_tr_b16 v[190:191], v7 offset:63744
v_cvt_pk_bf16_f32 v228, v84, v85
s_waitcnt lgkmcnt(8)
v_mfma_f32_16x16x32_bf16 v[200:203], v[168:171], v[32:35], v[200:203]
ds_read_b64_tr_b16 v[128:129], v7 offset:33280
v_cvt_pk_bf16_f32 v229, v86, v87
v_mfma_f32_16x16x32_bf16 v[204:207], v[168:171], v[36:39], v[204:207]
ds_read_b64_tr_b16 v[130:131], v7 offset:35328
v_cvt_pk_bf16_f32 v230, v92, v93
v_mfma_f32_16x16x32_bf16 v[200:203], v[172:175], v[40:43], v[200:203]
ds_read_b64_tr_b16 v[132:133], v7 offset:37376
v_cvt_pk_bf16_f32 v231, v94, v95
v_mfma_f32_16x16x32_bf16 v[204:207], v[172:175], v[44:47], v[204:207]
ds_read_b64_tr_b16 v[134:135], v7 offset:39424
s_add_u32 s24, s37, 20480
buffer_store_dwordx4 v[228:231], v3, s[4:7], s24 offen offset:2048 sc1
s_waitcnt lgkmcnt(8)
v_mfma_f32_16x16x32_bf16 v[200:203], v[176:179], v[48:51], v[200:203]
ds_read_b64_tr_b16 v[136:137], v7 offset:41472
v_cvt_pk_bf16_f32 v232, v96, v97
v_mfma_f32_16x16x32_bf16 v[204:207], v[176:179], v[52:55], v[204:207]
ds_read_b64_tr_b16 v[138:139], v7 offset:43520
v_cvt_pk_bf16_f32 v233, v98, v99
v_mfma_f32_16x16x32_bf16 v[200:203], v[180:183], v[56:59], v[200:203]
ds_read_b64_tr_b16 v[140:141], v7 offset:45568
v_cvt_pk_bf16_f32 v234, v104, v105
v_mfma_f32_16x16x32_bf16 v[204:207], v[180:183], v[60:63], v[204:207]
ds_read_b64_tr_b16 v[142:143], v7 offset:47616
v_cvt_pk_bf16_f32 v235, v106, v107
s_waitcnt lgkmcnt(8)
v_mfma_f32_16x16x32_bf16 v[200:203], v[184:187], v[64:67], v[200:203]
ds_read_b64_tr_b16 v[144:145], v7 offset:49664
s_add_u32 s24, s37, 8192
buffer_store_dwordx4 v[232:235], v3, s[4:7], s24 offen offset:1024 sc1
v_mfma_f32_16x16x32_bf16 v[204:207], v[184:187], v[68:71], v[204:207]
ds_read_b64_tr_b16 v[146:147], v7 offset:51712
v_cvt_pk_bf16_f32 v236, v100, v101
v_mfma_f32_16x16x32_bf16 v[200:203], v[188:191], v[72:75], v[200:203]
ds_read_b64_tr_b16 v[148:149], v7 offset:53760
v_cvt_pk_bf16_f32 v237, v102, v103
v_mfma_f32_16x16x32_bf16 v[204:207], v[188:191], v[76:79], v[204:207]
ds_read_b64_tr_b16 v[150:151], v7 offset:55808
v_cvt_pk_bf16_f32 v238, v108, v109
s_waitcnt lgkmcnt(8)
v_mfma_f32_16x16x32_bf16 v[208:211], v[128:131], v[16:19], 0
ds_read_b64_tr_b16 v[152:153], v7 offset:57856
v_cvt_pk_bf16_f32 v239, v110, v111
v_mfma_f32_16x16x32_bf16 v[212:215], v[128:131], v[20:23], 0
ds_read_b64_tr_b16 v[154:155], v7 offset:59904
s_add_u32 s24, s37, 20480
buffer_store_dwordx4 v[236:239], v3, s[4:7], s24 offen offset:3072 sc1
v_mfma_f32_16x16x32_bf16 v[208:211], v[132:135], v[24:27], v[208:211]
ds_read_b64_tr_b16 v[156:157], v7 offset:61952
s_add_u32 s51, s51, 114688
v_mfma_f32_16x16x32_bf16 v[212:215], v[132:135], v[28:31], v[212:215]
ds_read_b64_tr_b16 v[158:159], v7 offset:64000
buffer_load_dwordx4 a[68:71], v3, s[4:7], s51 offen sc1
s_waitcnt lgkmcnt(8)
v_mfma_f32_16x16x32_bf16 v[208:211], v[136:139], v[32:35], v[208:211]
ds_read_b64_tr_b16 v[160:161], v7 offset:33536
buffer_load_dwordx4 a[76:79], v11, s[4:7], s51 offen sc1
v_mfma_f32_16x16x32_bf16 v[212:215], v[136:139], v[36:39], v[212:215]
ds_read_b64_tr_b16 v[162:163], v7 offset:35584
s_add_u32 s51, s43, 1146880
s_bitcmp1_b32 s50, 10
s_cselect_b32 s51, s51, 1073741824
v_mfma_f32_16x16x32_bf16 v[208:211], v[140:143], v[40:43], v[208:211]
ds_read_b64_tr_b16 v[164:165], v7 offset:37632
buffer_load_dwordx4 a[80:83], v3, s[4:7], s51 offen sc1
v_mfma_f32_16x16x32_bf16 v[212:215], v[140:143], v[44:47], v[212:215]
ds_read_b64_tr_b16 v[166:167], v7 offset:39680
buffer_load_dwordx4 a[88:91], v11, s[4:7], s51 offen sc1
s_waitcnt lgkmcnt(8)
v_mfma_f32_16x16x32_bf16 v[208:211], v[144:147], v[48:51], v[208:211]
ds_read_b64_tr_b16 v[168:169], v7 offset:41728
s_add_u32 s51, s51, 114688
v_mfma_f32_16x16x32_bf16 v[212:215], v[144:147], v[52:55], v[212:215]
ds_read_b64_tr_b16 v[170:171], v7 offset:43776
buffer_load_dwordx4 a[84:87], v3, s[4:7], s51 offen sc1
v_mfma_f32_16x16x32_bf16 v[208:211], v[148:151], v[56:59], v[208:211]
ds_read_b64_tr_b16 v[172:173], v7 offset:45824
buffer_load_dwordx4 a[92:95], v11, s[4:7], s51 offen sc1
v_mfma_f32_16x16x32_bf16 v[212:215], v[148:151], v[60:63], v[212:215]
ds_read_b64_tr_b16 v[174:175], v7 offset:47872
s_waitcnt lgkmcnt(8)
v_mfma_f32_16x16x32_bf16 v[208:211], v[152:155], v[64:67], v[208:211]
ds_read_b64_tr_b16 v[176:177], v7 offset:49920
v_mfma_f32_16x16x32_bf16 v[212:215], v[152:155], v[68:71], v[212:215]
ds_read_b64_tr_b16 v[178:179], v7 offset:51968
v_mfma_f32_16x16x32_bf16 v[208:211], v[156:159], v[72:75], v[208:211]
ds_read_b64_tr_b16 v[180:181], v7 offset:54016
v_mfma_f32_16x16x32_bf16 v[212:215], v[156:159], v[76:79], v[212:215]
ds_read_b64_tr_b16 v[182:183], v7 offset:56064
s_waitcnt lgkmcnt(8)
v_mfma_f32_16x16x32_bf16 v[216:219], v[160:163], v[16:19], 0
ds_read_b64_tr_b16 v[184:185], v7 offset:58112
v_mfma_f32_16x16x32_bf16 v[220:223], v[160:163], v[20:23], 0
ds_read_b64_tr_b16 v[186:187], v7 offset:60160
v_mfma_f32_16x16x32_bf16 v[216:219], v[164:167], v[24:27], v[216:219]
ds_read_b64_tr_b16 v[188:189], v7 offset:62208
v_mfma_f32_16x16x32_bf16 v[220:223], v[164:167], v[28:31], v[220:223]
ds_read_b64_tr_b16 v[190:191], v7 offset:64256
s_waitcnt lgkmcnt(8)
v_mfma_f32_16x16x32_bf16 v[216:219], v[168:171], v[32:35], v[216:219]
s_waitcnt vmcnt(34)
s_barrier
ds_read_b64_tr_b16 v[128:129], v6 offset:0
v_mfma_f32_16x16x32_bf16 v[220:223], v[168:171], v[36:39], v[220:223]
ds_read_b64_tr_b16 v[130:131], v6 offset:2048
v_mfma_f32_16x16x32_bf16 v[216:219], v[172:175], v[40:43], v[216:219]
ds_read_b64_tr_b16 v[132:133], v6 offset:4096
v_mfma_f32_16x16x32_bf16 v[220:223], v[172:175], v[44:47], v[220:223]
ds_read_b64_tr_b16 v[134:135], v6 offset:6144
s_waitcnt lgkmcnt(8)
v_mfma_f32_16x16x32_bf16 v[216:219], v[176:179], v[48:51], v[216:219]
ds_read_b64_tr_b16 v[136:137], v6 offset:8192
v_mfma_f32_16x16x32_bf16 v[220:223], v[176:179], v[52:55], v[220:223]
ds_read_b64_tr_b16 v[138:139], v6 offset:10240
v_mfma_f32_16x16x32_bf16 v[216:219], v[180:183], v[56:59], v[216:219]
ds_read_b64_tr_b16 v[140:141], v6 offset:12288
v_mfma_f32_16x16x32_bf16 v[220:223], v[180:183], v[60:63], v[220:223]
ds_read_b64_tr_b16 v[142:143], v6 offset:14336
s_waitcnt lgkmcnt(8)
v_mfma_f32_16x16x32_bf16 v[216:219], v[184:187], v[64:67], v[216:219]
ds_read_b64_tr_b16 v[144:145], v6 offset:16384
v_mfma_f32_16x16x32_bf16 v[220:223], v[184:187], v[68:71], v[220:223]
ds_read_b64_tr_b16 v[146:147], v6 offset:18432
v_mfma_f32_16x16x32_bf16 v[216:219], v[188:191], v[72:75], v[216:219]
ds_read_b64_tr_b16 v[148:149], v6 offset:20480
v_mfma_f32_16x16x32_bf16 v[220:223], v[188:191], v[76:79], v[220:223]
ds_read_b64_tr_b16 v[150:151], v6 offset:22528
s_waitcnt vmcnt(16)
v_cmp_eq_u32 vcc, 1, v13
s_nop 3
s_lshr_b32 s50, vcc_lo, 1
s_and_b32 s50, s50, vcc_lo
s_and_b32 s50, s50, 0x5555
s_and_b32 s25, s50, 20480
s_or_b32 s44, s44, s25
s_waitcnt lgkmcnt(8)
v_mfma_f32_16x16x32_bf16 v[80:83], v[128:131], v[16:19], 0
ds_read_b64_tr_b16 v[152:153], v6 offset:24576
v_mfma_f32_16x16x32_bf16 v[84:87], v[128:131], v[20:23], 0
ds_read_b64_tr_b16 v[154:155], v6 offset:26624
v_mfma_f32_16x16x32_bf16 v[80:83], v[132:135], v[24:27], v[80:83]
ds_read_b64_tr_b16 v[156:157], v6 offset:28672
v_mfma_f32_16x16x32_bf16 v[84:87], v[132:135], v[28:31], v[84:87]
ds_read_b64_tr_b16 v[158:159], v6 offset:30720
s_waitcnt lgkmcnt(8)
v_mfma_f32_16x16x32_bf16 v[80:83], v[136:139], v[32:35], v[80:83]
ds_read_b64_tr_b16 v[160:161], v6 offset:256
s_add_u32 s51, s43, 1376256
s_bitcmp1_b32 s50, 12
s_cselect_b32 s51, s51, 1073741824
v_mfma_f32_16x16x32_bf16 v[84:87], v[136:139], v[36:39], v[84:87]
ds_read_b64_tr_b16 v[162:163], v6 offset:2304
buffer_load_dwordx4 a[96:99], v3, s[4:7], s51 offen sc1
v_mfma_f32_16x16x32_bf16 v[80:83], v[140:143], v[40:43], v[80:83]
ds_read_b64_tr_b16 v[164:165], v6 offset:4352
buffer_load_dwordx4 a[104:107], v11, s[4:7], s51 offen sc1
v_mfma_f32_16x16x32_bf16 v[84:87], v[140:143], v[44:47], v[84:87]
ds_read_b64_tr_b16 v[166:167], v6 offset:6400
s_add_u32 s51, s51, 114688
s_waitcnt lgkmcnt(8)
v_mfma_f32_16x16x32_bf16 v[80:83], v[144:147], v[48:51], v[80:83]
ds_read_b64_tr_b16 v[168:169], v6 offset:8448
buffer_load_dwordx4 a[100:103], v3, s[4:7], s51 offen sc1
v_mfma_f32_16x16x32_bf16 v[84:87], v[144:147], v[52:55], v[84:87]
ds_read_b64_tr_b16 v[170:171], v6 offset:10496
buffer_load_dwordx4 a[108:111], v11, s[4:7], s51 offen sc1
v_mfma_f32_16x16x32_bf16 v[80:83], v[148:151], v[56:59], v[80:83]
ds_read_b64_tr_b16 v[172:173], v6 offset:12544
v_cvt_pk_bf16_f32 v224, v192, v193
v_mfma_f32_16x16x32_bf16 v[84:87], v[148:151], v[60:63], v[84:87]
ds_read_b64_tr_b16 v[174:175], v6 offset:14592
v_cvt_pk_bf16_f32 v225, v194, v195
s_waitcnt lgkmcnt(8)
v_mfma_f32_16x16x32_bf16 v[80:83], v[152:155], v[64:67], v[80:83]
ds_read_b64_tr_b16 v[176:177], v6 offset:16640
v_cvt_pk_bf16_f32 v226, v200, v201
v_mfma_f32_16x16x32_bf16 v[84:87], v[152:155], v[68:71], v[84:87]
ds_read_b64_tr_b16 v[178:179], v6 offset:18688
v_cvt_pk_bf16_f32 v227, v202, v203
v_mfma_f32_16x16x32_bf16 v[80:83], v[156:159], v[72:75], v[80:83]
ds_read_b64_tr_b16 v[180:181], v6 offset:20736
s_add_u32 s24, s37, 8192
buffer_store_dwordx4 v[224:227], v3, s[4:7], s24 offen offset:2048 sc1
v_mfma_f32_16x16x32_bf16 v[84:87], v[156:159], v[76:79], v[84:87]
ds_read_b64_tr_b16 v[182:183], v6 offset:22784
v_cvt_pk_bf16_f32 v228, v196, v197
s_waitcnt lgkmcnt(8)
v_mfma_f32_16x16x32_bf16 v[88:91], v[160:163], v[16:19], 0
ds_read_b64_tr_b16 v[184:185], v6 offset:24832
v_cvt_pk_bf16_f32 v229, v198, v199
v_mfma_f32_16x16x32_bf16 v[92:95], v[160:163], v[20:23], 0
ds_read_b64_tr_b16 v[186:187], v6 offset:26880
v_cvt_pk_bf16_f32 v230, v204, v205
v_mfma_f32_16x16x32_bf16 v[88:91], v[164:167], v[24:27], v[88:91]
ds_read_b64_tr_b16 v[188:189], v6 offset:28928
v_cvt_pk_bf16_f32 v231, v206, v207
v_mfma_f32_16x16x32_bf16 v[92:95], v[164:167], v[28:31], v[92:95]
ds_read_b64_tr_b16 v[190:191], v6 offset:30976
s_add_u32 s24, s37, 24576
buffer_store_dwordx4 v[228:231], v3, s[4:7], s24 offen offset:0 sc1
s_waitcnt lgkmcnt(8)
v_mfma_f32_16x16x32_bf16 v[88:91], v[168:171], v[32:35], v[88:91]
ds_read_b64_tr_b16 v[128:129], v6 offset:512
v_cvt_pk_bf16_f32 v232, v208, v209
v_mfma_f32_16x16x32_bf16 v[92:95], v[168:171], v[36:39], v[92:95]
ds_read_b64_tr_b16 v[130:131], v6 offset:2560
v_cvt_pk_bf16_f32 v233, v210, v211
v_mfma_f32_16x16x32_bf16 v[88:91], v[172:175], v[40:43], v[88:91]
ds_read_b64_tr_b16 v[132:133], v6 offset:4608
v_cvt_pk_bf16_f32 v234, v216, v217
v_mfma_f32_16x16x32_bf16 v[92:95], v[172:175], v[44:47], v[92:95]
ds_read_b64_tr_b16 v[134:135], v6 offset:6656
v_cvt_pk_bf16_f32 v235, v218, v219
s_waitcnt lgkmcnt(8)
v_mfma_f32_16x16x32_bf16 v[88:91], v[176:179], v[48:51], v[88:91]
ds_read_b64_tr_b16 v[136:137], v6 offset:8704
s_add_u32 s24, s37, 8192
buffer_store_dwordx4 v[232:235], v3, s[4:7], s24 offen offset:3072 sc1
v_mfma_f32_16x16x32_bf16 v[92:95], v[176:179], v[52:55], v[92:95]
ds_read_b64_tr_b16 v[138:139], v6 offset:10752
v_cvt_pk_bf16_f32 v236, v212, v213
v_mfma_f32_16x16x32_bf16 v[88:91], v[180:183], v[56:59], v[88:91]
ds_read_b64_tr_b16 v[140:141], v6 offset:12800
v_cvt_pk_bf16_f32 v237, v214, v215
v_mfma_f32_16x16x32_bf16 v[92:95], v[180:183], v[60:63], v[92:95]
ds_read_b64_tr_b16 v[142:143], v6 offset:14848
v_cvt_pk_bf16_f32 v238, v220, v221
s_waitcnt lgkmcnt(8)
v_mfma_f32_16x16x32_bf16 v[88:91], v[184:187], v[64:67], v[88:91]
ds_read_b64_tr_b16 v[144:145], v6 offset:16896
v_cvt_pk_bf16_f32 v239, v222, v223
v_mfma_f32_16x16x32_bf16 v[92:95], v[184:187], v[68:71], v[92:95]
ds_read_b64_tr_b16 v[146:147], v6 offset:18944
s_add_u32 s24, s37, 24576
buffer_store_dwordx4 v[236:239], v3, s[4:7], s24 offen offset:1024 sc1
v_mfma_f32_16x16x32_bf16 v[88:91], v[188:191], v[72:75], v[88:91]
ds_read_b64_tr_b16 v[148:149], v6 offset:20992
s_add_u32 s51, s43, 1605632
s_bitcmp1_b32 s50, 14
s_cselect_b32 s51, s51, 1073741824
v_mfma_f32_16x16x32_bf16 v[92:95], v[188:191], v[76:79], v[92:95]
ds_read_b64_tr_b16 v[150:151], v6 offset:23040
buffer_load_dwordx4 a[112:115], v3, s[4:7], s51 offen sc1
s_waitcnt lgkmcnt(8)
v_mfma_f32_16x16x32_bf16 v[96:99], v[128:131], v[16:19], 0
ds_read_b64_tr_b16 v[152:153], v6 offset:25088
buffer_load_dwordx4 a[120:123], v11, s[4:7], s51 offen sc1
v_mfma_f32_16x16x32_bf16 v[100:103], v[128:131], v[20:23], 0
ds_read_b64_tr_b16 v[154:155], v6 offset:27136
s_add_u32 s51, s51, 114688
v_mfma_f32_16x16x32_bf16 v[96:99], v[132:135], v[24:27], v[96:99]
ds_read_b64_tr_b16 v[156:157], v6 offset:29184
buffer_load_dwordx4 a[116:119], v3, s[4:7], s51 offen sc1
v_mfma_f32_16x16x32_bf16 v[100:103], v[132:135], v[28:31], v[100:103]
ds_read_b64_tr_b16 v[158:159], v6 offset:31232
buffer_load_dwordx4 a[124:127], v11, s[4:7], s51 offen sc1
s_waitcnt lgkmcnt(8)
v_mfma_f32_16x16x32_bf16 v[96:99], v[136:139], v[32:35], v[96:99]
ds_read_b64_tr_b16 v[160:161], v6 offset:768
v_mfma_f32_16x16x32_bf16 v[100:103], v[136:139], v[36:39], v[100:103]
ds_read_b64_tr_b16 v[162:163], v6 offset:2816
v_mfma_f32_16x16x32_bf16 v[96:99], v[140:143], v[40:43], v[96:99]
ds_read_b64_tr_b16 v[164:165], v6 offset:4864
v_mfma_f32_16x16x32_bf16 v[100:103], v[140:143], v[44:47], v[100:103]
ds_read_b64_tr_b16 v[166:167], v6 offset:6912
s_waitcnt lgkmcnt(8)
v_mfma_f32_16x16x32_bf16 v[96:99], v[144:147], v[48:51], v[96:99]
ds_read_b64_tr_b16 v[168:169], v6 offset:8960
v_mfma_f32_16x16x32_bf16 v[100:103], v[144:147], v[52:55], v[100:103]
ds_read_b64_tr_b16 v[170:171], v6 offset:11008
v_mfma_f32_16x16x32_bf16 v[96:99], v[148:151], v[56:59], v[96:99]
ds_read_b64_tr_b16 v[172:173], v6 offset:13056
v_mfma_f32_16x16x32_bf16 v[100:103], v[148:151], v[60:63], v[100:103]
ds_read_b64_tr_b16 v[174:175], v6 offset:15104
s_waitcnt lgkmcnt(8)
v_mfma_f32_16x16x32_bf16 v[96:99], v[152:155], v[64:67], v[96:99]
ds_read_b64_tr_b16 v[176:177], v6 offset:17152
v_mfma_f32_16x16x32_bf16 v[100:103], v[152:155], v[68:71], v[100:103]
ds_read_b64_tr_b16 v[178:179], v6 offset:19200
v_mfma_f32_16x16x32_bf16 v[96:99], v[156:159], v[72:75], v[96:99]
ds_read_b64_tr_b16 v[180:181], v6 offset:21248
v_mfma_f32_16x16x32_bf16 v[100:103], v[156:159], v[76:79], v[100:103]
ds_read_b64_tr_b16 v[182:183], v6 offset:23296
s_waitcnt lgkmcnt(8)
v_mfma_f32_16x16x32_bf16 v[104:107], v[160:163], v[16:19], 0
ds_read_b64_tr_b16 v[184:185], v6 offset:25344
v_mfma_f32_16x16x32_bf16 v[108:111], v[160:163], v[20:23], 0
ds_read_b64_tr_b16 v[186:187], v6 offset:27392
v_mfma_f32_16x16x32_bf16 v[104:107], v[164:167], v[24:27], v[104:107]
ds_read_b64_tr_b16 v[188:189], v6 offset:29440
v_mfma_f32_16x16x32_bf16 v[108:111], v[164:167], v[28:31], v[108:111]
ds_read_b64_tr_b16 v[190:191], v6 offset:31488
s_waitcnt lgkmcnt(8)
v_mfma_f32_16x16x32_bf16 v[104:107], v[168:171], v[32:35], v[104:107]
v_mfma_f32_16x16x32_bf16 v[108:111], v[168:171], v[36:39], v[108:111]
v_mfma_f32_16x16x32_bf16 v[104:107], v[172:175], v[40:43], v[104:107]
v_mfma_f32_16x16x32_bf16 v[108:111], v[172:175], v[44:47], v[108:111]
s_waitcnt lgkmcnt(4)
v_mfma_f32_16x16x32_bf16 v[104:107], v[176:179], v[48:51], v[104:107]
v_mfma_f32_16x16x32_bf16 v[108:111], v[176:179], v[52:55], v[108:111]
v_mfma_f32_16x16x32_bf16 v[104:107], v[180:183], v[56:59], v[104:107]
v_mfma_f32_16x16x32_bf16 v[108:111], v[180:183], v[60:63], v[108:111]
s_waitcnt lgkmcnt(0)
v_mfma_f32_16x16x32_bf16 v[104:107], v[184:187], v[64:67], v[104:107]
v_mfma_f32_16x16x32_bf16 v[108:111], v[184:187], v[68:71], v[108:111]
v_mfma_f32_16x16x32_bf16 v[104:107], v[188:191], v[72:75], v[104:107]
v_mfma_f32_16x16x32_bf16 v[108:111], v[188:191], v[76:79], v[108:111]
s_nop 7
v_cvt_pk_bf16_f32 v224, v80, v81
v_cvt_pk_bf16_f32 v225, v82, v83
v_cvt_pk_bf16_f32 v226, v88, v89
v_cvt_pk_bf16_f32 v227, v90, v91
s_add_u32 s24, s37, 12288
buffer_store_dwordx4 v[224:227], v3, s[4:7], s24 offen offset:0 sc1
v_cvt_pk_bf16_f32 v228, v84, v85
v_cvt_pk_bf16_f32 v229, v86, v87
v_cvt_pk_bf16_f32 v230, v92, v93
v_cvt_pk_bf16_f32 v231, v94, v95
s_add_u32 s24, s37, 24576
buffer_store_dwordx4 v[228:231], v3, s[4:7], s24 offen offset:2048 sc1
v_cvt_pk_bf16_f32 v232, v96, v97
v_cvt_pk_bf16_f32 v233, v98, v99
v_cvt_pk_bf16_f32 v234, v104, v105
v_cvt_pk_bf16_f32 v235, v106, v107
s_add_u32 s24, s37, 12288
buffer_store_dwordx4 v[232:235], v3, s[4:7], s24 offen offset:1024 sc1
v_cvt_pk_bf16_f32 v236, v100, v101
v_cvt_pk_bf16_f32 v237, v102, v103
v_cvt_pk_bf16_f32 v238, v108, v109
v_cvt_pk_bf16_f32 v239, v110, v111
s_add_u32 s24, s37, 24576
buffer_store_dwordx4 v[236:239], v3, s[4:7], s24 offen offset:3072 sc1
s_mul_hi_u32 s24, s2, 0x24924925
s_mul_i32 s25, s24, 7
s_sub_u32 s25, s2, s25
v_and_b32 v6, 31, v0
v_lshrrev_b32 v7, 5, v0
v_lshlrev_b32 v252, 13, v6
v_lshl_add_u32 v252, v7, 4, v252
s_lshl_b32 s39, s25, 18
s_lshl_b32 s23, s24, 7
s_add_u32 s39, s39, s23
s_add_u32 s39, s39, 113246208
v_mul_u32_u24 v253, 14336, v7
v_lshl_add_u32 v253, v6, 2, v253
s_mul_i32 s38, s24, 114688
s_lshl_b32 s23, s25, 7
s_add_u32 s38, s38, s23
s_add_u32 s38, s38, 896
buffer_load_dword v15, v14, s[8:11], 0 offen sc1
buffer_load_dword v13, v12, s[4:7], s40 offen sc1
s_waitcnt vmcnt(0)
s_barrier
s_cmp_lg_u32 s12, 0
s_cbranch_scc1 F_OP_NOF
v_mov_b32 v16, 1
v_mov_b32 v17, 0
s_mov_b64 exec, 1
buffer_store_dword v16, v17, s[4:7], s3 offen sc1
s_mov_b64 exec, -1
F_OP_NOF:
s_cmp_ge_u32 s2, 224
s_cbranch_scc1 F_NOTR
s_mov_b32 s22, 0x80808080
F_OP_CHK:
v_and_b32 v15, 0x80808080, v15
v_cmp_ne_u32 vcc, s22, v15
s_cbranch_vccz F_OP_CHK_OK
s_sleep 4
buffer_load_dword v15, v14, s[8:11], 0 offen sc1
s_waitcnt vmcnt(0)
s_branch F_OP_CHK
F_OP_CHK_OK:
buffer_load_dwordx4 v[244:247], v252, s[4:7], s39 offen sc1
s_add_u32 s39, s39, 4096
buffer_load_dwordx4 v[248:251], v252, s[4:7], s39 offen sc1
F_NOTR:
F_RLOOP:
s_mov_b32 s25, s44
v_cmp_eq_u32 vcc, 1, v13
s_nop 3
s_lshr_b32 s50, vcc_lo, 1
s_and_b32 s50, s50, vcc_lo
s_and_b32 s50, s50, 0x5555
s_andn2_b32 s24, s50, s44
s_or_b32 s44, s44, s50
s_bitcmp1_b32 s24, 0
s_cbranch_scc0 F_RL_0
s_add_u32 s51, s43, 0
buffer_load_dwordx4 a[0:3], v3, s[4:7], s51 offen sc1
buffer_load_dwordx4 a[8:11], v11, s[4:7], s51 offen sc1
s_add_u32 s51, s51, 114688
buffer_load_dwordx4 a[4:7], v3, s[4:7], s51 offen sc1
buffer_load_dwordx4 a[12:15], v11, s[4:7], s51 offen sc1
F_RL_0:
s_bitcmp1_b32 s24, 2
s_cbranch_scc0 F_RL_1
s_add_u32 s51, s43, 229376
buffer_load_dwordx4 a[16:19], v3, s[4:7], s51 offen sc1
buffer_load_dwordx4 a[24:27], v11, s[4:7], s51 offen sc1
s_add_u32 s51, s51, 114688
buffer_load_dwordx4 a[20:23], v3, s[4:7], s51 offen sc1
buffer_load_dwordx4 a[28:31], v11, s[4:7], s51 offen sc1
F_RL_1:
s_bitcmp1_b32 s24, 4
s_cbranch_scc0 F_RL_2
s_add_u32 s51, s43, 458752
buffer_load_dwordx4 a[32:35], v3, s[4:7], s51 offen sc1
buffer_load_dwordx4 a[40:43], v11, s[4:7], s51 offen sc1
s_add_u32 s51, s51, 114688
buffer_load_dwordx4 a[36:39], v3, s[4:7], s51 offen sc1
buffer_load_dwordx4 a[44:47], v11, s[4:7], s51 offen sc1
F_RL_2:
s_bitcmp1_b32 s24, 6
s_cbranch_scc0 F_RL_3
s_add_u32 s51, s43, 688128
buffer_load_dwordx4 a[48:51], v3, s[4:7], s51 offen sc1
buffer_load_dwordx4 a[56:59], v11, s[4:7], s51 offen sc1
s_add_u32 s51, s51, 114688
buffer_load_dwordx4 a[52:55], v3, s[4:7], s51 offen sc1
buffer_load_dwordx4 a[60:63], v11, s[4:7], s51 offen sc1
F_RL_3:
s_bitcmp1_b32 s24, 8
s_cbranch_scc0 F_RL_4
s_add_u32 s51, s43, 917504
buffer_load_dwordx4 a[64:67], v3, s[4:7], s51 offen sc1
buffer_load_dwordx4 a[72:75], v11, s[4:7], s51 offen sc1
s_add_u32 s51, s51, 114688
buffer_load_dwordx4 a[68:71], v3, s[4:7], s51 offen sc1
buffer_load_dwordx4 a[76:79], v11, s[4:7], s51 offen sc1
F_RL_4:
s_bitcmp1_b32 s24, 10
s_cbranch_scc0 F_RL_5
s_add_u32 s51, s43, 1146880
buffer_load_dwordx4 a[80:83], v3, s[4:7], s51 offen sc1
buffer_load_dwordx4 a[88:91], v11, s[4:7], s51 offen sc1
s_add_u32 s51, s51, 114688
buffer_load_dwordx4 a[84:87], v3, s[4:7], s51 offen sc1
buffer_load_dwordx4 a[92:95], v11, s[4:7], s51 offen sc1
F_RL_5:
s_bitcmp1_b32 s24, 12
s_cbranch_scc0 F_RL_6
s_add_u32 s51, s43, 1376256
buffer_load_dwordx4 a[96:99], v3, s[4:7], s51 offen sc1
buffer_load_dwordx4 a[104:107], v11, s[4:7], s51 offen sc1
s_add_u32 s51, s51, 114688
buffer_load_dwordx4 a[100:103], v3, s[4:7], s51 offen sc1
buffer_load_dwordx4 a[108:111], v11, s[4:7], s51 offen sc1
F_RL_6:
s_bitcmp1_b32 s24, 14
s_cbranch_scc0 F_RL_7
s_add_u32 s51, s43, 1605632
buffer_load_dwordx4 a[112:115], v3, s[4:7], s51 offen sc1
buffer_load_dwordx4 a[120:123], v11, s[4:7], s51 offen sc1
s_add_u32 s51, s51, 114688
buffer_load_dwordx4 a[116:119], v3, s[4:7], s51 offen sc1
buffer_load_dwordx4 a[124:127], v11, s[4:7], s51 offen sc1
F_RL_7:
buffer_load_dword v10, v12, s[4:7], s40 offen sc1
s_andn2_b32 s25, s25, s45
s_or_b32 s45, s45, s25
s_bitcmp1_b32 s25, 0
s_cbranch_scc0 F_RP_0
v_accvgpr_read_b32 v16, a0
v_accvgpr_read_b32 v17, a4
v_lshlrev_b32 v18, 16, v16
v_lshlrev_b32 v19, 16, v17
v_and_b32 v16, 0xffff0000, v16
v_and_b32 v17, 0xffff0000, v17
v_add_f32 v32, v18, v19
v_add_f32 v33, v16, v17
v_accvgpr_read_b32 v16, a1
v_accvgpr_read_b32 v17, a5
v_lshlrev_b32 v18, 16, v16
v_lshlrev_b32 v19, 16, v17
v_and_b32 v16, 0xffff0000, v16
v_and_b32 v17, 0xffff0000, v17
v_add_f32 v34, v18, v19
v_add_f32 v35, v16, v17
v_accvgpr_read_b32 v16, a2
v_accvgpr_read_b32 v17, a6
v_lshlrev_b32 v18, 16, v16
v_lshlrev_b32 v19, 16, v17
v_and_b32 v16, 0xffff0000, v16
v_and_b32 v17, 0xffff0000, v17
v_add_f32 v36, v18, v19
v_add_f32 v37, v16, v17
v_accvgpr_read_b32 v16, a3
v_accvgpr_read_b32 v17, a7
v_lshlrev_b32 v18, 16, v16
v_lshlrev_b32 v19, 16, v17
v_and_b32 v16, 0xffff0000, v16
v_and_b32 v17, 0xffff0000, v17
v_add_f32 v38, v18, v19
v_add_f32 v39, v16, v17
v_accvgpr_read_b32 v16, a8
v_accvgpr_read_b32 v17, a12
v_lshlrev_b32 v18, 16, v16
v_lshlrev_b32 v19, 16, v17
v_and_b32 v16, 0xffff0000, v16
v_and_b32 v17, 0xffff0000, v17
v_add_f32 v40, v18, v19
v_add_f32 v41, v16, v17
v_accvgpr_read_b32 v16, a9
v_accvgpr_read_b32 v17, a13
v_lshlrev_b32 v18, 16, v16
v_lshlrev_b32 v19, 16, v17
v_and_b32 v16, 0xffff0000, v16
v_and_b32 v17, 0xffff0000, v17
v_add_f32 v42, v18, v19
v_add_f32 v43, v16, v17
v_accvgpr_read_b32 v16, a10
v_accvgpr_read_b32 v17, a14
v_lshlrev_b32 v18, 16, v16
v_lshlrev_b32 v19, 16, v17
v_and_b32 v16, 0xffff0000, v16
v_and_b32 v17, 0xffff0000, v17
v_add_f32 v44, v18, v19
v_add_f32 v45, v16, v17
v_accvgpr_read_b32 v16, a11
v_accvgpr_read_b32 v17, a15
v_lshlrev_b32 v18, 16, v16
v_lshlrev_b32 v19, 16, v17
v_and_b32 v16, 0xffff0000, v16
v_and_b32 v17, 0xffff0000, v17
v_add_f32 v46, v18, v19
v_add_f32 v47, v16, v17
F_RP_0:
s_bitcmp1_b32 s25, 2
s_cbranch_scc0 F_RP_1
v_accvgpr_read_b32 v16, a16
v_accvgpr_read_b32 v17, a20
v_lshlrev_b32 v18, 16, v16
v_lshlrev_b32 v19, 16, v17
v_and_b32 v16, 0xffff0000, v16
v_and_b32 v17, 0xffff0000, v17
v_add_f32 v48, v18, v19
v_add_f32 v49, v16, v17
v_accvgpr_read_b32 v16, a17
v_accvgpr_read_b32 v17, a21
v_lshlrev_b32 v18, 16, v16
v_lshlrev_b32 v19, 16, v17
v_and_b32 v16, 0xffff0000, v16
v_and_b32 v17, 0xffff0000, v17
v_add_f32 v50, v18, v19
v_add_f32 v51, v16, v17
v_accvgpr_read_b32 v16, a18
v_accvgpr_read_b32 v17, a22
v_lshlrev_b32 v18, 16, v16
v_lshlrev_b32 v19, 16, v17
v_and_b32 v16, 0xffff0000, v16
v_and_b32 v17, 0xffff0000, v17
v_add_f32 v52, v18, v19
v_add_f32 v53, v16, v17
v_accvgpr_read_b32 v16, a19
v_accvgpr_read_b32 v17, a23
v_lshlrev_b32 v18, 16, v16
v_lshlrev_b32 v19, 16, v17
v_and_b32 v16, 0xffff0000, v16
v_and_b32 v17, 0xffff0000, v17
v_add_f32 v54, v18, v19
v_add_f32 v55, v16, v17
v_accvgpr_read_b32 v16, a24
v_accvgpr_read_b32 v17, a28
v_lshlrev_b32 v18, 16, v16
v_lshlrev_b32 v19, 16, v17
v_and_b32 v16, 0xffff0000, v16
v_and_b32 v17, 0xffff0000, v17
v_add_f32 v56, v18, v19
v_add_f32 v57, v16, v17
v_accvgpr_read_b32 v16, a25
v_accvgpr_read_b32 v17, a29
v_lshlrev_b32 v18, 16, v16
v_lshlrev_b32 v19, 16, v17
v_and_b32 v16, 0xffff0000, v16
v_and_b32 v17, 0xffff0000, v17
v_add_f32 v58, v18, v19
v_add_f32 v59, v16, v17
v_accvgpr_read_b32 v16, a26
v_accvgpr_read_b32 v17, a30
v_lshlrev_b32 v18, 16, v16
v_lshlrev_b32 v19, 16, v17
v_and_b32 v16, 0xffff0000, v16
v_and_b32 v17, 0xffff0000, v17
v_add_f32 v60, v18, v19
v_add_f32 v61, v16, v17
v_accvgpr_read_b32 v16, a27
v_accvgpr_read_b32 v17, a31
v_lshlrev_b32 v18, 16, v16
v_lshlrev_b32 v19, 16, v17
v_and_b32 v16, 0xffff0000, v16
v_and_b32 v17, 0xffff0000, v17
v_add_f32 v62, v18, v19
v_add_f32 v63, v16, v17
F_RP_1:
s_bitcmp1_b32 s25, 4
s_cbranch_scc0 F_RP_2
v_accvgpr_read_b32 v16, a32
v_accvgpr_read_b32 v17, a36
v_lshlrev_b32 v18, 16, v16
v_lshlrev_b32 v19, 16, v17
v_and_b32 v16, 0xffff0000, v16
v_and_b32 v17, 0xffff0000, v17
v_add_f32 v64, v18, v19
v_add_f32 v65, v16, v17
v_accvgpr_read_b32 v16, a33
v_accvgpr_read_b32 v17, a37
v_lshlrev_b32 v18, 16, v16
v_lshlrev_b32 v19, 16, v17
v_and_b32 v16, 0xffff0000, v16
v_and_b32 v17, 0xffff0000, v17
v_add_f32 v66, v18, v19
v_add_f32 v67, v16, v17
v_accvgpr_read_b32 v16, a34
v_accvgpr_read_b32 v17, a38
v_lshlrev_b32 v18, 16, v16
v_lshlrev_b32 v19, 16, v17
v_and_b32 v16, 0xffff0000, v16
v_and_b32 v17, 0xffff0000, v17
v_add_f32 v68, v18, v19
v_add_f32 v69, v16, v17
v_accvgpr_read_b32 v16, a35
v_accvgpr_read_b32 v17, a39
v_lshlrev_b32 v18, 16, v16
v_lshlrev_b32 v19, 16, v17
v_and_b32 v16, 0xffff0000, v16
v_and_b32 v17, 0xffff0000, v17
v_add_f32 v70, v18, v19
v_add_f32 v71, v16, v17
v_accvgpr_read_b32 v16, a40
v_accvgpr_read_b32 v17, a44
v_lshlrev_b32 v18, 16, v16
v_lshlrev_b32 v19, 16, v17
v_and_b32 v16, 0xffff0000, v16
v_and_b32 v17, 0xffff0000, v17
v_add_f32 v72, v18, v19
v_add_f32 v73, v16, v17
v_accvgpr_read_b32 v16, a41
v_accvgpr_read_b32 v17, a45
v_lshlrev_b32 v18, 16, v16
v_lshlrev_b32 v19, 16, v17
v_and_b32 v16, 0xffff0000, v16
v_and_b32 v17, 0xffff0000, v17
v_add_f32 v74, v18, v19
v_add_f32 v75, v16, v17
v_accvgpr_read_b32 v16, a42
v_accvgpr_read_b32 v17, a46
v_lshlrev_b32 v18, 16, v16
v_lshlrev_b32 v19, 16, v17
v_and_b32 v16, 0xffff0000, v16
v_and_b32 v17, 0xffff0000, v17
v_add_f32 v76, v18, v19
v_add_f32 v77, v16, v17
v_accvgpr_read_b32 v16, a43
v_accvgpr_read_b32 v17, a47
v_lshlrev_b32 v18, 16, v16
v_lshlrev_b32 v19, 16, v17
v_and_b32 v16, 0xffff0000, v16
v_and_b32 v17, 0xffff0000, v17
v_add_f32 v78, v18, v19
v_add_f32 v79, v16, v17
F_RP_2:
s_bitcmp1_b32 s25, 6
s_cbranch_scc0 F_RP_3
v_accvgpr_read_b32 v16, a48
v_accvgpr_read_b32 v17, a52
v_lshlrev_b32 v18, 16, v16
v_lshlrev_b32 v19, 16, v17
v_and_b32 v16, 0xffff0000, v16
v_and_b32 v17, 0xffff0000, v17
v_add_f32 v80, v18, v19
v_add_f32 v81, v16, v17
v_accvgpr_read_b32 v16, a49
v_accvgpr_read_b32 v17, a53
v_lshlrev_b32 v18, 16, v16
v_lshlrev_b32 v19, 16, v17
v_and_b32 v16, 0xffff0000, v16
v_and_b32 v17, 0xffff0000, v17
v_add_f32 v82, v18, v19
v_add_f32 v83, v16, v17
v_accvgpr_read_b32 v16, a50
v_accvgpr_read_b32 v17, a54
v_lshlrev_b32 v18, 16, v16
v_lshlrev_b32 v19, 16, v17
v_and_b32 v16, 0xffff0000, v16
v_and_b32 v17, 0xffff0000, v17
v_add_f32 v84, v18, v19
v_add_f32 v85, v16, v17
v_accvgpr_read_b32 v16, a51
v_accvgpr_read_b32 v17, a55
v_lshlrev_b32 v18, 16, v16
v_lshlrev_b32 v19, 16, v17
v_and_b32 v16, 0xffff0000, v16
v_and_b32 v17, 0xffff0000, v17
v_add_f32 v86, v18, v19
v_add_f32 v87, v16, v17
v_accvgpr_read_b32 v16, a56
v_accvgpr_read_b32 v17, a60
v_lshlrev_b32 v18, 16, v16
v_lshlrev_b32 v19, 16, v17
v_and_b32 v16, 0xffff0000, v16
v_and_b32 v17, 0xffff0000, v17
v_add_f32 v88, v18, v19
v_add_f32 v89, v16, v17
v_accvgpr_read_b32 v16, a57
v_accvgpr_read_b32 v17, a61
v_lshlrev_b32 v18, 16, v16
v_lshlrev_b32 v19, 16, v17
v_and_b32 v16, 0xffff0000, v16
v_and_b32 v17, 0xffff0000, v17
v_add_f32 v90, v18, v19
v_add_f32 v91, v16, v17
v_accvgpr_read_b32 v16, a58
v_accvgpr_read_b32 v17, a62
v_lshlrev_b32 v18, 16, v16
v_lshlrev_b32 v19, 16, v17
v_and_b32 v16, 0xffff0000, v16
v_and_b32 v17, 0xffff0000, v17
v_add_f32 v92, v18, v19
v_add_f32 v93, v16, v17
v_accvgpr_read_b32 v16, a59
v_accvgpr_read_b32 v17, a63
v_lshlrev_b32 v18, 16, v16
v_lshlrev_b32 v19, 16, v17
v_and_b32 v16, 0xffff0000, v16
v_and_b32 v17, 0xffff0000, v17
v_add_f32 v94, v18, v19
v_add_f32 v95, v16, v17
F_RP_3:
s_bitcmp1_b32 s25, 8
s_cbranch_scc0 F_RP_4
v_accvgpr_read_b32 v16, a64
v_accvgpr_read_b32 v17, a68
v_lshlrev_b32 v18, 16, v16
v_lshlrev_b32 v19, 16, v17
v_and_b32 v16, 0xffff0000, v16
v_and_b32 v17, 0xffff0000, v17
v_add_f32 v96, v18, v19
v_add_f32 v97, v16, v17
v_accvgpr_read_b32 v16, a65
v_accvgpr_read_b32 v17, a69
v_lshlrev_b32 v18, 16, v16
v_lshlrev_b32 v19, 16, v17
v_and_b32 v16, 0xffff0000, v16
v_and_b32 v17, 0xffff0000, v17
v_add_f32 v98, v18, v19
v_add_f32 v99, v16, v17
v_accvgpr_read_b32 v16, a66
v_accvgpr_read_b32 v17, a70
v_lshlrev_b32 v18, 16, v16
v_lshlrev_b32 v19, 16, v17
v_and_b32 v16, 0xffff0000, v16
v_and_b32 v17, 0xffff0000, v17
v_add_f32 v100, v18, v19
v_add_f32 v101, v16, v17
v_accvgpr_read_b32 v16, a67
v_accvgpr_read_b32 v17, a71
v_lshlrev_b32 v18, 16, v16
v_lshlrev_b32 v19, 16, v17
v_and_b32 v16, 0xffff0000, v16
v_and_b32 v17, 0xffff0000, v17
v_add_f32 v102, v18, v19
v_add_f32 v103, v16, v17
v_accvgpr_read_b32 v16, a72
v_accvgpr_read_b32 v17, a76
v_lshlrev_b32 v18, 16, v16
v_lshlrev_b32 v19, 16, v17
v_and_b32 v16, 0xffff0000, v16
v_and_b32 v17, 0xffff0000, v17
v_add_f32 v104, v18, v19
v_add_f32 v105, v16, v17
v_accvgpr_read_b32 v16, a73
v_accvgpr_read_b32 v17, a77
v_lshlrev_b32 v18, 16, v16
v_lshlrev_b32 v19, 16, v17
v_and_b32 v16, 0xffff0000, v16
v_and_b32 v17, 0xffff0000, v17
v_add_f32 v106, v18, v19
v_add_f32 v107, v16, v17
v_accvgpr_read_b32 v16, a74
v_accvgpr_read_b32 v17, a78
v_lshlrev_b32 v18, 16, v16
v_lshlrev_b32 v19, 16, v17
v_and_b32 v16, 0xffff0000, v16
v_and_b32 v17, 0xffff0000, v17
v_add_f32 v108, v18, v19
v_add_f32 v109, v16, v17
v_accvgpr_read_b32 v16, a75
v_accvgpr_read_b32 v17, a79
v_lshlrev_b32 v18, 16, v16
v_lshlrev_b32 v19, 16, v17
v_and_b32 v16, 0xffff0000, v16
v_and_b32 v17, 0xffff0000, v17
v_add_f32 v110, v18, v19
v_add_f32 v111, v16, v17
F_RP_4:
s_bitcmp1_b32 s25, 10
s_cbranch_scc0 F_RP_5
v_accvgpr_read_b32 v16, a80
v_accvgpr_read_b32 v17, a84
v_lshlrev_b32 v18, 16, v16
v_lshlrev_b32 v19, 16, v17
v_and_b32 v16, 0xffff0000, v16
v_and_b32 v17, 0xffff0000, v17
v_add_f32 v112, v18, v19
v_add_f32 v113, v16, v17
v_accvgpr_read_b32 v16, a81
v_accvgpr_read_b32 v17, a85
v_lshlrev_b32 v18, 16, v16
v_lshlrev_b32 v19, 16, v17
v_and_b32 v16, 0xffff0000, v16
v_and_b32 v17, 0xffff0000, v17
v_add_f32 v114, v18, v19
v_add_f32 v115, v16, v17
v_accvgpr_read_b32 v16, a82
v_accvgpr_read_b32 v17, a86
v_lshlrev_b32 v18, 16, v16
v_lshlrev_b32 v19, 16, v17
v_and_b32 v16, 0xffff0000, v16
v_and_b32 v17, 0xffff0000, v17
v_add_f32 v116, v18, v19
v_add_f32 v117, v16, v17
v_accvgpr_read_b32 v16, a83
v_accvgpr_read_b32 v17, a87
v_lshlrev_b32 v18, 16, v16
v_lshlrev_b32 v19, 16, v17
v_and_b32 v16, 0xffff0000, v16
v_and_b32 v17, 0xffff0000, v17
v_add_f32 v118, v18, v19
v_add_f32 v119, v16, v17
v_accvgpr_read_b32 v16, a88
v_accvgpr_read_b32 v17, a92
v_lshlrev_b32 v18, 16, v16
v_lshlrev_b32 v19, 16, v17
v_and_b32 v16, 0xffff0000, v16
v_and_b32 v17, 0xffff0000, v17
v_add_f32 v120, v18, v19
v_add_f32 v121, v16, v17
v_accvgpr_read_b32 v16, a89
v_accvgpr_read_b32 v17, a93
v_lshlrev_b32 v18, 16, v16
v_lshlrev_b32 v19, 16, v17
v_and_b32 v16, 0xffff0000, v16
v_and_b32 v17, 0xffff0000, v17
v_add_f32 v122, v18, v19
v_add_f32 v123, v16, v17
v_accvgpr_read_b32 v16, a90
v_accvgpr_read_b32 v17, a94
v_lshlrev_b32 v18, 16, v16
v_lshlrev_b32 v19, 16, v17
v_and_b32 v16, 0xffff0000, v16
v_and_b32 v17, 0xffff0000, v17
v_add_f32 v124, v18, v19
v_add_f32 v125, v16, v17
v_accvgpr_read_b32 v16, a91
v_accvgpr_read_b32 v17, a95
v_lshlrev_b32 v18, 16, v16
v_lshlrev_b32 v19, 16, v17
v_and_b32 v16, 0xffff0000, v16
v_and_b32 v17, 0xffff0000, v17
v_add_f32 v126, v18, v19
v_add_f32 v127, v16, v17
F_RP_5:
s_bitcmp1_b32 s25, 12
s_cbranch_scc0 F_RP_6
v_accvgpr_read_b32 v16, a96
v_accvgpr_read_b32 v17, a100
v_lshlrev_b32 v18, 16, v16
v_lshlrev_b32 v19, 16, v17
v_and_b32 v16, 0xffff0000, v16
v_and_b32 v17, 0xffff0000, v17
v_add_f32 v128, v18, v19
v_add_f32 v129, v16, v17
v_accvgpr_read_b32 v16, a97
v_accvgpr_read_b32 v17, a101
v_lshlrev_b32 v18, 16, v16
v_lshlrev_b32 v19, 16, v17
v_and_b32 v16, 0xffff0000, v16
v_and_b32 v17, 0xffff0000, v17
v_add_f32 v130, v18, v19
v_add_f32 v131, v16, v17
v_accvgpr_read_b32 v16, a98
v_accvgpr_read_b32 v17, a102
v_lshlrev_b32 v18, 16, v16
v_lshlrev_b32 v19, 16, v17
v_and_b32 v16, 0xffff0000, v16
v_and_b32 v17, 0xffff0000, v17
v_add_f32 v132, v18, v19
v_add_f32 v133, v16, v17
v_accvgpr_read_b32 v16, a99
v_accvgpr_read_b32 v17, a103
v_lshlrev_b32 v18, 16, v16
v_lshlrev_b32 v19, 16, v17
v_and_b32 v16, 0xffff0000, v16
v_and_b32 v17, 0xffff0000, v17
v_add_f32 v134, v18, v19
v_add_f32 v135, v16, v17
v_accvgpr_read_b32 v16, a104
v_accvgpr_read_b32 v17, a108
v_lshlrev_b32 v18, 16, v16
v_lshlrev_b32 v19, 16, v17
v_and_b32 v16, 0xffff0000, v16
v_and_b32 v17, 0xffff0000, v17
v_add_f32 v136, v18, v19
v_add_f32 v137, v16, v17
v_accvgpr_read_b32 v16, a105
v_accvgpr_read_b32 v17, a109
v_lshlrev_b32 v18, 16, v16
v_lshlrev_b32 v19, 16, v17
v_and_b32 v16, 0xffff0000, v16
v_and_b32 v17, 0xffff0000, v17
v_add_f32 v138, v18, v19
v_add_f32 v139, v16, v17
v_accvgpr_read_b32 v16, a106
v_accvgpr_read_b32 v17, a110
v_lshlrev_b32 v18, 16, v16
v_lshlrev_b32 v19, 16, v17
v_and_b32 v16, 0xffff0000, v16
v_and_b32 v17, 0xffff0000, v17
v_add_f32 v140, v18, v19
v_add_f32 v141, v16, v17
v_accvgpr_read_b32 v16, a107
v_accvgpr_read_b32 v17, a111
v_lshlrev_b32 v18, 16, v16
v_lshlrev_b32 v19, 16, v17
v_and_b32 v16, 0xffff0000, v16
v_and_b32 v17, 0xffff0000, v17
v_add_f32 v142, v18, v19
v_add_f32 v143, v16, v17
F_RP_6:
s_bitcmp1_b32 s25, 14
s_cbranch_scc0 F_RP_7
v_accvgpr_read_b32 v16, a112
v_accvgpr_read_b32 v17, a116
v_lshlrev_b32 v18, 16, v16
v_lshlrev_b32 v19, 16, v17
v_and_b32 v16, 0xffff0000, v16
v_and_b32 v17, 0xffff0000, v17
v_add_f32 v144, v18, v19
v_add_f32 v145, v16, v17
v_accvgpr_read_b32 v16, a113
v_accvgpr_read_b32 v17, a117
v_lshlrev_b32 v18, 16, v16
v_lshlrev_b32 v19, 16, v17
v_and_b32 v16, 0xffff0000, v16
v_and_b32 v17, 0xffff0000, v17
v_add_f32 v146, v18, v19
v_add_f32 v147, v16, v17
v_accvgpr_read_b32 v16, a114
v_accvgpr_read_b32 v17, a118
v_lshlrev_b32 v18, 16, v16
v_lshlrev_b32 v19, 16, v17
v_and_b32 v16, 0xffff0000, v16
v_and_b32 v17, 0xffff0000, v17
v_add_f32 v148, v18, v19
v_add_f32 v149, v16, v17
v_accvgpr_read_b32 v16, a115
v_accvgpr_read_b32 v17, a119
v_lshlrev_b32 v18, 16, v16
v_lshlrev_b32 v19, 16, v17
v_and_b32 v16, 0xffff0000, v16
v_and_b32 v17, 0xffff0000, v17
v_add_f32 v150, v18, v19
v_add_f32 v151, v16, v17
v_accvgpr_read_b32 v16, a120
v_accvgpr_read_b32 v17, a124
v_lshlrev_b32 v18, 16, v16
v_lshlrev_b32 v19, 16, v17
v_and_b32 v16, 0xffff0000, v16
v_and_b32 v17, 0xffff0000, v17
v_add_f32 v152, v18, v19
v_add_f32 v153, v16, v17
v_accvgpr_read_b32 v16, a121
v_accvgpr_read_b32 v17, a125
v_lshlrev_b32 v18, 16, v16
v_lshlrev_b32 v19, 16, v17
v_and_b32 v16, 0xffff0000, v16
v_and_b32 v17, 0xffff0000, v17
v_add_f32 v154, v18, v19
v_add_f32 v155, v16, v17
v_accvgpr_read_b32 v16, a122
v_accvgpr_read_b32 v17, a126
v_lshlrev_b32 v18, 16, v16
v_lshlrev_b32 v19, 16, v17
v_and_b32 v16, 0xffff0000, v16
v_and_b32 v17, 0xffff0000, v17
v_add_f32 v156, v18, v19
v_add_f32 v157, v16, v17
v_accvgpr_read_b32 v16, a123
v_accvgpr_read_b32 v17, a127
v_lshlrev_b32 v18, 16, v16
v_lshlrev_b32 v19, 16, v17
v_and_b32 v16, 0xffff0000, v16
v_and_b32 v17, 0xffff0000, v17
v_add_f32 v158, v18, v19
v_add_f32 v159, v16, v17
F_RP_7:
s_cmp_eq_u32 s45, 0x5555
s_cbranch_scc1 F_RDONE
s_waitcnt vmcnt(0)
v_mov_b32 v13, v10
s_branch F_RLOOP
F_RDONE:
s_waitcnt vmcnt(1)
v_add_f32 v32, v32, v48
v_add_f32 v33, v33, v49
v_add_f32 v34, v34, v50
v_add_f32 v35, v35, v51
v_add_f32 v36, v36, v52
v_add_f32 v37, v37, v53
v_add_f32 v38, v38, v54
v_add_f32 v39, v39, v55
v_add_f32 v40, v40, v56
v_add_f32 v41, v41, v57
v_add_f32 v42, v42, v58
v_add_f32 v43, v43, v59
v_add_f32 v44, v44, v60
v_add_f32 v45, v45, v61
v_add_f32 v46, v46, v62
v_add_f32 v47, v47, v63
v_add_f32 v64, v64, v80
v_add_f32 v65, v65, v81
v_add_f32 v66, v66, v82
v_add_f32 v67, v67, v83
v_add_f32 v68, v68, v84
v_add_f32 v69, v69, v85
v_add_f32 v70, v70, v86
v_add_f32 v71, v71, v87
v_add_f32 v72, v72, v88
v_add_f32 v73, v73, v89
v_add_f32 v74, v74, v90
v_add_f32 v75, v75, v91
v_add_f32 v76, v76, v92
v_add_f32 v77, v77, v93
v_add_f32 v78, v78, v94
v_add_f32 v79, v79, v95
v_add_f32 v96, v96, v112
v_add_f32 v97, v97, v113
v_add_f32 v98, v98, v114
v_add_f32 v99, v99, v115
v_add_f32 v100, v100, v116
v_add_f32 v101, v101, v117
v_add_f32 v102, v102, v118
v_add_f32 v103, v103, v119
v_add_f32 v104, v104, v120
v_add_f32 v105, v105, v121
v_add_f32 v106, v106, v122
v_add_f32 v107, v107, v123
v_add_f32 v108, v108, v124
v_add_f32 v109, v109, v125
v_add_f32 v110, v110, v126
v_add_f32 v111, v111, v127
v_add_f32 v128, v128, v144
v_add_f32 v129, v129, v145
v_add_f32 v130, v130, v146
v_add_f32 v131, v131, v147
v_add_f32 v132, v132, v148
v_add_f32 v133, v133, v149
v_add_f32 v134, v134, v150
v_add_f32 v135, v135, v151
v_add_f32 v136, v136, v152
v_add_f32 v137, v137, v153
v_add_f32 v138, v138, v154
v_add_f32 v139, v139, v155
v_add_f32 v140, v140, v156
v_add_f32 v141, v141, v157
v_add_f32 v142, v142, v158
v_add_f32 v143, v143, v159
v_add_f32 v32, v32, v64
v_add_f32 v33, v33, v65
v_add_f32 v34, v34, v66
v_add_f32 v35, v35, v67
v_add_f32 v36, v36, v68
v_add_f32 v37, v37, v69
v_add_f32 v38, v38, v70
v_add_f32 v39, v39, v71
v_add_f32 v40, v40, v72
v_add_f32 v41, v41, v73
v_add_f32 v42, v42, v74
v_add_f32 v43, v43, v75
v_add_f32 v44, v44, v76
v_add_f32 v45, v45, v77
v_add_f32 v46, v46, v78
v_add_f32 v47, v47, v79
v_add_f32 v96, v96, v128
v_add_f32 v97, v97, v129
v_add_f32 v98, v98, v130
v_add_f32 v99, v99, v131
v_add_f32 v100, v100, v132
v_add_f32 v101, v101, v133
v_add_f32 v102, v102, v134
v_add_f32 v103, v103, v135
v_add_f32 v104, v104, v136
v_add_f32 v105, v105, v137
v_add_f32 v106, v106, v138
v_add_f32 v107, v107, v139
v_add_f32 v108, v108, v140
v_add_f32 v109, v109, v141
v_add_f32 v110, v110, v142
v_add_f32 v111, v111, v143
v_add_f32 v32, v32, v96
v_add_f32 v33, v33, v97
v_add_f32 v34, v34, v98
v_add_f32 v35, v35, v99
v_add_f32 v36, v36, v100
v_add_f32 v37, v37, v101
v_add_f32 v38, v38, v102
v_add_f32 v39, v39, v103
v_add_f32 v40, v40, v104
v_add_f32 v41, v41, v105
v_add_f32 v42, v42, v106
v_add_f32 v43, v43, v107
v_add_f32 v44, v44, v108
v_add_f32 v45, v45, v109
v_add_f32 v46, v46, v110
v_add_f32 v47, v47, v111
v_and_b32 v9, 15, v5
v_mul_u32_u24 v9, 1792, v9
v_lshrrev_b32 v8, 4, v5
v_lshl_add_u32 v9, v8, 3, v9
s_add_u32 s22, s42, 0
s_mul_hi_u32 s23, s22, 0x12492493
s_mul_i32 s24, s23, 14
s_sub_u32 s24, s22, s24
s_lshl_b32 s25, s41, 3
s_add_u32 s23, s23, s25
s_mul_i32 s23, s23, 28672
s_lshl_b32 s24, s24, 6
s_add_u32 s23, s23, s24
v_cvt_pk_bf16_f32 v160, v32, v33
v_cvt_pk_bf16_f32 v161, v34, v35
v_cvt_pk_bf16_f32 v162, v36, v37
v_cvt_pk_bf16_f32 v163, v38, v39
buffer_store_dwordx2 v[160:161], v9, s[32:35], s23 offen
buffer_store_dwordx2 v[162:163], v9, s[32:35], s23 offen offset:32
s_cmp_eq_u32 s12, 3
s_cbranch_scc1 F_ST1
s_add_u32 s22, s42, 4
s_mul_hi_u32 s23, s22, 0x12492493
s_mul_i32 s24, s23, 14
s_sub_u32 s24, s22, s24
s_lshl_b32 s25, s41, 3
s_add_u32 s23, s23, s25
s_mul_i32 s23, s23, 28672
s_lshl_b32 s24, s24, 6
s_add_u32 s23, s23, s24
v_cvt_pk_bf16_f32 v164, v40, v41
v_cvt_pk_bf16_f32 v165, v42, v43
v_cvt_pk_bf16_f32 v166, v44, v45
v_cvt_pk_bf16_f32 v167, v46, v47
buffer_store_dwordx2 v[164:165], v9, s[32:35], s23 offen
buffer_store_dwordx2 v[166:167], v9, s[32:35], s23 offen offset:32
F_ST1:
s_cmp_ge_u32 s2, 224
s_cbranch_scc1 F_DONE
s_mov_b32 s22, 0x05040100
s_mov_b32 s23, 0x07060302
v_perm_b32 v176, v248, v244, s22
v_perm_b32 v177, v248, v244, s23
v_perm_b32 v178, v249, v245, s22
v_perm_b32 v179, v249, v245, s23
v_perm_b32 v180, v250, v246, s22
v_perm_b32 v181, v250, v246, s23
v_perm_b32 v182, v251, v247, s22
v_perm_b32 v183, v251, v247, s23
buffer_store_dword v176, v253, s[32:35], s38 offen offset:0
buffer_store_dword v177, v253, s[32:35], s38 offen offset:1792
s_add_u32 s38, s38, 3584
buffer_store_dword v178, v253, s[32:35], s38 offen offset:0
buffer_store_dword v179, v253, s[32:35], s38 offen offset:1792
s_add_u32 s38, s38, 3584
buffer_store_dword v180, v253, s[32:35], s38 offen offset:0
buffer_store_dword v181, v253, s[32:35], s38 offen offset:1792
s_add_u32 s38, s38, 3584
buffer_store_dword v182, v253, s[32:35], s38 offen offset:0
buffer_store_dword v183, v253, s[32:35], s38 offen offset:1792
F_DONE:
s_endpgm
F_EVA_0:
s_sub_u32 s24, s63, 2
s_cmp_eq_u32 s24, s52
s_cbranch_scc1 F_PUB_0
F_PUB_RET_0:
s_cmp_ge_u32 s63, 15
s_cbranch_scc1 F_MASK_1
F_MASK_RET_1:
s_cmp_eq_u32 s63, s52
s_cbranch_scc1 F_INIT_1
F_INIT_RET_1:
s_branch F_EVA_RET_0
F_EVB_0:
s_cmp_eq_u32 s63, s72
s_cbranch_scc1 F_REG2_0
F_REG2_RET_0:
s_cmp_eq_u32 s63, 13
s_cbranch_scc1 F_PCK
F_PCK_RET:
s_cmp_eq_u32 s63, 15
s_cbranch_scc1 F_PFL2
F_PFL2_RET:
s_cmp_eq_u32 s63, s52
s_cbranch_scc1 F_SPECIAL
s_branch F_EVB_RET_0
F_EVA_1:
s_cmp_ge_u32 s63, 15
s_cbranch_scc1 F_MASK_0
F_MASK_RET_0:
s_cmp_eq_u32 s63, s52
s_cbranch_scc1 F_INIT_0
F_INIT_RET_0:
s_branch F_EVA_RET_1
F_EVB_1:
s_cmp_eq_u32 s63, s72
s_cbranch_scc1 F_REG2_1
F_REG2_RET_1:
s_cmp_eq_u32 s63, 12
s_cbranch_scc1 F_PFL
F_PFL_RET:
s_add_u32 s24, s63, 1
s_cmp_eq_u32 s24, s52
s_cbranch_scc1 F_QSW_1
F_QSW_RET_1:
s_branch F_EVB_RET_1
F_PFL:
.p2align 3
s_getpc_b64 s[24:25]
F_PC_B2:
s_sub_u32 s24, s24, F_PC_B2-F_TAILC
s_subb_u32 s25, s25, 0
s_mov_b32 s22, s14
s_lshl_b32 s22, s22, 2
s_add_u32 s22, s22, s12
v_and_b32 v238, 7, v0
v_lshlrev_b32 v238, 7, v238
v_add_u32 v238, s22, v238
v_lshlrev_b32 v238, 7, v238
v_min_u32 v238, F_END-F_TAILC-4, v238
s_mov_b64 exec, 0xff
global_load_dword v239, v238, s[24:25]
s_mov_b64 exec, -1
s_lshr_b32 s22, s14, 1
s_lshl_b32 s22, s22, 2
s_add_u32 s22, s22, s12
s_mul_i32 s22, s22, 3584
s_mul_i32 s23, s15, 229376
s_add_u32 s22, s22, s23
v_lshlrev_b32 v234, 3, v3
s_mov_b64 exec, 0xfffffff
buffer_load_dword v235, v234, s[28:31], s22 offen
s_mov_b64 exec, -1
v_mov_b32 v249, 0
buffer_load_dword v248, v249, s[4:7], s73 offen sc1
s_branch F_PFL_RET
F_PFL2:
v_mov_b32 v249, 0
buffer_load_dword v248, v249, s[4:7], s73 offen sc1
s_branch F_PFL2_RET
F_PCK:
s_cmp_lg_u32 s17, 0
s_cbranch_scc1 F_PCK_RET
s_cmp_eq_u32 s19, 0
s_cbranch_scc1 F_PCK_RET
s_waitcnt vmcnt(16)
v_cmp_ne_u32 vcc, 1, v248
s_cbranch_vccnz F_PCK_RET
s_mov_b32 s78, s65
s_mov_b32 s74, 1
s_branch F_PCK_RET
F_SPECIAL:
s_add_u32 s63, s63, 1
s_waitcnt lgkmcnt(4)
v_mfma_f32_16x16x32_bf16 v[16:19], v[128:131], a[128:131], v[208:211]
v_exp_f32 v120, v64
v_mfma_f32_16x16x32_bf16 v[20:23], v[128:131], a[160:163], v[212:215]
ds_read_b128 v[160:163], v4 offset:8192
s_add_u32 s23, s75, 32768
v_mfma_f32_16x16x32_bf16 v[16:19], v[132:135], a[132:135], v[16:19]
s_lshl_b32 s24, s12, 10
s_add_u32 s24, s24, s65
s_add_u32 s24, s24, 131072
buffer_store_dwordx4 v[200:203], v3, s[4:7], s24 offen sc1
v_mfma_f32_16x16x32_bf16 v[20:23], v[132:135], a[164:167], v[20:23]
ds_read_b128 v[164:167], v4 offset:9216
v_mfma_f32_16x16x32_bf16 v[16:19], v[136:139], a[136:139], v[16:19]
s_add_u32 s24, s65, 0
buffer_store_dwordx4 a[0:3], v252, s[4:7], s24 offen offset:0 sc1
v_mfma_f32_16x16x32_bf16 v[20:23], v[136:139], a[168:171], v[20:23]
ds_read_b128 v[168:171], v4 offset:10240
v_mfma_f32_16x16x32_bf16 v[16:19], v[140:143], a[140:143], v[16:19]
s_add_u32 s24, s65, 0
buffer_store_dwordx4 a[4:7], v252, s[4:7], s24 offen offset:1024 sc1
v_mfma_f32_16x16x32_bf16 v[20:23], v[140:143], a[172:175], v[20:23]
ds_read_b128 v[172:175], v4 offset:11264
s_waitcnt lgkmcnt(4)
v_mfma_f32_16x16x32_bf16 v[16:19], v[144:147], a[144:147], v[16:19]
s_sub_u32 s76, s23, 163840
s_cselect_b32 s76, s23, s76
v_mfma_f32_16x16x32_bf16 v[20:23], v[144:147], a[176:179], v[20:23]
ds_read_b128 v[176:179], v4 offset:12288
v_add_u32 v5, s76, v3
v_mfma_f32_16x16x32_bf16 v[16:19], v[148:151], a[148:151], v[16:19]
s_add_u32 s24, s65, 0
buffer_store_dwordx4 a[8:11], v252, s[4:7], s24 offen offset:2048 sc1
v_mfma_f32_16x16x32_bf16 v[20:23], v[148:151], a[180:183], v[20:23]
ds_read_b128 v[180:183], v4 offset:13312
s_add_u32 m0, s60, s62
v_mfma_f32_16x16x32_bf16 v[16:19], v[152:155], a[152:155], v[16:19]
buffer_load_dwordx4 v252, s[4:7], s57 offen lds
v_mfma_f32_16x16x32_bf16 v[20:23], v[152:155], a[184:187], v[20:23]
ds_read_b128 v[184:187], v4 offset:14336
v_mfma_f32_16x16x32_bf16 v[16:19], v[156:159], a[156:159], v[16:19]
s_add_u32 s24, s65, 0
buffer_store_dwordx4 a[12:15], v252, s[4:7], s24 offen offset:3072 sc1
v_mfma_f32_16x16x32_bf16 v[20:23], v[156:159], a[188:191], v[20:23]
ds_read_b128 v[188:191], v4 offset:15360
s_waitcnt lgkmcnt(4)
v_mfma_f32_16x16x32_bf16 v[24:27], v[160:163], a[128:131], v[208:211]
buffer_load_dwordx4 v252, s[4:7], s57 offen offset:1024 lds
v_mfma_f32_16x16x32_bf16 v[28:31], v[160:163], a[160:163], v[212:215]
ds_read_b128 v[128:131], v4 offset:16384
v_mfma_f32_16x16x32_bf16 v[24:27], v[164:167], a[132:135], v[24:27]
s_add_u32 s24, s65, 0
buffer_store_dwordx4 a[16:19], v253, s[4:7], s24 offen offset:0 sc1
v_mfma_f32_16x16x32_bf16 v[28:31], v[164:167], a[164:167], v[28:31]
ds_read_b128 v[132:135], v4 offset:17408
v_mfma_f32_16x16x32_bf16 v[24:27], v[168:171], a[136:139], v[24:27]
s_add_u32 s24, s65, 0
buffer_store_dwordx4 a[20:23], v253, s[4:7], s24 offen offset:1024 sc1
v_mfma_f32_16x16x32_bf16 v[28:31], v[168:171], a[168:171], v[28:31]
ds_read_b128 v[136:139], v4 offset:18432
v_mfma_f32_16x16x32_bf16 v[24:27], v[172:175], a[140:143], v[24:27]
buffer_load_dwordx4 v252, s[4:7], s57 offen offset:2048 lds
v_mfma_f32_16x16x32_bf16 v[28:31], v[172:175], a[172:175], v[28:31]
ds_read_b128 v[140:143], v4 offset:19456
s_waitcnt lgkmcnt(4)
v_mfma_f32_16x16x32_bf16 v[24:27], v[176:179], a[144:147], v[24:27]
s_add_u32 s24, s65, 0
buffer_store_dwordx4 a[24:27], v253, s[4:7], s24 offen offset:2048 sc1
v_mfma_f32_16x16x32_bf16 v[28:31], v[176:179], a[176:179], v[28:31]
ds_read_b128 v[144:147], v4 offset:20480
v_mfma_f32_16x16x32_bf16 v[24:27], v[180:183], a[148:151], v[24:27]
buffer_load_dwordx4 v252, s[4:7], s57 offen offset:3072 lds
v_mfma_f32_16x16x32_bf16 v[28:31], v[180:183], a[180:183], v[28:31]
ds_read_b128 v[148:151], v4 offset:21504
s_add_u32 m0, m0, 4096
v_mfma_f32_16x16x32_bf16 v[24:27], v[184:187], a[152:155], v[24:27]
s_add_u32 s24, s65, 0
buffer_store_dwordx4 a[28:31], v253, s[4:7], s24 offen offset:3072 sc1
v_mfma_f32_16x16x32_bf16 v[28:31], v[184:187], a[184:187], v[28:31]
ds_read_b128 v[152:155], v4 offset:22528
v_mfma_f32_16x16x32_bf16 v[24:27], v[188:191], a[156:159], v[24:27]
buffer_load_dwordx4 v253, s[4:7], s57 offen lds
v_mfma_f32_16x16x32_bf16 v[28:31], v[188:191], a[188:191], v[28:31]
ds_read_b128 v[156:159], v4 offset:23552
s_waitcnt lgkmcnt(4)
v_mfma_f32_16x16x32_bf16 v[32:35], v[128:131], a[128:131], v[208:211]
s_add_u32 s24, s65, 32768
buffer_store_dwordx4 a[32:35], v252, s[4:7], s24 offen offset:0 sc1
v_mfma_f32_16x16x32_bf16 v[36:39], v[128:131], a[160:163], v[212:215]
ds_read_b128 v[160:163], v4 offset:24576
v_mfma_f32_16x16x32_bf16 v[32:35], v[132:135], a[132:135], v[32:35]
s_add_u32 s24, s65, 32768
buffer_store_dwordx4 a[36:39], v252, s[4:7], s24 offen offset:1024 sc1
v_mfma_f32_16x16x32_bf16 v[36:39], v[132:135], a[164:167], v[36:39]
ds_read_b128 v[164:167], v4 offset:25600
v_mfma_f32_16x16x32_bf16 v[32:35], v[136:139], a[136:139], v[32:35]
buffer_load_dwordx4 v253, s[4:7], s57 offen offset:1024 lds
v_mfma_f32_16x16x32_bf16 v[36:39], v[136:139], a[168:171], v[36:39]
ds_read_b128 v[168:171], v4 offset:26624
v_mfma_f32_16x16x32_bf16 v[32:35], v[140:143], a[140:143], v[32:35]
s_add_u32 s24, s65, 32768
buffer_store_dwordx4 a[40:43], v252, s[4:7], s24 offen offset:2048 sc1
v_mfma_f32_16x16x32_bf16 v[36:39], v[140:143], a[172:175], v[36:39]
ds_read_b128 v[172:175], v4 offset:27648
s_waitcnt lgkmcnt(4)
v_mfma_f32_16x16x32_bf16 v[32:35], v[144:147], a[144:147], v[32:35]
buffer_load_dwordx4 v253, s[4:7], s57 offen offset:2048 lds
v_mfma_f32_16x16x32_bf16 v[36:39], v[144:147], a[176:179], v[36:39]
ds_read_b128 v[176:179], v4 offset:28672
v_mfma_f32_16x16x32_bf16 v[32:35], v[148:151], a[148:151], v[32:35]
s_add_u32 s24, s65, 32768
buffer_store_dwordx4 a[44:47], v252, s[4:7], s24 offen offset:3072 sc1
v_mfma_f32_16x16x32_bf16 v[36:39], v[148:151], a[180:183], v[36:39]
ds_read_b128 v[180:183], v4 offset:29696
v_mfma_f32_16x16x32_bf16 v[32:35], v[152:155], a[152:155], v[32:35]
buffer_load_dwordx4 v253, s[4:7], s57 offen offset:3072 lds
v_mfma_f32_16x16x32_bf16 v[36:39], v[152:155], a[184:187], v[36:39]
ds_read_b128 v[184:187], v4 offset:30720
s_add_u32 s59, s59, 1
s_add_u32 s57, s57, 32768
s_cmp_eq_u32 s59, s52
s_cselect_b32 s57, s58, s57
s_cmp_ge_u32 s59, s53
s_cselect_b32 s57, 1073741824, s57
v_mfma_f32_16x16x32_bf16 v[32:35], v[156:159], a[156:159], v[32:35]
s_add_u32 s24, s65, 32768
buffer_store_dwordx4 a[48:51], v253, s[4:7], s24 offen offset:0 sc1
v_mfma_f32_16x16x32_bf16 v[36:39], v[156:159], a[188:191], v[36:39]
ds_read_b128 v[188:191], v4 offset:31744
s_waitcnt lgkmcnt(4)
v_mfma_f32_16x16x32_bf16 v[40:43], v[160:163], a[128:131], v[208:211]
s_add_u32 s24, s65, 32768
buffer_store_dwordx4 a[52:55], v253, s[4:7], s24 offen offset:1024 sc1
v_mfma_f32_16x16x32_bf16 v[44:47], v[160:163], a[160:163], v[212:215]
s_waitcnt vmcnt(31)
s_barrier
ds_read_b128 v[128:131], v5 offset:0
v_mfma_f32_16x16x32_bf16 v[40:43], v[164:167], a[132:135], v[40:43]
v_exp_f32 v121, v65
v_mfma_f32_16x16x32_bf16 v[44:47], v[164:167], a[164:167], v[44:47]
ds_read_b128 v[132:135], v5 offset:1024
v_mfma_f32_16x16x32_bf16 v[40:43], v[168:171], a[136:139], v[40:43]
s_add_u32 s24, s65, 32768
buffer_store_dwordx4 a[56:59], v253, s[4:7], s24 offen offset:2048 sc1
v_mfma_f32_16x16x32_bf16 v[44:47], v[168:171], a[168:171], v[44:47]
ds_read_b128 v[136:139], v5 offset:2048
v_mfma_f32_16x16x32_bf16 v[40:43], v[172:175], a[140:143], v[40:43]
v_exp_f32 v122, v66
v_mfma_f32_16x16x32_bf16 v[44:47], v[172:175], a[172:175], v[44:47]
ds_read_b128 v[140:143], v5 offset:3072
s_waitcnt lgkmcnt(4)
v_mfma_f32_16x16x32_bf16 v[40:43], v[176:179], a[144:147], v[40:43]
s_add_u32 s24, s65, 32768
buffer_store_dwordx4 a[60:63], v253, s[4:7], s24 offen offset:3072 sc1
v_mfma_f32_16x16x32_bf16 v[44:47], v[176:179], a[176:179], v[44:47]
ds_read_b128 v[144:147], v5 offset:4096
v_mfma_f32_16x16x32_bf16 v[40:43], v[180:183], a[148:151], v[40:43]
v_exp_f32 v123, v67
v_mfma_f32_16x16x32_bf16 v[44:47], v[180:183], a[180:183], v[44:47]
ds_read_b128 v[148:151], v5 offset:5120
v_add_f32 v198, v120, v121
v_mfma_f32_16x16x32_bf16 v[40:43], v[184:187], a[152:155], v[40:43]
s_add_u32 s24, s65, 65536
buffer_store_dwordx4 a[64:67], v252, s[4:7], s24 offen offset:0 sc1
v_mfma_f32_16x16x32_bf16 v[44:47], v[184:187], a[184:187], v[44:47]
ds_read_b128 v[152:155], v5 offset:6144
v_cvt_pk_bf16_f32 v104, v120, v121
v_mfma_f32_16x16x32_bf16 v[40:43], v[188:191], a[156:159], v[40:43]
s_add_u32 s24, s65, 65536
buffer_store_dwordx4 a[68:71], v252, s[4:7], s24 offen offset:1024 sc1
v_mfma_f32_16x16x32_bf16 v[44:47], v[188:191], a[188:191], v[44:47]
ds_read_b128 v[156:159], v5 offset:7168
v_exp_f32 v124, v68
v_exp_f32 v125, v69
v_exp_f32 v126, v70
v_exp_f32 v127, v71
v_add_f32 v198, v198, v122
v_add_f32 v198, v198, v123
v_cvt_pk_bf16_f32 v105, v122, v123
v_exp_f32 v120, v72
v_exp_f32 v121, v73
v_exp_f32 v122, v74
v_exp_f32 v123, v75
v_add_f32 v199, v124, v125
v_cvt_pk_bf16_f32 v108, v124, v125
v_add_f32 v199, v199, v126
v_add_f32 v199, v199, v127
v_cvt_pk_bf16_f32 v109, v126, v127
v_exp_f32 v124, v76
v_exp_f32 v125, v77
v_exp_f32 v126, v78
v_exp_f32 v127, v79
v_add_f32 v198, v198, v120
v_add_f32 v198, v198, v121
v_cvt_pk_bf16_f32 v106, v120, v121
v_add_f32 v198, v198, v122
v_add_f32 v198, v198, v123
v_cvt_pk_bf16_f32 v107, v122, v123
v_add_f32 v199, v199, v124
v_add_f32 v199, v199, v125
v_cvt_pk_bf16_f32 v110, v124, v125
v_add_f32 v199, v199, v126
v_add_f32 v199, v199, v127
v_cvt_pk_bf16_f32 v111, v126, v127
v_add_f32 v196, v196, v198
v_add_f32 v197, v197, v199
v_add_f32 v13, v196, v197
v_cmp_nge_f32 vcc, s68, v13
s_cbranch_vccnz F_RARE_3
F_RARE_RET_3:
v_add_f32 v194, v194, v196
v_add_f32 v195, v195, v197
s_cmp_ge_u32 s63, 15
s_cbranch_scc1 F_MASK_2
F_MASK_RET_2:
s_waitcnt lgkmcnt(4)
v_mfma_f32_16x16x32_bf16 a[0:3], v[128:131], v[96:99], 0
v_exp_f32 v112, v16
v_mfma_f32_16x16x32_bf16 a[4:7], v[128:131], v[100:103], 0
ds_read_b128 v[160:163], v5 offset:8192
s_add_u32 s23, s76, 32768
v_mfma_f32_16x16x32_bf16 a[0:3], v[132:135], v[104:107], a[0:3]
s_add_u32 s24, s65, 65536
buffer_store_dwordx4 a[72:75], v252, s[4:7], s24 offen offset:2048 sc1
v_mfma_f32_16x16x32_bf16 a[4:7], v[132:135], v[108:111], a[4:7]
ds_read_b128 v[164:167], v5 offset:9216
v_mfma_f32_16x16x32_bf16 a[8:11], v[136:139], v[96:99], 0
s_sub_u32 s60, s23, 163840
s_cselect_b32 s60, s23, s60
v_mfma_f32_16x16x32_bf16 a[12:15], v[136:139], v[100:103], 0
ds_read_b128 v[168:171], v5 offset:10240
v_add_u32 v4, s60, v3
v_mfma_f32_16x16x32_bf16 a[8:11], v[140:143], v[104:107], a[8:11]
s_add_u32 s24, s65, 65536
buffer_store_dwordx4 a[76:79], v252, s[4:7], s24 offen offset:3072 sc1
v_mfma_f32_16x16x32_bf16 a[12:15], v[140:143], v[108:111], a[12:15]
ds_read_b128 v[172:175], v5 offset:11264
s_waitcnt lgkmcnt(4)
v_mfma_f32_16x16x32_bf16 a[16:19], v[144:147], v[96:99], 0
v_exp_f32 v113, v17
v_mfma_f32_16x16x32_bf16 a[20:23], v[144:147], v[100:103], 0
ds_read_b128 v[176:179], v5 offset:12288
s_add_u32 m0, s61, s62
v_mfma_f32_16x16x32_bf16 a[16:19], v[148:151], v[104:107], a[16:19]
s_add_u32 s24, s65, 65536
buffer_store_dwordx4 a[80:83], v253, s[4:7], s24 offen offset:0 sc1
v_mfma_f32_16x16x32_bf16 a[20:23], v[148:151], v[108:111], a[20:23]
ds_read_b128 v[180:183], v5 offset:13312
v_mfma_f32_16x16x32_bf16 a[24:27], v[152:155], v[96:99], 0
s_add_u32 s24, s65, 65536
buffer_store_dwordx4 a[84:87], v253, s[4:7], s24 offen offset:1024 sc1
v_mfma_f32_16x16x32_bf16 a[28:31], v[152:155], v[100:103], 0
ds_read_b128 v[184:187], v5 offset:14336
v_mfma_f32_16x16x32_bf16 a[24:27], v[156:159], v[104:107], a[24:27]
buffer_load_dwordx4 v252, s[4:7], s54 offen lds
v_mfma_f32_16x16x32_bf16 a[28:31], v[156:159], v[108:111], a[28:31]
ds_read_b128 v[188:191], v5 offset:15360
s_waitcnt lgkmcnt(4)
v_mfma_f32_16x16x32_bf16 a[32:35], v[160:163], v[96:99], 0
s_add_u32 s24, s65, 65536
buffer_store_dwordx4 a[88:91], v253, s[4:7], s24 offen offset:2048 sc1
v_mfma_f32_16x16x32_bf16 a[36:39], v[160:163], v[100:103], 0
ds_read_b128 v[128:131], v5 offset:16384
v_mfma_f32_16x16x32_bf16 a[32:35], v[164:167], v[104:107], a[32:35]
buffer_load_dwordx4 v252, s[4:7], s54 offen offset:1024 lds
v_mfma_f32_16x16x32_bf16 a[36:39], v[164:167], v[108:111], a[36:39]
ds_read_b128 v[132:135], v5 offset:17408
v_mfma_f32_16x16x32_bf16 a[40:43], v[168:171], v[96:99], 0
s_add_u32 s24, s65, 65536
buffer_store_dwordx4 a[92:95], v253, s[4:7], s24 offen offset:3072 sc1
v_mfma_f32_16x16x32_bf16 a[44:47], v[168:171], v[100:103], 0
ds_read_b128 v[136:139], v5 offset:18432
v_mfma_f32_16x16x32_bf16 a[40:43], v[172:175], v[104:107], a[40:43]
buffer_load_dwordx4 v252, s[4:7], s54 offen offset:2048 lds
v_mfma_f32_16x16x32_bf16 a[44:47], v[172:175], v[108:111], a[44:47]
ds_read_b128 v[140:143], v5 offset:19456
s_waitcnt lgkmcnt(4)
v_mfma_f32_16x16x32_bf16 a[48:51], v[176:179], v[96:99], 0
s_add_u32 s24, s65, 98304
buffer_store_dwordx4 a[96:99], v252, s[4:7], s24 offen offset:0 sc1
v_mfma_f32_16x16x32_bf16 a[52:55], v[176:179], v[100:103], 0
ds_read_b128 v[144:147], v5 offset:20480
v_mfma_f32_16x16x32_bf16 a[48:51], v[180:183], v[104:107], a[48:51]
s_add_u32 s24, s65, 98304
buffer_store_dwordx4 a[100:103], v252, s[4:7], s24 offen offset:1024 sc1
v_mfma_f32_16x16x32_bf16 a[52:55], v[180:183], v[108:111], a[52:55]
ds_read_b128 v[148:151], v5 offset:21504
v_mfma_f32_16x16x32_bf16 a[56:59], v[184:187], v[96:99], 0
buffer_load_dwordx4 v252, s[4:7], s54 offen offset:3072 lds
v_mfma_f32_16x16x32_bf16 a[60:63], v[184:187], v[100:103], 0
ds_read_b128 v[152:155], v5 offset:22528
s_add_u32 m0, m0, 4096
v_mfma_f32_16x16x32_bf16 a[56:59], v[188:191], v[104:107], a[56:59]
s_add_u32 s24, s65, 98304
buffer_store_dwordx4 a[104:107], v252, s[4:7], s24 offen offset:2048 sc1
v_mfma_f32_16x16x32_bf16 a[60:63], v[188:191], v[108:111], a[60:63]
ds_read_b128 v[156:159], v5 offset:23552
s_waitcnt lgkmcnt(4)
v_mfma_f32_16x16x32_bf16 a[64:67], v[128:131], v[96:99], 0
buffer_load_dwordx4 v253, s[4:7], s54 offen lds
v_mfma_f32_16x16x32_bf16 a[68:71], v[128:131], v[100:103], 0
ds_read_b128 v[160:163], v5 offset:24576
v_mfma_f32_16x16x32_bf16 a[64:67], v[132:135], v[104:107], a[64:67]
s_add_u32 s24, s65, 98304
buffer_store_dwordx4 a[108:111], v252, s[4:7], s24 offen offset:3072 sc1
v_mfma_f32_16x16x32_bf16 a[68:71], v[132:135], v[108:111], a[68:71]
ds_read_b128 v[164:167], v5 offset:25600
v_mfma_f32_16x16x32_bf16 a[72:75], v[136:139], v[96:99], 0
buffer_load_dwordx4 v253, s[4:7], s54 offen offset:1024 lds
v_mfma_f32_16x16x32_bf16 a[76:79], v[136:139], v[100:103], 0
ds_read_b128 v[168:171], v5 offset:26624
v_mfma_f32_16x16x32_bf16 a[72:75], v[140:143], v[104:107], a[72:75]
s_add_u32 s24, s65, 98304
buffer_store_dwordx4 a[112:115], v253, s[4:7], s24 offen offset:0 sc1
v_mfma_f32_16x16x32_bf16 a[76:79], v[140:143], v[108:111], a[76:79]
ds_read_b128 v[172:175], v5 offset:27648
s_waitcnt lgkmcnt(4)
v_mfma_f32_16x16x32_bf16 a[80:83], v[144:147], v[96:99], 0
s_add_u32 s24, s65, 98304
buffer_store_dwordx4 a[116:119], v253, s[4:7], s24 offen offset:1024 sc1
v_mfma_f32_16x16x32_bf16 a[84:87], v[144:147], v[100:103], 0
ds_read_b128 v[176:179], v5 offset:28672
v_mfma_f32_16x16x32_bf16 a[80:83], v[148:151], v[104:107], a[80:83]
buffer_load_dwordx4 v253, s[4:7], s54 offen offset:2048 lds
v_mfma_f32_16x16x32_bf16 a[84:87], v[148:151], v[108:111], a[84:87]
ds_read_b128 v[180:183], v5 offset:29696
v_mfma_f32_16x16x32_bf16 a[88:91], v[152:155], v[96:99], 0
s_add_u32 s24, s65, 98304
buffer_store_dwordx4 a[120:123], v253, s[4:7], s24 offen offset:2048 sc1
v_mfma_f32_16x16x32_bf16 a[92:95], v[152:155], v[100:103], 0
ds_read_b128 v[184:187], v5 offset:30720
buffer_load_dwordx4 v253, s[4:7], s54 offen offset:3072 lds
s_add_u32 s56, s56, 1
s_add_u32 s54, s54, 32768
s_cmp_eq_u32 s56, s52
s_cselect_b32 s54, s55, s54
s_cmp_eq_u32 s56, s53
s_cselect_b32 s54, s78, s54
v_mfma_f32_16x16x32_bf16 a[88:91], v[156:159], v[104:107], a[88:91]
v_exp_f32 v114, v18
v_mfma_f32_16x16x32_bf16 a[92:95], v[156:159], v[108:111], a[92:95]
ds_read_b128 v[188:191], v5 offset:31744
s_waitcnt lgkmcnt(4)
v_mfma_f32_16x16x32_bf16 a[96:99], v[160:163], v[96:99], 0
s_add_u32 s24, s65, 98304
buffer_store_dwordx4 a[124:127], v253, s[4:7], s24 offen offset:3072 sc1
v_mfma_f32_16x16x32_bf16 a[100:103], v[160:163], v[100:103], 0
s_waitcnt vmcnt(49)
s_barrier
ds_read_b128 v[128:131], v4 offset:0
v_mfma_f32_16x16x32_bf16 a[96:99], v[164:167], v[104:107], a[96:99]
v_exp_f32 v115, v19
v_mfma_f32_16x16x32_bf16 a[100:103], v[164:167], v[108:111], a[100:103]
ds_read_b128 v[132:135], v4 offset:1024
v_add_f32 v196, v112, v113
v_mfma_f32_16x16x32_bf16 a[104:107], v[168:171], v[96:99], 0
v_exp_f32 v116, v20
v_mfma_f32_16x16x32_bf16 a[108:111], v[168:171], v[100:103], 0
ds_read_b128 v[136:139], v4 offset:2048
v_cvt_pk_bf16_f32 v80, v112, v113
v_mfma_f32_16x16x32_bf16 a[104:107], v[172:175], v[104:107], a[104:107]
v_exp_f32 v117, v21
v_mfma_f32_16x16x32_bf16 a[108:111], v[172:175], v[108:111], a[108:111]
ds_read_b128 v[140:143], v4 offset:3072
s_waitcnt lgkmcnt(4)
v_mfma_f32_16x16x32_bf16 a[112:115], v[176:179], v[96:99], 0
v_exp_f32 v118, v22
v_mfma_f32_16x16x32_bf16 a[116:119], v[176:179], v[100:103], 0
ds_read_b128 v[144:147], v4 offset:4096
v_add_f32 v196, v196, v114
v_mfma_f32_16x16x32_bf16 a[112:115], v[180:183], v[104:107], a[112:115]
v_exp_f32 v119, v23
v_mfma_f32_16x16x32_bf16 a[116:119], v[180:183], v[108:111], a[116:119]
ds_read_b128 v[148:151], v4 offset:5120
v_add_f32 v196, v196, v115
v_mfma_f32_16x16x32_bf16 a[120:123], v[184:187], v[96:99], 0
v_cvt_pk_bf16_f32 v81, v114, v115
v_add_f32 v197, v116, v117
v_mfma_f32_16x16x32_bf16 a[124:127], v[184:187], v[100:103], 0
ds_read_b128 v[152:155], v4 offset:6144
v_cvt_pk_bf16_f32 v84, v116, v117
v_mfma_f32_16x16x32_bf16 a[120:123], v[188:191], v[104:107], a[120:123]
v_exp_f32 v112, v24
v_mfma_f32_16x16x32_bf16 a[124:127], v[188:191], v[108:111], a[124:127]
ds_read_b128 v[156:159], v4 offset:7168
v_exp_f32 v113, v25
v_exp_f32 v114, v26
v_exp_f32 v115, v27
v_add_f32 v197, v197, v118
v_add_f32 v197, v197, v119
v_cvt_pk_bf16_f32 v85, v118, v119
v_exp_f32 v116, v28
v_exp_f32 v117, v29
v_exp_f32 v118, v30
v_exp_f32 v119, v31
v_add_f32 v196, v196, v112
v_add_f32 v196, v196, v113
v_cvt_pk_bf16_f32 v82, v112, v113
v_add_f32 v196, v196, v114
v_add_f32 v196, v196, v115
v_cvt_pk_bf16_f32 v83, v114, v115
v_add_f32 v197, v197, v116
v_add_f32 v197, v197, v117
v_cvt_pk_bf16_f32 v86, v116, v117
v_add_f32 v197, v197, v118
v_add_f32 v197, v197, v119
v_cvt_pk_bf16_f32 v87, v118, v119
s_mov_b32 s67, 1
s_branch F_HALF_END_1
F_REG2_0:
s_cmp_lg_u32 s12, 0
s_cbranch_scc1 F_REG2_RET_0
s_add_u32 s23, s18, 0x81
v_mov_b32 v13, s23
v_mov_b32 v14, 0
s_mov_b64 exec, 1
buffer_store_byte v13, v14, s[8:11], s21 offen sc1
s_mov_b64 exec, -1
s_branch F_REG2_RET_0
F_REG2_1:
s_cmp_lg_u32 s12, 0
s_cbranch_scc1 F_REG2_RET_1
s_add_u32 s23, s18, 0x81
v_mov_b32 v13, s23
v_mov_b32 v14, 0
s_mov_b64 exec, 1
buffer_store_byte v13, v14, s[8:11], s21 offen sc1
s_mov_b64 exec, -1
s_branch F_REG2_RET_1
F_W49_A0:
s_sub_u32 s67, s67, 1
s_waitcnt vmcnt(8)
s_branch F_WD_A0
F_QSW_0:
s_nop 7
v_accvgpr_mov_b32 a128, a192
v_accvgpr_mov_b32 a129, a193
v_accvgpr_mov_b32 a130, a194
v_accvgpr_mov_b32 a131, a195
v_accvgpr_mov_b32 a132, a196
v_accvgpr_mov_b32 a133, a197
v_accvgpr_mov_b32 a134, a198
v_accvgpr_mov_b32 a135, a199
v_accvgpr_mov_b32 a136, a200
v_accvgpr_mov_b32 a137, a201
v_accvgpr_mov_b32 a138, a202
v_accvgpr_mov_b32 a139, a203
v_accvgpr_mov_b32 a140, a204
v_accvgpr_mov_b32 a141, a205
v_accvgpr_mov_b32 a142, a206
v_accvgpr_mov_b32 a143, a207
v_accvgpr_mov_b32 a144, a208
v_accvgpr_mov_b32 a145, a209
v_accvgpr_mov_b32 a146, a210
v_accvgpr_mov_b32 a147, a211
v_accvgpr_mov_b32 a148, a212
v_accvgpr_mov_b32 a149, a213
v_accvgpr_mov_b32 a150, a214
v_accvgpr_mov_b32 a151, a215
v_accvgpr_mov_b32 a152, a216
v_accvgpr_mov_b32 a153, a217
v_accvgpr_mov_b32 a154, a218
v_accvgpr_mov_b32 a155, a219
v_accvgpr_mov_b32 a156, a220
v_accvgpr_mov_b32 a157, a221
v_accvgpr_mov_b32 a158, a222
v_accvgpr_mov_b32 a159, a223
v_accvgpr_mov_b32 a160, a224
v_accvgpr_mov_b32 a161, a225
v_accvgpr_mov_b32 a162, a226
v_accvgpr_mov_b32 a163, a227
v_accvgpr_mov_b32 a164, a228
v_accvgpr_mov_b32 a165, a229
v_accvgpr_mov_b32 a166, a230
v_accvgpr_mov_b32 a167, a231
v_accvgpr_mov_b32 a168, a232
v_accvgpr_mov_b32 a169, a233
v_accvgpr_mov_b32 a170, a234
v_accvgpr_mov_b32 a171, a235
v_accvgpr_mov_b32 a172, a236
v_accvgpr_mov_b32 a173, a237
v_accvgpr_mov_b32 a174, a238
v_accvgpr_mov_b32 a175, a239
v_accvgpr_mov_b32 a176, a240
v_accvgpr_mov_b32 a177, a241
v_accvgpr_mov_b32 a178, a242
v_accvgpr_mov_b32 a179, a243
v_accvgpr_mov_b32 a180, a244
v_accvgpr_mov_b32 a181, a245
v_accvgpr_mov_b32 a182, a246
v_accvgpr_mov_b32 a183, a247
v_accvgpr_mov_b32 a184, a248
v_accvgpr_mov_b32 a185, a249
v_accvgpr_mov_b32 a186, a250
v_accvgpr_mov_b32 a187, a251
v_accvgpr_mov_b32 a188, a252
v_accvgpr_mov_b32 a189, a253
v_accvgpr_mov_b32 a190, a254
v_accvgpr_mov_b32 a191, a255
s_nop 1
s_branch F_QSW_RET_0
F_QSW_1:
s_nop 7
v_accvgpr_mov_b32 a128, a192
v_accvgpr_mov_b32 a129, a193
v_accvgpr_mov_b32 a130, a194
v_accvgpr_mov_b32 a131, a195
v_accvgpr_mov_b32 a132, a196
v_accvgpr_mov_b32 a133, a197
v_accvgpr_mov_b32 a134, a198
v_accvgpr_mov_b32 a135, a199
v_accvgpr_mov_b32 a136, a200
v_accvgpr_mov_b32 a137, a201
v_accvgpr_mov_b32 a138, a202
v_accvgpr_mov_b32 a139, a203
v_accvgpr_mov_b32 a140, a204
v_accvgpr_mov_b32 a141, a205
v_accvgpr_mov_b32 a142, a206
v_accvgpr_mov_b32 a143, a207
v_accvgpr_mov_b32 a144, a208
v_accvgpr_mov_b32 a145, a209
v_accvgpr_mov_b32 a146, a210
v_accvgpr_mov_b32 a147, a211
v_accvgpr_mov_b32 a148, a212
v_accvgpr_mov_b32 a149, a213
v_accvgpr_mov_b32 a150, a214
v_accvgpr_mov_b32 a151, a215
v_accvgpr_mov_b32 a152, a216
v_accvgpr_mov_b32 a153, a217
v_accvgpr_mov_b32 a154, a218
v_accvgpr_mov_b32 a155, a219
v_accvgpr_mov_b32 a156, a220
v_accvgpr_mov_b32 a157, a221
v_accvgpr_mov_b32 a158, a222
v_accvgpr_mov_b32 a159, a223
v_accvgpr_mov_b32 a160, a224
v_accvgpr_mov_b32 a161, a225
v_accvgpr_mov_b32 a162, a226
v_accvgpr_mov_b32 a163, a227
v_accvgpr_mov_b32 a164, a228
v_accvgpr_mov_b32 a165, a229
v_accvgpr_mov_b32 a166, a230
v_accvgpr_mov_b32 a167, a231
v_accvgpr_mov_b32 a168, a232
v_accvgpr_mov_b32 a169, a233
v_accvgpr_mov_b32 a170, a234
v_accvgpr_mov_b32 a171, a235
v_accvgpr_mov_b32 a172, a236
v_accvgpr_mov_b32 a173, a237
v_accvgpr_mov_b32 a174, a238
v_accvgpr_mov_b32 a175, a239
v_accvgpr_mov_b32 a176, a240
v_accvgpr_mov_b32 a177, a241
v_accvgpr_mov_b32 a178, a242
v_accvgpr_mov_b32 a179, a243
v_accvgpr_mov_b32 a180, a244
v_accvgpr_mov_b32 a181, a245
v_accvgpr_mov_b32 a182, a246
v_accvgpr_mov_b32 a183, a247
v_accvgpr_mov_b32 a184, a248
v_accvgpr_mov_b32 a185, a249
v_accvgpr_mov_b32 a186, a250
v_accvgpr_mov_b32 a187, a251
v_accvgpr_mov_b32 a188, a252
v_accvgpr_mov_b32 a189, a253
v_accvgpr_mov_b32 a190, a254
v_accvgpr_mov_b32 a191, a255
s_nop 1
s_branch F_QSW_RET_1
F_RARE_0:
s_nop 15
v_max3_f32 v13, v16, v17, v18
v_max3_f32 v13, v13, v19, v24
v_max3_f32 v13, v13, v25, v26
v_max3_f32 v13, v13, v27, v32
v_max3_f32 v13, v13, v33, v34
v_max3_f32 v13, v13, v35, v40
v_max3_f32 v13, v13, v41, v42
v_max_f32 v13, v13, v43
v_mov_b32 v15, v13
s_nop 1
v_permlane32_swap_b32 v15, v13
s_nop 1
v_max_f32 v13, v13, v15
v_mov_b32 v15, v13
s_nop 1
v_permlane16_swap_b32 v15, v13
s_nop 1
v_max_f32 v13, v13, v15
v_max3_f32 v14, v20, v21, v22
v_max3_f32 v14, v14, v23, v28
v_max3_f32 v14, v14, v29, v30
v_max3_f32 v14, v14, v31, v36
v_max3_f32 v14, v14, v37, v38
v_max3_f32 v14, v14, v39, v44
v_max3_f32 v14, v14, v45, v46
v_max_f32 v14, v14, v47
v_mov_b32 v15, v14
s_nop 1
v_permlane32_swap_b32 v15, v14
s_nop 1
v_max_f32 v14, v14, v15
v_mov_b32 v15, v14
s_nop 1
v_permlane16_swap_b32 v15, v14
s_nop 1
v_max_f32 v14, v14, v15
v_max_f32 v13, 0, v13
v_sub_f32 v204, 0, v13
v_exp_f32 v204, v204
s_nop 0
v_mul_f32 v194, v194, v204
v_max_f32 v14, 0, v14
v_sub_f32 v205, 0, v14
v_exp_f32 v205, v205
s_nop 0
v_mul_f32 v195, v195, v205
v_add_f32 v192, v192, v13
v_sub_f32 v208, 0, v192
v_sub_f32 v209, 0, v192
v_sub_f32 v210, 0, v192
v_sub_f32 v211, 0, v192
v_add_f32 v193, v193, v14
v_sub_f32 v212, 0, v193
v_sub_f32 v213, 0, v193
v_sub_f32 v214, 0, v193
v_sub_f32 v215, 0, v193
v_sub_f32 v16, v16, v13
v_sub_f32 v17, v17, v13
v_sub_f32 v18, v18, v13
v_sub_f32 v19, v19, v13
v_sub_f32 v20, v20, v14
v_sub_f32 v21, v21, v14
v_sub_f32 v22, v22, v14
v_sub_f32 v23, v23, v14
v_sub_f32 v24, v24, v13
v_sub_f32 v25, v25, v13
v_sub_f32 v26, v26, v13
v_sub_f32 v27, v27, v13
v_sub_f32 v28, v28, v14
v_sub_f32 v29, v29, v14
v_sub_f32 v30, v30, v14
v_sub_f32 v31, v31, v14
v_sub_f32 v32, v32, v13
v_sub_f32 v33, v33, v13
v_sub_f32 v34, v34, v13
v_sub_f32 v35, v35, v13
v_sub_f32 v36, v36, v14
v_sub_f32 v37, v37, v14
v_sub_f32 v38, v38, v14
v_sub_f32 v39, v39, v14
v_sub_f32 v40, v40, v13
v_sub_f32 v41, v41, v13
v_sub_f32 v42, v42, v13
v_sub_f32 v43, v43, v13
v_sub_f32 v44, v44, v14
v_sub_f32 v45, v45, v14
v_sub_f32 v46, v46, v14
v_sub_f32 v47, v47, v14
v_sub_f32 v48, v48, v13
v_sub_f32 v49, v49, v13
v_sub_f32 v50, v50, v13
v_sub_f32 v51, v51, v13
v_sub_f32 v52, v52, v14
v_sub_f32 v53, v53, v14
v_sub_f32 v54, v54, v14
v_sub_f32 v55, v55, v14
v_sub_f32 v56, v56, v13
v_sub_f32 v57, v57, v13
v_sub_f32 v58, v58, v13
v_sub_f32 v59, v59, v13
v_sub_f32 v60, v60, v14
v_sub_f32 v61, v61, v14
v_sub_f32 v62, v62, v14
v_sub_f32 v63, v63, v14
v_sub_f32 v64, v64, v13
v_sub_f32 v65, v65, v13
v_sub_f32 v66, v66, v13
v_sub_f32 v67, v67, v13
v_sub_f32 v68, v68, v14
v_sub_f32 v69, v69, v14
v_sub_f32 v70, v70, v14
v_sub_f32 v71, v71, v14
v_sub_f32 v72, v72, v13
v_sub_f32 v73, v73, v13
v_sub_f32 v74, v74, v13
v_sub_f32 v75, v75, v13
v_sub_f32 v76, v76, v14
v_sub_f32 v77, v77, v14
v_sub_f32 v78, v78, v14
v_sub_f32 v79, v79, v14
v_accvgpr_read_b32 v112, a0
v_accvgpr_read_b32 v113, a1
v_accvgpr_read_b32 v114, a2
v_accvgpr_read_b32 v115, a3
v_mul_f32 v112, v204, v112
v_mul_f32 v113, v204, v113
v_mul_f32 v114, v204, v114
v_mul_f32 v115, v204, v115
v_accvgpr_write_b32 a0, v112
v_accvgpr_write_b32 a1, v113
v_accvgpr_write_b32 a2, v114
v_accvgpr_write_b32 a3, v115
v_accvgpr_read_b32 v112, a4
v_accvgpr_read_b32 v113, a5
v_accvgpr_read_b32 v114, a6
v_accvgpr_read_b32 v115, a7
v_mul_f32 v112, v205, v112
v_mul_f32 v113, v205, v113
v_mul_f32 v114, v205, v114
v_mul_f32 v115, v205, v115
v_accvgpr_write_b32 a4, v112
v_accvgpr_write_b32 a5, v113
v_accvgpr_write_b32 a6, v114
v_accvgpr_write_b32 a7, v115
v_accvgpr_read_b32 v112, a8
v_accvgpr_read_b32 v113, a9
v_accvgpr_read_b32 v114, a10
v_accvgpr_read_b32 v115, a11
v_mul_f32 v112, v204, v112
v_mul_f32 v113, v204, v113
v_mul_f32 v114, v204, v114
v_mul_f32 v115, v204, v115
v_accvgpr_write_b32 a8, v112
v_accvgpr_write_b32 a9, v113
v_accvgpr_write_b32 a10, v114
v_accvgpr_write_b32 a11, v115
v_accvgpr_read_b32 v112, a12
v_accvgpr_read_b32 v113, a13
v_accvgpr_read_b32 v114, a14
v_accvgpr_read_b32 v115, a15
v_mul_f32 v112, v205, v112
v_mul_f32 v113, v205, v113
v_mul_f32 v114, v205, v114
v_mul_f32 v115, v205, v115
v_accvgpr_write_b32 a12, v112
v_accvgpr_write_b32 a13, v113
v_accvgpr_write_b32 a14, v114
v_accvgpr_write_b32 a15, v115
v_accvgpr_read_b32 v112, a16
v_accvgpr_read_b32 v113, a17
v_accvgpr_read_b32 v114, a18
v_accvgpr_read_b32 v115, a19
v_mul_f32 v112, v204, v112
v_mul_f32 v113, v204, v113
v_mul_f32 v114, v204, v114
v_mul_f32 v115, v204, v115
v_accvgpr_write_b32 a16, v112
v_accvgpr_write_b32 a17, v113
v_accvgpr_write_b32 a18, v114
v_accvgpr_write_b32 a19, v115
v_accvgpr_read_b32 v112, a20
v_accvgpr_read_b32 v113, a21
v_accvgpr_read_b32 v114, a22
v_accvgpr_read_b32 v115, a23
v_mul_f32 v112, v205, v112
v_mul_f32 v113, v205, v113
v_mul_f32 v114, v205, v114
v_mul_f32 v115, v205, v115
v_accvgpr_write_b32 a20, v112
v_accvgpr_write_b32 a21, v113
v_accvgpr_write_b32 a22, v114
v_accvgpr_write_b32 a23, v115
v_accvgpr_read_b32 v112, a24
v_accvgpr_read_b32 v113, a25
v_accvgpr_read_b32 v114, a26
v_accvgpr_read_b32 v115, a27
v_mul_f32 v112, v204, v112
v_mul_f32 v113, v204, v113
v_mul_f32 v114, v204, v114
v_mul_f32 v115, v204, v115
v_accvgpr_write_b32 a24, v112
v_accvgpr_write_b32 a25, v113
v_accvgpr_write_b32 a26, v114
v_accvgpr_write_b32 a27, v115
v_accvgpr_read_b32 v112, a28
v_accvgpr_read_b32 v113, a29
v_accvgpr_read_b32 v114, a30
v_accvgpr_read_b32 v115, a31
v_mul_f32 v112, v205, v112
v_mul_f32 v113, v205, v113
v_mul_f32 v114, v205, v114
v_mul_f32 v115, v205, v115
v_accvgpr_write_b32 a28, v112
v_accvgpr_write_b32 a29, v113
v_accvgpr_write_b32 a30, v114
v_accvgpr_write_b32 a31, v115
v_accvgpr_read_b32 v112, a32
v_accvgpr_read_b32 v113, a33
v_accvgpr_read_b32 v114, a34
v_accvgpr_read_b32 v115, a35
v_mul_f32 v112, v204, v112
v_mul_f32 v113, v204, v113
v_mul_f32 v114, v204, v114
v_mul_f32 v115, v204, v115
v_accvgpr_write_b32 a32, v112
v_accvgpr_write_b32 a33, v113
v_accvgpr_write_b32 a34, v114
v_accvgpr_write_b32 a35, v115
v_accvgpr_read_b32 v112, a36
v_accvgpr_read_b32 v113, a37
v_accvgpr_read_b32 v114, a38
v_accvgpr_read_b32 v115, a39
v_mul_f32 v112, v205, v112
v_mul_f32 v113, v205, v113
v_mul_f32 v114, v205, v114
v_mul_f32 v115, v205, v115
v_accvgpr_write_b32 a36, v112
v_accvgpr_write_b32 a37, v113
v_accvgpr_write_b32 a38, v114
v_accvgpr_write_b32 a39, v115
v_accvgpr_read_b32 v112, a40
v_accvgpr_read_b32 v113, a41
v_accvgpr_read_b32 v114, a42
v_accvgpr_read_b32 v115, a43
v_mul_f32 v112, v204, v112
v_mul_f32 v113, v204, v113
v_mul_f32 v114, v204, v114
v_mul_f32 v115, v204, v115
v_accvgpr_write_b32 a40, v112
v_accvgpr_write_b32 a41, v113
v_accvgpr_write_b32 a42, v114
v_accvgpr_write_b32 a43, v115
v_accvgpr_read_b32 v112, a44
v_accvgpr_read_b32 v113, a45
v_accvgpr_read_b32 v114, a46
v_accvgpr_read_b32 v115, a47
v_mul_f32 v112, v205, v112
v_mul_f32 v113, v205, v113
v_mul_f32 v114, v205, v114
v_mul_f32 v115, v205, v115
v_accvgpr_write_b32 a44, v112
v_accvgpr_write_b32 a45, v113
v_accvgpr_write_b32 a46, v114
v_accvgpr_write_b32 a47, v115
v_accvgpr_read_b32 v112, a48
v_accvgpr_read_b32 v113, a49
v_accvgpr_read_b32 v114, a50
v_accvgpr_read_b32 v115, a51
v_mul_f32 v112, v204, v112
v_mul_f32 v113, v204, v113
v_mul_f32 v114, v204, v114
v_mul_f32 v115, v204, v115
v_accvgpr_write_b32 a48, v112
v_accvgpr_write_b32 a49, v113
v_accvgpr_write_b32 a50, v114
v_accvgpr_write_b32 a51, v115
v_accvgpr_read_b32 v112, a52
v_accvgpr_read_b32 v113, a53
v_accvgpr_read_b32 v114, a54
v_accvgpr_read_b32 v115, a55
v_mul_f32 v112, v205, v112
v_mul_f32 v113, v205, v113
v_mul_f32 v114, v205, v114
v_mul_f32 v115, v205, v115
v_accvgpr_write_b32 a52, v112
v_accvgpr_write_b32 a53, v113
v_accvgpr_write_b32 a54, v114
v_accvgpr_write_b32 a55, v115
v_accvgpr_read_b32 v112, a56
v_accvgpr_read_b32 v113, a57
v_accvgpr_read_b32 v114, a58
v_accvgpr_read_b32 v115, a59
v_mul_f32 v112, v204, v112
v_mul_f32 v113, v204, v113
v_mul_f32 v114, v204, v114
v_mul_f32 v115, v204, v115
v_accvgpr_write_b32 a56, v112
v_accvgpr_write_b32 a57, v113
v_accvgpr_write_b32 a58, v114
v_accvgpr_write_b32 a59, v115
v_accvgpr_read_b32 v112, a60
v_accvgpr_read_b32 v113, a61
v_accvgpr_read_b32 v114, a62
v_accvgpr_read_b32 v115, a63
v_mul_f32 v112, v205, v112
v_mul_f32 v113, v205, v113
v_mul_f32 v114, v205, v114
v_mul_f32 v115, v205, v115
v_accvgpr_write_b32 a60, v112
v_accvgpr_write_b32 a61, v113
v_accvgpr_write_b32 a62, v114
v_accvgpr_write_b32 a63, v115
v_accvgpr_read_b32 v112, a64
v_accvgpr_read_b32 v113, a65
v_accvgpr_read_b32 v114, a66
v_accvgpr_read_b32 v115, a67
v_mul_f32 v112, v204, v112
v_mul_f32 v113, v204, v113
v_mul_f32 v114, v204, v114
v_mul_f32 v115, v204, v115
v_accvgpr_write_b32 a64, v112
v_accvgpr_write_b32 a65, v113
v_accvgpr_write_b32 a66, v114
v_accvgpr_write_b32 a67, v115
v_accvgpr_read_b32 v112, a68
v_accvgpr_read_b32 v113, a69
v_accvgpr_read_b32 v114, a70
v_accvgpr_read_b32 v115, a71
v_mul_f32 v112, v205, v112
v_mul_f32 v113, v205, v113
v_mul_f32 v114, v205, v114
v_mul_f32 v115, v205, v115
v_accvgpr_write_b32 a68, v112
v_accvgpr_write_b32 a69, v113
v_accvgpr_write_b32 a70, v114
v_accvgpr_write_b32 a71, v115
v_accvgpr_read_b32 v112, a72
v_accvgpr_read_b32 v113, a73
v_accvgpr_read_b32 v114, a74
v_accvgpr_read_b32 v115, a75
v_mul_f32 v112, v204, v112
v_mul_f32 v113, v204, v113
v_mul_f32 v114, v204, v114
v_mul_f32 v115, v204, v115
v_accvgpr_write_b32 a72, v112
v_accvgpr_write_b32 a73, v113
v_accvgpr_write_b32 a74, v114
v_accvgpr_write_b32 a75, v115
v_accvgpr_read_b32 v112, a76
v_accvgpr_read_b32 v113, a77
v_accvgpr_read_b32 v114, a78
v_accvgpr_read_b32 v115, a79
v_mul_f32 v112, v205, v112
v_mul_f32 v113, v205, v113
v_mul_f32 v114, v205, v114
v_mul_f32 v115, v205, v115
v_accvgpr_write_b32 a76, v112
v_accvgpr_write_b32 a77, v113
v_accvgpr_write_b32 a78, v114
v_accvgpr_write_b32 a79, v115
v_accvgpr_read_b32 v112, a80
v_accvgpr_read_b32 v113, a81
v_accvgpr_read_b32 v114, a82
v_accvgpr_read_b32 v115, a83
v_mul_f32 v112, v204, v112
v_mul_f32 v113, v204, v113
v_mul_f32 v114, v204, v114
v_mul_f32 v115, v204, v115
v_accvgpr_write_b32 a80, v112
v_accvgpr_write_b32 a81, v113
v_accvgpr_write_b32 a82, v114
v_accvgpr_write_b32 a83, v115
v_accvgpr_read_b32 v112, a84
v_accvgpr_read_b32 v113, a85
v_accvgpr_read_b32 v114, a86
v_accvgpr_read_b32 v115, a87
v_mul_f32 v112, v205, v112
v_mul_f32 v113, v205, v113
v_mul_f32 v114, v205, v114
v_mul_f32 v115, v205, v115
v_accvgpr_write_b32 a84, v112
v_accvgpr_write_b32 a85, v113
v_accvgpr_write_b32 a86, v114
v_accvgpr_write_b32 a87, v115
v_accvgpr_read_b32 v112, a88
v_accvgpr_read_b32 v113, a89
v_accvgpr_read_b32 v114, a90
v_accvgpr_read_b32 v115, a91
v_mul_f32 v112, v204, v112
v_mul_f32 v113, v204, v113
v_mul_f32 v114, v204, v114
v_mul_f32 v115, v204, v115
v_accvgpr_write_b32 a88, v112
v_accvgpr_write_b32 a89, v113
v_accvgpr_write_b32 a90, v114
v_accvgpr_write_b32 a91, v115
v_accvgpr_read_b32 v112, a92
v_accvgpr_read_b32 v113, a93
v_accvgpr_read_b32 v114, a94
v_accvgpr_read_b32 v115, a95
v_mul_f32 v112, v205, v112
v_mul_f32 v113, v205, v113
v_mul_f32 v114, v205, v114
v_mul_f32 v115, v205, v115
v_accvgpr_write_b32 a92, v112
v_accvgpr_write_b32 a93, v113
v_accvgpr_write_b32 a94, v114
v_accvgpr_write_b32 a95, v115
v_accvgpr_read_b32 v112, a96
v_accvgpr_read_b32 v113, a97
v_accvgpr_read_b32 v114, a98
v_accvgpr_read_b32 v115, a99
v_mul_f32 v112, v204, v112
v_mul_f32 v113, v204, v113
v_mul_f32 v114, v204, v114
v_mul_f32 v115, v204, v115
v_accvgpr_write_b32 a96, v112
v_accvgpr_write_b32 a97, v113
v_accvgpr_write_b32 a98, v114
v_accvgpr_write_b32 a99, v115
v_accvgpr_read_b32 v112, a100
v_accvgpr_read_b32 v113, a101
v_accvgpr_read_b32 v114, a102
v_accvgpr_read_b32 v115, a103
v_mul_f32 v112, v205, v112
v_mul_f32 v113, v205, v113
v_mul_f32 v114, v205, v114
v_mul_f32 v115, v205, v115
v_accvgpr_write_b32 a100, v112
v_accvgpr_write_b32 a101, v113
v_accvgpr_write_b32 a102, v114
v_accvgpr_write_b32 a103, v115
v_accvgpr_read_b32 v112, a104
v_accvgpr_read_b32 v113, a105
v_accvgpr_read_b32 v114, a106
v_accvgpr_read_b32 v115, a107
v_mul_f32 v112, v204, v112
v_mul_f32 v113, v204, v113
v_mul_f32 v114, v204, v114
v_mul_f32 v115, v204, v115
v_accvgpr_write_b32 a104, v112
v_accvgpr_write_b32 a105, v113
v_accvgpr_write_b32 a106, v114
v_accvgpr_write_b32 a107, v115
v_accvgpr_read_b32 v112, a108
v_accvgpr_read_b32 v113, a109
v_accvgpr_read_b32 v114, a110
v_accvgpr_read_b32 v115, a111
v_mul_f32 v112, v205, v112
v_mul_f32 v113, v205, v113
v_mul_f32 v114, v205, v114
v_mul_f32 v115, v205, v115
v_accvgpr_write_b32 a108, v112
v_accvgpr_write_b32 a109, v113
v_accvgpr_write_b32 a110, v114
v_accvgpr_write_b32 a111, v115
v_accvgpr_read_b32 v112, a112
v_accvgpr_read_b32 v113, a113
v_accvgpr_read_b32 v114, a114
v_accvgpr_read_b32 v115, a115
v_mul_f32 v112, v204, v112
v_mul_f32 v113, v204, v113
v_mul_f32 v114, v204, v114
v_mul_f32 v115, v204, v115
v_accvgpr_write_b32 a112, v112
v_accvgpr_write_b32 a113, v113
v_accvgpr_write_b32 a114, v114
v_accvgpr_write_b32 a115, v115
v_accvgpr_read_b32 v112, a116
v_accvgpr_read_b32 v113, a117
v_accvgpr_read_b32 v114, a118
v_accvgpr_read_b32 v115, a119
v_mul_f32 v112, v205, v112
v_mul_f32 v113, v205, v113
v_mul_f32 v114, v205, v114
v_mul_f32 v115, v205, v115
v_accvgpr_write_b32 a116, v112
v_accvgpr_write_b32 a117, v113
v_accvgpr_write_b32 a118, v114
v_accvgpr_write_b32 a119, v115
v_accvgpr_read_b32 v112, a120
v_accvgpr_read_b32 v113, a121
v_accvgpr_read_b32 v114, a122
v_accvgpr_read_b32 v115, a123
v_mul_f32 v112, v204, v112
v_mul_f32 v113, v204, v113
v_mul_f32 v114, v204, v114
v_mul_f32 v115, v204, v115
v_accvgpr_write_b32 a120, v112
v_accvgpr_write_b32 a121, v113
v_accvgpr_write_b32 a122, v114
v_accvgpr_write_b32 a123, v115
v_accvgpr_read_b32 v112, a124
v_accvgpr_read_b32 v113, a125
v_accvgpr_read_b32 v114, a126
v_accvgpr_read_b32 v115, a127
v_mul_f32 v112, v205, v112
v_mul_f32 v113, v205, v113
v_mul_f32 v114, v205, v114
v_mul_f32 v115, v205, v115
v_accvgpr_write_b32 a124, v112
v_accvgpr_write_b32 a125, v113
v_accvgpr_write_b32 a126, v114
v_accvgpr_write_b32 a127, v115
v_exp_f32 v112, v16
v_exp_f32 v113, v17
v_exp_f32 v114, v18
v_exp_f32 v115, v19
v_add_f32 v196, v112, v113
v_cvt_pk_bf16_f32 v80, v112, v113
v_add_f32 v196, v196, v114
v_add_f32 v196, v196, v115
v_cvt_pk_bf16_f32 v81, v114, v115
v_exp_f32 v116, v20
v_exp_f32 v117, v21
v_exp_f32 v118, v22
v_exp_f32 v119, v23
v_add_f32 v197, v116, v117
v_cvt_pk_bf16_f32 v84, v116, v117
v_add_f32 v197, v197, v118
v_add_f32 v197, v197, v119
v_cvt_pk_bf16_f32 v85, v118, v119
v_exp_f32 v112, v24
v_exp_f32 v113, v25
v_exp_f32 v114, v26
v_exp_f32 v115, v27
v_add_f32 v196, v196, v112
v_add_f32 v196, v196, v113
v_cvt_pk_bf16_f32 v82, v112, v113
v_add_f32 v196, v196, v114
v_add_f32 v196, v196, v115
v_cvt_pk_bf16_f32 v83, v114, v115
v_exp_f32 v116, v28
v_exp_f32 v117, v29
v_exp_f32 v118, v30
v_exp_f32 v119, v31
v_add_f32 v197, v197, v116
v_add_f32 v197, v197, v117
v_cvt_pk_bf16_f32 v86, v116, v117
v_add_f32 v197, v197, v118
v_add_f32 v197, v197, v119
v_cvt_pk_bf16_f32 v87, v118, v119
v_exp_f32 v120, v32
v_exp_f32 v121, v33
v_exp_f32 v122, v34
v_exp_f32 v123, v35
v_add_f32 v198, v120, v121
v_cvt_pk_bf16_f32 v88, v120, v121
v_add_f32 v198, v198, v122
v_add_f32 v198, v198, v123
v_cvt_pk_bf16_f32 v89, v122, v123
v_exp_f32 v124, v36
v_exp_f32 v125, v37
v_exp_f32 v126, v38
v_exp_f32 v127, v39
v_add_f32 v199, v124, v125
v_cvt_pk_bf16_f32 v92, v124, v125
v_add_f32 v199, v199, v126
v_add_f32 v199, v199, v127
v_cvt_pk_bf16_f32 v93, v126, v127
v_exp_f32 v120, v40
v_exp_f32 v121, v41
v_exp_f32 v122, v42
v_exp_f32 v123, v43
v_add_f32 v198, v198, v120
v_add_f32 v198, v198, v121
v_cvt_pk_bf16_f32 v90, v120, v121
v_add_f32 v198, v198, v122
v_add_f32 v198, v198, v123
v_cvt_pk_bf16_f32 v91, v122, v123
v_exp_f32 v124, v44
v_exp_f32 v125, v45
v_exp_f32 v126, v46
v_exp_f32 v127, v47
v_add_f32 v199, v199, v124
v_add_f32 v199, v199, v125
v_cvt_pk_bf16_f32 v94, v124, v125
v_add_f32 v199, v199, v126
v_add_f32 v199, v199, v127
v_cvt_pk_bf16_f32 v95, v126, v127
v_add_f32 v196, v196, v198
v_add_f32 v197, v197, v199
s_nop 1
s_branch F_RARE_RET_0
F_RARE_1:
s_nop 15
v_max3_f32 v13, v48, v49, v50
v_max3_f32 v13, v13, v51, v56
v_max3_f32 v13, v13, v57, v58
v_max3_f32 v13, v13, v59, v64
v_max3_f32 v13, v13, v65, v66
v_max3_f32 v13, v13, v67, v72
v_max3_f32 v13, v13, v73, v74
v_max_f32 v13, v13, v75
v_mov_b32 v15, v13
s_nop 1
v_permlane32_swap_b32 v15, v13
s_nop 1
v_max_f32 v13, v13, v15
v_mov_b32 v15, v13
s_nop 1
v_permlane16_swap_b32 v15, v13
s_nop 1
v_max_f32 v13, v13, v15
v_max3_f32 v14, v52, v53, v54
v_max3_f32 v14, v14, v55, v60
v_max3_f32 v14, v14, v61, v62
v_max3_f32 v14, v14, v63, v68
v_max3_f32 v14, v14, v69, v70
v_max3_f32 v14, v14, v71, v76
v_max3_f32 v14, v14, v77, v78
v_max_f32 v14, v14, v79
v_mov_b32 v15, v14
s_nop 1
v_permlane32_swap_b32 v15, v14
s_nop 1
v_max_f32 v14, v14, v15
v_mov_b32 v15, v14
s_nop 1
v_permlane16_swap_b32 v15, v14
s_nop 1
v_max_f32 v14, v14, v15
v_max_f32 v13, 0, v13
v_sub_f32 v204, 0, v13
v_exp_f32 v204, v204
s_nop 0
v_mul_f32 v194, v194, v204
v_max_f32 v14, 0, v14
v_sub_f32 v205, 0, v14
v_exp_f32 v205, v205
s_nop 0
v_mul_f32 v195, v195, v205
v_add_f32 v192, v192, v13
v_sub_f32 v208, 0, v192
v_sub_f32 v209, 0, v192
v_sub_f32 v210, 0, v192
v_sub_f32 v211, 0, v192
v_add_f32 v193, v193, v14
v_sub_f32 v212, 0, v193
v_sub_f32 v213, 0, v193
v_sub_f32 v214, 0, v193
v_sub_f32 v215, 0, v193
v_sub_f32 v48, v48, v13
v_sub_f32 v49, v49, v13
v_sub_f32 v50, v50, v13
v_sub_f32 v51, v51, v13
v_sub_f32 v52, v52, v14
v_sub_f32 v53, v53, v14
v_sub_f32 v54, v54, v14
v_sub_f32 v55, v55, v14
v_sub_f32 v56, v56, v13
v_sub_f32 v57, v57, v13
v_sub_f32 v58, v58, v13
v_sub_f32 v59, v59, v13
v_sub_f32 v60, v60, v14
v_sub_f32 v61, v61, v14
v_sub_f32 v62, v62, v14
v_sub_f32 v63, v63, v14
v_sub_f32 v64, v64, v13
v_sub_f32 v65, v65, v13
v_sub_f32 v66, v66, v13
v_sub_f32 v67, v67, v13
v_sub_f32 v68, v68, v14
v_sub_f32 v69, v69, v14
v_sub_f32 v70, v70, v14
v_sub_f32 v71, v71, v14
v_sub_f32 v72, v72, v13
v_sub_f32 v73, v73, v13
v_sub_f32 v74, v74, v13
v_sub_f32 v75, v75, v13
v_sub_f32 v76, v76, v14
v_sub_f32 v77, v77, v14
v_sub_f32 v78, v78, v14
v_sub_f32 v79, v79, v14
v_sub_f32 v16, v16, v13
v_sub_f32 v17, v17, v13
v_sub_f32 v18, v18, v13
v_sub_f32 v19, v19, v13
v_sub_f32 v20, v20, v14
v_sub_f32 v21, v21, v14
v_sub_f32 v22, v22, v14
v_sub_f32 v23, v23, v14
v_sub_f32 v24, v24, v13
v_sub_f32 v25, v25, v13
v_sub_f32 v26, v26, v13
v_sub_f32 v27, v27, v13
v_sub_f32 v28, v28, v14
v_sub_f32 v29, v29, v14
v_sub_f32 v30, v30, v14
v_sub_f32 v31, v31, v14
v_sub_f32 v32, v32, v13
v_sub_f32 v33, v33, v13
v_sub_f32 v34, v34, v13
v_sub_f32 v35, v35, v13
v_sub_f32 v36, v36, v14
v_sub_f32 v37, v37, v14
v_sub_f32 v38, v38, v14
v_sub_f32 v39, v39, v14
v_sub_f32 v40, v40, v13
v_sub_f32 v41, v41, v13
v_sub_f32 v42, v42, v13
v_sub_f32 v43, v43, v13
v_sub_f32 v44, v44, v14
v_sub_f32 v45, v45, v14
v_sub_f32 v46, v46, v14
v_sub_f32 v47, v47, v14
v_accvgpr_read_b32 v112, a0
v_accvgpr_read_b32 v113, a1
v_accvgpr_read_b32 v114, a2
v_accvgpr_read_b32 v115, a3
v_mul_f32 v112, v204, v112
v_mul_f32 v113, v204, v113
v_mul_f32 v114, v204, v114
v_mul_f32 v115, v204, v115
v_accvgpr_write_b32 a0, v112
v_accvgpr_write_b32 a1, v113
v_accvgpr_write_b32 a2, v114
v_accvgpr_write_b32 a3, v115
v_accvgpr_read_b32 v112, a4
v_accvgpr_read_b32 v113, a5
v_accvgpr_read_b32 v114, a6
v_accvgpr_read_b32 v115, a7
v_mul_f32 v112, v205, v112
v_mul_f32 v113, v205, v113
v_mul_f32 v114, v205, v114
v_mul_f32 v115, v205, v115
v_accvgpr_write_b32 a4, v112
v_accvgpr_write_b32 a5, v113
v_accvgpr_write_b32 a6, v114
v_accvgpr_write_b32 a7, v115
v_accvgpr_read_b32 v112, a8
v_accvgpr_read_b32 v113, a9
v_accvgpr_read_b32 v114, a10
v_accvgpr_read_b32 v115, a11
v_mul_f32 v112, v204, v112
v_mul_f32 v113, v204, v113
v_mul_f32 v114, v204, v114
v_mul_f32 v115, v204, v115
v_accvgpr_write_b32 a8, v112
v_accvgpr_write_b32 a9, v113
v_accvgpr_write_b32 a10, v114
v_accvgpr_write_b32 a11, v115
v_accvgpr_read_b32 v112, a12
v_accvgpr_read_b32 v113, a13
v_accvgpr_read_b32 v114, a14
v_accvgpr_read_b32 v115, a15
v_mul_f32 v112, v205, v112
v_mul_f32 v113, v205, v113
v_mul_f32 v114, v205, v114
v_mul_f32 v115, v205, v115
v_accvgpr_write_b32 a12, v112
v_accvgpr_write_b32 a13, v113
v_accvgpr_write_b32 a14, v114
v_accvgpr_write_b32 a15, v115
v_accvgpr_read_b32 v112, a16
v_accvgpr_read_b32 v113, a17
v_accvgpr_read_b32 v114, a18
v_accvgpr_read_b32 v115, a19
v_mul_f32 v112, v204, v112
v_mul_f32 v113, v204, v113
v_mul_f32 v114, v204, v114
v_mul_f32 v115, v204, v115
v_accvgpr_write_b32 a16, v112
v_accvgpr_write_b32 a17, v113
v_accvgpr_write_b32 a18, v114
v_accvgpr_write_b32 a19, v115
v_accvgpr_read_b32 v112, a20
v_accvgpr_read_b32 v113, a21
v_accvgpr_read_b32 v114, a22
v_accvgpr_read_b32 v115, a23
v_mul_f32 v112, v205, v112
v_mul_f32 v113, v205, v113
v_mul_f32 v114, v205, v114
v_mul_f32 v115, v205, v115
v_accvgpr_write_b32 a20, v112
v_accvgpr_write_b32 a21, v113
v_accvgpr_write_b32 a22, v114
v_accvgpr_write_b32 a23, v115
v_accvgpr_read_b32 v112, a24
v_accvgpr_read_b32 v113, a25
v_accvgpr_read_b32 v114, a26
v_accvgpr_read_b32 v115, a27
v_mul_f32 v112, v204, v112
v_mul_f32 v113, v204, v113
v_mul_f32 v114, v204, v114
v_mul_f32 v115, v204, v115
v_accvgpr_write_b32 a24, v112
v_accvgpr_write_b32 a25, v113
v_accvgpr_write_b32 a26, v114
v_accvgpr_write_b32 a27, v115
v_accvgpr_read_b32 v112, a28
v_accvgpr_read_b32 v113, a29
v_accvgpr_read_b32 v114, a30
v_accvgpr_read_b32 v115, a31
v_mul_f32 v112, v205, v112
v_mul_f32 v113, v205, v113
v_mul_f32 v114, v205, v114
v_mul_f32 v115, v205, v115
v_accvgpr_write_b32 a28, v112
v_accvgpr_write_b32 a29, v113
v_accvgpr_write_b32 a30, v114
v_accvgpr_write_b32 a31, v115
v_accvgpr_read_b32 v112, a32
v_accvgpr_read_b32 v113, a33
v_accvgpr_read_b32 v114, a34
v_accvgpr_read_b32 v115, a35
v_mul_f32 v112, v204, v112
v_mul_f32 v113, v204, v113
v_mul_f32 v114, v204, v114
v_mul_f32 v115, v204, v115
v_accvgpr_write_b32 a32, v112
v_accvgpr_write_b32 a33, v113
v_accvgpr_write_b32 a34, v114
v_accvgpr_write_b32 a35, v115
v_accvgpr_read_b32 v112, a36
v_accvgpr_read_b32 v113, a37
v_accvgpr_read_b32 v114, a38
v_accvgpr_read_b32 v115, a39
v_mul_f32 v112, v205, v112
v_mul_f32 v113, v205, v113
v_mul_f32 v114, v205, v114
v_mul_f32 v115, v205, v115
v_accvgpr_write_b32 a36, v112
v_accvgpr_write_b32 a37, v113
v_accvgpr_write_b32 a38, v114
v_accvgpr_write_b32 a39, v115
v_accvgpr_read_b32 v112, a40
v_accvgpr_read_b32 v113, a41
v_accvgpr_read_b32 v114, a42
v_accvgpr_read_b32 v115, a43
v_mul_f32 v112, v204, v112
v_mul_f32 v113, v204, v113
v_mul_f32 v114, v204, v114
v_mul_f32 v115, v204, v115
v_accvgpr_write_b32 a40, v112
v_accvgpr_write_b32 a41, v113
v_accvgpr_write_b32 a42, v114
v_accvgpr_write_b32 a43, v115
v_accvgpr_read_b32 v112, a44
v_accvgpr_read_b32 v113, a45
v_accvgpr_read_b32 v114, a46
v_accvgpr_read_b32 v115, a47
v_mul_f32 v112, v205, v112
v_mul_f32 v113, v205, v113
v_mul_f32 v114, v205, v114
v_mul_f32 v115, v205, v115
v_accvgpr_write_b32 a44, v112
v_accvgpr_write_b32 a45, v113
v_accvgpr_write_b32 a46, v114
v_accvgpr_write_b32 a47, v115
v_accvgpr_read_b32 v112, a48
v_accvgpr_read_b32 v113, a49
v_accvgpr_read_b32 v114, a50
v_accvgpr_read_b32 v115, a51
v_mul_f32 v112, v204, v112
v_mul_f32 v113, v204, v113
v_mul_f32 v114, v204, v114
v_mul_f32 v115, v204, v115
v_accvgpr_write_b32 a48, v112
v_accvgpr_write_b32 a49, v113
v_accvgpr_write_b32 a50, v114
v_accvgpr_write_b32 a51, v115
v_accvgpr_read_b32 v112, a52
v_accvgpr_read_b32 v113, a53
v_accvgpr_read_b32 v114, a54
v_accvgpr_read_b32 v115, a55
v_mul_f32 v112, v205, v112
v_mul_f32 v113, v205, v113
v_mul_f32 v114, v205, v114
v_mul_f32 v115, v205, v115
v_accvgpr_write_b32 a52, v112
v_accvgpr_write_b32 a53, v113
v_accvgpr_write_b32 a54, v114
v_accvgpr_write_b32 a55, v115
v_accvgpr_read_b32 v112, a56
v_accvgpr_read_b32 v113, a57
v_accvgpr_read_b32 v114, a58
v_accvgpr_read_b32 v115, a59
v_mul_f32 v112, v204, v112
v_mul_f32 v113, v204, v113
v_mul_f32 v114, v204, v114
v_mul_f32 v115, v204, v115
v_accvgpr_write_b32 a56, v112
v_accvgpr_write_b32 a57, v113
v_accvgpr_write_b32 a58, v114
v_accvgpr_write_b32 a59, v115
v_accvgpr_read_b32 v112, a60
v_accvgpr_read_b32 v113, a61
v_accvgpr_read_b32 v114, a62
v_accvgpr_read_b32 v115, a63
v_mul_f32 v112, v205, v112
v_mul_f32 v113, v205, v113
v_mul_f32 v114, v205, v114
v_mul_f32 v115, v205, v115
v_accvgpr_write_b32 a60, v112
v_accvgpr_write_b32 a61, v113
v_accvgpr_write_b32 a62, v114
v_accvgpr_write_b32 a63, v115
v_accvgpr_read_b32 v112, a64
v_accvgpr_read_b32 v113, a65
v_accvgpr_read_b32 v114, a66
v_accvgpr_read_b32 v115, a67
v_mul_f32 v112, v204, v112
v_mul_f32 v113, v204, v113
v_mul_f32 v114, v204, v114
v_mul_f32 v115, v204, v115
v_accvgpr_write_b32 a64, v112
v_accvgpr_write_b32 a65, v113
v_accvgpr_write_b32 a66, v114
v_accvgpr_write_b32 a67, v115
v_accvgpr_read_b32 v112, a68
v_accvgpr_read_b32 v113, a69
v_accvgpr_read_b32 v114, a70
v_accvgpr_read_b32 v115, a71
v_mul_f32 v112, v205, v112
v_mul_f32 v113, v205, v113
v_mul_f32 v114, v205, v114
v_mul_f32 v115, v205, v115
v_accvgpr_write_b32 a68, v112
v_accvgpr_write_b32 a69, v113
v_accvgpr_write_b32 a70, v114
v_accvgpr_write_b32 a71, v115
v_accvgpr_read_b32 v112, a72
v_accvgpr_read_b32 v113, a73
v_accvgpr_read_b32 v114, a74
v_accvgpr_read_b32 v115, a75
v_mul_f32 v112, v204, v112
v_mul_f32 v113, v204, v113
v_mul_f32 v114, v204, v114
v_mul_f32 v115, v204, v115
v_accvgpr_write_b32 a72, v112
v_accvgpr_write_b32 a73, v113
v_accvgpr_write_b32 a74, v114
v_accvgpr_write_b32 a75, v115
v_accvgpr_read_b32 v112, a76
v_accvgpr_read_b32 v113, a77
v_accvgpr_read_b32 v114, a78
v_accvgpr_read_b32 v115, a79
v_mul_f32 v112, v205, v112
v_mul_f32 v113, v205, v113
v_mul_f32 v114, v205, v114
v_mul_f32 v115, v205, v115
v_accvgpr_write_b32 a76, v112
v_accvgpr_write_b32 a77, v113
v_accvgpr_write_b32 a78, v114
v_accvgpr_write_b32 a79, v115
v_accvgpr_read_b32 v112, a80
v_accvgpr_read_b32 v113, a81
v_accvgpr_read_b32 v114, a82
v_accvgpr_read_b32 v115, a83
v_mul_f32 v112, v204, v112
v_mul_f32 v113, v204, v113
v_mul_f32 v114, v204, v114
v_mul_f32 v115, v204, v115
v_accvgpr_write_b32 a80, v112
v_accvgpr_write_b32 a81, v113
v_accvgpr_write_b32 a82, v114
v_accvgpr_write_b32 a83, v115
v_accvgpr_read_b32 v112, a84
v_accvgpr_read_b32 v113, a85
v_accvgpr_read_b32 v114, a86
v_accvgpr_read_b32 v115, a87
v_mul_f32 v112, v205, v112
v_mul_f32 v113, v205, v113
v_mul_f32 v114, v205, v114
v_mul_f32 v115, v205, v115
v_accvgpr_write_b32 a84, v112
v_accvgpr_write_b32 a85, v113
v_accvgpr_write_b32 a86, v114
v_accvgpr_write_b32 a87, v115
v_accvgpr_read_b32 v112, a88
v_accvgpr_read_b32 v113, a89
v_accvgpr_read_b32 v114, a90
v_accvgpr_read_b32 v115, a91
v_mul_f32 v112, v204, v112
v_mul_f32 v113, v204, v113
v_mul_f32 v114, v204, v114
v_mul_f32 v115, v204, v115
v_accvgpr_write_b32 a88, v112
v_accvgpr_write_b32 a89, v113
v_accvgpr_write_b32 a90, v114
v_accvgpr_write_b32 a91, v115
v_accvgpr_read_b32 v112, a92
v_accvgpr_read_b32 v113, a93
v_accvgpr_read_b32 v114, a94
v_accvgpr_read_b32 v115, a95
v_mul_f32 v112, v205, v112
v_mul_f32 v113, v205, v113
v_mul_f32 v114, v205, v114
v_mul_f32 v115, v205, v115
v_accvgpr_write_b32 a92, v112
v_accvgpr_write_b32 a93, v113
v_accvgpr_write_b32 a94, v114
v_accvgpr_write_b32 a95, v115
v_accvgpr_read_b32 v112, a96
v_accvgpr_read_b32 v113, a97
v_accvgpr_read_b32 v114, a98
v_accvgpr_read_b32 v115, a99
v_mul_f32 v112, v204, v112
v_mul_f32 v113, v204, v113
v_mul_f32 v114, v204, v114
v_mul_f32 v115, v204, v115
v_accvgpr_write_b32 a96, v112
v_accvgpr_write_b32 a97, v113
v_accvgpr_write_b32 a98, v114
v_accvgpr_write_b32 a99, v115
v_accvgpr_read_b32 v112, a100
v_accvgpr_read_b32 v113, a101
v_accvgpr_read_b32 v114, a102
v_accvgpr_read_b32 v115, a103
v_mul_f32 v112, v205, v112
v_mul_f32 v113, v205, v113
v_mul_f32 v114, v205, v114
v_mul_f32 v115, v205, v115
v_accvgpr_write_b32 a100, v112
v_accvgpr_write_b32 a101, v113
v_accvgpr_write_b32 a102, v114
v_accvgpr_write_b32 a103, v115
v_accvgpr_read_b32 v112, a104
v_accvgpr_read_b32 v113, a105
v_accvgpr_read_b32 v114, a106
v_accvgpr_read_b32 v115, a107
v_mul_f32 v112, v204, v112
v_mul_f32 v113, v204, v113
v_mul_f32 v114, v204, v114
v_mul_f32 v115, v204, v115
v_accvgpr_write_b32 a104, v112
v_accvgpr_write_b32 a105, v113
v_accvgpr_write_b32 a106, v114
v_accvgpr_write_b32 a107, v115
v_accvgpr_read_b32 v112, a108
v_accvgpr_read_b32 v113, a109
v_accvgpr_read_b32 v114, a110
v_accvgpr_read_b32 v115, a111
v_mul_f32 v112, v205, v112
v_mul_f32 v113, v205, v113
v_mul_f32 v114, v205, v114
v_mul_f32 v115, v205, v115
v_accvgpr_write_b32 a108, v112
v_accvgpr_write_b32 a109, v113
v_accvgpr_write_b32 a110, v114
v_accvgpr_write_b32 a111, v115
v_accvgpr_read_b32 v112, a112
v_accvgpr_read_b32 v113, a113
v_accvgpr_read_b32 v114, a114
v_accvgpr_read_b32 v115, a115
v_mul_f32 v112, v204, v112
v_mul_f32 v113, v204, v113
v_mul_f32 v114, v204, v114
v_mul_f32 v115, v204, v115
v_accvgpr_write_b32 a112, v112
v_accvgpr_write_b32 a113, v113
v_accvgpr_write_b32 a114, v114
v_accvgpr_write_b32 a115, v115
v_accvgpr_read_b32 v112, a116
v_accvgpr_read_b32 v113, a117
v_accvgpr_read_b32 v114, a118
v_accvgpr_read_b32 v115, a119
v_mul_f32 v112, v205, v112
v_mul_f32 v113, v205, v113
v_mul_f32 v114, v205, v114
v_mul_f32 v115, v205, v115
v_accvgpr_write_b32 a116, v112
v_accvgpr_write_b32 a117, v113
v_accvgpr_write_b32 a118, v114
v_accvgpr_write_b32 a119, v115
v_accvgpr_read_b32 v112, a120
v_accvgpr_read_b32 v113, a121
v_accvgpr_read_b32 v114, a122
v_accvgpr_read_b32 v115, a123
v_mul_f32 v112, v204, v112
v_mul_f32 v113, v204, v113
v_mul_f32 v114, v204, v114
v_mul_f32 v115, v204, v115
v_accvgpr_write_b32 a120, v112
v_accvgpr_write_b32 a121, v113
v_accvgpr_write_b32 a122, v114
v_accvgpr_write_b32 a123, v115
v_accvgpr_read_b32 v112, a124
v_accvgpr_read_b32 v113, a125
v_accvgpr_read_b32 v114, a126
v_accvgpr_read_b32 v115, a127
v_mul_f32 v112, v205, v112
v_mul_f32 v113, v205, v113
v_mul_f32 v114, v205, v114
v_mul_f32 v115, v205, v115
v_accvgpr_write_b32 a124, v112
v_accvgpr_write_b32 a125, v113
v_accvgpr_write_b32 a126, v114
v_accvgpr_write_b32 a127, v115
v_exp_f32 v112, v48
v_exp_f32 v113, v49
v_exp_f32 v114, v50
v_exp_f32 v115, v51
v_add_f32 v196, v112, v113
v_cvt_pk_bf16_f32 v96, v112, v113
v_add_f32 v196, v196, v114
v_add_f32 v196, v196, v115
v_cvt_pk_bf16_f32 v97, v114, v115
v_exp_f32 v116, v52
v_exp_f32 v117, v53
v_exp_f32 v118, v54
v_exp_f32 v119, v55
v_add_f32 v197, v116, v117
v_cvt_pk_bf16_f32 v100, v116, v117
v_add_f32 v197, v197, v118
v_add_f32 v197, v197, v119
v_cvt_pk_bf16_f32 v101, v118, v119
v_exp_f32 v112, v56
v_exp_f32 v113, v57
v_exp_f32 v114, v58
v_exp_f32 v115, v59
v_add_f32 v196, v196, v112
v_add_f32 v196, v196, v113
v_cvt_pk_bf16_f32 v98, v112, v113
v_add_f32 v196, v196, v114
v_add_f32 v196, v196, v115
v_cvt_pk_bf16_f32 v99, v114, v115
v_exp_f32 v116, v60
v_exp_f32 v117, v61
v_exp_f32 v118, v62
v_exp_f32 v119, v63
v_add_f32 v197, v197, v116
v_add_f32 v197, v197, v117
v_cvt_pk_bf16_f32 v102, v116, v117
v_add_f32 v197, v197, v118
v_add_f32 v197, v197, v119
v_cvt_pk_bf16_f32 v103, v118, v119
v_exp_f32 v120, v64
v_exp_f32 v121, v65
v_exp_f32 v122, v66
v_exp_f32 v123, v67
v_add_f32 v198, v120, v121
v_cvt_pk_bf16_f32 v104, v120, v121
v_add_f32 v198, v198, v122
v_add_f32 v198, v198, v123
v_cvt_pk_bf16_f32 v105, v122, v123
v_exp_f32 v124, v68
v_exp_f32 v125, v69
v_exp_f32 v126, v70
v_exp_f32 v127, v71
v_add_f32 v199, v124, v125
v_cvt_pk_bf16_f32 v108, v124, v125
v_add_f32 v199, v199, v126
v_add_f32 v199, v199, v127
v_cvt_pk_bf16_f32 v109, v126, v127
v_exp_f32 v120, v72
v_exp_f32 v121, v73
v_exp_f32 v122, v74
v_exp_f32 v123, v75
v_add_f32 v198, v198, v120
v_add_f32 v198, v198, v121
v_cvt_pk_bf16_f32 v106, v120, v121
v_add_f32 v198, v198, v122
v_add_f32 v198, v198, v123
v_cvt_pk_bf16_f32 v107, v122, v123
v_exp_f32 v124, v76
v_exp_f32 v125, v77
v_exp_f32 v126, v78
v_exp_f32 v127, v79
v_add_f32 v199, v199, v124
v_add_f32 v199, v199, v125
v_cvt_pk_bf16_f32 v110, v124, v125
v_add_f32 v199, v199, v126
v_add_f32 v199, v199, v127
v_cvt_pk_bf16_f32 v111, v126, v127
v_add_f32 v196, v196, v198
v_add_f32 v197, v197, v199
s_nop 1
s_branch F_RARE_RET_1
F_RARE_2:
s_nop 15
v_max3_f32 v13, v16, v17, v18
v_max3_f32 v13, v13, v19, v24
v_max3_f32 v13, v13, v25, v26
v_max3_f32 v13, v13, v27, v32
v_max3_f32 v13, v13, v33, v34
v_max3_f32 v13, v13, v35, v40
v_max3_f32 v13, v13, v41, v42
v_max_f32 v13, v13, v43
v_mov_b32 v15, v13
s_nop 1
v_permlane32_swap_b32 v15, v13
s_nop 1
v_max_f32 v13, v13, v15
v_mov_b32 v15, v13
s_nop 1
v_permlane16_swap_b32 v15, v13
s_nop 1
v_max_f32 v13, v13, v15
v_max3_f32 v14, v20, v21, v22
v_max3_f32 v14, v14, v23, v28
v_max3_f32 v14, v14, v29, v30
v_max3_f32 v14, v14, v31, v36
v_max3_f32 v14, v14, v37, v38
v_max3_f32 v14, v14, v39, v44
v_max3_f32 v14, v14, v45, v46
v_max_f32 v14, v14, v47
v_mov_b32 v15, v14
s_nop 1
v_permlane32_swap_b32 v15, v14
s_nop 1
v_max_f32 v14, v14, v15
v_mov_b32 v15, v14
s_nop 1
v_permlane16_swap_b32 v15, v14
s_nop 1
v_max_f32 v14, v14, v15
v_max_f32 v13, 0, v13
v_sub_f32 v204, 0, v13
v_exp_f32 v204, v204
s_nop 0
v_mul_f32 v194, v194, v204
v_max_f32 v14, 0, v14
v_sub_f32 v205, 0, v14
v_exp_f32 v205, v205
s_nop 0
v_mul_f32 v195, v195, v205
v_add_f32 v192, v192, v13
v_sub_f32 v208, 0, v192
v_sub_f32 v209, 0, v192
v_sub_f32 v210, 0, v192
v_sub_f32 v211, 0, v192
v_add_f32 v193, v193, v14
v_sub_f32 v212, 0, v193
v_sub_f32 v213, 0, v193
v_sub_f32 v214, 0, v193
v_sub_f32 v215, 0, v193
v_sub_f32 v16, v16, v13
v_sub_f32 v17, v17, v13
v_sub_f32 v18, v18, v13
v_sub_f32 v19, v19, v13
v_sub_f32 v20, v20, v14
v_sub_f32 v21, v21, v14
v_sub_f32 v22, v22, v14
v_sub_f32 v23, v23, v14
v_sub_f32 v24, v24, v13
v_sub_f32 v25, v25, v13
v_sub_f32 v26, v26, v13
v_sub_f32 v27, v27, v13
v_sub_f32 v28, v28, v14
v_sub_f32 v29, v29, v14
v_sub_f32 v30, v30, v14
v_sub_f32 v31, v31, v14
v_sub_f32 v32, v32, v13
v_sub_f32 v33, v33, v13
v_sub_f32 v34, v34, v13
v_sub_f32 v35, v35, v13
v_sub_f32 v36, v36, v14
v_sub_f32 v37, v37, v14
v_sub_f32 v38, v38, v14
v_sub_f32 v39, v39, v14
v_sub_f32 v40, v40, v13
v_sub_f32 v41, v41, v13
v_sub_f32 v42, v42, v13
v_sub_f32 v43, v43, v13
v_sub_f32 v44, v44, v14
v_sub_f32 v45, v45, v14
v_sub_f32 v46, v46, v14
v_sub_f32 v47, v47, v14
v_accvgpr_read_b32 v112, a0
v_accvgpr_read_b32 v113, a1
v_accvgpr_read_b32 v114, a2
v_accvgpr_read_b32 v115, a3
v_mul_f32 v112, v204, v112
v_mul_f32 v113, v204, v113
v_mul_f32 v114, v204, v114
v_mul_f32 v115, v204, v115
v_accvgpr_write_b32 a0, v112
v_accvgpr_write_b32 a1, v113
v_accvgpr_write_b32 a2, v114
v_accvgpr_write_b32 a3, v115
v_accvgpr_read_b32 v112, a4
v_accvgpr_read_b32 v113, a5
v_accvgpr_read_b32 v114, a6
v_accvgpr_read_b32 v115, a7
v_mul_f32 v112, v205, v112
v_mul_f32 v113, v205, v113
v_mul_f32 v114, v205, v114
v_mul_f32 v115, v205, v115
v_accvgpr_write_b32 a4, v112
v_accvgpr_write_b32 a5, v113
v_accvgpr_write_b32 a6, v114
v_accvgpr_write_b32 a7, v115
v_accvgpr_read_b32 v112, a8
v_accvgpr_read_b32 v113, a9
v_accvgpr_read_b32 v114, a10
v_accvgpr_read_b32 v115, a11
v_mul_f32 v112, v204, v112
v_mul_f32 v113, v204, v113
v_mul_f32 v114, v204, v114
v_mul_f32 v115, v204, v115
v_accvgpr_write_b32 a8, v112
v_accvgpr_write_b32 a9, v113
v_accvgpr_write_b32 a10, v114
v_accvgpr_write_b32 a11, v115
v_accvgpr_read_b32 v112, a12
v_accvgpr_read_b32 v113, a13
v_accvgpr_read_b32 v114, a14
v_accvgpr_read_b32 v115, a15
v_mul_f32 v112, v205, v112
v_mul_f32 v113, v205, v113
v_mul_f32 v114, v205, v114
v_mul_f32 v115, v205, v115
v_accvgpr_write_b32 a12, v112
v_accvgpr_write_b32 a13, v113
v_accvgpr_write_b32 a14, v114
v_accvgpr_write_b32 a15, v115
v_accvgpr_read_b32 v112, a16
v_accvgpr_read_b32 v113, a17
v_accvgpr_read_b32 v114, a18
v_accvgpr_read_b32 v115, a19
v_mul_f32 v112, v204, v112
v_mul_f32 v113, v204, v113
v_mul_f32 v114, v204, v114
v_mul_f32 v115, v204, v115
v_accvgpr_write_b32 a16, v112
v_accvgpr_write_b32 a17, v113
v_accvgpr_write_b32 a18, v114
v_accvgpr_write_b32 a19, v115
v_accvgpr_read_b32 v112, a20
v_accvgpr_read_b32 v113, a21
v_accvgpr_read_b32 v114, a22
v_accvgpr_read_b32 v115, a23
v_mul_f32 v112, v205, v112
v_mul_f32 v113, v205, v113
v_mul_f32 v114, v205, v114
v_mul_f32 v115, v205, v115
v_accvgpr_write_b32 a20, v112
v_accvgpr_write_b32 a21, v113
v_accvgpr_write_b32 a22, v114
v_accvgpr_write_b32 a23, v115
v_accvgpr_read_b32 v112, a24
v_accvgpr_read_b32 v113, a25
v_accvgpr_read_b32 v114, a26
v_accvgpr_read_b32 v115, a27
v_mul_f32 v112, v204, v112
v_mul_f32 v113, v204, v113
v_mul_f32 v114, v204, v114
v_mul_f32 v115, v204, v115
v_accvgpr_write_b32 a24, v112
v_accvgpr_write_b32 a25, v113
v_accvgpr_write_b32 a26, v114
v_accvgpr_write_b32 a27, v115
v_accvgpr_read_b32 v112, a28
v_accvgpr_read_b32 v113, a29
v_accvgpr_read_b32 v114, a30
v_accvgpr_read_b32 v115, a31
v_mul_f32 v112, v205, v112
v_mul_f32 v113, v205, v113
v_mul_f32 v114, v205, v114
v_mul_f32 v115, v205, v115
v_accvgpr_write_b32 a28, v112
v_accvgpr_write_b32 a29, v113
v_accvgpr_write_b32 a30, v114
v_accvgpr_write_b32 a31, v115
v_accvgpr_read_b32 v112, a32
v_accvgpr_read_b32 v113, a33
v_accvgpr_read_b32 v114, a34
v_accvgpr_read_b32 v115, a35
v_mul_f32 v112, v204, v112
v_mul_f32 v113, v204, v113
v_mul_f32 v114, v204, v114
v_mul_f32 v115, v204, v115
v_accvgpr_write_b32 a32, v112
v_accvgpr_write_b32 a33, v113
v_accvgpr_write_b32 a34, v114
v_accvgpr_write_b32 a35, v115
v_accvgpr_read_b32 v112, a36
v_accvgpr_read_b32 v113, a37
v_accvgpr_read_b32 v114, a38
v_accvgpr_read_b32 v115, a39
v_mul_f32 v112, v205, v112
v_mul_f32 v113, v205, v113
v_mul_f32 v114, v205, v114
v_mul_f32 v115, v205, v115
v_accvgpr_write_b32 a36, v112
v_accvgpr_write_b32 a37, v113
v_accvgpr_write_b32 a38, v114
v_accvgpr_write_b32 a39, v115
v_accvgpr_read_b32 v112, a40
v_accvgpr_read_b32 v113, a41
v_accvgpr_read_b32 v114, a42
v_accvgpr_read_b32 v115, a43
v_mul_f32 v112, v204, v112
v_mul_f32 v113, v204, v113
v_mul_f32 v114, v204, v114
v_mul_f32 v115, v204, v115
v_accvgpr_write_b32 a40, v112
v_accvgpr_write_b32 a41, v113
v_accvgpr_write_b32 a42, v114
v_accvgpr_write_b32 a43, v115
v_accvgpr_read_b32 v112, a44
v_accvgpr_read_b32 v113, a45
v_accvgpr_read_b32 v114, a46
v_accvgpr_read_b32 v115, a47
v_mul_f32 v112, v205, v112
v_mul_f32 v113, v205, v113
v_mul_f32 v114, v205, v114
v_mul_f32 v115, v205, v115
v_accvgpr_write_b32 a44, v112
v_accvgpr_write_b32 a45, v113
v_accvgpr_write_b32 a46, v114
v_accvgpr_write_b32 a47, v115
v_accvgpr_read_b32 v112, a48
v_accvgpr_read_b32 v113, a49
v_accvgpr_read_b32 v114, a50
v_accvgpr_read_b32 v115, a51
v_mul_f32 v112, v204, v112
v_mul_f32 v113, v204, v113
v_mul_f32 v114, v204, v114
v_mul_f32 v115, v204, v115
v_accvgpr_write_b32 a48, v112
v_accvgpr_write_b32 a49, v113
v_accvgpr_write_b32 a50, v114
v_accvgpr_write_b32 a51, v115
v_accvgpr_read_b32 v112, a52
v_accvgpr_read_b32 v113, a53
v_accvgpr_read_b32 v114, a54
v_accvgpr_read_b32 v115, a55
v_mul_f32 v112, v205, v112
v_mul_f32 v113, v205, v113
v_mul_f32 v114, v205, v114
v_mul_f32 v115, v205, v115
v_accvgpr_write_b32 a52, v112
v_accvgpr_write_b32 a53, v113
v_accvgpr_write_b32 a54, v114
v_accvgpr_write_b32 a55, v115
v_accvgpr_read_b32 v112, a56
v_accvgpr_read_b32 v113, a57
v_accvgpr_read_b32 v114, a58
v_accvgpr_read_b32 v115, a59
v_mul_f32 v112, v204, v112
v_mul_f32 v113, v204, v113
v_mul_f32 v114, v204, v114
v_mul_f32 v115, v204, v115
v_accvgpr_write_b32 a56, v112
v_accvgpr_write_b32 a57, v113
v_accvgpr_write_b32 a58, v114
v_accvgpr_write_b32 a59, v115
v_accvgpr_read_b32 v112, a60
v_accvgpr_read_b32 v113, a61
v_accvgpr_read_b32 v114, a62
v_accvgpr_read_b32 v115, a63
v_mul_f32 v112, v205, v112
v_mul_f32 v113, v205, v113
v_mul_f32 v114, v205, v114
v_mul_f32 v115, v205, v115
v_accvgpr_write_b32 a60, v112
v_accvgpr_write_b32 a61, v113
v_accvgpr_write_b32 a62, v114
v_accvgpr_write_b32 a63, v115
v_accvgpr_read_b32 v112, a64
v_accvgpr_read_b32 v113, a65
v_accvgpr_read_b32 v114, a66
v_accvgpr_read_b32 v115, a67
v_mul_f32 v112, v204, v112
v_mul_f32 v113, v204, v113
v_mul_f32 v114, v204, v114
v_mul_f32 v115, v204, v115
v_accvgpr_write_b32 a64, v112
v_accvgpr_write_b32 a65, v113
v_accvgpr_write_b32 a66, v114
v_accvgpr_write_b32 a67, v115
v_accvgpr_read_b32 v112, a68
v_accvgpr_read_b32 v113, a69
v_accvgpr_read_b32 v114, a70
v_accvgpr_read_b32 v115, a71
v_mul_f32 v112, v205, v112
v_mul_f32 v113, v205, v113
v_mul_f32 v114, v205, v114
v_mul_f32 v115, v205, v115
v_accvgpr_write_b32 a68, v112
v_accvgpr_write_b32 a69, v113
v_accvgpr_write_b32 a70, v114
v_accvgpr_write_b32 a71, v115
v_accvgpr_read_b32 v112, a72
v_accvgpr_read_b32 v113, a73
v_accvgpr_read_b32 v114, a74
v_accvgpr_read_b32 v115, a75
v_mul_f32 v112, v204, v112
v_mul_f32 v113, v204, v113
v_mul_f32 v114, v204, v114
v_mul_f32 v115, v204, v115
v_accvgpr_write_b32 a72, v112
v_accvgpr_write_b32 a73, v113
v_accvgpr_write_b32 a74, v114
v_accvgpr_write_b32 a75, v115
v_accvgpr_read_b32 v112, a76
v_accvgpr_read_b32 v113, a77
v_accvgpr_read_b32 v114, a78
v_accvgpr_read_b32 v115, a79
v_mul_f32 v112, v205, v112
v_mul_f32 v113, v205, v113
v_mul_f32 v114, v205, v114
v_mul_f32 v115, v205, v115
v_accvgpr_write_b32 a76, v112
v_accvgpr_write_b32 a77, v113
v_accvgpr_write_b32 a78, v114
v_accvgpr_write_b32 a79, v115
v_accvgpr_read_b32 v112, a80
v_accvgpr_read_b32 v113, a81
v_accvgpr_read_b32 v114, a82
v_accvgpr_read_b32 v115, a83
v_mul_f32 v112, v204, v112
v_mul_f32 v113, v204, v113
v_mul_f32 v114, v204, v114
v_mul_f32 v115, v204, v115
v_accvgpr_write_b32 a80, v112
v_accvgpr_write_b32 a81, v113
v_accvgpr_write_b32 a82, v114
v_accvgpr_write_b32 a83, v115
v_accvgpr_read_b32 v112, a84
v_accvgpr_read_b32 v113, a85
v_accvgpr_read_b32 v114, a86
v_accvgpr_read_b32 v115, a87
v_mul_f32 v112, v205, v112
v_mul_f32 v113, v205, v113
v_mul_f32 v114, v205, v114
v_mul_f32 v115, v205, v115
v_accvgpr_write_b32 a84, v112
v_accvgpr_write_b32 a85, v113
v_accvgpr_write_b32 a86, v114
v_accvgpr_write_b32 a87, v115
v_accvgpr_read_b32 v112, a88
v_accvgpr_read_b32 v113, a89
v_accvgpr_read_b32 v114, a90
v_accvgpr_read_b32 v115, a91
v_mul_f32 v112, v204, v112
v_mul_f32 v113, v204, v113
v_mul_f32 v114, v204, v114
v_mul_f32 v115, v204, v115
v_accvgpr_write_b32 a88, v112
v_accvgpr_write_b32 a89, v113
v_accvgpr_write_b32 a90, v114
v_accvgpr_write_b32 a91, v115
v_accvgpr_read_b32 v112, a92
v_accvgpr_read_b32 v113, a93
v_accvgpr_read_b32 v114, a94
v_accvgpr_read_b32 v115, a95
v_mul_f32 v112, v205, v112
v_mul_f32 v113, v205, v113
v_mul_f32 v114, v205, v114
v_mul_f32 v115, v205, v115
v_accvgpr_write_b32 a92, v112
v_accvgpr_write_b32 a93, v113
v_accvgpr_write_b32 a94, v114
v_accvgpr_write_b32 a95, v115
v_accvgpr_read_b32 v112, a96
v_accvgpr_read_b32 v113, a97
v_accvgpr_read_b32 v114, a98
v_accvgpr_read_b32 v115, a99
v_mul_f32 v112, v204, v112
v_mul_f32 v113, v204, v113
v_mul_f32 v114, v204, v114
v_mul_f32 v115, v204, v115
v_accvgpr_write_b32 a96, v112
v_accvgpr_write_b32 a97, v113
v_accvgpr_write_b32 a98, v114
v_accvgpr_write_b32 a99, v115
v_accvgpr_read_b32 v112, a100
v_accvgpr_read_b32 v113, a101
v_accvgpr_read_b32 v114, a102
v_accvgpr_read_b32 v115, a103
v_mul_f32 v112, v205, v112
v_mul_f32 v113, v205, v113
v_mul_f32 v114, v205, v114
v_mul_f32 v115, v205, v115
v_accvgpr_write_b32 a100, v112
v_accvgpr_write_b32 a101, v113
v_accvgpr_write_b32 a102, v114
v_accvgpr_write_b32 a103, v115
v_accvgpr_read_b32 v112, a104
v_accvgpr_read_b32 v113, a105
v_accvgpr_read_b32 v114, a106
v_accvgpr_read_b32 v115, a107
v_mul_f32 v112, v204, v112
v_mul_f32 v113, v204, v113
v_mul_f32 v114, v204, v114
v_mul_f32 v115, v204, v115
v_accvgpr_write_b32 a104, v112
v_accvgpr_write_b32 a105, v113
v_accvgpr_write_b32 a106, v114
v_accvgpr_write_b32 a107, v115
v_accvgpr_read_b32 v112, a108
v_accvgpr_read_b32 v113, a109
v_accvgpr_read_b32 v114, a110
v_accvgpr_read_b32 v115, a111
v_mul_f32 v112, v205, v112
v_mul_f32 v113, v205, v113
v_mul_f32 v114, v205, v114
v_mul_f32 v115, v205, v115
v_accvgpr_write_b32 a108, v112
v_accvgpr_write_b32 a109, v113
v_accvgpr_write_b32 a110, v114
v_accvgpr_write_b32 a111, v115
v_accvgpr_read_b32 v112, a112
v_accvgpr_read_b32 v113, a113
v_accvgpr_read_b32 v114, a114
v_accvgpr_read_b32 v115, a115
v_mul_f32 v112, v204, v112
v_mul_f32 v113, v204, v113
v_mul_f32 v114, v204, v114
v_mul_f32 v115, v204, v115
v_accvgpr_write_b32 a112, v112
v_accvgpr_write_b32 a113, v113
v_accvgpr_write_b32 a114, v114
v_accvgpr_write_b32 a115, v115
v_accvgpr_read_b32 v112, a116
v_accvgpr_read_b32 v113, a117
v_accvgpr_read_b32 v114, a118
v_accvgpr_read_b32 v115, a119
v_mul_f32 v112, v205, v112
v_mul_f32 v113, v205, v113
v_mul_f32 v114, v205, v114
v_mul_f32 v115, v205, v115
v_accvgpr_write_b32 a116, v112
v_accvgpr_write_b32 a117, v113
v_accvgpr_write_b32 a118, v114
v_accvgpr_write_b32 a119, v115
v_accvgpr_read_b32 v112, a120
v_accvgpr_read_b32 v113, a121
v_accvgpr_read_b32 v114, a122
v_accvgpr_read_b32 v115, a123
v_mul_f32 v112, v204, v112
v_mul_f32 v113, v204, v113
v_mul_f32 v114, v204, v114
v_mul_f32 v115, v204, v115
v_accvgpr_write_b32 a120, v112
v_accvgpr_write_b32 a121, v113
v_accvgpr_write_b32 a122, v114
v_accvgpr_write_b32 a123, v115
v_accvgpr_read_b32 v112, a124
v_accvgpr_read_b32 v113, a125
v_accvgpr_read_b32 v114, a126
v_accvgpr_read_b32 v115, a127
v_mul_f32 v112, v205, v112
v_mul_f32 v113, v205, v113
v_mul_f32 v114, v205, v114
v_mul_f32 v115, v205, v115
v_accvgpr_write_b32 a124, v112
v_accvgpr_write_b32 a125, v113
v_accvgpr_write_b32 a126, v114
v_accvgpr_write_b32 a127, v115
v_exp_f32 v112, v16
v_exp_f32 v113, v17
v_exp_f32 v114, v18
v_exp_f32 v115, v19
v_add_f32 v196, v112, v113
v_cvt_pk_bf16_f32 v80, v112, v113
v_add_f32 v196, v196, v114
v_add_f32 v196, v196, v115
v_cvt_pk_bf16_f32 v81, v114, v115
v_exp_f32 v116, v20
v_exp_f32 v117, v21
v_exp_f32 v118, v22
v_exp_f32 v119, v23
v_add_f32 v197, v116, v117
v_cvt_pk_bf16_f32 v84, v116, v117
v_add_f32 v197, v197, v118
v_add_f32 v197, v197, v119
v_cvt_pk_bf16_f32 v85, v118, v119
v_exp_f32 v112, v24
v_exp_f32 v113, v25
v_exp_f32 v114, v26
v_exp_f32 v115, v27
v_add_f32 v196, v196, v112
v_add_f32 v196, v196, v113
v_cvt_pk_bf16_f32 v82, v112, v113
v_add_f32 v196, v196, v114
v_add_f32 v196, v196, v115
v_cvt_pk_bf16_f32 v83, v114, v115
v_exp_f32 v116, v28
v_exp_f32 v117, v29
v_exp_f32 v118, v30
v_exp_f32 v119, v31
v_add_f32 v197, v197, v116
v_add_f32 v197, v197, v117
v_cvt_pk_bf16_f32 v86, v116, v117
v_add_f32 v197, v197, v118
v_add_f32 v197, v197, v119
v_cvt_pk_bf16_f32 v87, v118, v119
v_exp_f32 v120, v32
v_exp_f32 v121, v33
v_exp_f32 v122, v34
v_exp_f32 v123, v35
v_add_f32 v198, v120, v121
v_cvt_pk_bf16_f32 v88, v120, v121
v_add_f32 v198, v198, v122
v_add_f32 v198, v198, v123
v_cvt_pk_bf16_f32 v89, v122, v123
v_exp_f32 v124, v36
v_exp_f32 v125, v37
v_exp_f32 v126, v38
v_exp_f32 v127, v39
v_add_f32 v199, v124, v125
v_cvt_pk_bf16_f32 v92, v124, v125
v_add_f32 v199, v199, v126
v_add_f32 v199, v199, v127
v_cvt_pk_bf16_f32 v93, v126, v127
v_exp_f32 v120, v40
v_exp_f32 v121, v41
v_exp_f32 v122, v42
v_exp_f32 v123, v43
v_add_f32 v198, v198, v120
v_add_f32 v198, v198, v121
v_cvt_pk_bf16_f32 v90, v120, v121
v_add_f32 v198, v198, v122
v_add_f32 v198, v198, v123
v_cvt_pk_bf16_f32 v91, v122, v123
v_exp_f32 v124, v44
v_exp_f32 v125, v45
v_exp_f32 v126, v46
v_exp_f32 v127, v47
v_add_f32 v199, v199, v124
v_add_f32 v199, v199, v125
v_cvt_pk_bf16_f32 v94, v124, v125
v_add_f32 v199, v199, v126
v_add_f32 v199, v199, v127
v_cvt_pk_bf16_f32 v95, v126, v127
v_add_f32 v196, v196, v198
v_add_f32 v197, v197, v199
s_nop 1
s_branch F_RARE_RET_2
F_RARE_3:
s_nop 15
v_max3_f32 v13, v48, v49, v50
v_max3_f32 v13, v13, v51, v56
v_max3_f32 v13, v13, v57, v58
v_max3_f32 v13, v13, v59, v64
v_max3_f32 v13, v13, v65, v66
v_max3_f32 v13, v13, v67, v72
v_max3_f32 v13, v13, v73, v74
v_max_f32 v13, v13, v75
v_mov_b32 v15, v13
s_nop 1
v_permlane32_swap_b32 v15, v13
s_nop 1
v_max_f32 v13, v13, v15
v_mov_b32 v15, v13
s_nop 1
v_permlane16_swap_b32 v15, v13
s_nop 1
v_max_f32 v13, v13, v15
v_max3_f32 v14, v52, v53, v54
v_max3_f32 v14, v14, v55, v60
v_max3_f32 v14, v14, v61, v62
v_max3_f32 v14, v14, v63, v68
v_max3_f32 v14, v14, v69, v70
v_max3_f32 v14, v14, v71, v76
v_max3_f32 v14, v14, v77, v78
v_max_f32 v14, v14, v79
v_mov_b32 v15, v14
s_nop 1
v_permlane32_swap_b32 v15, v14
s_nop 1
v_max_f32 v14, v14, v15
v_mov_b32 v15, v14
s_nop 1
v_permlane16_swap_b32 v15, v14
s_nop 1
v_max_f32 v14, v14, v15
v_max_f32 v13, 0, v13
v_sub_f32 v204, 0, v13
v_exp_f32 v204, v204
s_nop 0
v_mul_f32 v194, v194, v204
v_max_f32 v14, 0, v14
v_sub_f32 v205, 0, v14
v_exp_f32 v205, v205
s_nop 0
v_mul_f32 v195, v195, v205
v_add_f32 v192, v192, v13
v_sub_f32 v208, 0, v192
v_sub_f32 v209, 0, v192
v_sub_f32 v210, 0, v192
v_sub_f32 v211, 0, v192
v_add_f32 v193, v193, v14
v_sub_f32 v212, 0, v193
v_sub_f32 v213, 0, v193
v_sub_f32 v214, 0, v193
v_sub_f32 v215, 0, v193
v_sub_f32 v48, v48, v13
v_sub_f32 v49, v49, v13
v_sub_f32 v50, v50, v13
v_sub_f32 v51, v51, v13
v_sub_f32 v52, v52, v14
v_sub_f32 v53, v53, v14
v_sub_f32 v54, v54, v14
v_sub_f32 v55, v55, v14
v_sub_f32 v56, v56, v13
v_sub_f32 v57, v57, v13
v_sub_f32 v58, v58, v13
v_sub_f32 v59, v59, v13
v_sub_f32 v60, v60, v14
v_sub_f32 v61, v61, v14
v_sub_f32 v62, v62, v14
v_sub_f32 v63, v63, v14
v_sub_f32 v64, v64, v13
v_sub_f32 v65, v65, v13
v_sub_f32 v66, v66, v13
v_sub_f32 v67, v67, v13
v_sub_f32 v68, v68, v14
v_sub_f32 v69, v69, v14
v_sub_f32 v70, v70, v14
v_sub_f32 v71, v71, v14
v_sub_f32 v72, v72, v13
v_sub_f32 v73, v73, v13
v_sub_f32 v74, v74, v13
v_sub_f32 v75, v75, v13
v_sub_f32 v76, v76, v14
v_sub_f32 v77, v77, v14
v_sub_f32 v78, v78, v14
v_sub_f32 v79, v79, v14
v_sub_f32 v16, v16, v13
v_sub_f32 v17, v17, v13
v_sub_f32 v18, v18, v13
v_sub_f32 v19, v19, v13
v_sub_f32 v20, v20, v14
v_sub_f32 v21, v21, v14
v_sub_f32 v22, v22, v14
v_sub_f32 v23, v23, v14
v_sub_f32 v24, v24, v13
v_sub_f32 v25, v25, v13
v_sub_f32 v26, v26, v13
v_sub_f32 v27, v27, v13
v_sub_f32 v28, v28, v14
v_sub_f32 v29, v29, v14
v_sub_f32 v30, v30, v14
v_sub_f32 v31, v31, v14
v_sub_f32 v32, v32, v13
v_sub_f32 v33, v33, v13
v_sub_f32 v34, v34, v13
v_sub_f32 v35, v35, v13
v_sub_f32 v36, v36, v14
v_sub_f32 v37, v37, v14
v_sub_f32 v38, v38, v14
v_sub_f32 v39, v39, v14
v_sub_f32 v40, v40, v13
v_sub_f32 v41, v41, v13
v_sub_f32 v42, v42, v13
v_sub_f32 v43, v43, v13
v_sub_f32 v44, v44, v14
v_sub_f32 v45, v45, v14
v_sub_f32 v46, v46, v14
v_sub_f32 v47, v47, v14
v_exp_f32 v112, v48
v_exp_f32 v113, v49
v_exp_f32 v114, v50
v_exp_f32 v115, v51
v_add_f32 v196, v112, v113
v_cvt_pk_bf16_f32 v96, v112, v113
v_add_f32 v196, v196, v114
v_add_f32 v196, v196, v115
v_cvt_pk_bf16_f32 v97, v114, v115
v_exp_f32 v116, v52
v_exp_f32 v117, v53
v_exp_f32 v118, v54
v_exp_f32 v119, v55
v_add_f32 v197, v116, v117
v_cvt_pk_bf16_f32 v100, v116, v117
v_add_f32 v197, v197, v118
v_add_f32 v197, v197, v119
v_cvt_pk_bf16_f32 v101, v118, v119
v_exp_f32 v112, v56
v_exp_f32 v113, v57
v_exp_f32 v114, v58
v_exp_f32 v115, v59
v_add_f32 v196, v196, v112
v_add_f32 v196, v196, v113
v_cvt_pk_bf16_f32 v98, v112, v113
v_add_f32 v196, v196, v114
v_add_f32 v196, v196, v115
v_cvt_pk_bf16_f32 v99, v114, v115
v_exp_f32 v116, v60
v_exp_f32 v117, v61
v_exp_f32 v118, v62
v_exp_f32 v119, v63
v_add_f32 v197, v197, v116
v_add_f32 v197, v197, v117
v_cvt_pk_bf16_f32 v102, v116, v117
v_add_f32 v197, v197, v118
v_add_f32 v197, v197, v119
v_cvt_pk_bf16_f32 v103, v118, v119
v_exp_f32 v120, v64
v_exp_f32 v121, v65
v_exp_f32 v122, v66
v_exp_f32 v123, v67
v_add_f32 v198, v120, v121
v_cvt_pk_bf16_f32 v104, v120, v121
v_add_f32 v198, v198, v122
v_add_f32 v198, v198, v123
v_cvt_pk_bf16_f32 v105, v122, v123
v_exp_f32 v124, v68
v_exp_f32 v125, v69
v_exp_f32 v126, v70
v_exp_f32 v127, v71
v_add_f32 v199, v124, v125
v_cvt_pk_bf16_f32 v108, v124, v125
v_add_f32 v199, v199, v126
v_add_f32 v199, v199, v127
v_cvt_pk_bf16_f32 v109, v126, v127
v_exp_f32 v120, v72
v_exp_f32 v121, v73
v_exp_f32 v122, v74
v_exp_f32 v123, v75
v_add_f32 v198, v198, v120
v_add_f32 v198, v198, v121
v_cvt_pk_bf16_f32 v106, v120, v121
v_add_f32 v198, v198, v122
v_add_f32 v198, v198, v123
v_cvt_pk_bf16_f32 v107, v122, v123
v_exp_f32 v124, v76
v_exp_f32 v125, v77
v_exp_f32 v126, v78
v_exp_f32 v127, v79
v_add_f32 v199, v199, v124
v_add_f32 v199, v199, v125
v_cvt_pk_bf16_f32 v110, v124, v125
v_add_f32 v199, v199, v126
v_add_f32 v199, v199, v127
v_cvt_pk_bf16_f32 v111, v126, v127
v_add_f32 v196, v196, v198
v_add_f32 v197, v197, v199
s_nop 1
s_branch F_RARE_RET_3
F_MASK_0:
s_nop 15
v_add_f32 v112, 0xe2800000, v10
v_min_f32 v16, v16, v112
v_add_f32 v113, 0xe2820000, v10
v_min_f32 v17, v17, v113
v_add_f32 v114, 0xe2840000, v10
v_min_f32 v18, v18, v114
v_add_f32 v115, 0xe2860000, v10
v_min_f32 v19, v19, v115
v_add_f32 v112, 0xe2400000, v10
v_min_f32 v20, v20, v112
v_add_f32 v113, 0xe2440000, v10
v_min_f32 v21, v21, v113
v_add_f32 v114, 0xe2480000, v10
v_min_f32 v22, v22, v114
v_add_f32 v115, 0xe24c0000, v10
v_min_f32 v23, v23, v115
v_add_f32 v112, 0xe2a00000, v10
v_min_f32 v24, v24, v112
v_add_f32 v113, 0xe2a20000, v10
v_min_f32 v25, v25, v113
v_add_f32 v114, 0xe2a40000, v10
v_min_f32 v26, v26, v114
v_add_f32 v115, 0xe2a60000, v10
v_min_f32 v27, v27, v115
v_add_f32 v112, 0xe2800000, v10
v_min_f32 v28, v28, v112
v_add_f32 v113, 0xe2820000, v10
v_min_f32 v29, v29, v113
v_add_f32 v114, 0xe2840000, v10
v_min_f32 v30, v30, v114
v_add_f32 v115, 0xe2860000, v10
v_min_f32 v31, v31, v115
v_add_f32 v112, 0xe2c00000, v10
v_min_f32 v32, v32, v112
v_add_f32 v113, 0xe2c20000, v10
v_min_f32 v33, v33, v113
v_add_f32 v114, 0xe2c40000, v10
v_min_f32 v34, v34, v114
v_add_f32 v115, 0xe2c60000, v10
v_min_f32 v35, v35, v115
v_add_f32 v112, 0xe2a00000, v10
v_min_f32 v36, v36, v112
v_add_f32 v113, 0xe2a20000, v10
v_min_f32 v37, v37, v113
v_add_f32 v114, 0xe2a40000, v10
v_min_f32 v38, v38, v114
v_add_f32 v115, 0xe2a60000, v10
v_min_f32 v39, v39, v115
v_add_f32 v112, 0xe2e00000, v10
v_min_f32 v40, v40, v112
v_add_f32 v113, 0xe2e20000, v10
v_min_f32 v41, v41, v113
v_add_f32 v114, 0xe2e40000, v10
v_min_f32 v42, v42, v114
v_add_f32 v115, 0xe2e60000, v10
v_min_f32 v43, v43, v115
v_add_f32 v112, 0xe2c00000, v10
v_min_f32 v44, v44, v112
v_add_f32 v113, 0xe2c20000, v10
v_min_f32 v45, v45, v113
v_add_f32 v114, 0xe2c40000, v10
v_min_f32 v46, v46, v114
v_add_f32 v115, 0xe2c60000, v10
v_min_f32 v47, v47, v115
s_branch F_MASK_RET_0
F_MASK_2:
s_nop 15
v_add_f32 v112, 0xe2800000, v10
v_min_f32 v16, v16, v112
v_add_f32 v113, 0xe2820000, v10
v_min_f32 v17, v17, v113
v_add_f32 v114, 0xe2840000, v10
v_min_f32 v18, v18, v114
v_add_f32 v115, 0xe2860000, v10
v_min_f32 v19, v19, v115
v_add_f32 v112, 0xe2400000, v10
v_min_f32 v20, v20, v112
v_add_f32 v113, 0xe2440000, v10
v_min_f32 v21, v21, v113
v_add_f32 v114, 0xe2480000, v10
v_min_f32 v22, v22, v114
v_add_f32 v115, 0xe24c0000, v10
v_min_f32 v23, v23, v115
v_add_f32 v112, 0xe2a00000, v10
v_min_f32 v24, v24, v112
v_add_f32 v113, 0xe2a20000, v10
v_min_f32 v25, v25, v113
v_add_f32 v114, 0xe2a40000, v10
v_min_f32 v26, v26, v114
v_add_f32 v115, 0xe2a60000, v10
v_min_f32 v27, v27, v115
v_add_f32 v112, 0xe2800000, v10
v_min_f32 v28, v28, v112
v_add_f32 v113, 0xe2820000, v10
v_min_f32 v29, v29, v113
v_add_f32 v114, 0xe2840000, v10
v_min_f32 v30, v30, v114
v_add_f32 v115, 0xe2860000, v10
v_min_f32 v31, v31, v115
v_add_f32 v112, 0xe2c00000, v10
v_min_f32 v32, v32, v112
v_add_f32 v113, 0xe2c20000, v10
v_min_f32 v33, v33, v113
v_add_f32 v114, 0xe2c40000, v10
v_min_f32 v34, v34, v114
v_add_f32 v115, 0xe2c60000, v10
v_min_f32 v35, v35, v115
v_add_f32 v112, 0xe2a00000, v10
v_min_f32 v36, v36, v112
v_add_f32 v113, 0xe2a20000, v10
v_min_f32 v37, v37, v113
v_add_f32 v114, 0xe2a40000, v10
v_min_f32 v38, v38, v114
v_add_f32 v115, 0xe2a60000, v10
v_min_f32 v39, v39, v115
v_add_f32 v112, 0xe2e00000, v10
v_min_f32 v40, v40, v112
v_add_f32 v113, 0xe2e20000, v10
v_min_f32 v41, v41, v113
v_add_f32 v114, 0xe2e40000, v10
v_min_f32 v42, v42, v114
v_add_f32 v115, 0xe2e60000, v10
v_min_f32 v43, v43, v115
v_add_f32 v112, 0xe2c00000, v10
v_min_f32 v44, v44, v112
v_add_f32 v113, 0xe2c20000, v10
v_min_f32 v45, v45, v113
v_add_f32 v114, 0xe2c40000, v10
v_min_f32 v46, v46, v114
v_add_f32 v115, 0xe2c60000, v10
v_min_f32 v47, v47, v115
s_branch F_MASK_RET_2
F_INIT_0:
s_nop 15
v_mov_b32 v200, v192
v_mov_b32 v202, v194
v_mov_b32 v201, v193
v_mov_b32 v203, v195
v_max3_f32 v13, v16, v17, v18
v_max3_f32 v13, v13, v19, v24
v_max3_f32 v13, v13, v25, v26
v_max3_f32 v13, v13, v27, v32
v_max3_f32 v13, v13, v33, v34
v_max3_f32 v13, v13, v35, v40
v_max3_f32 v13, v13, v41, v42
v_max_f32 v13, v13, v43
v_mov_b32 v15, v13
s_nop 1
v_permlane32_swap_b32 v15, v13
s_nop 1
v_max_f32 v13, v13, v15
v_mov_b32 v15, v13
s_nop 1
v_permlane16_swap_b32 v15, v13
s_nop 1
v_max_f32 v13, v13, v15
v_max3_f32 v14, v20, v21, v22
v_max3_f32 v14, v14, v23, v28
v_max3_f32 v14, v14, v29, v30
v_max3_f32 v14, v14, v31, v36
v_max3_f32 v14, v14, v37, v38
v_max3_f32 v14, v14, v39, v44
v_max3_f32 v14, v14, v45, v46
v_max_f32 v14, v14, v47
v_mov_b32 v15, v14
s_nop 1
v_permlane32_swap_b32 v15, v14
s_nop 1
v_max_f32 v14, v14, v15
v_mov_b32 v15, v14
s_nop 1
v_permlane16_swap_b32 v15, v14
s_nop 1
v_max_f32 v14, v14, v15
v_add_f32 v192, v192, v13
v_sub_f32 v208, 0, v192
v_sub_f32 v209, 0, v192
v_sub_f32 v210, 0, v192
v_sub_f32 v211, 0, v192
v_add_f32 v193, v193, v14
v_sub_f32 v212, 0, v193
v_sub_f32 v213, 0, v193
v_sub_f32 v214, 0, v193
v_sub_f32 v215, 0, v193
v_sub_f32 v16, v16, v13
v_sub_f32 v17, v17, v13
v_sub_f32 v18, v18, v13
v_sub_f32 v19, v19, v13
v_sub_f32 v20, v20, v14
v_sub_f32 v21, v21, v14
v_sub_f32 v22, v22, v14
v_sub_f32 v23, v23, v14
v_sub_f32 v24, v24, v13
v_sub_f32 v25, v25, v13
v_sub_f32 v26, v26, v13
v_sub_f32 v27, v27, v13
v_sub_f32 v28, v28, v14
v_sub_f32 v29, v29, v14
v_sub_f32 v30, v30, v14
v_sub_f32 v31, v31, v14
v_sub_f32 v32, v32, v13
v_sub_f32 v33, v33, v13
v_sub_f32 v34, v34, v13
v_sub_f32 v35, v35, v13
v_sub_f32 v36, v36, v14
v_sub_f32 v37, v37, v14
v_sub_f32 v38, v38, v14
v_sub_f32 v39, v39, v14
v_sub_f32 v40, v40, v13
v_sub_f32 v41, v41, v13
v_sub_f32 v42, v42, v13
v_sub_f32 v43, v43, v13
v_sub_f32 v44, v44, v14
v_sub_f32 v45, v45, v14
v_sub_f32 v46, v46, v14
v_sub_f32 v47, v47, v14
v_mov_b32 v194, 0
v_mov_b32 v195, 0
s_branch F_INIT_RET_0
F_MASK_1:
s_nop 15
v_mov_b32 v112, v10
v_min_f32 v48, v48, v112
v_add_f32 v113, 0xdf800000, v10
v_min_f32 v49, v49, v113
v_add_f32 v114, 0xe0000000, v10
v_min_f32 v50, v50, v114
v_add_f32 v115, 0xe0400000, v10
v_min_f32 v51, v51, v115
v_add_f32 v112, 0x61800000, v10
v_min_f32 v52, v52, v112
v_add_f32 v113, 0x61700000, v10
v_min_f32 v53, v53, v113
v_add_f32 v114, 0x61600000, v10
v_min_f32 v54, v54, v114
v_add_f32 v115, 0x61500000, v10
v_min_f32 v55, v55, v115
v_add_f32 v112, 0xe1800000, v10
v_min_f32 v56, v56, v112
v_add_f32 v113, 0xe1880000, v10
v_min_f32 v57, v57, v113
v_add_f32 v114, 0xe1900000, v10
v_min_f32 v58, v58, v114
v_add_f32 v115, 0xe1980000, v10
v_min_f32 v59, v59, v115
v_mov_b32 v112, v10
v_min_f32 v60, v60, v112
v_add_f32 v113, 0xdf800000, v10
v_min_f32 v61, v61, v113
v_add_f32 v114, 0xe0000000, v10
v_min_f32 v62, v62, v114
v_add_f32 v115, 0xe0400000, v10
v_min_f32 v63, v63, v115
v_add_f32 v112, 0xe2000000, v10
v_min_f32 v64, v64, v112
v_add_f32 v113, 0xe2040000, v10
v_min_f32 v65, v65, v113
v_add_f32 v114, 0xe2080000, v10
v_min_f32 v66, v66, v114
v_add_f32 v115, 0xe20c0000, v10
v_min_f32 v67, v67, v115
v_add_f32 v112, 0xe1800000, v10
v_min_f32 v68, v68, v112
v_add_f32 v113, 0xe1880000, v10
v_min_f32 v69, v69, v113
v_add_f32 v114, 0xe1900000, v10
v_min_f32 v70, v70, v114
v_add_f32 v115, 0xe1980000, v10
v_min_f32 v71, v71, v115
v_add_f32 v112, 0xe2400000, v10
v_min_f32 v72, v72, v112
v_add_f32 v113, 0xe2440000, v10
v_min_f32 v73, v73, v113
v_add_f32 v114, 0xe2480000, v10
v_min_f32 v74, v74, v114
v_add_f32 v115, 0xe24c0000, v10
v_min_f32 v75, v75, v115
v_add_f32 v112, 0xe2000000, v10
v_min_f32 v76, v76, v112
v_add_f32 v113, 0xe2040000, v10
v_min_f32 v77, v77, v113
v_add_f32 v114, 0xe2080000, v10
v_min_f32 v78, v78, v114
v_add_f32 v115, 0xe20c0000, v10
v_min_f32 v79, v79, v115
s_branch F_MASK_RET_1
F_INIT_1:
s_nop 15
v_mov_b32 v200, v192
v_mov_b32 v202, v194
v_mov_b32 v201, v193
v_mov_b32 v203, v195
v_max3_f32 v13, v48, v49, v50
v_max3_f32 v13, v13, v51, v56
v_max3_f32 v13, v13, v57, v58
v_max3_f32 v13, v13, v59, v64
v_max3_f32 v13, v13, v65, v66
v_max3_f32 v13, v13, v67, v72
v_max3_f32 v13, v13, v73, v74
v_max_f32 v13, v13, v75
v_mov_b32 v15, v13
s_nop 1
v_permlane32_swap_b32 v15, v13
s_nop 1
v_max_f32 v13, v13, v15
v_mov_b32 v15, v13
s_nop 1
v_permlane16_swap_b32 v15, v13
s_nop 1
v_max_f32 v13, v13, v15
v_max3_f32 v14, v52, v53, v54
v_max3_f32 v14, v14, v55, v60
v_max3_f32 v14, v14, v61, v62
v_max3_f32 v14, v14, v63, v68
v_max3_f32 v14, v14, v69, v70
v_max3_f32 v14, v14, v71, v76
v_max3_f32 v14, v14, v77, v78
v_max_f32 v14, v14, v79
v_mov_b32 v15, v14
s_nop 1
v_permlane32_swap_b32 v15, v14
s_nop 1
v_max_f32 v14, v14, v15
v_mov_b32 v15, v14
s_nop 1
v_permlane16_swap_b32 v15, v14
s_nop 1
v_max_f32 v14, v14, v15
v_add_f32 v192, v192, v13
v_sub_f32 v208, 0, v192
v_sub_f32 v209, 0, v192
v_sub_f32 v210, 0, v192
v_sub_f32 v211, 0, v192
v_add_f32 v193, v193, v14
v_sub_f32 v212, 0, v193
v_sub_f32 v213, 0, v193
v_sub_f32 v214, 0, v193
v_sub_f32 v215, 0, v193
v_sub_f32 v48, v48, v13
v_sub_f32 v49, v49, v13
v_sub_f32 v50, v50, v13
v_sub_f32 v51, v51, v13
v_sub_f32 v52, v52, v14
v_sub_f32 v53, v53, v14
v_sub_f32 v54, v54, v14
v_sub_f32 v55, v55, v14
v_sub_f32 v56, v56, v13
v_sub_f32 v57, v57, v13
v_sub_f32 v58, v58, v13
v_sub_f32 v59, v59, v13
v_sub_f32 v60, v60, v14
v_sub_f32 v61, v61, v14
v_sub_f32 v62, v62, v14
v_sub_f32 v63, v63, v14
v_sub_f32 v64, v64, v13
v_sub_f32 v65, v65, v13
v_sub_f32 v66, v66, v13
v_sub_f32 v67, v67, v13
v_sub_f32 v68, v68, v14
v_sub_f32 v69, v69, v14
v_sub_f32 v70, v70, v14
v_sub_f32 v71, v71, v14
v_sub_f32 v72, v72, v13
v_sub_f32 v73, v73, v13
v_sub_f32 v74, v74, v13
v_sub_f32 v75, v75, v13
v_sub_f32 v76, v76, v14
v_sub_f32 v77, v77, v14
v_sub_f32 v78, v78, v14
v_sub_f32 v79, v79, v14
v_mov_b32 v194, 0
v_mov_b32 v195, 0
s_branch F_INIT_RET_1
F_PUB_0:
s_cmp_lg_u32 s12, 0
s_cbranch_scc1 F_FS_PUB0
s_cmp_lg_u32 s19, 0
s_cbranch_scc1 F_REL_PUB0
buffer_wbl2 sc1
s_waitcnt vmcnt(0)
F_REL_PUB0:
s_lshl_b32 s23, s16, 2
s_add_u32 s23, s23, 64
s_add_u32 s23, s23, s20
v_mov_b32 v13, 1
v_mov_b32 v14, 0
s_mov_b64 exec, 1
buffer_store_dword v13, v14, s[4:7], s23 offen sc1
s_mov_b64 exec, -1
F_FS_PUB0:
s_branch F_PUB_RET_0
F_PUB_2:
s_cmp_lg_u32 s12, 0
s_cbranch_scc1 F_FS_PUB2
s_cmp_lg_u32 s19, 0
s_cbranch_scc1 F_REL_PUB2
buffer_wbl2 sc1
s_waitcnt vmcnt(0)
F_REL_PUB2:
s_lshl_b32 s23, s16, 2
s_add_u32 s23, s23, 64
s_add_u32 s23, s23, s20
v_mov_b32 v13, 1
v_mov_b32 v14, 0
s_mov_b64 exec, 1
buffer_store_dword v13, v14, s[4:7], s23 offen sc1
s_mov_b64 exec, -1
F_FS_PUB2:
s_branch F_PUB_RET_2
F_WQ_K:
s_lshl_b32 s24, s14, 2
s_add_u32 s24, s24, s12
s_mul_i32 s25, s24, 28
v_lshrrev_b32 v26, 2, v25
v_add_u32 v26, s25, v26
v_lshrrev_b32 v27, 3, v26
v_lshlrev_b32 v27, 13, v27
v_and_b32 v26, 7, v26
v_lshlrev_b32 v26, 7, v26
v_add_u32 v26, v26, v27
s_lshl_b32 s25, s13, 10
s_mov_b64 exec, 0xfffffff
buffer_load_dword v28, v26, s[40:43], s25 offen
s_mov_b64 exec, -1
s_branch F_WQ_RET_K
F_WQ_V:
s_lshl_b32 s24, s14, 2
s_add_u32 s24, s24, s12
s_mul_i32 s25, s24, 28
v_lshrrev_b32 v26, 2, v25
v_add_u32 v26, s25, v26
v_lshrrev_b32 v27, 3, v26
v_lshlrev_b32 v27, 13, v27
v_and_b32 v26, 7, v26
v_lshlrev_b32 v26, 7, v26
v_add_u32 v26, v26, v27
s_lshl_b32 s25, s13, 10
s_mov_b64 exec, 0xfffffff
buffer_load_dword v28, v26, s[40:43], s25 offen
s_mov_b64 exec, -1
s_branch F_WQ_RET_V
F_REG_K:
s_add_u32 s23, s18, 1
v_mov_b32 v24, s23
s_mov_b64 exec, 1
buffer_store_byte v24, v23, s[8:11], s21 offen sc1
s_mov_b64 exec, -1
s_branch F_REG_RET_K
F_REG_V:
s_add_u32 s23, s18, 1
v_mov_b32 v24, s23
s_mov_b64 exec, 1
buffer_store_byte v24, v23, s[8:11], s21 offen sc1
s_mov_b64 exec, -1
s_branch F_REG_RET_V
F_END:
s_endpgm
.section .rodata,"a"
.p2align 6
.amdhsa_kernel concat_heads__compressed_kv_cla__ssm_conv_h3__prompt_kernel
  .amdhsa_next_free_vgpr 512
  .amdhsa_next_free_sgpr 102
  .amdhsa_accum_offset 256
  .amdhsa_group_segment_fixed_size 0
  .amdhsa_kernarg_size 120
  .amdhsa_user_sgpr_count 2
  .amdhsa_user_sgpr_kernarg_segment_ptr 1
  .amdhsa_system_sgpr_workgroup_id_x 1
  .amdhsa_float_denorm_mode_32 3
.end_amdhsa_kernel
```
